```python
import torch

def _softmax(x, axis=-1):
    return torch.softmax(x, dim=axis)

def _gelu(x):
    return torch.nn.functional.gelu(x, approximate='tanh')

def _silu(x):
    return torch.nn.functional.silu(x)

def _sigmoid(x):
    return torch.sigmoid(x)

def _layernorm(x, axis=-1, eps=1e-05):
    m = x.mean(dim=axis, keepdim=True)
    v = x.var(dim=axis, keepdim=True, unbiased=False)
    return (x - m) / torch.sqrt(v + eps)

def _scatter_add(tgt, idx, src, axis=0):
    return tgt.clone().index_add_(axis, idx, src)

def _segment_sum(src, seg, n):
    out = torch.zeros((n,) + src.shape[1:], dtype=src.dtype)
    return out.index_add_(0, seg, src)

def _pad(x, pw):
    flat = tuple((v for pair in reversed(pw) for v in pair))
    return torch.nn.functional.pad(x, flat)
kernel_name = 'adaLN_cond__mha_block_cached__dense_activation_silu__prompt'

def setup_inputs():

    _w = lambda a: (lambda t: t.to(torch.bfloat16) if t.is_floating_point() else t)(torch.as_tensor(a))

    def _A_setup():
        B, Sq, D = (1, 2048, 640)
        H, Sk, Dh = (32, 2048, 128)
        return {'x': _w((lambda *s: torch.randn(*s, dtype=torch.bfloat16) * 0.1)(B, Sq, D)), 'k_cache': _w((lambda *s: torch.randn(*s, dtype=torch.bfloat16) * 0.8)(B, H, Sk, Dh)), 'v_cache': _w((lambda *s: torch.randn(*s, dtype=torch.bfloat16) * 3.2)(B, H, Sk, Dh)), 'wq': _w((lambda *s: torch.randn(*s, dtype=torch.bfloat16) * 0.8)(D, H * Dh) * D ** (-0.5)), 'wo': _w((lambda *s: torch.randn(*s, dtype=torch.bfloat16) * 3.2)(H * Dh, D) * (H * Dh) ** (-0.5))}
    _A_in = _A_setup()

    def _B_setup():
        B, S, D, F = (1, 2048, 640, 1728)
        return {'x': _w((lambda *s: torch.randn(*s, dtype=torch.bfloat16) * 0.1)(B, S, D)), 'w1': _w((lambda *s: torch.randn(*s, dtype=torch.bfloat16) * 3.2)(D, F) * D ** (-0.5)), 'w2': _w((lambda *s: torch.randn(*s, dtype=torch.bfloat16) * 3.2)(F, D) * F ** (-0.5))}
    _B_in = _B_setup()
    return {'A_x': _A_in['x'], 'A_k_cache': _A_in['k_cache'], 'A_v_cache': _A_in['v_cache'], 'A_wq': _A_in['wq'], 'A_wo': _A_in['wo'], 'B_x': _B_in['x'], 'B_w1': _B_in['w1'], 'B_w2': _B_in['w2'], 'c': _w((lambda *s: torch.randn(*s, dtype=torch.bfloat16) * 0.2)(1, 640) * 8.0), 'w_mod': _w((lambda *s: torch.randn(*s, dtype=torch.bfloat16) * 0.2)(640, 6 * 640) * 640 ** (-0.5) * 8.0)}

def reference(A_x, A_k_cache, A_v_cache, A_wq, A_wo, B_x, B_w1, B_w2, c, w_mod):

    def _A_ref(x, k_cache, v_cache, wq, wo):
        B, Sq, D = x.shape
        H, Dh = (32, 128)
        q = (lambda x, *d: x.permute(*d))((x @ wq).reshape(B, Sq, H, Dh), 0, 2, 1, 3)
        scores = torch.einsum('bhqd,bhkd->bhqk', q, k_cache) * Dh ** (-0.5)
        p = _softmax(scores, axis=-1)
        o = torch.einsum('bhqk,bhkd->bhqd', p, v_cache)
        return (lambda x, *d: x.permute(*d))(o, 0, 2, 1, 3).reshape(B, Sq, H * Dh) @ wo

    def _B_ref(x, w1, w2):
        h = torch.einsum('bsd,df->bsf', x, w1)
        h = _silu(h)
        out = torch.einsum('bsf,fd->bsd', h, w2)
        return out
    x = A_x
    mod = (_silu(c) @ w_mod).reshape(c.shape[0], 6, 1, -1)
    sa, ca, ga, sb, cb, gb = (mod[:, 0].clone(), mod[:, 1].clone(), mod[:, 2].clone(), mod[:, 3].clone(), mod[:, 4].clone(), mod[:, 5].clone())
    h = _layernorm(x, axis=-1) * (1 + ca) + sa
    x = x + ga * _A_ref(h, A_k_cache, A_v_cache, A_wq, A_wo)
    h = _layernorm(x, axis=-1) * (1 + cb) + sb
    x = x + gb * _B_ref(h, B_w1, B_w2)
    return x
```

```asm
; @launch kernel=pre1_kernel grid=(240,1,1) block=(256,1,1) lds=9216
; @launch kernel=main_kernel grid=(256,1,1) block=(256,1,1) lds=163840
.amdgcn_target "amdgcn-amd-amdhsa--gfx950"
.text
.globl pre1_kernel
.p2align 8
.type pre1_kernel,@function
pre1_kernel:
    s_cmp_ge_u32 s2, 240
    s_cbranch_scc1 L_k1_end
    s_load_dwordx4 s[4:7], s[0:1], 64
    s_load_dwordx2 s[8:9], s[0:1], 96
    v_and_b32 v1, 7, v0
    v_lshrrev_b32 v2, 3, v0
    s_mov_b32 s30, 7680
    v_mul_lo_u32 v3, v2, s30
    v_lshl_add_u32 v3, v1, 4, v3
    v_lshlrev_b32 v4, 1, v2
    s_and_b32 s28, s2, 3
    s_lshr_b32 s29, s2, 2
    s_mul_i32 s31, s28, 1228800
    s_lshl_b32 s32, s29, 7
    s_add_u32 s31, s31, s32
    s_mul_i32 s33, s28, 320
    s_waitcnt lgkmcnt(0)
    s_mov_b32 s20, s6
    s_and_b32 s21, s7, 0xffff
    s_mov_b32 s22, 0x4b0000
    s_mov_b32 s23, 0x20000
    buffer_load_dwordx4 v[24:27], v3, s[20:23], s31 offen
    s_add_u32 s31, s31, 245760
    buffer_load_dwordx4 v[28:31], v3, s[20:23], s31 offen
    s_add_u32 s31, s31, 245760
    buffer_load_dwordx4 v[32:35], v3, s[20:23], s31 offen
    s_add_u32 s31, s31, 245760
    buffer_load_dwordx4 v[36:39], v3, s[20:23], s31 offen
    s_add_u32 s31, s31, 245760
    buffer_load_dwordx4 v[40:43], v3, s[20:23], s31 offen
    s_mov_b32 s16, s4
    s_and_b32 s17, s5, 0xffff
    s_mov_b32 s18, 0x500
    s_mov_b32 s19, 0x20000
    buffer_load_ushort v10, v4, s[16:19], s33 offen offset:0
    buffer_load_ushort v11, v4, s[16:19], s33 offen offset:64
    buffer_load_ushort v12, v4, s[16:19], s33 offen offset:128
    buffer_load_ushort v13, v4, s[16:19], s33 offen offset:192
    buffer_load_ushort v14, v4, s[16:19], s33 offen offset:256
    s_add_u32 s24, s8, 0x30000
    s_addc_u32 s25, s9, 0
    s_and_b32 s25, s25, 0xffff
    s_mov_b32 s26, 0xf000
    s_mov_b32 s27, 0x20000
    s_cmp_lg_u32 s2, 0
    s_cbranch_scc1 L_k1_nozero
    s_add_u32 s36, s8, 0x60000
    s_addc_u32 s37, s9, 0
    s_and_b32 s37, s37, 0xffff
    s_mov_b32 s38, 0x2300
    s_mov_b32 s39, 0x20000
    v_lshlrev_b32 v90, 7, v0
    v_mov_b32 v91, 0
    buffer_store_dword v91, v90, s[36:39], 0 offen
L_k1_nozero:
    s_getpc_b64 s[40:41]
L_k1_pc:
    s_add_u32 s40, s40, main_kernel-L_k1_pc
    s_addc_u32 s41, s41, 0
    s_lshr_b32 s42, s2, 3
    s_mul_i32 s42, s42, 2560
    v_min_u32 v92, 19, v0
    v_lshlrev_b32 v92, 7, v92
    v_add_u32 v92, s42, v92
    v_min_u32 v92, L_attn_slow-main_kernel, v92
    global_load_dword v93, v92, s[40:41]
    s_load_dwordx2 s[44:45], s[0:1], 24
    s_waitcnt lgkmcnt(0)
    s_mov_b32 s48, s44
    s_and_b32 s49, s45, 0xffff
    s_mov_b32 s50, 0x500000
    s_mov_b32 s51, 0x20000
    s_lshr_b32 s46, s2, 3
    s_mul_i32 s46, s46, 35
    v_min_u32 v94, 34, v0
    v_add_u32 v94, s46, v94
    v_min_u32 v94, 0x3ff, v94
    v_lshrrev_b32 v95, 3, v94
    v_lshlrev_b32 v95, 13, v95
    v_and_b32 v94, 7, v94
    v_lshl_add_u32 v94, v94, 7, v95
    s_and_b32 s46, s2, 7
    s_lshl_b32 s46, s46, 10
    buffer_load_dword v96, v94, s[48:51], s46 offen
    s_load_dwordx2 s[44:45], s[0:1], 0
    s_waitcnt lgkmcnt(0)
    s_mov_b32 s48, s44
    s_and_b32 s49, s45, 0xffff
    s_mov_b32 s50, 0x280000
    s_mov_b32 s51, 0x20000
    v_min_u32 v94, 79, v0
    v_lshlrev_b32 v94, 7, v94
    s_mul_i32 s46, s2, 10240
    buffer_load_dword v99, v94, s[48:51], s46 offen
    s_add_u32 s46, s46, 2457600
    s_cmp_lt_u32 s2, 16
    s_cselect_b32 s50, s50, 0
    buffer_load_dword v100, v94, s[48:51], s46 offen
    s_mov_b32 s32, 0x3fb8aa3b
    s_waitcnt vmcnt(4)
    v_lshlrev_b32 v10, 16, v10
    v_lshlrev_b32 v11, 16, v11
    v_lshlrev_b32 v12, 16, v12
    v_lshlrev_b32 v13, 16, v13
    v_lshlrev_b32 v14, 16, v14
    v_mul_f32 v64, s32, v10
    v_mul_f32 v65, s32, v11
    v_mul_f32 v66, s32, v12
    v_mul_f32 v67, s32, v13
    v_mul_f32 v68, s32, v14
    v_exp_f32 v64, -v64
    v_exp_f32 v65, -v65
    v_exp_f32 v66, -v66
    v_exp_f32 v67, -v67
    v_exp_f32 v68, -v68
    v_add_f32 v64, 1.0, v64
    v_add_f32 v65, 1.0, v65
    v_add_f32 v66, 1.0, v66
    v_add_f32 v67, 1.0, v67
    v_add_f32 v68, 1.0, v68
    v_rcp_f32 v64, v64
    v_rcp_f32 v65, v65
    v_rcp_f32 v66, v66
    v_rcp_f32 v67, v67
    v_rcp_f32 v68, v68
    v_mul_f32 v10, v10, v64
    v_mul_f32 v11, v11, v65
    v_mul_f32 v12, v12, v66
    v_mul_f32 v13, v13, v67
    v_mul_f32 v14, v14, v68
    v_cvt_pk_bf16_f32 v10, v10, v10
    v_lshlrev_b32 v10, 16, v10
    v_cvt_pk_bf16_f32 v11, v11, v11
    v_lshlrev_b32 v11, 16, v11
    v_cvt_pk_bf16_f32 v12, v12, v12
    v_lshlrev_b32 v12, 16, v12
    v_cvt_pk_bf16_f32 v13, v13, v13
    v_lshlrev_b32 v13, 16, v13
    v_cvt_pk_bf16_f32 v14, v14, v14
    v_lshlrev_b32 v14, 16, v14
    s_mov_b32 s33, 0xffff0000
    v_lshlrev_b32 v8, 16, v24
    v_and_b32 v9, s33, v24
    v_mul_f32 v80, v10, v8
    v_mul_f32 v81, v10, v9
    v_lshlrev_b32 v8, 16, v25
    v_and_b32 v9, s33, v25
    v_mul_f32 v82, v10, v8
    v_mul_f32 v83, v10, v9
    v_lshlrev_b32 v8, 16, v26
    v_and_b32 v9, s33, v26
    v_mul_f32 v84, v10, v8
    v_mul_f32 v85, v10, v9
    v_lshlrev_b32 v8, 16, v27
    v_and_b32 v9, s33, v27
    v_mul_f32 v86, v10, v8
    v_mul_f32 v87, v10, v9
    v_lshlrev_b32 v8, 16, v28
    v_and_b32 v9, s33, v28
    v_fmac_f32 v80, v11, v8
    v_fmac_f32 v81, v11, v9
    v_lshlrev_b32 v8, 16, v29
    v_and_b32 v9, s33, v29
    v_fmac_f32 v82, v11, v8
    v_fmac_f32 v83, v11, v9
    v_lshlrev_b32 v8, 16, v30
    v_and_b32 v9, s33, v30
    v_fmac_f32 v84, v11, v8
    v_fmac_f32 v85, v11, v9
    v_lshlrev_b32 v8, 16, v31
    v_and_b32 v9, s33, v31
    v_fmac_f32 v86, v11, v8
    v_fmac_f32 v87, v11, v9
    v_lshlrev_b32 v8, 16, v32
    v_and_b32 v9, s33, v32
    v_fmac_f32 v80, v12, v8
    v_fmac_f32 v81, v12, v9
    v_lshlrev_b32 v8, 16, v33
    v_and_b32 v9, s33, v33
    v_fmac_f32 v82, v12, v8
    v_fmac_f32 v83, v12, v9
    v_lshlrev_b32 v8, 16, v34
    v_and_b32 v9, s33, v34
    v_fmac_f32 v84, v12, v8
    v_fmac_f32 v85, v12, v9
    v_lshlrev_b32 v8, 16, v35
    v_and_b32 v9, s33, v35
    v_fmac_f32 v86, v12, v8
    v_fmac_f32 v87, v12, v9
    v_lshlrev_b32 v8, 16, v36
    v_and_b32 v9, s33, v36
    v_fmac_f32 v80, v13, v8
    v_fmac_f32 v81, v13, v9
    v_lshlrev_b32 v8, 16, v37
    v_and_b32 v9, s33, v37
    v_fmac_f32 v82, v13, v8
    v_fmac_f32 v83, v13, v9
    v_lshlrev_b32 v8, 16, v38
    v_and_b32 v9, s33, v38
    v_fmac_f32 v84, v13, v8
    v_fmac_f32 v85, v13, v9
    v_lshlrev_b32 v8, 16, v39
    v_and_b32 v9, s33, v39
    v_fmac_f32 v86, v13, v8
    v_fmac_f32 v87, v13, v9
    v_lshlrev_b32 v8, 16, v40
    v_and_b32 v9, s33, v40
    v_fmac_f32 v80, v14, v8
    v_fmac_f32 v81, v14, v9
    v_lshlrev_b32 v8, 16, v41
    v_and_b32 v9, s33, v41
    v_fmac_f32 v82, v14, v8
    v_fmac_f32 v83, v14, v9
    v_lshlrev_b32 v8, 16, v42
    v_and_b32 v9, s33, v42
    v_fmac_f32 v84, v14, v8
    v_fmac_f32 v85, v14, v9
    v_lshlrev_b32 v8, 16, v43
    v_and_b32 v9, s33, v43
    v_fmac_f32 v86, v14, v8
    v_fmac_f32 v87, v14, v9
    v_lshlrev_b32 v5, 8, v2
    v_lshl_add_u32 v5, v1, 5, v5
    ds_write_b128 v5, v[80:83]
    ds_write_b128 v5, v[84:87] offset:16
    v_and_b32 v1, 63, v0
    v_lshrrev_b32 v2, 6, v0
    v_lshlrev_b32 v5, 11, v2
    v_lshl_add_u32 v5, v1, 2, v5
    s_waitcnt lgkmcnt(0)
    s_barrier
    ds_read_b32 v24, v5 offset:0
    ds_read_b32 v25, v5 offset:256
    ds_read_b32 v26, v5 offset:512
    ds_read_b32 v27, v5 offset:768
    ds_read_b32 v28, v5 offset:1024
    ds_read_b32 v29, v5 offset:1280
    ds_read_b32 v30, v5 offset:1536
    ds_read_b32 v31, v5 offset:1792
    v_lshlrev_b32 v6, 2, v0
    s_waitcnt lgkmcnt(0)
    v_add_f32 v24, v24, v25
    v_add_f32 v24, v24, v26
    v_add_f32 v24, v24, v27
    v_add_f32 v24, v24, v28
    v_add_f32 v24, v24, v29
    v_add_f32 v24, v24, v30
    v_add_f32 v24, v24, v31
    ds_write_b32 v6, v24 offset:8192
    v_lshlrev_b32 v6, 2, v1
    s_waitcnt lgkmcnt(0)
    s_barrier
    ds_read_b32 v24, v6 offset:8192
    ds_read_b32 v25, v6 offset:8448
    ds_read_b32 v26, v6 offset:8704
    ds_read_b32 v27, v6 offset:8960
    s_mul_i32 s30, s28, 15360
    s_lshl_b32 s31, s29, 8
    s_add_u32 s30, s30, s31
    s_waitcnt lgkmcnt(0)
    v_add_f32 v24, v24, v25
    v_add_f32 v26, v26, v27
    v_add_f32 v24, v24, v26
    v_cmp_gt_u32 vcc, 64, v0
    s_nop 1
    s_and_saveexec_b64 s[34:35], vcc
    s_cbranch_execz L_k1_nost
    buffer_store_dword v24, v6, s[24:27], s30 offen
L_k1_nost:
L_k1_end:
    s_endpgm
.globl main_kernel
.p2align 8
.type main_kernel,@function
main_kernel:
    s_cmp_ge_u32 s2, 256
    s_cbranch_scc1 L_attn_end
    s_load_dwordx4 s[4:7], s[0:1], 8
    s_load_dwordx2 s[40:41], s[0:1], 24
    s_load_dwordx2 s[46:47], s[0:1], 96
    s_load_dwordx2 s[96:97], s[0:1], 32
    s_load_dwordx2 s[98:99], s[0:1], 56
    s_load_dwordx2 s[88:89], s[0:1], 96
    s_load_dwordx2 s[90:91], s[0:1], 0
    s_load_dwordx2 s[92:93], s[0:1], 80
    s_load_dwordx2 s[94:95], s[0:1], 48
    v_lshrrev_b32 v224, 6, v0
    v_and_b32 v225, 63, v0
    v_readfirstlane_b32 s28, v224
    s_and_b32 s35, s2, 7
    s_lshl_b32 s35, s35, 2
    s_bfe_u32 s38, s2, 0x20003
    s_add_u32 s30, s35, s38
    s_lshr_b32 s31, s2, 5
    s_lshl_b32 s29, s28, 12
    s_mov_b32 s48, 0
    v_and_b32 v226, 15, v225
    v_lshrrev_b32 v227, 5, v225
    v_lshrrev_b32 v228, 4, v225
    v_bfe_u32 v229, v225, 2, 2
    v_lshlrev_b32 v221, 4, v225
    v_lshlrev_b32 v230, 8, v226
    v_xor_b32 v231, v226, v228
    v_lshl_or_b32 v230, v231, 4, v230
    v_xor_b32 v192, 0x0, v230
    v_xor_b32 v193, 0x40, v230
    v_xor_b32 v194, 0x80, v230
    v_xor_b32 v195, 0xc0, v230
    v_lshl_add_u32 v232, v228, 2, v229
    v_and_b32 v231, 7, v232
    v_lshlrev_b32 v231, 5, v231
    v_lshl_or_b32 v232, v232, 8, v231
    v_and_b32 v233, 3, v225
    v_lshl_or_b32 v232, v233, 3, v232
    v_or_b32 v232, 0x10000, v232
    v_xor_b32 v196, 0x0, v232
    v_xor_b32 v197, 0x20, v232
    v_xor_b32 v198, 0x40, v232
    v_xor_b32 v199, 0x60, v232
    v_xor_b32 v200, 0x80, v232
    v_xor_b32 v201, 0xa0, v232
    v_xor_b32 v202, 0xc0, v232
    v_xor_b32 v203, 0xe0, v232
    v_lshl_add_u32 v232, v228, 3, v229
    v_lshlrev_b32 v232, 8, v232
    v_lshl_or_b32 v232, v229, 6, v232
    v_lshl_or_b32 v232, v233, 4, v232
    v_xor_b32 v213, 0x0, v232
    v_or_b32 v217, 0x10000, v213
    v_xor_b32 v214, 0x40, v232
    v_or_b32 v218, 0x10000, v214
    v_xor_b32 v215, 0x80, v232
    v_or_b32 v219, 0x10000, v215
    v_xor_b32 v216, 0xc0, v232
    v_or_b32 v220, 0x10000, v216
    s_lshl_b32 s35, s28, 4
    v_add_u32 v230, s35, v228
    v_add_u32 v231, 0, v228
    v_xor_b32 v231, v231, v226
    v_lshlrev_b32 v231, 4, v231
    v_lshl_or_b32 v204, v230, 8, v231
    v_add_u32 v231, 4, v228
    v_xor_b32 v231, v231, v226
    v_lshlrev_b32 v231, 4, v231
    v_lshl_or_b32 v205, v230, 8, v231
    v_add_u32 v231, 8, v228
    v_xor_b32 v231, v231, v226
    v_lshlrev_b32 v231, 4, v231
    v_lshl_or_b32 v206, v230, 8, v231
    v_add_u32 v231, 12, v228
    v_xor_b32 v231, v231, v226
    v_lshlrev_b32 v231, 4, v231
    v_lshl_or_b32 v207, v230, 8, v231
    v_add_u32 v231, 0, v228
    v_lshlrev_b32 v231, 1, v231
    v_xor_b32 v231, v231, v226
    v_lshlrev_b32 v231, 4, v231
    v_lshl_or_b32 v208, v230, 8, v231
    v_add_u32 v231, 4, v228
    v_lshlrev_b32 v231, 1, v231
    v_xor_b32 v231, v231, v226
    v_lshlrev_b32 v231, 4, v231
    v_lshl_or_b32 v242, v230, 8, v231
    v_lshlrev_b32 v231, 2, v228
    v_xor_b32 v231, v231, v226
    v_lshlrev_b32 v231, 4, v231
    v_add_u32 v232, 0, v230
    v_lshl_or_b32 v232, v232, 13, v231
    v_subrev_u32 v209, 0x0, v232
    v_add_u32 v232, 4, v230
    v_lshl_or_b32 v232, v232, 13, v231
    v_subrev_u32 v210, 0x400, v232
    v_add_u32 v232, 8, v230
    v_lshl_or_b32 v232, v232, 13, v231
    v_subrev_u32 v211, 0x800, v232
    v_add_u32 v232, 12, v230
    v_lshl_or_b32 v232, v232, 13, v231
    v_subrev_u32 v212, 0xc00, v232
    v_mov_b32 v176, 0
    v_mov_b32 v177, 0
    v_mov_b32 v178, 0
    v_mov_b32 v179, 0
    s_waitcnt lgkmcnt(0)
    s_lshl_b32 s35, s30, 8
    s_add_u32 s40, s40, s35
    s_addc_u32 s41, s41, 0
    s_mov_b32 s16, s40
    s_and_b32 s17, s41, 0xffff
    s_mov_b32 s18, 0x0
    s_mov_b32 s19, 0x20000
    s_sub_u32 s18, 0x500000, s35
    s_lshl_b32 s35, s31, 4
    s_lshl_b32 s38, s28, 2
    s_add_u32 s35, s35, s38
    s_mul_i32 s35, s35, 20480
    s_add_u32 s35, s35, 0x100000
    s_add_u32 s42, s46, s35
    s_addc_u32 s43, s47, 0
    s_mov_b32 s20, s42
    s_and_b32 s21, s43, 0xffff
    s_mov_b32 s22, 0x14000
    s_mov_b32 s23, 0x20000
    s_mov_b32 s32, 0
    s_mov_b32 s33, 0
    v_mbcnt_lo_u32_b32 v114, -1, 0
    v_mbcnt_hi_u32_b32 v114, -1, v114
    v_and_b32 v115, 31, v114
    v_lshrrev_b32 v116, 5, v114
    s_lshl_b32 s50, s2, 3
    s_lshl_b32 s51, s28, 1
    s_add_u32 s50, s50, s51
    v_add_u32 v116, s50, v116
    s_mov_b32 s51, 1280
    v_mul_lo_u32 v117, v116, s51
    v_lshl_add_u32 v117, v115, 3, v117
    s_lshl_b32 s51, s28, 6
    v_add_u32 v118, s51, v114
    v_min_u32 v80, 159, v118
    v_lshlrev_b32 v80, 4, v80
    s_add_u32 s56, s88, 0x30000
    s_addc_u32 s57, s89, 0
    s_and_b32 s57, s57, 0xffff
    s_mov_b32 s58, 0xf000
    s_mov_b32 s59, 0x20000
    s_lshl_b32 s50, s2, 6
    v_add_u32 v30, s50, v114
    v_add_u32 v31, 320, v30
    v_add_u32 v32, 0x280, v30
    v_cmp_gt_u32 vcc, 0xa0, v30
    s_nop 1
    v_cndmask_b32 v31, v32, v31, vcc
    v_lshlrev_b32 v243, 4, v31
    s_cmp_lg_u32 s28, 2
    s_cbranch_scc1 L_p0_nofin
    s_cmp_ge_u32 s2, 5
    s_cbranch_scc1 L_p0_nofin
    s_mov_b32 s51, 0
    buffer_load_dwordx4 a[128:131], v243, s[56:59], s51 offen
    s_mov_b32 s51, 15360
    buffer_load_dwordx4 a[132:135], v243, s[56:59], s51 offen
    s_mov_b32 s51, 30720
    buffer_load_dwordx4 a[136:139], v243, s[56:59], s51 offen
    s_mov_b32 s51, 46080
    buffer_load_dwordx4 a[140:143], v243, s[56:59], s51 offen
L_p0_nofin:
    s_mov_b32 s52, s90
    s_and_b32 s53, s91, 0xffff
    s_mov_b32 s54, 0x280000
    s_mov_b32 s55, 0x20000
    buffer_load_dwordx2 v[0:1], v117, s[52:55], 0 offen offset:0
    buffer_load_dwordx2 v[2:3], v117, s[52:55], 0 offen offset:256
    buffer_load_dwordx2 v[4:5], v117, s[52:55], 0 offen offset:512
    buffer_load_dwordx2 v[6:7], v117, s[52:55], 0 offen offset:768
    buffer_load_dwordx2 v[8:9], v117, s[52:55], 0 offen offset:1024
    s_mov_b32 s50, 0
    buffer_load_dwordx4 v[82:85], v80, s[56:59], s50 offen
    s_mov_b32 s50, 15360
    buffer_load_dwordx4 v[86:89], v80, s[56:59], s50 offen
    s_mov_b32 s50, 30720
    buffer_load_dwordx4 v[90:93], v80, s[56:59], s50 offen
    s_mov_b32 s50, 46080
    buffer_load_dwordx4 v[94:97], v80, s[56:59], s50 offen
    s_mov_b32 s50, 2560
    buffer_load_dwordx4 v[98:101], v80, s[56:59], s50 offen
    s_mov_b32 s50, 17920
    buffer_load_dwordx4 v[102:105], v80, s[56:59], s50 offen
    s_mov_b32 s50, 33280
    buffer_load_dwordx4 v[106:109], v80, s[56:59], s50 offen
    s_mov_b32 s50, 48640
    buffer_load_dwordx4 v[110:113], v80, s[56:59], s50 offen
    s_min_u32 s101, s2, 134
    s_mul_hi_u32 s40, s101, 0x33333334
    s_mul_i32 s41, s40, 5
    s_sub_u32 s41, s101, s41
    s_lshl_b32 s100, s41, 2
    s_add_u32 s100, s100, s28
    v_lshrrev_b32 v191, 4, v221
    v_lshrrev_b32 v128, 3, v191
    v_and_b32 v129, 7, v191
    v_mul_u32_u24 v128, 0xd80, v128
    v_lshl_add_u32 v128, v129, 4, v128
    v_min_u32 v129, 15, v191
    v_and_b32 v130, 7, v129
    v_lshlrev_b32 v130, 4, v130
    v_lshrrev_b32 v129, 3, v129
    v_mul_u32_u24 v129, 0xa00, v129
    v_add_u32 v130, v130, v129
    s_mov_b32 s52, s94
    s_and_b32 s53, s95, 0xffff
    s_mov_b32 s54, 0x21c000
    s_mov_b32 s55, 0x20000
    s_add_u32 s56, s88, 0x30000
    s_addc_u32 s57, s89, 0
    s_and_b32 s57, s57, 0xffff
    s_mov_b32 s58, 0xf000
    s_mov_b32 s59, 0x20000
    s_mul_i32 s101, s100, 110592
    s_lshl_b32 s3, s40, 7
    s_add_u32 s101, s101, s3
    s_lshl_b32 s3, s28, 12
    s_add_u32 s3, s3, 0x23c00
    s_add_u32 m0, s3, 0
    s_add_u32 s50, s101, 0
    buffer_load_dwordx4 v128, s[52:55], s50 offen lds
    s_add_u32 m0, s3, 1024
    s_add_u32 s50, s101, 27648
    buffer_load_dwordx4 v128, s[52:55], s50 offen lds
    s_add_u32 m0, s3, 2048
    s_add_u32 s50, s101, 55296
    buffer_load_dwordx4 v128, s[52:55], s50 offen lds
    s_add_u32 m0, s3, 3072
    s_add_u32 s50, s101, 82944
    buffer_load_dwordx4 v128, s[52:55], s50 offen lds
    s_lshl_b32 s101, s100, 7
    s_add_u32 s101, s101, 7680
    s_add_u32 s50, s101, 0
    buffer_load_dwordx4 v[132:135], v130, s[56:59], s50 offen
    s_add_u32 s50, s101, 15360
    buffer_load_dwordx4 v[136:139], v130, s[56:59], s50 offen
    s_add_u32 s50, s101, 30720
    buffer_load_dwordx4 v[140:143], v130, s[56:59], s50 offen
    s_add_u32 s50, s101, 46080
    buffer_load_dwordx4 v[144:147], v130, s[56:59], s50 offen
    s_lshl_b32 s35, s30, 19
    s_add_u32 s4, s4, s35
    s_addc_u32 s5, s5, 0
    s_add_u32 s6, s6, s35
    s_addc_u32 s7, s7, 0
    s_mov_b32 s8, s4
    s_and_b32 s9, s5, 0xffff
    s_mov_b32 s10, 0x80000
    s_mov_b32 s11, 0x20000
    s_mov_b32 s12, s6
    s_and_b32 s13, s7, 0xffff
    s_mov_b32 s14, 0x80000
    s_mov_b32 s15, 0x20000
    s_lshl_b32 s35, s31, 2
    s_add_u32 s35, s35, s28
    s_lshl_b32 s35, s35, 19
    s_lshl_b32 s38, s30, 14
    s_add_u32 s35, s35, s38
    s_add_u32 s35, s35, 0x400000
    s_add_u32 s4, s46, s35
    s_addc_u32 s5, s47, 0
    s_mov_b32 s24, s4
    s_and_b32 s25, s5, 0xffff
    s_mov_b32 s26, 0x4000
    s_mov_b32 s27, 0x20000
    s_mov_b32 s36, 0x3e0293ee
    s_mov_b32 s37, 0x3e0293ee
    v_lshrrev_b32 v224, 4, v221
    v_add_u32 v225, 0, v224
    v_mul_u32_u24 v226, 0x199a, v225
    v_lshrrev_b32 v226, 16, v226
    v_mul_u32_u24 v227, 10, v226
    v_sub_u32 v227, v225, v227
    v_mul_u32_u24 v226, 0x500, v226
    v_lshl_add_u32 v244, v227, 4, v226
    v_add_u32 v225, 64, v224
    v_mul_u32_u24 v226, 0x199a, v225
    v_lshrrev_b32 v226, 16, v226
    v_mul_u32_u24 v227, 10, v226
    v_sub_u32 v227, v225, v227
    v_mul_u32_u24 v226, 0x500, v226
    v_lshl_add_u32 v245, v227, 4, v226
    v_add_u32 v225, 128, v224
    v_mul_u32_u24 v226, 0x199a, v225
    v_lshrrev_b32 v226, 16, v226
    v_mul_u32_u24 v227, 10, v226
    v_sub_u32 v227, v225, v227
    v_mul_u32_u24 v226, 0x500, v226
    v_lshl_add_u32 v246, v227, 4, v226
    v_add_u32 v225, 192, v224
    v_mul_u32_u24 v226, 0x199a, v225
    v_lshrrev_b32 v226, 16, v226
    v_mul_u32_u24 v227, 10, v226
    v_sub_u32 v227, v225, v227
    v_mul_u32_u24 v226, 0x500, v226
    v_lshl_add_u32 v247, v227, 4, v226
    v_add_u32 v225, 256, v224
    v_mul_u32_u24 v226, 0x199a, v225
    v_lshrrev_b32 v226, 16, v226
    v_mul_u32_u24 v227, 10, v226
    v_sub_u32 v227, v225, v227
    v_mul_u32_u24 v226, 0x500, v226
    v_lshl_add_u32 v250, v227, 4, v226
    v_lshrrev_b32 v225, 4, v224
    v_bfe_u32 v226, v224, 2, 2
    v_and_b32 v227, 3, v224
    v_lshl_add_u32 v229, v225, 2, v226
    v_mul_u32_u24 v229, 0xa0, v229
    v_lshl_add_u32 v229, v227, 3, v229
    s_mul_i32 s35, s28, 5120
    s_add_u32 s35, s35, 0x20000
    v_add_u32 v254, s35, v229
    s_and_b32 s35, s28, 1
    s_mul_i32 s35, s35, 5120
    s_add_u32 s35, s35, 0x25000
    v_add_u32 v255, s35, v229
    s_waitcnt vmcnt(8)
    v_add_f32 v82, v82, v86
    v_add_f32 v90, v90, v94
    v_add_f32 v83, v83, v87
    v_add_f32 v91, v91, v95
    v_add_f32 v84, v84, v88
    v_add_f32 v92, v92, v96
    v_add_f32 v85, v85, v89
    v_add_f32 v93, v93, v97
    v_add_f32 v72, v82, v90
    v_add_f32 v73, v83, v91
    v_add_f32 v74, v84, v92
    v_add_f32 v75, v85, v93
    v_cvt_pk_bf16_f32 v72, v72, v72
    v_lshlrev_b32 v72, 16, v72
    v_cvt_pk_bf16_f32 v73, v73, v73
    v_lshlrev_b32 v73, 16, v73
    v_cvt_pk_bf16_f32 v74, v74, v74
    v_lshlrev_b32 v74, 16, v74
    v_cvt_pk_bf16_f32 v75, v75, v75
    v_lshlrev_b32 v75, 16, v75
    v_add_f32 v98, v98, v102
    v_add_f32 v106, v106, v110
    v_add_f32 v99, v99, v103
    v_add_f32 v107, v107, v111
    v_add_f32 v100, v100, v104
    v_add_f32 v108, v108, v112
    v_add_f32 v101, v101, v105
    v_add_f32 v109, v109, v113
    v_add_f32 v76, v98, v106
    v_add_f32 v77, v99, v107
    v_add_f32 v78, v100, v108
    v_add_f32 v79, v101, v109
    v_cvt_pk_bf16_f32 v76, v76, v76
    v_lshlrev_b32 v76, 16, v76
    v_cvt_pk_bf16_f32 v77, v77, v77
    v_lshlrev_b32 v77, 16, v77
    v_cvt_pk_bf16_f32 v78, v78, v78
    v_lshlrev_b32 v78, 16, v78
    v_cvt_pk_bf16_f32 v79, v79, v79
    v_lshlrev_b32 v79, 16, v79
    v_add_f32 v76, 1.0, v76
    v_add_f32 v77, 1.0, v77
    v_add_f32 v78, 1.0, v78
    v_add_f32 v79, 1.0, v79
    v_cvt_pk_bf16_f32 v76, v76, v76
    v_lshlrev_b32 v76, 16, v76
    v_cvt_pk_bf16_f32 v77, v77, v77
    v_lshlrev_b32 v77, 16, v77
    v_cvt_pk_bf16_f32 v78, v78, v78
    v_lshlrev_b32 v78, 16, v78
    v_cvt_pk_bf16_f32 v79, v79, v79
    v_lshlrev_b32 v79, 16, v79
    v_add_u32 v81, 0x20000, v80
    ds_write_b128 v81, v[72:75]
    ds_write_b128 v81, v[76:79] offset:2560
    s_mov_b32 s51, 0xffff0000
    v_lshlrev_b32 v10, 16, v0
    v_and_b32 v11, s51, v0
    v_lshlrev_b32 v12, 16, v1
    v_and_b32 v13, s51, v1
    v_lshlrev_b32 v14, 16, v2
    v_and_b32 v15, s51, v2
    v_lshlrev_b32 v16, 16, v3
    v_and_b32 v17, s51, v3
    v_lshlrev_b32 v18, 16, v4
    v_and_b32 v19, s51, v4
    v_lshlrev_b32 v20, 16, v5
    v_and_b32 v21, s51, v5
    v_lshlrev_b32 v22, 16, v6
    v_and_b32 v23, s51, v6
    v_lshlrev_b32 v24, 16, v7
    v_and_b32 v25, s51, v7
    v_lshlrev_b32 v26, 16, v8
    v_and_b32 v27, s51, v8
    v_lshlrev_b32 v28, 16, v9
    v_and_b32 v29, s51, v9
    v_lshlrev_b32 v119, 4, v115
    v_add_u32 v119, 0x20000, v119
    s_waitcnt lgkmcnt(0)
    s_barrier
    ds_read_b128 v[30:33], v119 offset:2560
    ds_read_b128 v[50:53], v119 offset:0
    ds_read_b128 v[34:37], v119 offset:3072
    ds_read_b128 v[54:57], v119 offset:512
    ds_read_b128 v[38:41], v119 offset:3584
    ds_read_b128 v[58:61], v119 offset:1024
    ds_read_b128 v[42:45], v119 offset:4096
    ds_read_b128 v[62:65], v119 offset:1536
    ds_read_b128 v[46:49], v119 offset:4608
    ds_read_b128 v[66:69], v119 offset:2048
    v_add_f32 v120, v10, v11
    v_add_f32 v121, v12, v13
    v_add_f32 v120, v120, v14
    v_add_f32 v121, v121, v15
    v_add_f32 v120, v120, v16
    v_add_f32 v121, v121, v17
    v_add_f32 v120, v120, v18
    v_add_f32 v121, v121, v19
    v_add_f32 v120, v120, v20
    v_add_f32 v121, v121, v21
    v_add_f32 v120, v120, v22
    v_add_f32 v121, v121, v23
    v_add_f32 v120, v120, v24
    v_add_f32 v121, v121, v25
    v_add_f32 v120, v120, v26
    v_add_f32 v121, v121, v27
    v_add_f32 v120, v120, v28
    v_add_f32 v121, v121, v29
    v_add_f32 v120, v120, v121
    s_nop 1
    v_add_f32_dpp v120, v120, v120 row_ror:8 row_mask:0xf bank_mask:0xf
    s_nop 1
    v_add_f32_dpp v120, v120, v120 row_ror:4 row_mask:0xf bank_mask:0xf
    s_nop 1
    v_add_f32_dpp v120, v120, v120 row_ror:2 row_mask:0xf bank_mask:0xf
    s_nop 1
    v_add_f32_dpp v120, v120, v120 row_ror:1 row_mask:0xf bank_mask:0xf
    v_mov_b32 v122, v120
    s_nop 1
    v_permlane16_swap_b32 v120, v122
    v_add_f32 v120, v120, v122
    s_mov_b32 s50, 0x3acccccd
    v_mul_f32 v120, s50, v120
    v_sub_f32 v10, v10, v120
    v_sub_f32 v11, v11, v120
    v_sub_f32 v12, v12, v120
    v_sub_f32 v13, v13, v120
    v_sub_f32 v14, v14, v120
    v_sub_f32 v15, v15, v120
    v_sub_f32 v16, v16, v120
    v_sub_f32 v17, v17, v120
    v_sub_f32 v18, v18, v120
    v_sub_f32 v19, v19, v120
    v_sub_f32 v20, v20, v120
    v_sub_f32 v21, v21, v120
    v_sub_f32 v22, v22, v120
    v_sub_f32 v23, v23, v120
    v_sub_f32 v24, v24, v120
    v_sub_f32 v25, v25, v120
    v_sub_f32 v26, v26, v120
    v_sub_f32 v27, v27, v120
    v_sub_f32 v28, v28, v120
    v_sub_f32 v29, v29, v120
    v_mul_f32 v120, v10, v10
    v_mul_f32 v121, v11, v11
    v_fmac_f32 v120, v12, v12
    v_fmac_f32 v121, v13, v13
    v_fmac_f32 v120, v14, v14
    v_fmac_f32 v121, v15, v15
    v_fmac_f32 v120, v16, v16
    v_fmac_f32 v121, v17, v17
    v_fmac_f32 v120, v18, v18
    v_fmac_f32 v121, v19, v19
    v_fmac_f32 v120, v20, v20
    v_fmac_f32 v121, v21, v21
    v_fmac_f32 v120, v22, v22
    v_fmac_f32 v121, v23, v23
    v_fmac_f32 v120, v24, v24
    v_fmac_f32 v121, v25, v25
    v_fmac_f32 v120, v26, v26
    v_fmac_f32 v121, v27, v27
    v_fmac_f32 v120, v28, v28
    v_fmac_f32 v121, v29, v29
    v_add_f32 v120, v120, v121
    s_nop 1
    v_add_f32_dpp v120, v120, v120 row_ror:8 row_mask:0xf bank_mask:0xf
    s_nop 1
    v_add_f32_dpp v120, v120, v120 row_ror:4 row_mask:0xf bank_mask:0xf
    s_nop 1
    v_add_f32_dpp v120, v120, v120 row_ror:2 row_mask:0xf bank_mask:0xf
    s_nop 1
    v_add_f32_dpp v120, v120, v120 row_ror:1 row_mask:0xf bank_mask:0xf
    v_mov_b32 v122, v120
    s_nop 1
    v_permlane16_swap_b32 v120, v122
    v_add_f32 v120, v120, v122
    v_mov_b32 v121, 0x3727c5ac
    v_fmac_f32 v121, s50, v120
    v_rsq_f32 v121, v121
    s_waitcnt lgkmcnt(0)
    v_mul_f32 v10, v10, v121
    v_mul_f32 v11, v11, v121
    v_mul_f32 v12, v12, v121
    v_mul_f32 v13, v13, v121
    v_mul_f32 v14, v14, v121
    v_mul_f32 v15, v15, v121
    v_mul_f32 v16, v16, v121
    v_mul_f32 v17, v17, v121
    v_mul_f32 v18, v18, v121
    v_mul_f32 v19, v19, v121
    v_mul_f32 v20, v20, v121
    v_mul_f32 v21, v21, v121
    v_mul_f32 v22, v22, v121
    v_mul_f32 v23, v23, v121
    v_mul_f32 v24, v24, v121
    v_mul_f32 v25, v25, v121
    v_mul_f32 v26, v26, v121
    v_mul_f32 v27, v27, v121
    v_mul_f32 v28, v28, v121
    v_mul_f32 v29, v29, v121
    v_fma_f32 v10, v10, v30, v50
    v_fma_f32 v11, v11, v31, v51
    v_fma_f32 v12, v12, v32, v52
    v_fma_f32 v13, v13, v33, v53
    v_fma_f32 v14, v14, v34, v54
    v_fma_f32 v15, v15, v35, v55
    v_fma_f32 v16, v16, v36, v56
    v_fma_f32 v17, v17, v37, v57
    v_fma_f32 v18, v18, v38, v58
    v_fma_f32 v19, v19, v39, v59
    v_fma_f32 v20, v20, v40, v60
    v_fma_f32 v21, v21, v41, v61
    v_fma_f32 v22, v22, v42, v62
    v_fma_f32 v23, v23, v43, v63
    v_fma_f32 v24, v24, v44, v64
    v_fma_f32 v25, v25, v45, v65
    v_fma_f32 v26, v26, v46, v66
    v_fma_f32 v27, v27, v47, v67
    v_fma_f32 v28, v28, v48, v68
    v_fma_f32 v29, v29, v49, v69
    v_cvt_pk_bf16_f32 v0, v10, v11
    v_cvt_pk_bf16_f32 v1, v12, v13
    v_cvt_pk_bf16_f32 v2, v14, v15
    v_cvt_pk_bf16_f32 v3, v16, v17
    v_cvt_pk_bf16_f32 v4, v18, v19
    v_cvt_pk_bf16_f32 v5, v20, v21
    v_cvt_pk_bf16_f32 v6, v22, v23
    v_cvt_pk_bf16_f32 v7, v24, v25
    v_cvt_pk_bf16_f32 v8, v26, v27
    v_cvt_pk_bf16_f32 v9, v28, v29
    v_lshrrev_b32 v122, 1, v115
    v_lshlrev_b32 v122, 7, v122
    v_and_b32 v123, 7, v116
    v_lshl_add_u32 v122, v123, 4, v122
    v_and_b32 v123, 1, v115
    v_lshl_add_u32 v122, v123, 3, v122
    v_add_u32 v122, 0x21400, v122
    ds_write_b64 v122, v[0:1] offset:0
    ds_write_b64 v122, v[2:3] offset:2048
    ds_write_b64 v122, v[4:5] offset:4096
    ds_write_b64 v122, v[6:7] offset:6144
    ds_write_b64 v122, v[8:9] offset:8192
    v_lshrrev_b32 v123, 3, v118
    v_lshlrev_b32 v123, 8, v123
    v_and_b32 v124, 7, v118
    v_lshl_add_u32 v123, v124, 4, v123
    s_lshr_b32 s50, s2, 1
    s_mul_i32 s50, s50, 20480
    s_and_b32 s51, s2, 1
    s_lshl_b32 s51, s51, 7
    s_add_u32 s50, s50, s51
    v_lshlrev_b32 v124, 4, v118
    v_add_u32 v124, 0x21400, v124
    s_add_u32 s52, s88, 0x100000
    s_addc_u32 s53, s89, 0
    s_and_b32 s53, s53, 0xffff
    s_mov_b32 s54, 0x280000
    s_mov_b32 s55, 0x20000
    s_waitcnt lgkmcnt(0)
    s_barrier
    ds_read_b128 v[12:15], v124 offset:0
    ds_read_b128 v[16:19], v124 offset:4096
    ds_read_b128 v[20:23], v124 offset:8192
    s_waitcnt lgkmcnt(0)
    buffer_store_dwordx4 v[12:15], v123, s[52:55], s50 offen sc1
    s_add_u32 s50, s50, 0x2000
    buffer_store_dwordx4 v[16:19], v123, s[52:55], s50 offen sc1
    s_add_u32 s50, s50, 0x2000
    s_cmp_ge_u32 s28, 2
    s_cbranch_scc1 L_p0_nost
    buffer_store_dwordx4 v[20:23], v123, s[52:55], s50 offen sc1
L_p0_nost:
    s_lshr_b32 s59, s2, 5
    s_lshl_b32 s59, s59, 7
    s_add_u32 s59, s59, 6144
    s_waitcnt vmcnt(0)
    s_barrier
    s_cmp_lg_u32 s28, 0
    s_cbranch_scc1 L_arr_H
    s_add_u32 s56, s88, 0x60000
    s_addc_u32 s57, s89, 0
    v_mov_b32 v248, s59
    v_mov_b32 v249, 1
    s_mov_b64 exec, 1
    global_atomic_add v248, v249, s[56:57] sc1
    s_mov_b64 exec, -1
L_arr_H:
    s_cmp_lg_u32 s28, 2
    s_cbranch_scc1 L_p0_fin_done
    s_cmp_ge_u32 s2, 5
    s_cbranch_scc1 L_p0_fin_done
    v_accvgpr_read_b32 v32, a128
    v_accvgpr_read_b32 v33, a129
    v_accvgpr_read_b32 v34, a130
    v_accvgpr_read_b32 v35, a131
    v_accvgpr_read_b32 v36, a132
    v_accvgpr_read_b32 v37, a133
    v_accvgpr_read_b32 v38, a134
    v_accvgpr_read_b32 v39, a135
    v_accvgpr_read_b32 v40, a136
    v_accvgpr_read_b32 v41, a137
    v_accvgpr_read_b32 v42, a138
    v_accvgpr_read_b32 v43, a139
    v_accvgpr_read_b32 v44, a140
    v_accvgpr_read_b32 v45, a141
    v_accvgpr_read_b32 v46, a142
    v_accvgpr_read_b32 v47, a143
    s_add_u32 s52, s88, 0x0
    s_addc_u32 s53, s89, 0
    s_and_b32 s53, s53, 0xffff
    s_mov_b32 s54, 0x3c00
    s_mov_b32 s55, 0x20000
    v_add_f32 v32, v32, v36
    v_add_f32 v40, v40, v44
    v_add_f32 v33, v33, v37
    v_add_f32 v41, v41, v45
    v_add_f32 v34, v34, v38
    v_add_f32 v42, v42, v46
    v_add_f32 v35, v35, v39
    v_add_f32 v43, v43, v47
    v_add_f32 v32, v32, v40
    v_add_f32 v33, v33, v41
    v_add_f32 v34, v34, v42
    v_add_f32 v35, v35, v43
    v_cvt_pk_bf16_f32 v32, v32, v32
    v_lshlrev_b32 v32, 16, v32
    v_cvt_pk_bf16_f32 v33, v33, v33
    v_lshlrev_b32 v33, 16, v33
    v_cvt_pk_bf16_f32 v34, v34, v34
    v_lshlrev_b32 v34, 16, v34
    v_cvt_pk_bf16_f32 v35, v35, v35
    v_lshlrev_b32 v35, 16, v35
    buffer_store_dwordx4 v[32:35], v243, s[52:55], 0 offen sc1
L_p0_fin_done:
    s_add_u32 m0, s29, 0xc000
    s_mov_b32 s39, 0x0
    buffer_load_dwordx4 v209, s[16:19], s39 offen offset:0 lds
    buffer_load_dwordx4 v210, s[16:19], s39 offen offset:1024 lds
    buffer_load_dwordx4 v211, s[16:19], s39 offen offset:2048 lds
    buffer_load_dwordx4 v212, s[16:19], s39 offen offset:3072 lds
    s_add_u32 m0, s29, 0x1c000
    s_mov_b32 s39, 0x80000
    buffer_load_dwordx4 v209, s[16:19], s39 offen offset:0 lds
    buffer_load_dwordx4 v210, s[16:19], s39 offen offset:1024 lds
    buffer_load_dwordx4 v211, s[16:19], s39 offen offset:2048 lds
    buffer_load_dwordx4 v212, s[16:19], s39 offen offset:3072 lds
    v_lshrrev_b32 v224, 4, v221
    v_min_u32 v224, 39, v224
    s_mul_i32 s35, s31, 80
    s_mul_i32 s38, s28, 20
    s_add_u32 s35, s35, s38
    v_lshrrev_b32 v225, 1, v224
    v_add_u32 v225, s35, v225
    v_lshlrev_b32 v225, 13, v225
    v_and_b32 v224, 1, v224
    v_lshl_add_u32 v225, v224, 7, v225
    buffer_load_dword v251, v225, s[16:19], 0 offen
    s_waitcnt vmcnt(14)
    v_add_f32 v132, v132, v136
    v_add_f32 v140, v140, v144
    v_add_f32 v133, v133, v137
    v_add_f32 v141, v141, v145
    v_add_f32 v134, v134, v138
    v_add_f32 v142, v142, v146
    v_add_f32 v135, v135, v139
    v_add_f32 v143, v143, v147
    v_add_f32 v132, v132, v140
    v_add_f32 v133, v133, v141
    v_add_f32 v134, v134, v142
    v_add_f32 v135, v135, v143
    v_cvt_pk_bf16_f32 v132, v132, v132
    v_lshlrev_b32 v132, 16, v132
    v_cvt_pk_bf16_f32 v133, v133, v133
    v_lshlrev_b32 v133, 16, v133
    v_cvt_pk_bf16_f32 v134, v134, v134
    v_lshlrev_b32 v134, 16, v134
    v_cvt_pk_bf16_f32 v135, v135, v135
    v_lshlrev_b32 v135, 16, v135
    v_add_f32 v136, 1.0, v132
    v_add_f32 v137, 1.0, v133
    v_add_f32 v138, 1.0, v134
    v_add_f32 v139, 1.0, v135
    v_cvt_pk_bf16_f32 v136, v136, v136
    v_lshlrev_b32 v136, 16, v136
    v_cvt_pk_bf16_f32 v137, v137, v137
    v_lshlrev_b32 v137, 16, v137
    v_cvt_pk_bf16_f32 v138, v138, v138
    v_lshlrev_b32 v138, 16, v138
    v_cvt_pk_bf16_f32 v139, v139, v139
    v_lshlrev_b32 v139, 16, v139
    v_cmp_lt_u32 vcc, 7, v191
    s_lshl_b32 s3, s28, 8
    s_add_u32 s3, s3, 0x27c00
    v_min_u32 v129, 15, v191
    v_lshlrev_b32 v129, 4, v129
    v_add_u32 v129, s3, v129
    v_cndmask_b32 v132, v132, v136, vcc
    v_cndmask_b32 v133, v133, v137, vcc
    v_cndmask_b32 v134, v134, v138, vcc
    v_cndmask_b32 v135, v135, v139, vcc
    ds_write_b128 v129, v[132:135]
    v_lshrrev_b32 v130, 4, v191
    v_bfe_u32 v131, v191, 2, 2
    v_and_b32 v136, 3, v191
    v_lshl_add_u32 v131, v130, 2, v131
    v_lshlrev_b32 v131, 7, v131
    v_lshl_add_u32 v131, v136, 3, v131
    s_lshl_b32 s50, s28, 12
    s_add_u32 s50, s50, 0x23c00
    v_add_u32 v131, s50, v131
    v_lshlrev_b32 v137, 4, v130
    v_add_u32 v137, s3, v137
    s_waitcnt lgkmcnt(0)
    ds_read_b64_tr_b16 v[140:141], v131 offset:0
    ds_read_b64_tr_b16 v[142:143], v131 offset:2048
    ds_read_b64_tr_b16 v[144:145], v131 offset:32
    ds_read_b64_tr_b16 v[146:147], v131 offset:2080
    ds_read_b64_tr_b16 v[148:149], v131 offset:64
    ds_read_b64_tr_b16 v[150:151], v131 offset:2112
    ds_read_b64_tr_b16 v[152:153], v131 offset:96
    ds_read_b64_tr_b16 v[154:155], v131 offset:2144
    ds_read_b128 v[156:159], v137 offset:0
    ds_read_b128 v[164:167], v137 offset:128
    ds_read_b128 v[160:163], v137 offset:64
    ds_read_b128 v[168:171], v137 offset:192
    s_add_u32 s52, s88, 0x2900000
    s_addc_u32 s53, s89, 0
    s_and_b32 s53, s53, 0xffff
    s_mov_b32 s54, 0x21c000
    s_mov_b32 s55, 0x20000
    s_cmp_lt_u32 s2, 135
    s_cselect_b32 s54, s54, 0
    s_mov_b32 s101, 0xffff0000
    s_lshl_b32 s50, s40, 2
    s_mul_i32 s50, s50, 20
    s_add_u32 s50, s50, s100
    s_lshl_b32 s50, s50, 10
    s_waitcnt lgkmcnt(0)
    v_lshlrev_b32 v180, 16, v140
    v_and_b32 v181, s101, v140
    v_lshlrev_b32 v182, 16, v141
    v_and_b32 v183, s101, v141
    v_lshlrev_b32 v184, 16, v142
    v_and_b32 v185, s101, v142
    v_lshlrev_b32 v186, 16, v143
    v_and_b32 v187, s101, v143
    v_mul_f32 v176, v180, v156
    v_fmac_f32 v176, v181, v157
    v_fmac_f32 v176, v182, v158
    v_fmac_f32 v176, v183, v159
    v_fmac_f32 v176, v184, v160
    v_fmac_f32 v176, v185, v161
    v_fmac_f32 v176, v186, v162
    v_fmac_f32 v176, v187, v163
    v_mul_f32 v180, v180, v164
    v_mul_f32 v181, v181, v165
    v_mul_f32 v182, v182, v166
    v_mul_f32 v183, v183, v167
    v_mul_f32 v184, v184, v168
    v_mul_f32 v185, v185, v169
    v_mul_f32 v186, v186, v170
    v_mul_f32 v187, v187, v171
    v_cvt_pk_bf16_f32 v140, v180, v181
    v_cvt_pk_bf16_f32 v141, v182, v183
    v_cvt_pk_bf16_f32 v142, v184, v185
    v_cvt_pk_bf16_f32 v143, v186, v187
    buffer_store_dwordx4 v[140:143], v221, s[52:55], s50 offen sc1
    s_add_u32 s50, s50, 20480
    v_lshlrev_b32 v180, 16, v140
    v_and_b32 v181, s101, v140
    v_lshlrev_b32 v182, 16, v141
    v_and_b32 v183, s101, v141
    v_lshlrev_b32 v184, 16, v142
    v_and_b32 v185, s101, v142
    v_lshlrev_b32 v186, 16, v143
    v_and_b32 v187, s101, v143
    v_add_f32 v172, v180, v181
    v_add_f32 v172, v172, v182
    v_add_f32 v172, v172, v183
    v_add_f32 v172, v172, v184
    v_add_f32 v172, v172, v185
    v_add_f32 v172, v172, v186
    v_add_f32 v172, v172, v187
    v_lshlrev_b32 v180, 16, v144
    v_and_b32 v181, s101, v144
    v_lshlrev_b32 v182, 16, v145
    v_and_b32 v183, s101, v145
    v_lshlrev_b32 v184, 16, v146
    v_and_b32 v185, s101, v146
    v_lshlrev_b32 v186, 16, v147
    v_and_b32 v187, s101, v147
    v_mul_f32 v177, v180, v156
    v_fmac_f32 v177, v181, v157
    v_fmac_f32 v177, v182, v158
    v_fmac_f32 v177, v183, v159
    v_fmac_f32 v177, v184, v160
    v_fmac_f32 v177, v185, v161
    v_fmac_f32 v177, v186, v162
    v_fmac_f32 v177, v187, v163
    v_mul_f32 v180, v180, v164
    v_mul_f32 v181, v181, v165
    v_mul_f32 v182, v182, v166
    v_mul_f32 v183, v183, v167
    v_mul_f32 v184, v184, v168
    v_mul_f32 v185, v185, v169
    v_mul_f32 v186, v186, v170
    v_mul_f32 v187, v187, v171
    v_cvt_pk_bf16_f32 v144, v180, v181
    v_cvt_pk_bf16_f32 v145, v182, v183
    v_cvt_pk_bf16_f32 v146, v184, v185
    v_cvt_pk_bf16_f32 v147, v186, v187
    buffer_store_dwordx4 v[144:147], v221, s[52:55], s50 offen sc1
    s_add_u32 s50, s50, 20480
    v_lshlrev_b32 v180, 16, v144
    v_and_b32 v181, s101, v144
    v_lshlrev_b32 v182, 16, v145
    v_and_b32 v183, s101, v145
    v_lshlrev_b32 v184, 16, v146
    v_and_b32 v185, s101, v146
    v_lshlrev_b32 v186, 16, v147
    v_and_b32 v187, s101, v147
    v_add_f32 v173, v180, v181
    v_add_f32 v173, v173, v182
    v_add_f32 v173, v173, v183
    v_add_f32 v173, v173, v184
    v_add_f32 v173, v173, v185
    v_add_f32 v173, v173, v186
    v_add_f32 v173, v173, v187
    v_lshlrev_b32 v180, 16, v148
    v_and_b32 v181, s101, v148
    v_lshlrev_b32 v182, 16, v149
    v_and_b32 v183, s101, v149
    v_lshlrev_b32 v184, 16, v150
    v_and_b32 v185, s101, v150
    v_lshlrev_b32 v186, 16, v151
    v_and_b32 v187, s101, v151
    v_mul_f32 v178, v180, v156
    v_fmac_f32 v178, v181, v157
    v_fmac_f32 v178, v182, v158
    v_fmac_f32 v178, v183, v159
    v_fmac_f32 v178, v184, v160
    v_fmac_f32 v178, v185, v161
    v_fmac_f32 v178, v186, v162
    v_fmac_f32 v178, v187, v163
    v_mul_f32 v180, v180, v164
    v_mul_f32 v181, v181, v165
    v_mul_f32 v182, v182, v166
    v_mul_f32 v183, v183, v167
    v_mul_f32 v184, v184, v168
    v_mul_f32 v185, v185, v169
    v_mul_f32 v186, v186, v170
    v_mul_f32 v187, v187, v171
    v_cvt_pk_bf16_f32 v148, v180, v181
    v_cvt_pk_bf16_f32 v149, v182, v183
    v_cvt_pk_bf16_f32 v150, v184, v185
    v_cvt_pk_bf16_f32 v151, v186, v187
    buffer_store_dwordx4 v[148:151], v221, s[52:55], s50 offen sc1
    s_add_u32 s50, s50, 20480
    v_lshlrev_b32 v180, 16, v148
    v_and_b32 v181, s101, v148
    v_lshlrev_b32 v182, 16, v149
    v_and_b32 v183, s101, v149
    v_lshlrev_b32 v184, 16, v150
    v_and_b32 v185, s101, v150
    v_lshlrev_b32 v186, 16, v151
    v_and_b32 v187, s101, v151
    v_add_f32 v174, v180, v181
    v_add_f32 v174, v174, v182
    v_add_f32 v174, v174, v183
    v_add_f32 v174, v174, v184
    v_add_f32 v174, v174, v185
    v_add_f32 v174, v174, v186
    v_add_f32 v174, v174, v187
    v_lshlrev_b32 v180, 16, v152
    v_and_b32 v181, s101, v152
    v_lshlrev_b32 v182, 16, v153
    v_and_b32 v183, s101, v153
    v_lshlrev_b32 v184, 16, v154
    v_and_b32 v185, s101, v154
    v_lshlrev_b32 v186, 16, v155
    v_and_b32 v187, s101, v155
    v_mul_f32 v179, v180, v156
    v_fmac_f32 v179, v181, v157
    v_fmac_f32 v179, v182, v158
    v_fmac_f32 v179, v183, v159
    v_fmac_f32 v179, v184, v160
    v_fmac_f32 v179, v185, v161
    v_fmac_f32 v179, v186, v162
    v_fmac_f32 v179, v187, v163
    v_mul_f32 v180, v180, v164
    v_mul_f32 v181, v181, v165
    v_mul_f32 v182, v182, v166
    v_mul_f32 v183, v183, v167
    v_mul_f32 v184, v184, v168
    v_mul_f32 v185, v185, v169
    v_mul_f32 v186, v186, v170
    v_mul_f32 v187, v187, v171
    v_cvt_pk_bf16_f32 v152, v180, v181
    v_cvt_pk_bf16_f32 v153, v182, v183
    v_cvt_pk_bf16_f32 v154, v184, v185
    v_cvt_pk_bf16_f32 v155, v186, v187
    buffer_store_dwordx4 v[152:155], v221, s[52:55], s50 offen sc1
    s_add_u32 s50, s50, 20480
    v_lshlrev_b32 v180, 16, v152
    v_and_b32 v181, s101, v152
    v_lshlrev_b32 v182, 16, v153
    v_and_b32 v183, s101, v153
    v_lshlrev_b32 v184, 16, v154
    v_and_b32 v185, s101, v154
    v_lshlrev_b32 v186, 16, v155
    v_and_b32 v187, s101, v155
    v_add_f32 v175, v180, v181
    v_add_f32 v175, v175, v182
    v_add_f32 v175, v175, v183
    v_add_f32 v175, v175, v184
    v_add_f32 v175, v175, v185
    v_add_f32 v175, v175, v186
    v_add_f32 v175, v175, v187
    v_mov_b32 v180, v172
    v_mov_b32 v181, v173
    v_mov_b32 v182, v174
    v_mov_b32 v183, v175
    v_mov_b32 v184, v176
    v_mov_b32 v185, v177
    v_mov_b32 v186, v178
    v_mov_b32 v187, v179
    v_permlane16_swap_b32 v172, v180
    v_permlane16_swap_b32 v173, v181
    v_permlane16_swap_b32 v174, v182
    v_permlane16_swap_b32 v175, v183
    v_permlane16_swap_b32 v176, v184
    v_permlane16_swap_b32 v177, v185
    v_permlane16_swap_b32 v178, v186
    v_permlane16_swap_b32 v179, v187
    v_add_f32 v172, v172, v180
    v_add_f32 v173, v173, v181
    v_add_f32 v174, v174, v182
    v_add_f32 v175, v175, v183
    v_add_f32 v176, v176, v184
    v_add_f32 v177, v177, v185
    v_add_f32 v178, v178, v186
    v_add_f32 v179, v179, v187
    v_mov_b32 v180, v172
    v_mov_b32 v181, v173
    v_mov_b32 v182, v174
    v_mov_b32 v183, v175
    v_mov_b32 v184, v176
    v_mov_b32 v185, v177
    v_mov_b32 v186, v178
    v_mov_b32 v187, v179
    v_permlane32_swap_b32 v172, v180
    v_permlane32_swap_b32 v173, v181
    v_permlane32_swap_b32 v174, v182
    v_permlane32_swap_b32 v175, v183
    v_permlane32_swap_b32 v176, v184
    v_permlane32_swap_b32 v177, v185
    v_permlane32_swap_b32 v178, v186
    v_permlane32_swap_b32 v179, v187
    v_add_f32 v172, v172, v180
    v_add_f32 v173, v173, v181
    v_add_f32 v174, v174, v182
    v_add_f32 v175, v175, v183
    v_add_f32 v176, v176, v184
    v_add_f32 v177, v177, v185
    v_add_f32 v178, v178, v186
    v_add_f32 v179, v179, v187
    v_and_b32 v129, 15, v191
    v_lshlrev_b32 v129, 2, v129
    s_lshl_b32 s50, s28, 9
    s_add_u32 s50, s50, 0x20000
    v_add_u32 v129, s50, v129
    ds_write_b32 v129, v172 offset:0
    ds_write_b32 v129, v173 offset:64
    ds_write_b32 v129, v174 offset:128
    ds_write_b32 v129, v175 offset:192
    ds_write_b32 v129, v176 offset:256
    ds_write_b32 v129, v177 offset:320
    ds_write_b32 v129, v178 offset:384
    ds_write_b32 v129, v179 offset:448
    s_lshl_b32 s50, s28, 6
    v_add_u32 v138, s50, v191
    v_lshlrev_b32 v130, 2, v138
    v_add_u32 v130, 0x20000, v130
    v_lshrrev_b32 v131, 6, v138
    v_mul_u32_u24 v131, 0xa000, v131
    v_and_b32 v136, 63, v138
    v_lshl_add_u32 v131, v136, 2, v131
    s_waitcnt lgkmcnt(0)
    s_barrier
    ds_read_b32 v132, v130 offset:0
    ds_read_b32 v133, v130 offset:512
    ds_read_b32 v134, v130 offset:1024
    ds_read_b32 v135, v130 offset:1536
    s_add_u32 s52, s88, 0x40000
    s_addc_u32 s53, s89, 0
    s_and_b32 s53, s53, 0xffff
    s_mov_b32 s54, 0x14000
    s_mov_b32 s55, 0x20000
    s_cmp_lt_u32 s2, 135
    s_cselect_b32 s54, s54, 0
    s_cmp_lt_u32 s28, 2
    s_cselect_b32 s54, s54, 0
    s_lshl_b32 s50, s41, 13
    s_lshl_b32 s101, s40, 8
    s_add_u32 s50, s50, s101
    s_waitcnt lgkmcnt(0)
    v_add_f32 v132, v132, v133
    v_add_f32 v134, v134, v135
    v_add_f32 v132, v132, v134
    buffer_store_dword v132, v131, s[52:55], s50 offen sc1
    s_lshr_b32 s59, s2, 5
    s_lshl_b32 s59, s59, 7
    s_cmp_lg_u32 s28, 0
    s_cbranch_scc1 L_wt_H_done
    s_add_u32 s56, s88, 0x61800
    s_addc_u32 s57, s89, 0
    v_mbcnt_lo_u32_b32 v248, -1, 0
    v_mbcnt_hi_u32_b32 v248, -1, v248
    v_min_u32 v248, 0, v248
    v_lshlrev_b32 v248, 7, v248
    v_add_u32 v248, s59, v248
    s_mov_b32 s58, 60000
    global_load_dword v249, v248, s[56:57] sc1
L_wt_H_loop:
    global_load_dword v251, v248, s[56:57] sc1
    s_waitcnt vmcnt(1)
    v_cmp_gt_u32 vcc, 32, v249
    s_sub_u32 s58, s58, 1
    s_cmp_eq_u32 s58, 0
    s_cbranch_scc1 L_wt_H_done
    s_cmp_eq_u64 vcc, 0
    s_cbranch_scc1 L_wt_H_done
    s_sleep 2
    global_load_dword v249, v248, s[56:57] sc1
    s_waitcnt vmcnt(1)
    v_cmp_gt_u32 vcc, 32, v251
    s_sub_u32 s58, s58, 1
    s_cmp_eq_u32 s58, 0
    s_cbranch_scc1 L_wt_H_done
    s_cmp_eq_u64 vcc, 0
    s_cbranch_scc1 L_wt_H_done
    s_sleep 2
    s_branch L_wt_H_loop
L_wt_H_done:
    s_barrier
    s_lshl_b32 s42, s48, 11
    s_add_u32 s43, s42, 0x5000
    s_add_u32 s44, s42, 0xa000
    s_add_u32 s45, s42, 0xf000
    buffer_load_dwordx4 a[0:3], v221, s[20:23], s42 offen offset:0 sc1
    buffer_load_dwordx4 a[4:7], v221, s[20:23], s43 offen offset:0 sc1
    buffer_load_dwordx4 a[8:11], v221, s[20:23], s44 offen offset:0 sc1
    buffer_load_dwordx4 a[12:15], v221, s[20:23], s45 offen offset:0 sc1
    buffer_load_dwordx4 a[16:19], v221, s[20:23], s42 offen offset:1024 sc1
    buffer_load_dwordx4 a[20:23], v221, s[20:23], s43 offen offset:1024 sc1
    buffer_load_dwordx4 a[24:27], v221, s[20:23], s44 offen offset:1024 sc1
    buffer_load_dwordx4 a[28:31], v221, s[20:23], s45 offen offset:1024 sc1
    s_add_u32 s48, s48, 1
    s_cmp_eq_u32 s48, 10
    s_cselect_b32 s48, 0, s48
    s_lshl_b32 s42, s48, 11
    s_add_u32 s43, s42, 0x5000
    s_add_u32 s44, s42, 0xa000
    s_add_u32 s45, s42, 0xf000
    buffer_load_dwordx4 a[32:35], v221, s[20:23], s42 offen offset:0 sc1
    buffer_load_dwordx4 a[36:39], v221, s[20:23], s43 offen offset:0 sc1
    buffer_load_dwordx4 a[40:43], v221, s[20:23], s44 offen offset:0 sc1
    buffer_load_dwordx4 a[44:47], v221, s[20:23], s45 offen offset:0 sc1
    buffer_load_dwordx4 a[48:51], v221, s[20:23], s42 offen offset:1024 sc1
    buffer_load_dwordx4 a[52:55], v221, s[20:23], s43 offen offset:1024 sc1
    buffer_load_dwordx4 a[56:59], v221, s[20:23], s44 offen offset:1024 sc1
    buffer_load_dwordx4 a[60:63], v221, s[20:23], s45 offen offset:1024 sc1
    s_add_u32 s48, s48, 1
    s_cmp_eq_u32 s48, 10
    s_cselect_b32 s48, 0, s48
    s_waitcnt vmcnt(8)
    s_barrier
    ds_read_b64_tr_b16 a[192:193], v213 offset:49152
    ds_read_b64_tr_b16 a[194:195], v213 offset:50176
    ds_read_b64_tr_b16 a[196:197], v213 offset:49160
    ds_read_b64_tr_b16 a[198:199], v213 offset:50184
    ds_read_b64_tr_b16 a[200:201], v214 offset:49152
    ds_read_b64_tr_b16 a[202:203], v214 offset:50176
    ds_read_b64_tr_b16 a[204:205], v214 offset:49160
    ds_read_b64_tr_b16 a[206:207], v214 offset:50184
    ds_read_b64_tr_b16 a[208:209], v215 offset:49152
    ds_read_b64_tr_b16 a[210:211], v215 offset:50176
    ds_read_b64_tr_b16 a[212:213], v215 offset:49160
    ds_read_b64_tr_b16 a[214:215], v215 offset:50184
    ds_read_b64_tr_b16 a[216:217], v216 offset:49152
    ds_read_b64_tr_b16 a[218:219], v216 offset:50176
    ds_read_b64_tr_b16 a[220:221], v216 offset:49160
    ds_read_b64_tr_b16 a[222:223], v216 offset:50184
    s_waitcnt lgkmcnt(0)
    v_mfma_f32_16x16x32_bf16 v[0:3], a[192:195], a[0:3], 0
    ds_read_b64_tr_b16 a[224:225], v213 offset:57344
    v_mfma_f32_16x16x32_bf16 v[32:35], a[192:195], a[4:7], 0
    ds_read_b64_tr_b16 a[226:227], v213 offset:58368
    v_mfma_f32_16x16x32_bf16 v[64:67], a[192:195], a[8:11], 0
    ds_read_b64_tr_b16 a[228:229], v213 offset:57352
    v_mfma_f32_16x16x32_bf16 v[96:99], a[192:195], a[12:15], 0
    ds_read_b64_tr_b16 a[230:231], v213 offset:58376
    v_mfma_f32_16x16x32_bf16 v[4:7], a[196:199], a[0:3], 0
    ds_read_b64_tr_b16 a[232:233], v214 offset:57344
    v_mfma_f32_16x16x32_bf16 v[36:39], a[196:199], a[4:7], 0
    ds_read_b64_tr_b16 a[234:235], v214 offset:58368
    v_mfma_f32_16x16x32_bf16 v[68:71], a[196:199], a[8:11], 0
    ds_read_b64_tr_b16 a[236:237], v214 offset:57352
    v_mfma_f32_16x16x32_bf16 v[100:103], a[196:199], a[12:15], 0
    ds_read_b64_tr_b16 a[238:239], v214 offset:58376
    v_mfma_f32_16x16x32_bf16 v[8:11], a[200:203], a[0:3], 0
    ds_read_b64_tr_b16 a[240:241], v215 offset:57344
    v_mfma_f32_16x16x32_bf16 v[40:43], a[200:203], a[4:7], 0
    ds_read_b64_tr_b16 a[242:243], v215 offset:58368
    s_add_u32 m0, s29, 0x0
    s_lshl_b32 s39, s48, 19
    buffer_load_dwordx4 v209, s[16:19], s39 offen offset:0 lds
    v_mfma_f32_16x16x32_bf16 v[72:75], a[200:203], a[8:11], 0
    ds_read_b64_tr_b16 a[244:245], v215 offset:57352
    v_mfma_f32_16x16x32_bf16 v[104:107], a[200:203], a[12:15], 0
    ds_read_b64_tr_b16 a[246:247], v215 offset:58376
    v_mfma_f32_16x16x32_bf16 v[12:15], a[204:207], a[0:3], 0
    ds_read_b64_tr_b16 a[248:249], v216 offset:57344
    v_mfma_f32_16x16x32_bf16 v[44:47], a[204:207], a[4:7], 0
    ds_read_b64_tr_b16 a[250:251], v216 offset:58368
    s_lshl_b32 s42, s48, 11
    s_add_u32 s43, s42, 0x5000
    s_add_u32 s44, s42, 0xa000
    s_add_u32 s45, s42, 0xf000
    buffer_load_dwordx4 a[64:67], v221, s[20:23], s42 offen offset:0 sc1
    v_mfma_f32_16x16x32_bf16 v[76:79], a[204:207], a[8:11], 0
    ds_read_b64_tr_b16 a[252:253], v216 offset:57352
    v_mfma_f32_16x16x32_bf16 v[108:111], a[204:207], a[12:15], 0
    ds_read_b64_tr_b16 a[254:255], v216 offset:58376
    v_mfma_f32_16x16x32_bf16 v[16:19], a[208:211], a[0:3], 0
    v_mfma_f32_16x16x32_bf16 v[48:51], a[208:211], a[4:7], 0
    buffer_load_dwordx4 a[68:71], v221, s[20:23], s43 offen offset:0 sc1
    v_mfma_f32_16x16x32_bf16 v[80:83], a[208:211], a[8:11], 0
    v_mfma_f32_16x16x32_bf16 v[112:115], a[208:211], a[12:15], 0
    v_mfma_f32_16x16x32_bf16 v[20:23], a[212:215], a[0:3], 0
    v_mfma_f32_16x16x32_bf16 v[52:55], a[212:215], a[4:7], 0
    buffer_load_dwordx4 v210, s[16:19], s39 offen offset:1024 lds
    v_mfma_f32_16x16x32_bf16 v[84:87], a[212:215], a[8:11], 0
    v_mfma_f32_16x16x32_bf16 v[116:119], a[212:215], a[12:15], 0
    v_mfma_f32_16x16x32_bf16 v[24:27], a[216:219], a[0:3], 0
    v_mfma_f32_16x16x32_bf16 v[56:59], a[216:219], a[4:7], 0
    buffer_load_dwordx4 a[72:75], v221, s[20:23], s44 offen offset:0 sc1
    v_mfma_f32_16x16x32_bf16 v[88:91], a[216:219], a[8:11], 0
    v_mfma_f32_16x16x32_bf16 v[120:123], a[216:219], a[12:15], 0
    v_mfma_f32_16x16x32_bf16 v[28:31], a[220:223], a[0:3], 0
    v_mfma_f32_16x16x32_bf16 v[60:63], a[220:223], a[4:7], 0
    buffer_load_dwordx4 a[76:79], v221, s[20:23], s45 offen offset:0 sc1
    v_mfma_f32_16x16x32_bf16 v[92:95], a[220:223], a[8:11], 0
    v_mfma_f32_16x16x32_bf16 v[124:127], a[220:223], a[12:15], 0
    s_waitcnt lgkmcnt(0)
    v_mfma_f32_16x16x32_bf16 v[0:3], a[224:227], a[16:19], v[0:3]
    v_mfma_f32_16x16x32_bf16 v[32:35], a[224:227], a[20:23], v[32:35]
    s_waitcnt vmcnt(6)
    s_barrier
    v_mfma_f32_16x16x32_bf16 v[64:67], a[224:227], a[24:27], v[64:67]
    ds_read_b64_tr_b16 a[192:193], v217 offset:49152
    v_mfma_f32_16x16x32_bf16 v[96:99], a[224:227], a[28:31], v[96:99]
    ds_read_b64_tr_b16 a[194:195], v217 offset:50176
    v_mfma_f32_16x16x32_bf16 v[4:7], a[228:231], a[16:19], v[4:7]
    ds_read_b64_tr_b16 a[196:197], v217 offset:49160
    v_mfma_f32_16x16x32_bf16 v[36:39], a[228:231], a[20:23], v[36:39]
    ds_read_b64_tr_b16 a[198:199], v217 offset:50184
    v_mfma_f32_16x16x32_bf16 v[68:71], a[228:231], a[24:27], v[68:71]
    ds_read_b64_tr_b16 a[200:201], v218 offset:49152
    v_mfma_f32_16x16x32_bf16 v[100:103], a[228:231], a[28:31], v[100:103]
    ds_read_b64_tr_b16 a[202:203], v218 offset:50176
    v_mfma_f32_16x16x32_bf16 v[8:11], a[232:235], a[16:19], v[8:11]
    ds_read_b64_tr_b16 a[204:205], v218 offset:49160
    v_mfma_f32_16x16x32_bf16 v[40:43], a[232:235], a[20:23], v[40:43]
    ds_read_b64_tr_b16 a[206:207], v218 offset:50184
    buffer_load_dwordx4 v211, s[16:19], s39 offen offset:2048 lds
    v_mfma_f32_16x16x32_bf16 v[72:75], a[232:235], a[24:27], v[72:75]
    ds_read_b64_tr_b16 a[208:209], v219 offset:49152
    v_mfma_f32_16x16x32_bf16 v[104:107], a[232:235], a[28:31], v[104:107]
    ds_read_b64_tr_b16 a[210:211], v219 offset:50176
    v_mfma_f32_16x16x32_bf16 v[12:15], a[236:239], a[16:19], v[12:15]
    ds_read_b64_tr_b16 a[212:213], v219 offset:49160
    v_mfma_f32_16x16x32_bf16 v[44:47], a[236:239], a[20:23], v[44:47]
    ds_read_b64_tr_b16 a[214:215], v219 offset:50184
    buffer_load_dwordx4 a[80:83], v221, s[20:23], s42 offen offset:1024 sc1
    v_mfma_f32_16x16x32_bf16 v[76:79], a[236:239], a[24:27], v[76:79]
    ds_read_b64_tr_b16 a[216:217], v220 offset:49152
    v_mfma_f32_16x16x32_bf16 v[108:111], a[236:239], a[28:31], v[108:111]
    ds_read_b64_tr_b16 a[218:219], v220 offset:50176
    v_mfma_f32_16x16x32_bf16 v[16:19], a[240:243], a[16:19], v[16:19]
    ds_read_b64_tr_b16 a[220:221], v220 offset:49160
    v_mfma_f32_16x16x32_bf16 v[48:51], a[240:243], a[20:23], v[48:51]
    ds_read_b64_tr_b16 a[222:223], v220 offset:50184
    buffer_load_dwordx4 a[84:87], v221, s[20:23], s43 offen offset:1024 sc1
    v_mfma_f32_16x16x32_bf16 v[80:83], a[240:243], a[24:27], v[80:83]
    v_mfma_f32_16x16x32_bf16 v[112:115], a[240:243], a[28:31], v[112:115]
    v_mfma_f32_16x16x32_bf16 v[20:23], a[244:247], a[16:19], v[20:23]
    v_mfma_f32_16x16x32_bf16 v[52:55], a[244:247], a[20:23], v[52:55]
    buffer_load_dwordx4 v212, s[16:19], s39 offen offset:3072 lds
    v_mfma_f32_16x16x32_bf16 v[84:87], a[244:247], a[24:27], v[84:87]
    v_mfma_f32_16x16x32_bf16 v[116:119], a[244:247], a[28:31], v[116:119]
    v_mfma_f32_16x16x32_bf16 v[24:27], a[248:251], a[16:19], v[24:27]
    v_mfma_f32_16x16x32_bf16 v[56:59], a[248:251], a[20:23], v[56:59]
    buffer_load_dwordx4 a[88:91], v221, s[20:23], s44 offen offset:1024 sc1
    v_mfma_f32_16x16x32_bf16 v[88:91], a[248:251], a[24:27], v[88:91]
    v_mfma_f32_16x16x32_bf16 v[120:123], a[248:251], a[28:31], v[120:123]
    v_mfma_f32_16x16x32_bf16 v[28:31], a[252:255], a[16:19], v[28:31]
    v_mfma_f32_16x16x32_bf16 v[60:63], a[252:255], a[20:23], v[60:63]
    buffer_load_dwordx4 a[92:95], v221, s[20:23], s45 offen offset:1024 sc1
    s_add_u32 s48, s48, 1
    s_cmp_eq_u32 s48, 10
    s_cselect_b32 s48, 0, s48
    v_mfma_f32_16x16x32_bf16 v[92:95], a[252:255], a[24:27], v[92:95]
    v_mfma_f32_16x16x32_bf16 v[124:127], a[252:255], a[28:31], v[124:127]
    s_waitcnt lgkmcnt(0)
    v_mfma_f32_16x16x32_bf16 v[0:3], a[192:195], a[32:35], v[0:3]
    ds_read_b64_tr_b16 a[224:225], v217 offset:57344
    v_mfma_f32_16x16x32_bf16 v[32:35], a[192:195], a[36:39], v[32:35]
    ds_read_b64_tr_b16 a[226:227], v217 offset:58368
    v_mfma_f32_16x16x32_bf16 v[64:67], a[192:195], a[40:43], v[64:67]
    ds_read_b64_tr_b16 a[228:229], v217 offset:57352
    v_mfma_f32_16x16x32_bf16 v[96:99], a[192:195], a[44:47], v[96:99]
    ds_read_b64_tr_b16 a[230:231], v217 offset:58376
    v_mfma_f32_16x16x32_bf16 v[4:7], a[196:199], a[32:35], v[4:7]
    ds_read_b64_tr_b16 a[232:233], v218 offset:57344
    v_mfma_f32_16x16x32_bf16 v[36:39], a[196:199], a[36:39], v[36:39]
    ds_read_b64_tr_b16 a[234:235], v218 offset:58368
    v_mfma_f32_16x16x32_bf16 v[68:71], a[196:199], a[40:43], v[68:71]
    ds_read_b64_tr_b16 a[236:237], v218 offset:57352
    v_mfma_f32_16x16x32_bf16 v[100:103], a[196:199], a[44:47], v[100:103]
    ds_read_b64_tr_b16 a[238:239], v218 offset:58376
    v_mfma_f32_16x16x32_bf16 v[8:11], a[200:203], a[32:35], v[8:11]
    ds_read_b64_tr_b16 a[240:241], v219 offset:57344
    v_mfma_f32_16x16x32_bf16 v[40:43], a[200:203], a[36:39], v[40:43]
    ds_read_b64_tr_b16 a[242:243], v219 offset:58368
    s_add_u32 m0, s29, 0x10000
    s_lshl_b32 s39, s48, 19
    buffer_load_dwordx4 v209, s[16:19], s39 offen offset:0 lds
    v_mfma_f32_16x16x32_bf16 v[72:75], a[200:203], a[40:43], v[72:75]
    ds_read_b64_tr_b16 a[244:245], v219 offset:57352
    v_mfma_f32_16x16x32_bf16 v[104:107], a[200:203], a[44:47], v[104:107]
    ds_read_b64_tr_b16 a[246:247], v219 offset:58376
    v_mfma_f32_16x16x32_bf16 v[12:15], a[204:207], a[32:35], v[12:15]
    ds_read_b64_tr_b16 a[248:249], v220 offset:57344
    v_mfma_f32_16x16x32_bf16 v[44:47], a[204:207], a[36:39], v[44:47]
    ds_read_b64_tr_b16 a[250:251], v220 offset:58368
    s_lshl_b32 s42, s48, 11
    s_add_u32 s43, s42, 0x5000
    s_add_u32 s44, s42, 0xa000
    s_add_u32 s45, s42, 0xf000
    buffer_load_dwordx4 a[96:99], v221, s[20:23], s42 offen offset:0 sc1
    v_mfma_f32_16x16x32_bf16 v[76:79], a[204:207], a[40:43], v[76:79]
    ds_read_b64_tr_b16 a[252:253], v220 offset:57352
    v_mfma_f32_16x16x32_bf16 v[108:111], a[204:207], a[44:47], v[108:111]
    ds_read_b64_tr_b16 a[254:255], v220 offset:58376
    v_mfma_f32_16x16x32_bf16 v[16:19], a[208:211], a[32:35], v[16:19]
    v_mfma_f32_16x16x32_bf16 v[48:51], a[208:211], a[36:39], v[48:51]
    buffer_load_dwordx4 a[100:103], v221, s[20:23], s43 offen offset:0 sc1
    v_mfma_f32_16x16x32_bf16 v[80:83], a[208:211], a[40:43], v[80:83]
    v_mfma_f32_16x16x32_bf16 v[112:115], a[208:211], a[44:47], v[112:115]
    v_mfma_f32_16x16x32_bf16 v[20:23], a[212:215], a[32:35], v[20:23]
    v_mfma_f32_16x16x32_bf16 v[52:55], a[212:215], a[36:39], v[52:55]
    buffer_load_dwordx4 v210, s[16:19], s39 offen offset:1024 lds
    v_mfma_f32_16x16x32_bf16 v[84:87], a[212:215], a[40:43], v[84:87]
    v_mfma_f32_16x16x32_bf16 v[116:119], a[212:215], a[44:47], v[116:119]
    v_mfma_f32_16x16x32_bf16 v[24:27], a[216:219], a[32:35], v[24:27]
    v_mfma_f32_16x16x32_bf16 v[56:59], a[216:219], a[36:39], v[56:59]
    buffer_load_dwordx4 a[104:107], v221, s[20:23], s44 offen offset:0 sc1
    v_mfma_f32_16x16x32_bf16 v[88:91], a[216:219], a[40:43], v[88:91]
    v_mfma_f32_16x16x32_bf16 v[120:123], a[216:219], a[44:47], v[120:123]
    v_mfma_f32_16x16x32_bf16 v[28:31], a[220:223], a[32:35], v[28:31]
    v_mfma_f32_16x16x32_bf16 v[60:63], a[220:223], a[36:39], v[60:63]
    buffer_load_dwordx4 a[108:111], v221, s[20:23], s45 offen offset:0 sc1
    v_mfma_f32_16x16x32_bf16 v[92:95], a[220:223], a[40:43], v[92:95]
    v_mfma_f32_16x16x32_bf16 v[124:127], a[220:223], a[44:47], v[124:127]
    s_waitcnt lgkmcnt(0)
    v_mfma_f32_16x16x32_bf16 v[0:3], a[224:227], a[48:51], v[0:3]
    v_mfma_f32_16x16x32_bf16 v[32:35], a[224:227], a[52:55], v[32:35]
    s_waitcnt vmcnt(6)
    s_barrier
    v_mfma_f32_16x16x32_bf16 v[64:67], a[224:227], a[56:59], v[64:67]
    ds_read_b64_tr_b16 a[192:193], v213 offset:0
    v_mfma_f32_16x16x32_bf16 v[96:99], a[224:227], a[60:63], v[96:99]
    ds_read_b64_tr_b16 a[194:195], v213 offset:1024
    v_mfma_f32_16x16x32_bf16 v[4:7], a[228:231], a[48:51], v[4:7]
    ds_read_b64_tr_b16 a[196:197], v213 offset:8
    v_mfma_f32_16x16x32_bf16 v[36:39], a[228:231], a[52:55], v[36:39]
    ds_read_b64_tr_b16 a[198:199], v213 offset:1032
    v_mfma_f32_16x16x32_bf16 v[68:71], a[228:231], a[56:59], v[68:71]
    ds_read_b64_tr_b16 a[200:201], v214 offset:0
    v_mfma_f32_16x16x32_bf16 v[100:103], a[228:231], a[60:63], v[100:103]
    ds_read_b64_tr_b16 a[202:203], v214 offset:1024
    v_mfma_f32_16x16x32_bf16 v[8:11], a[232:235], a[48:51], v[8:11]
    ds_read_b64_tr_b16 a[204:205], v214 offset:8
    v_mfma_f32_16x16x32_bf16 v[40:43], a[232:235], a[52:55], v[40:43]
    ds_read_b64_tr_b16 a[206:207], v214 offset:1032
    buffer_load_dwordx4 v211, s[16:19], s39 offen offset:2048 lds
    v_mfma_f32_16x16x32_bf16 v[72:75], a[232:235], a[56:59], v[72:75]
    ds_read_b64_tr_b16 a[208:209], v215 offset:0
    v_mfma_f32_16x16x32_bf16 v[104:107], a[232:235], a[60:63], v[104:107]
    ds_read_b64_tr_b16 a[210:211], v215 offset:1024
    v_mfma_f32_16x16x32_bf16 v[12:15], a[236:239], a[48:51], v[12:15]
    ds_read_b64_tr_b16 a[212:213], v215 offset:8
    v_mfma_f32_16x16x32_bf16 v[44:47], a[236:239], a[52:55], v[44:47]
    ds_read_b64_tr_b16 a[214:215], v215 offset:1032
    buffer_load_dwordx4 a[112:115], v221, s[20:23], s42 offen offset:1024 sc1
    v_mfma_f32_16x16x32_bf16 v[76:79], a[236:239], a[56:59], v[76:79]
    ds_read_b64_tr_b16 a[216:217], v216 offset:0
    v_mfma_f32_16x16x32_bf16 v[108:111], a[236:239], a[60:63], v[108:111]
    ds_read_b64_tr_b16 a[218:219], v216 offset:1024
    v_mfma_f32_16x16x32_bf16 v[16:19], a[240:243], a[48:51], v[16:19]
    ds_read_b64_tr_b16 a[220:221], v216 offset:8
    v_mfma_f32_16x16x32_bf16 v[48:51], a[240:243], a[52:55], v[48:51]
    ds_read_b64_tr_b16 a[222:223], v216 offset:1032
    buffer_load_dwordx4 a[116:119], v221, s[20:23], s43 offen offset:1024 sc1
    v_mfma_f32_16x16x32_bf16 v[80:83], a[240:243], a[56:59], v[80:83]
    v_mfma_f32_16x16x32_bf16 v[112:115], a[240:243], a[60:63], v[112:115]
    v_mfma_f32_16x16x32_bf16 v[20:23], a[244:247], a[48:51], v[20:23]
    v_mfma_f32_16x16x32_bf16 v[52:55], a[244:247], a[52:55], v[52:55]
    buffer_load_dwordx4 v212, s[16:19], s39 offen offset:3072 lds
    v_mfma_f32_16x16x32_bf16 v[84:87], a[244:247], a[56:59], v[84:87]
    v_mfma_f32_16x16x32_bf16 v[116:119], a[244:247], a[60:63], v[116:119]
    v_mfma_f32_16x16x32_bf16 v[24:27], a[248:251], a[48:51], v[24:27]
    v_mfma_f32_16x16x32_bf16 v[56:59], a[248:251], a[52:55], v[56:59]
    buffer_load_dwordx4 a[120:123], v221, s[20:23], s44 offen offset:1024 sc1
    v_mfma_f32_16x16x32_bf16 v[88:91], a[248:251], a[56:59], v[88:91]
    v_mfma_f32_16x16x32_bf16 v[120:123], a[248:251], a[60:63], v[120:123]
    v_mfma_f32_16x16x32_bf16 v[28:31], a[252:255], a[48:51], v[28:31]
    v_mfma_f32_16x16x32_bf16 v[60:63], a[252:255], a[52:55], v[60:63]
    buffer_load_dwordx4 a[124:127], v221, s[20:23], s45 offen offset:1024 sc1
    s_add_u32 s48, s48, 1
    s_cmp_eq_u32 s48, 10
    s_cselect_b32 s48, 0, s48
    v_mfma_f32_16x16x32_bf16 v[92:95], a[252:255], a[56:59], v[92:95]
    v_mfma_f32_16x16x32_bf16 v[124:127], a[252:255], a[60:63], v[124:127]
    s_waitcnt lgkmcnt(0)
    v_mfma_f32_16x16x32_bf16 v[0:3], a[192:195], a[64:67], v[0:3]
    ds_read_b64_tr_b16 a[224:225], v213 offset:8192
    v_mfma_f32_16x16x32_bf16 v[32:35], a[192:195], a[68:71], v[32:35]
    ds_read_b64_tr_b16 a[226:227], v213 offset:9216
    v_mfma_f32_16x16x32_bf16 v[64:67], a[192:195], a[72:75], v[64:67]
    ds_read_b64_tr_b16 a[228:229], v213 offset:8200
    v_mfma_f32_16x16x32_bf16 v[96:99], a[192:195], a[76:79], v[96:99]
    ds_read_b64_tr_b16 a[230:231], v213 offset:9224
    v_mfma_f32_16x16x32_bf16 v[4:7], a[196:199], a[64:67], v[4:7]
    ds_read_b64_tr_b16 a[232:233], v214 offset:8192
    v_mfma_f32_16x16x32_bf16 v[36:39], a[196:199], a[68:71], v[36:39]
    ds_read_b64_tr_b16 a[234:235], v214 offset:9216
    v_mfma_f32_16x16x32_bf16 v[68:71], a[196:199], a[72:75], v[68:71]
    ds_read_b64_tr_b16 a[236:237], v214 offset:8200
    v_mfma_f32_16x16x32_bf16 v[100:103], a[196:199], a[76:79], v[100:103]
    ds_read_b64_tr_b16 a[238:239], v214 offset:9224
    v_mfma_f32_16x16x32_bf16 v[8:11], a[200:203], a[64:67], v[8:11]
    ds_read_b64_tr_b16 a[240:241], v215 offset:8192
    v_mfma_f32_16x16x32_bf16 v[40:43], a[200:203], a[68:71], v[40:43]
    ds_read_b64_tr_b16 a[242:243], v215 offset:9216
    s_add_u32 m0, s29, 0x4000
    s_lshl_b32 s39, s48, 19
    buffer_load_dwordx4 v209, s[16:19], s39 offen offset:0 lds
    v_mfma_f32_16x16x32_bf16 v[72:75], a[200:203], a[72:75], v[72:75]
    ds_read_b64_tr_b16 a[244:245], v215 offset:8200
    v_mfma_f32_16x16x32_bf16 v[104:107], a[200:203], a[76:79], v[104:107]
    ds_read_b64_tr_b16 a[246:247], v215 offset:9224
    v_mfma_f32_16x16x32_bf16 v[12:15], a[204:207], a[64:67], v[12:15]
    ds_read_b64_tr_b16 a[248:249], v216 offset:8192
    v_mfma_f32_16x16x32_bf16 v[44:47], a[204:207], a[68:71], v[44:47]
    ds_read_b64_tr_b16 a[250:251], v216 offset:9216
    s_lshl_b32 s42, s48, 11
    s_add_u32 s43, s42, 0x5000
    s_add_u32 s44, s42, 0xa000
    s_add_u32 s45, s42, 0xf000
    buffer_load_dwordx4 a[0:3], v221, s[20:23], s42 offen offset:0 sc1
    v_mfma_f32_16x16x32_bf16 v[76:79], a[204:207], a[72:75], v[76:79]
    ds_read_b64_tr_b16 a[252:253], v216 offset:8200
    v_mfma_f32_16x16x32_bf16 v[108:111], a[204:207], a[76:79], v[108:111]
    ds_read_b64_tr_b16 a[254:255], v216 offset:9224
    v_mfma_f32_16x16x32_bf16 v[16:19], a[208:211], a[64:67], v[16:19]
    v_mfma_f32_16x16x32_bf16 v[48:51], a[208:211], a[68:71], v[48:51]
    buffer_load_dwordx4 a[4:7], v221, s[20:23], s43 offen offset:0 sc1
    v_mfma_f32_16x16x32_bf16 v[80:83], a[208:211], a[72:75], v[80:83]
    v_mfma_f32_16x16x32_bf16 v[112:115], a[208:211], a[76:79], v[112:115]
    v_mfma_f32_16x16x32_bf16 v[20:23], a[212:215], a[64:67], v[20:23]
    v_mfma_f32_16x16x32_bf16 v[52:55], a[212:215], a[68:71], v[52:55]
    buffer_load_dwordx4 v210, s[16:19], s39 offen offset:1024 lds
    v_mfma_f32_16x16x32_bf16 v[84:87], a[212:215], a[72:75], v[84:87]
    v_mfma_f32_16x16x32_bf16 v[116:119], a[212:215], a[76:79], v[116:119]
    v_mfma_f32_16x16x32_bf16 v[24:27], a[216:219], a[64:67], v[24:27]
    v_mfma_f32_16x16x32_bf16 v[56:59], a[216:219], a[68:71], v[56:59]
    buffer_load_dwordx4 a[8:11], v221, s[20:23], s44 offen offset:0 sc1
    v_mfma_f32_16x16x32_bf16 v[88:91], a[216:219], a[72:75], v[88:91]
    v_mfma_f32_16x16x32_bf16 v[120:123], a[216:219], a[76:79], v[120:123]
    v_mfma_f32_16x16x32_bf16 v[28:31], a[220:223], a[64:67], v[28:31]
    v_mfma_f32_16x16x32_bf16 v[60:63], a[220:223], a[68:71], v[60:63]
    buffer_load_dwordx4 a[12:15], v221, s[20:23], s45 offen offset:0 sc1
    v_mfma_f32_16x16x32_bf16 v[92:95], a[220:223], a[72:75], v[92:95]
    v_mfma_f32_16x16x32_bf16 v[124:127], a[220:223], a[76:79], v[124:127]
    s_waitcnt lgkmcnt(0)
    v_mfma_f32_16x16x32_bf16 v[0:3], a[224:227], a[80:83], v[0:3]
    v_mfma_f32_16x16x32_bf16 v[32:35], a[224:227], a[84:87], v[32:35]
    s_waitcnt vmcnt(6)
    s_barrier
    v_mfma_f32_16x16x32_bf16 v[64:67], a[224:227], a[88:91], v[64:67]
    ds_read_b64_tr_b16 a[192:193], v217 offset:0
    v_mfma_f32_16x16x32_bf16 v[96:99], a[224:227], a[92:95], v[96:99]
    ds_read_b64_tr_b16 a[194:195], v217 offset:1024
    v_mfma_f32_16x16x32_bf16 v[4:7], a[228:231], a[80:83], v[4:7]
    ds_read_b64_tr_b16 a[196:197], v217 offset:8
    v_mfma_f32_16x16x32_bf16 v[36:39], a[228:231], a[84:87], v[36:39]
    ds_read_b64_tr_b16 a[198:199], v217 offset:1032
    v_mfma_f32_16x16x32_bf16 v[68:71], a[228:231], a[88:91], v[68:71]
    ds_read_b64_tr_b16 a[200:201], v218 offset:0
    v_mfma_f32_16x16x32_bf16 v[100:103], a[228:231], a[92:95], v[100:103]
    ds_read_b64_tr_b16 a[202:203], v218 offset:1024
    v_mfma_f32_16x16x32_bf16 v[8:11], a[232:235], a[80:83], v[8:11]
    ds_read_b64_tr_b16 a[204:205], v218 offset:8
    v_mfma_f32_16x16x32_bf16 v[40:43], a[232:235], a[84:87], v[40:43]
    ds_read_b64_tr_b16 a[206:207], v218 offset:1032
    buffer_load_dwordx4 v211, s[16:19], s39 offen offset:2048 lds
    v_mfma_f32_16x16x32_bf16 v[72:75], a[232:235], a[88:91], v[72:75]
    ds_read_b64_tr_b16 a[208:209], v219 offset:0
    v_mfma_f32_16x16x32_bf16 v[104:107], a[232:235], a[92:95], v[104:107]
    ds_read_b64_tr_b16 a[210:211], v219 offset:1024
    v_mfma_f32_16x16x32_bf16 v[12:15], a[236:239], a[80:83], v[12:15]
    ds_read_b64_tr_b16 a[212:213], v219 offset:8
    v_mfma_f32_16x16x32_bf16 v[44:47], a[236:239], a[84:87], v[44:47]
    ds_read_b64_tr_b16 a[214:215], v219 offset:1032
    buffer_load_dwordx4 a[16:19], v221, s[20:23], s42 offen offset:1024 sc1
    v_mfma_f32_16x16x32_bf16 v[76:79], a[236:239], a[88:91], v[76:79]
    ds_read_b64_tr_b16 a[216:217], v220 offset:0
    v_mfma_f32_16x16x32_bf16 v[108:111], a[236:239], a[92:95], v[108:111]
    ds_read_b64_tr_b16 a[218:219], v220 offset:1024
    v_mfma_f32_16x16x32_bf16 v[16:19], a[240:243], a[80:83], v[16:19]
    ds_read_b64_tr_b16 a[220:221], v220 offset:8
    v_mfma_f32_16x16x32_bf16 v[48:51], a[240:243], a[84:87], v[48:51]
    ds_read_b64_tr_b16 a[222:223], v220 offset:1032
    buffer_load_dwordx4 a[20:23], v221, s[20:23], s43 offen offset:1024 sc1
    v_mfma_f32_16x16x32_bf16 v[80:83], a[240:243], a[88:91], v[80:83]
    v_mfma_f32_16x16x32_bf16 v[112:115], a[240:243], a[92:95], v[112:115]
    v_mfma_f32_16x16x32_bf16 v[20:23], a[244:247], a[80:83], v[20:23]
    v_mfma_f32_16x16x32_bf16 v[52:55], a[244:247], a[84:87], v[52:55]
    buffer_load_dwordx4 v212, s[16:19], s39 offen offset:3072 lds
    v_mfma_f32_16x16x32_bf16 v[84:87], a[244:247], a[88:91], v[84:87]
    v_mfma_f32_16x16x32_bf16 v[116:119], a[244:247], a[92:95], v[116:119]
    v_mfma_f32_16x16x32_bf16 v[24:27], a[248:251], a[80:83], v[24:27]
    v_mfma_f32_16x16x32_bf16 v[56:59], a[248:251], a[84:87], v[56:59]
    buffer_load_dwordx4 a[24:27], v221, s[20:23], s44 offen offset:1024 sc1
    v_mfma_f32_16x16x32_bf16 v[88:91], a[248:251], a[88:91], v[88:91]
    v_mfma_f32_16x16x32_bf16 v[120:123], a[248:251], a[92:95], v[120:123]
    v_mfma_f32_16x16x32_bf16 v[28:31], a[252:255], a[80:83], v[28:31]
    v_mfma_f32_16x16x32_bf16 v[60:63], a[252:255], a[84:87], v[60:63]
    buffer_load_dwordx4 a[28:31], v221, s[20:23], s45 offen offset:1024 sc1
    s_add_u32 s48, s48, 1
    s_cmp_eq_u32 s48, 10
    s_cselect_b32 s48, 0, s48
    v_mfma_f32_16x16x32_bf16 v[92:95], a[252:255], a[88:91], v[92:95]
    v_mfma_f32_16x16x32_bf16 v[124:127], a[252:255], a[92:95], v[124:127]
    s_waitcnt lgkmcnt(0)
    v_mfma_f32_16x16x32_bf16 v[0:3], a[192:195], a[96:99], v[0:3]
    ds_read_b64_tr_b16 a[224:225], v217 offset:8192
    v_mfma_f32_16x16x32_bf16 v[32:35], a[192:195], a[100:103], v[32:35]
    ds_read_b64_tr_b16 a[226:227], v217 offset:9216
    v_mfma_f32_16x16x32_bf16 v[64:67], a[192:195], a[104:107], v[64:67]
    ds_read_b64_tr_b16 a[228:229], v217 offset:8200
    v_mfma_f32_16x16x32_bf16 v[96:99], a[192:195], a[108:111], v[96:99]
    ds_read_b64_tr_b16 a[230:231], v217 offset:9224
    v_mfma_f32_16x16x32_bf16 v[4:7], a[196:199], a[96:99], v[4:7]
    ds_read_b64_tr_b16 a[232:233], v218 offset:8192
    v_mfma_f32_16x16x32_bf16 v[36:39], a[196:199], a[100:103], v[36:39]
    ds_read_b64_tr_b16 a[234:235], v218 offset:9216
    v_mfma_f32_16x16x32_bf16 v[68:71], a[196:199], a[104:107], v[68:71]
    ds_read_b64_tr_b16 a[236:237], v218 offset:8200
    v_mfma_f32_16x16x32_bf16 v[100:103], a[196:199], a[108:111], v[100:103]
    ds_read_b64_tr_b16 a[238:239], v218 offset:9224
    v_mfma_f32_16x16x32_bf16 v[8:11], a[200:203], a[96:99], v[8:11]
    ds_read_b64_tr_b16 a[240:241], v219 offset:8192
    v_mfma_f32_16x16x32_bf16 v[40:43], a[200:203], a[100:103], v[40:43]
    ds_read_b64_tr_b16 a[242:243], v219 offset:9216
    s_add_u32 m0, s29, 0x14000
    s_lshl_b32 s39, s48, 19
    buffer_load_dwordx4 v209, s[16:19], s39 offen offset:0 lds
    v_mfma_f32_16x16x32_bf16 v[72:75], a[200:203], a[104:107], v[72:75]
    ds_read_b64_tr_b16 a[244:245], v219 offset:8200
    v_mfma_f32_16x16x32_bf16 v[104:107], a[200:203], a[108:111], v[104:107]
    ds_read_b64_tr_b16 a[246:247], v219 offset:9224
    v_mfma_f32_16x16x32_bf16 v[12:15], a[204:207], a[96:99], v[12:15]
    ds_read_b64_tr_b16 a[248:249], v220 offset:8192
    v_mfma_f32_16x16x32_bf16 v[44:47], a[204:207], a[100:103], v[44:47]
    ds_read_b64_tr_b16 a[250:251], v220 offset:9216
    s_lshl_b32 s42, s48, 11
    s_add_u32 s43, s42, 0x5000
    s_add_u32 s44, s42, 0xa000
    s_add_u32 s45, s42, 0xf000
    buffer_load_dwordx4 a[32:35], v221, s[20:23], s42 offen offset:0 sc1
    v_mfma_f32_16x16x32_bf16 v[76:79], a[204:207], a[104:107], v[76:79]
    ds_read_b64_tr_b16 a[252:253], v220 offset:8200
    v_mfma_f32_16x16x32_bf16 v[108:111], a[204:207], a[108:111], v[108:111]
    ds_read_b64_tr_b16 a[254:255], v220 offset:9224
    v_mfma_f32_16x16x32_bf16 v[16:19], a[208:211], a[96:99], v[16:19]
    v_mfma_f32_16x16x32_bf16 v[48:51], a[208:211], a[100:103], v[48:51]
    buffer_load_dwordx4 a[36:39], v221, s[20:23], s43 offen offset:0 sc1
    v_mfma_f32_16x16x32_bf16 v[80:83], a[208:211], a[104:107], v[80:83]
    v_mfma_f32_16x16x32_bf16 v[112:115], a[208:211], a[108:111], v[112:115]
    v_mfma_f32_16x16x32_bf16 v[20:23], a[212:215], a[96:99], v[20:23]
    v_mfma_f32_16x16x32_bf16 v[52:55], a[212:215], a[100:103], v[52:55]
    buffer_load_dwordx4 v210, s[16:19], s39 offen offset:1024 lds
    v_mfma_f32_16x16x32_bf16 v[84:87], a[212:215], a[104:107], v[84:87]
    v_mfma_f32_16x16x32_bf16 v[116:119], a[212:215], a[108:111], v[116:119]
    v_mfma_f32_16x16x32_bf16 v[24:27], a[216:219], a[96:99], v[24:27]
    v_mfma_f32_16x16x32_bf16 v[56:59], a[216:219], a[100:103], v[56:59]
    buffer_load_dwordx4 a[40:43], v221, s[20:23], s44 offen offset:0 sc1
    v_mfma_f32_16x16x32_bf16 v[88:91], a[216:219], a[104:107], v[88:91]
    v_mfma_f32_16x16x32_bf16 v[120:123], a[216:219], a[108:111], v[120:123]
    v_mfma_f32_16x16x32_bf16 v[28:31], a[220:223], a[96:99], v[28:31]
    v_mfma_f32_16x16x32_bf16 v[60:63], a[220:223], a[100:103], v[60:63]
    buffer_load_dwordx4 a[44:47], v221, s[20:23], s45 offen offset:0 sc1
    v_mfma_f32_16x16x32_bf16 v[92:95], a[220:223], a[104:107], v[92:95]
    v_mfma_f32_16x16x32_bf16 v[124:127], a[220:223], a[108:111], v[124:127]
    s_waitcnt lgkmcnt(0)
    v_mfma_f32_16x16x32_bf16 v[0:3], a[224:227], a[112:115], v[0:3]
    v_mfma_f32_16x16x32_bf16 v[32:35], a[224:227], a[116:119], v[32:35]
    s_waitcnt vmcnt(6)
    s_barrier
    v_mfma_f32_16x16x32_bf16 v[64:67], a[224:227], a[120:123], v[64:67]
    ds_read_b64_tr_b16 a[192:193], v213 offset:16384
    v_mfma_f32_16x16x32_bf16 v[96:99], a[224:227], a[124:127], v[96:99]
    ds_read_b64_tr_b16 a[194:195], v213 offset:17408
    v_mfma_f32_16x16x32_bf16 v[4:7], a[228:231], a[112:115], v[4:7]
    ds_read_b64_tr_b16 a[196:197], v213 offset:16392
    v_mfma_f32_16x16x32_bf16 v[36:39], a[228:231], a[116:119], v[36:39]
    ds_read_b64_tr_b16 a[198:199], v213 offset:17416
    v_mfma_f32_16x16x32_bf16 v[68:71], a[228:231], a[120:123], v[68:71]
    ds_read_b64_tr_b16 a[200:201], v214 offset:16384
    v_mfma_f32_16x16x32_bf16 v[100:103], a[228:231], a[124:127], v[100:103]
    ds_read_b64_tr_b16 a[202:203], v214 offset:17408
    v_mfma_f32_16x16x32_bf16 v[8:11], a[232:235], a[112:115], v[8:11]
    ds_read_b64_tr_b16 a[204:205], v214 offset:16392
    v_mfma_f32_16x16x32_bf16 v[40:43], a[232:235], a[116:119], v[40:43]
    ds_read_b64_tr_b16 a[206:207], v214 offset:17416
    buffer_load_dwordx4 v211, s[16:19], s39 offen offset:2048 lds
    v_mfma_f32_16x16x32_bf16 v[72:75], a[232:235], a[120:123], v[72:75]
    ds_read_b64_tr_b16 a[208:209], v215 offset:16384
    v_mfma_f32_16x16x32_bf16 v[104:107], a[232:235], a[124:127], v[104:107]
    ds_read_b64_tr_b16 a[210:211], v215 offset:17408
    v_mfma_f32_16x16x32_bf16 v[12:15], a[236:239], a[112:115], v[12:15]
    ds_read_b64_tr_b16 a[212:213], v215 offset:16392
    v_mfma_f32_16x16x32_bf16 v[44:47], a[236:239], a[116:119], v[44:47]
    ds_read_b64_tr_b16 a[214:215], v215 offset:17416
    buffer_load_dwordx4 a[48:51], v221, s[20:23], s42 offen offset:1024 sc1
    v_mfma_f32_16x16x32_bf16 v[76:79], a[236:239], a[120:123], v[76:79]
    ds_read_b64_tr_b16 a[216:217], v216 offset:16384
    v_mfma_f32_16x16x32_bf16 v[108:111], a[236:239], a[124:127], v[108:111]
    ds_read_b64_tr_b16 a[218:219], v216 offset:17408
    v_mfma_f32_16x16x32_bf16 v[16:19], a[240:243], a[112:115], v[16:19]
    ds_read_b64_tr_b16 a[220:221], v216 offset:16392
    v_mfma_f32_16x16x32_bf16 v[48:51], a[240:243], a[116:119], v[48:51]
    ds_read_b64_tr_b16 a[222:223], v216 offset:17416
    buffer_load_dwordx4 a[52:55], v221, s[20:23], s43 offen offset:1024 sc1
    v_mfma_f32_16x16x32_bf16 v[80:83], a[240:243], a[120:123], v[80:83]
    v_mfma_f32_16x16x32_bf16 v[112:115], a[240:243], a[124:127], v[112:115]
    v_mfma_f32_16x16x32_bf16 v[20:23], a[244:247], a[112:115], v[20:23]
    v_mfma_f32_16x16x32_bf16 v[52:55], a[244:247], a[116:119], v[52:55]
    buffer_load_dwordx4 v212, s[16:19], s39 offen offset:3072 lds
    v_mfma_f32_16x16x32_bf16 v[84:87], a[244:247], a[120:123], v[84:87]
    v_mfma_f32_16x16x32_bf16 v[116:119], a[244:247], a[124:127], v[116:119]
    v_mfma_f32_16x16x32_bf16 v[24:27], a[248:251], a[112:115], v[24:27]
    v_mfma_f32_16x16x32_bf16 v[56:59], a[248:251], a[116:119], v[56:59]
    buffer_load_dwordx4 a[56:59], v221, s[20:23], s44 offen offset:1024 sc1
    v_mfma_f32_16x16x32_bf16 v[88:91], a[248:251], a[120:123], v[88:91]
    v_mfma_f32_16x16x32_bf16 v[120:123], a[248:251], a[124:127], v[120:123]
    v_mfma_f32_16x16x32_bf16 v[28:31], a[252:255], a[112:115], v[28:31]
    v_mfma_f32_16x16x32_bf16 v[60:63], a[252:255], a[116:119], v[60:63]
    buffer_load_dwordx4 a[60:63], v221, s[20:23], s45 offen offset:1024 sc1
    s_add_u32 s48, s48, 1
    s_cmp_eq_u32 s48, 10
    s_cselect_b32 s48, 0, s48
    v_mfma_f32_16x16x32_bf16 v[92:95], a[252:255], a[120:123], v[92:95]
    v_mfma_f32_16x16x32_bf16 v[124:127], a[252:255], a[124:127], v[124:127]
    s_waitcnt lgkmcnt(0)
    v_mfma_f32_16x16x32_bf16 v[0:3], a[192:195], a[0:3], v[0:3]
    ds_read_b64_tr_b16 a[224:225], v213 offset:24576
    v_mfma_f32_16x16x32_bf16 v[32:35], a[192:195], a[4:7], v[32:35]
    ds_read_b64_tr_b16 a[226:227], v213 offset:25600
    v_mfma_f32_16x16x32_bf16 v[64:67], a[192:195], a[8:11], v[64:67]
    ds_read_b64_tr_b16 a[228:229], v213 offset:24584
    v_mfma_f32_16x16x32_bf16 v[96:99], a[192:195], a[12:15], v[96:99]
    ds_read_b64_tr_b16 a[230:231], v213 offset:25608
    v_mfma_f32_16x16x32_bf16 v[4:7], a[196:199], a[0:3], v[4:7]
    ds_read_b64_tr_b16 a[232:233], v214 offset:24576
    v_mfma_f32_16x16x32_bf16 v[36:39], a[196:199], a[4:7], v[36:39]
    ds_read_b64_tr_b16 a[234:235], v214 offset:25600
    v_mfma_f32_16x16x32_bf16 v[68:71], a[196:199], a[8:11], v[68:71]
    ds_read_b64_tr_b16 a[236:237], v214 offset:24584
    v_mfma_f32_16x16x32_bf16 v[100:103], a[196:199], a[12:15], v[100:103]
    ds_read_b64_tr_b16 a[238:239], v214 offset:25608
    v_mfma_f32_16x16x32_bf16 v[8:11], a[200:203], a[0:3], v[8:11]
    ds_read_b64_tr_b16 a[240:241], v215 offset:24576
    v_mfma_f32_16x16x32_bf16 v[40:43], a[200:203], a[4:7], v[40:43]
    ds_read_b64_tr_b16 a[242:243], v215 offset:25600
    s_add_u32 m0, s29, 0x8000
    s_lshl_b32 s39, s48, 19
    buffer_load_dwordx4 v209, s[16:19], s39 offen offset:0 lds
    v_mfma_f32_16x16x32_bf16 v[72:75], a[200:203], a[8:11], v[72:75]
    ds_read_b64_tr_b16 a[244:245], v215 offset:24584
    v_mfma_f32_16x16x32_bf16 v[104:107], a[200:203], a[12:15], v[104:107]
    ds_read_b64_tr_b16 a[246:247], v215 offset:25608
    v_mfma_f32_16x16x32_bf16 v[12:15], a[204:207], a[0:3], v[12:15]
    ds_read_b64_tr_b16 a[248:249], v216 offset:24576
    v_mfma_f32_16x16x32_bf16 v[44:47], a[204:207], a[4:7], v[44:47]
    ds_read_b64_tr_b16 a[250:251], v216 offset:25600
    s_lshl_b32 s42, s48, 11
    s_add_u32 s43, s42, 0x5000
    s_add_u32 s44, s42, 0xa000
    s_add_u32 s45, s42, 0xf000
    buffer_load_dwordx4 a[64:67], v221, s[20:23], s42 offen offset:0 sc1
    v_mfma_f32_16x16x32_bf16 v[76:79], a[204:207], a[8:11], v[76:79]
    ds_read_b64_tr_b16 a[252:253], v216 offset:24584
    v_mfma_f32_16x16x32_bf16 v[108:111], a[204:207], a[12:15], v[108:111]
    ds_read_b64_tr_b16 a[254:255], v216 offset:25608
    v_mfma_f32_16x16x32_bf16 v[16:19], a[208:211], a[0:3], v[16:19]
    v_mfma_f32_16x16x32_bf16 v[48:51], a[208:211], a[4:7], v[48:51]
    buffer_load_dwordx4 a[68:71], v221, s[20:23], s43 offen offset:0 sc1
    v_mfma_f32_16x16x32_bf16 v[80:83], a[208:211], a[8:11], v[80:83]
    v_mfma_f32_16x16x32_bf16 v[112:115], a[208:211], a[12:15], v[112:115]
    v_mfma_f32_16x16x32_bf16 v[20:23], a[212:215], a[0:3], v[20:23]
    v_mfma_f32_16x16x32_bf16 v[52:55], a[212:215], a[4:7], v[52:55]
    buffer_load_dwordx4 v210, s[16:19], s39 offen offset:1024 lds
    v_mfma_f32_16x16x32_bf16 v[84:87], a[212:215], a[8:11], v[84:87]
    v_mfma_f32_16x16x32_bf16 v[116:119], a[212:215], a[12:15], v[116:119]
    v_mfma_f32_16x16x32_bf16 v[24:27], a[216:219], a[0:3], v[24:27]
    v_mfma_f32_16x16x32_bf16 v[56:59], a[216:219], a[4:7], v[56:59]
    buffer_load_dwordx4 a[72:75], v221, s[20:23], s44 offen offset:0 sc1
    v_mfma_f32_16x16x32_bf16 v[88:91], a[216:219], a[8:11], v[88:91]
    v_mfma_f32_16x16x32_bf16 v[120:123], a[216:219], a[12:15], v[120:123]
    v_mfma_f32_16x16x32_bf16 v[28:31], a[220:223], a[0:3], v[28:31]
    v_mfma_f32_16x16x32_bf16 v[60:63], a[220:223], a[4:7], v[60:63]
    buffer_load_dwordx4 a[76:79], v221, s[20:23], s45 offen offset:0 sc1
    v_mfma_f32_16x16x32_bf16 v[92:95], a[220:223], a[8:11], v[92:95]
    v_mfma_f32_16x16x32_bf16 v[124:127], a[220:223], a[12:15], v[124:127]
    s_waitcnt lgkmcnt(0)
    v_mfma_f32_16x16x32_bf16 v[0:3], a[224:227], a[16:19], v[0:3]
    v_mfma_f32_16x16x32_bf16 v[32:35], a[224:227], a[20:23], v[32:35]
    s_waitcnt vmcnt(6)
    s_barrier
    v_mfma_f32_16x16x32_bf16 v[64:67], a[224:227], a[24:27], v[64:67]
    ds_read_b64_tr_b16 a[192:193], v217 offset:16384
    v_mfma_f32_16x16x32_bf16 v[96:99], a[224:227], a[28:31], v[96:99]
    ds_read_b64_tr_b16 a[194:195], v217 offset:17408
    v_mfma_f32_16x16x32_bf16 v[4:7], a[228:231], a[16:19], v[4:7]
    ds_read_b64_tr_b16 a[196:197], v217 offset:16392
    v_mfma_f32_16x16x32_bf16 v[36:39], a[228:231], a[20:23], v[36:39]
    ds_read_b64_tr_b16 a[198:199], v217 offset:17416
    v_mfma_f32_16x16x32_bf16 v[68:71], a[228:231], a[24:27], v[68:71]
    ds_read_b64_tr_b16 a[200:201], v218 offset:16384
    v_mfma_f32_16x16x32_bf16 v[100:103], a[228:231], a[28:31], v[100:103]
    ds_read_b64_tr_b16 a[202:203], v218 offset:17408
    v_mfma_f32_16x16x32_bf16 v[8:11], a[232:235], a[16:19], v[8:11]
    ds_read_b64_tr_b16 a[204:205], v218 offset:16392
    v_mfma_f32_16x16x32_bf16 v[40:43], a[232:235], a[20:23], v[40:43]
    ds_read_b64_tr_b16 a[206:207], v218 offset:17416
    buffer_load_dwordx4 v211, s[16:19], s39 offen offset:2048 lds
    v_mfma_f32_16x16x32_bf16 v[72:75], a[232:235], a[24:27], v[72:75]
    ds_read_b64_tr_b16 a[208:209], v219 offset:16384
    v_mfma_f32_16x16x32_bf16 v[104:107], a[232:235], a[28:31], v[104:107]
    ds_read_b64_tr_b16 a[210:211], v219 offset:17408
    v_mfma_f32_16x16x32_bf16 v[12:15], a[236:239], a[16:19], v[12:15]
    ds_read_b64_tr_b16 a[212:213], v219 offset:16392
    v_mfma_f32_16x16x32_bf16 v[44:47], a[236:239], a[20:23], v[44:47]
    ds_read_b64_tr_b16 a[214:215], v219 offset:17416
    buffer_load_dwordx4 a[80:83], v221, s[20:23], s42 offen offset:1024 sc1
    v_mfma_f32_16x16x32_bf16 v[76:79], a[236:239], a[24:27], v[76:79]
    ds_read_b64_tr_b16 a[216:217], v220 offset:16384
    v_mfma_f32_16x16x32_bf16 v[108:111], a[236:239], a[28:31], v[108:111]
    ds_read_b64_tr_b16 a[218:219], v220 offset:17408
    v_mfma_f32_16x16x32_bf16 v[16:19], a[240:243], a[16:19], v[16:19]
    ds_read_b64_tr_b16 a[220:221], v220 offset:16392
    v_mfma_f32_16x16x32_bf16 v[48:51], a[240:243], a[20:23], v[48:51]
    ds_read_b64_tr_b16 a[222:223], v220 offset:17416
    buffer_load_dwordx4 a[84:87], v221, s[20:23], s43 offen offset:1024 sc1
    v_mfma_f32_16x16x32_bf16 v[80:83], a[240:243], a[24:27], v[80:83]
    v_mfma_f32_16x16x32_bf16 v[112:115], a[240:243], a[28:31], v[112:115]
    v_mfma_f32_16x16x32_bf16 v[20:23], a[244:247], a[16:19], v[20:23]
    v_mfma_f32_16x16x32_bf16 v[52:55], a[244:247], a[20:23], v[52:55]
    buffer_load_dwordx4 v212, s[16:19], s39 offen offset:3072 lds
    v_mfma_f32_16x16x32_bf16 v[84:87], a[244:247], a[24:27], v[84:87]
    v_mfma_f32_16x16x32_bf16 v[116:119], a[244:247], a[28:31], v[116:119]
    v_mfma_f32_16x16x32_bf16 v[24:27], a[248:251], a[16:19], v[24:27]
    v_mfma_f32_16x16x32_bf16 v[56:59], a[248:251], a[20:23], v[56:59]
    buffer_load_dwordx4 a[88:91], v221, s[20:23], s44 offen offset:1024 sc1
    v_mfma_f32_16x16x32_bf16 v[88:91], a[248:251], a[24:27], v[88:91]
    v_mfma_f32_16x16x32_bf16 v[120:123], a[248:251], a[28:31], v[120:123]
    v_mfma_f32_16x16x32_bf16 v[28:31], a[252:255], a[16:19], v[28:31]
    v_mfma_f32_16x16x32_bf16 v[60:63], a[252:255], a[20:23], v[60:63]
    buffer_load_dwordx4 a[92:95], v221, s[20:23], s45 offen offset:1024 sc1
    s_add_u32 s48, s48, 1
    s_cmp_eq_u32 s48, 10
    s_cselect_b32 s48, 0, s48
    v_mfma_f32_16x16x32_bf16 v[92:95], a[252:255], a[24:27], v[92:95]
    v_mfma_f32_16x16x32_bf16 v[124:127], a[252:255], a[28:31], v[124:127]
    s_waitcnt lgkmcnt(0)
    v_mfma_f32_16x16x32_bf16 v[0:3], a[192:195], a[32:35], v[0:3]
    ds_read_b64_tr_b16 a[224:225], v217 offset:24576
    v_mfma_f32_16x16x32_bf16 v[32:35], a[192:195], a[36:39], v[32:35]
    ds_read_b64_tr_b16 a[226:227], v217 offset:25600
    v_mfma_f32_16x16x32_bf16 v[64:67], a[192:195], a[40:43], v[64:67]
    ds_read_b64_tr_b16 a[228:229], v217 offset:24584
    v_mfma_f32_16x16x32_bf16 v[96:99], a[192:195], a[44:47], v[96:99]
    ds_read_b64_tr_b16 a[230:231], v217 offset:25608
    v_mfma_f32_16x16x32_bf16 v[4:7], a[196:199], a[32:35], v[4:7]
    ds_read_b64_tr_b16 a[232:233], v218 offset:24576
    v_mfma_f32_16x16x32_bf16 v[36:39], a[196:199], a[36:39], v[36:39]
    ds_read_b64_tr_b16 a[234:235], v218 offset:25600
    v_mfma_f32_16x16x32_bf16 v[68:71], a[196:199], a[40:43], v[68:71]
    ds_read_b64_tr_b16 a[236:237], v218 offset:24584
    v_mfma_f32_16x16x32_bf16 v[100:103], a[196:199], a[44:47], v[100:103]
    ds_read_b64_tr_b16 a[238:239], v218 offset:25608
    v_mfma_f32_16x16x32_bf16 v[8:11], a[200:203], a[32:35], v[8:11]
    ds_read_b64_tr_b16 a[240:241], v219 offset:24576
    v_mfma_f32_16x16x32_bf16 v[40:43], a[200:203], a[36:39], v[40:43]
    ds_read_b64_tr_b16 a[242:243], v219 offset:25600
    s_add_u32 m0, s29, 0x18000
    s_lshl_b32 s39, s48, 19
    buffer_load_dwordx4 v209, s[16:19], s39 offen offset:0 lds
    v_mfma_f32_16x16x32_bf16 v[72:75], a[200:203], a[40:43], v[72:75]
    ds_read_b64_tr_b16 a[244:245], v219 offset:24584
    v_mfma_f32_16x16x32_bf16 v[104:107], a[200:203], a[44:47], v[104:107]
    ds_read_b64_tr_b16 a[246:247], v219 offset:25608
    v_mfma_f32_16x16x32_bf16 v[12:15], a[204:207], a[32:35], v[12:15]
    ds_read_b64_tr_b16 a[248:249], v220 offset:24576
    v_mfma_f32_16x16x32_bf16 v[44:47], a[204:207], a[36:39], v[44:47]
    ds_read_b64_tr_b16 a[250:251], v220 offset:25600
    s_lshl_b32 s42, s48, 11
    s_add_u32 s43, s42, 0x5000
    s_add_u32 s44, s42, 0xa000
    s_add_u32 s45, s42, 0xf000
    buffer_load_dwordx4 a[96:99], v221, s[20:23], s42 offen offset:0 sc1
    v_mfma_f32_16x16x32_bf16 v[76:79], a[204:207], a[40:43], v[76:79]
    ds_read_b64_tr_b16 a[252:253], v220 offset:24584
    v_mfma_f32_16x16x32_bf16 v[108:111], a[204:207], a[44:47], v[108:111]
    ds_read_b64_tr_b16 a[254:255], v220 offset:25608
    v_mfma_f32_16x16x32_bf16 v[16:19], a[208:211], a[32:35], v[16:19]
    v_mfma_f32_16x16x32_bf16 v[48:51], a[208:211], a[36:39], v[48:51]
    buffer_load_dwordx4 a[100:103], v221, s[20:23], s43 offen offset:0 sc1
    v_mfma_f32_16x16x32_bf16 v[80:83], a[208:211], a[40:43], v[80:83]
    v_mfma_f32_16x16x32_bf16 v[112:115], a[208:211], a[44:47], v[112:115]
    v_mfma_f32_16x16x32_bf16 v[20:23], a[212:215], a[32:35], v[20:23]
    v_mfma_f32_16x16x32_bf16 v[52:55], a[212:215], a[36:39], v[52:55]
    buffer_load_dwordx4 v210, s[16:19], s39 offen offset:1024 lds
    v_mfma_f32_16x16x32_bf16 v[84:87], a[212:215], a[40:43], v[84:87]
    v_mfma_f32_16x16x32_bf16 v[116:119], a[212:215], a[44:47], v[116:119]
    v_mfma_f32_16x16x32_bf16 v[24:27], a[216:219], a[32:35], v[24:27]
    v_mfma_f32_16x16x32_bf16 v[56:59], a[216:219], a[36:39], v[56:59]
    buffer_load_dwordx4 a[104:107], v221, s[20:23], s44 offen offset:0 sc1
    v_mfma_f32_16x16x32_bf16 v[88:91], a[216:219], a[40:43], v[88:91]
    v_mfma_f32_16x16x32_bf16 v[120:123], a[216:219], a[44:47], v[120:123]
    v_mfma_f32_16x16x32_bf16 v[28:31], a[220:223], a[32:35], v[28:31]
    v_mfma_f32_16x16x32_bf16 v[60:63], a[220:223], a[36:39], v[60:63]
    buffer_load_dwordx4 a[108:111], v221, s[20:23], s45 offen offset:0 sc1
    v_mfma_f32_16x16x32_bf16 v[92:95], a[220:223], a[40:43], v[92:95]
    v_mfma_f32_16x16x32_bf16 v[124:127], a[220:223], a[44:47], v[124:127]
    s_waitcnt lgkmcnt(0)
    v_mfma_f32_16x16x32_bf16 v[0:3], a[224:227], a[48:51], v[0:3]
    v_mfma_f32_16x16x32_bf16 v[32:35], a[224:227], a[52:55], v[32:35]
    s_waitcnt vmcnt(6)
    s_barrier
    v_mfma_f32_16x16x32_bf16 v[64:67], a[224:227], a[56:59], v[64:67]
    ds_read_b64_tr_b16 a[192:193], v213 offset:32768
    v_mfma_f32_16x16x32_bf16 v[96:99], a[224:227], a[60:63], v[96:99]
    ds_read_b64_tr_b16 a[194:195], v213 offset:33792
    v_mfma_f32_16x16x32_bf16 v[4:7], a[228:231], a[48:51], v[4:7]
    ds_read_b64_tr_b16 a[196:197], v213 offset:32776
    v_mfma_f32_16x16x32_bf16 v[36:39], a[228:231], a[52:55], v[36:39]
    ds_read_b64_tr_b16 a[198:199], v213 offset:33800
    v_mfma_f32_16x16x32_bf16 v[68:71], a[228:231], a[56:59], v[68:71]
    ds_read_b64_tr_b16 a[200:201], v214 offset:32768
    v_mfma_f32_16x16x32_bf16 v[100:103], a[228:231], a[60:63], v[100:103]
    ds_read_b64_tr_b16 a[202:203], v214 offset:33792
    v_mfma_f32_16x16x32_bf16 v[8:11], a[232:235], a[48:51], v[8:11]
    ds_read_b64_tr_b16 a[204:205], v214 offset:32776
    v_mfma_f32_16x16x32_bf16 v[40:43], a[232:235], a[52:55], v[40:43]
    ds_read_b64_tr_b16 a[206:207], v214 offset:33800
    buffer_load_dwordx4 v211, s[16:19], s39 offen offset:2048 lds
    v_mfma_f32_16x16x32_bf16 v[72:75], a[232:235], a[56:59], v[72:75]
    ds_read_b64_tr_b16 a[208:209], v215 offset:32768
    v_mfma_f32_16x16x32_bf16 v[104:107], a[232:235], a[60:63], v[104:107]
    ds_read_b64_tr_b16 a[210:211], v215 offset:33792
    v_mfma_f32_16x16x32_bf16 v[12:15], a[236:239], a[48:51], v[12:15]
    ds_read_b64_tr_b16 a[212:213], v215 offset:32776
    v_mfma_f32_16x16x32_bf16 v[44:47], a[236:239], a[52:55], v[44:47]
    ds_read_b64_tr_b16 a[214:215], v215 offset:33800
    buffer_load_dwordx4 a[112:115], v221, s[20:23], s42 offen offset:1024 sc1
    v_mfma_f32_16x16x32_bf16 v[76:79], a[236:239], a[56:59], v[76:79]
    ds_read_b64_tr_b16 a[216:217], v216 offset:32768
    v_mfma_f32_16x16x32_bf16 v[108:111], a[236:239], a[60:63], v[108:111]
    ds_read_b64_tr_b16 a[218:219], v216 offset:33792
    v_mfma_f32_16x16x32_bf16 v[16:19], a[240:243], a[48:51], v[16:19]
    ds_read_b64_tr_b16 a[220:221], v216 offset:32776
    v_mfma_f32_16x16x32_bf16 v[48:51], a[240:243], a[52:55], v[48:51]
    ds_read_b64_tr_b16 a[222:223], v216 offset:33800
    buffer_load_dwordx4 a[116:119], v221, s[20:23], s43 offen offset:1024 sc1
    v_mfma_f32_16x16x32_bf16 v[80:83], a[240:243], a[56:59], v[80:83]
    v_mfma_f32_16x16x32_bf16 v[112:115], a[240:243], a[60:63], v[112:115]
    v_mfma_f32_16x16x32_bf16 v[20:23], a[244:247], a[48:51], v[20:23]
    v_mfma_f32_16x16x32_bf16 v[52:55], a[244:247], a[52:55], v[52:55]
    buffer_load_dwordx4 v212, s[16:19], s39 offen offset:3072 lds
    v_mfma_f32_16x16x32_bf16 v[84:87], a[244:247], a[56:59], v[84:87]
    v_mfma_f32_16x16x32_bf16 v[116:119], a[244:247], a[60:63], v[116:119]
    v_mfma_f32_16x16x32_bf16 v[24:27], a[248:251], a[48:51], v[24:27]
    v_mfma_f32_16x16x32_bf16 v[56:59], a[248:251], a[52:55], v[56:59]
    buffer_load_dwordx4 a[120:123], v221, s[20:23], s44 offen offset:1024 sc1
    v_mfma_f32_16x16x32_bf16 v[88:91], a[248:251], a[56:59], v[88:91]
    v_mfma_f32_16x16x32_bf16 v[120:123], a[248:251], a[60:63], v[120:123]
    v_mfma_f32_16x16x32_bf16 v[28:31], a[252:255], a[48:51], v[28:31]
    v_mfma_f32_16x16x32_bf16 v[60:63], a[252:255], a[52:55], v[60:63]
    buffer_load_dwordx4 a[124:127], v221, s[20:23], s45 offen offset:1024 sc1
    s_add_u32 s48, s48, 1
    s_cmp_eq_u32 s48, 10
    s_cselect_b32 s48, 0, s48
    v_mfma_f32_16x16x32_bf16 v[92:95], a[252:255], a[56:59], v[92:95]
    v_mfma_f32_16x16x32_bf16 v[124:127], a[252:255], a[60:63], v[124:127]
    s_waitcnt lgkmcnt(0)
    v_mfma_f32_16x16x32_bf16 v[0:3], a[192:195], a[64:67], v[0:3]
    ds_read_b64_tr_b16 a[224:225], v213 offset:40960
    v_mfma_f32_16x16x32_bf16 v[32:35], a[192:195], a[68:71], v[32:35]
    ds_read_b64_tr_b16 a[226:227], v213 offset:41984
    v_mfma_f32_16x16x32_bf16 v[64:67], a[192:195], a[72:75], v[64:67]
    ds_read_b64_tr_b16 a[228:229], v213 offset:40968
    v_mfma_f32_16x16x32_bf16 v[96:99], a[192:195], a[76:79], v[96:99]
    ds_read_b64_tr_b16 a[230:231], v213 offset:41992
    v_mfma_f32_16x16x32_bf16 v[4:7], a[196:199], a[64:67], v[4:7]
    ds_read_b64_tr_b16 a[232:233], v214 offset:40960
    v_mfma_f32_16x16x32_bf16 v[36:39], a[196:199], a[68:71], v[36:39]
    ds_read_b64_tr_b16 a[234:235], v214 offset:41984
    v_mfma_f32_16x16x32_bf16 v[68:71], a[196:199], a[72:75], v[68:71]
    ds_read_b64_tr_b16 a[236:237], v214 offset:40968
    v_mfma_f32_16x16x32_bf16 v[100:103], a[196:199], a[76:79], v[100:103]
    ds_read_b64_tr_b16 a[238:239], v214 offset:41992
    v_mfma_f32_16x16x32_bf16 v[8:11], a[200:203], a[64:67], v[8:11]
    ds_read_b64_tr_b16 a[240:241], v215 offset:40960
    v_mfma_f32_16x16x32_bf16 v[40:43], a[200:203], a[68:71], v[40:43]
    ds_read_b64_tr_b16 a[242:243], v215 offset:41984
    s_add_u32 m0, s29, 0xc000
    s_lshl_b32 s39, s48, 19
    buffer_load_dwordx4 v209, s[16:19], s39 offen offset:0 lds
    v_mfma_f32_16x16x32_bf16 v[72:75], a[200:203], a[72:75], v[72:75]
    ds_read_b64_tr_b16 a[244:245], v215 offset:40968
    v_mfma_f32_16x16x32_bf16 v[104:107], a[200:203], a[76:79], v[104:107]
    ds_read_b64_tr_b16 a[246:247], v215 offset:41992
    v_mfma_f32_16x16x32_bf16 v[12:15], a[204:207], a[64:67], v[12:15]
    ds_read_b64_tr_b16 a[248:249], v216 offset:40960
    v_mfma_f32_16x16x32_bf16 v[44:47], a[204:207], a[68:71], v[44:47]
    ds_read_b64_tr_b16 a[250:251], v216 offset:41984
    s_lshl_b32 s42, s48, 11
    s_add_u32 s43, s42, 0x5000
    s_add_u32 s44, s42, 0xa000
    s_add_u32 s45, s42, 0xf000
    buffer_load_dwordx4 a[0:3], v221, s[20:23], s42 offen offset:0 sc1
    v_mfma_f32_16x16x32_bf16 v[76:79], a[204:207], a[72:75], v[76:79]
    ds_read_b64_tr_b16 a[252:253], v216 offset:40968
    v_mfma_f32_16x16x32_bf16 v[108:111], a[204:207], a[76:79], v[108:111]
    ds_read_b64_tr_b16 a[254:255], v216 offset:41992
    v_mfma_f32_16x16x32_bf16 v[16:19], a[208:211], a[64:67], v[16:19]
    v_mfma_f32_16x16x32_bf16 v[48:51], a[208:211], a[68:71], v[48:51]
    buffer_load_dwordx4 a[4:7], v221, s[20:23], s43 offen offset:0 sc1
    v_mfma_f32_16x16x32_bf16 v[80:83], a[208:211], a[72:75], v[80:83]
    v_mfma_f32_16x16x32_bf16 v[112:115], a[208:211], a[76:79], v[112:115]
    v_mfma_f32_16x16x32_bf16 v[20:23], a[212:215], a[64:67], v[20:23]
    v_mfma_f32_16x16x32_bf16 v[52:55], a[212:215], a[68:71], v[52:55]
    buffer_load_dwordx4 v210, s[16:19], s39 offen offset:1024 lds
    v_mfma_f32_16x16x32_bf16 v[84:87], a[212:215], a[72:75], v[84:87]
    v_mfma_f32_16x16x32_bf16 v[116:119], a[212:215], a[76:79], v[116:119]
    v_mfma_f32_16x16x32_bf16 v[24:27], a[216:219], a[64:67], v[24:27]
    v_mfma_f32_16x16x32_bf16 v[56:59], a[216:219], a[68:71], v[56:59]
    buffer_load_dwordx4 a[8:11], v221, s[20:23], s44 offen offset:0 sc1
    v_mfma_f32_16x16x32_bf16 v[88:91], a[216:219], a[72:75], v[88:91]
    v_mfma_f32_16x16x32_bf16 v[120:123], a[216:219], a[76:79], v[120:123]
    v_mfma_f32_16x16x32_bf16 v[28:31], a[220:223], a[64:67], v[28:31]
    v_mfma_f32_16x16x32_bf16 v[60:63], a[220:223], a[68:71], v[60:63]
    buffer_load_dwordx4 a[12:15], v221, s[20:23], s45 offen offset:0 sc1
    v_mfma_f32_16x16x32_bf16 v[92:95], a[220:223], a[72:75], v[92:95]
    v_mfma_f32_16x16x32_bf16 v[124:127], a[220:223], a[76:79], v[124:127]
    s_waitcnt lgkmcnt(0)
    v_mfma_f32_16x16x32_bf16 v[0:3], a[224:227], a[80:83], v[0:3]
    v_mfma_f32_16x16x32_bf16 v[32:35], a[224:227], a[84:87], v[32:35]
    s_waitcnt vmcnt(6)
    s_barrier
    v_mfma_f32_16x16x32_bf16 v[64:67], a[224:227], a[88:91], v[64:67]
    ds_read_b64_tr_b16 a[192:193], v217 offset:32768
    v_mfma_f32_16x16x32_bf16 v[96:99], a[224:227], a[92:95], v[96:99]
    ds_read_b64_tr_b16 a[194:195], v217 offset:33792
    v_mfma_f32_16x16x32_bf16 v[4:7], a[228:231], a[80:83], v[4:7]
    ds_read_b64_tr_b16 a[196:197], v217 offset:32776
    v_mfma_f32_16x16x32_bf16 v[36:39], a[228:231], a[84:87], v[36:39]
    ds_read_b64_tr_b16 a[198:199], v217 offset:33800
    v_mfma_f32_16x16x32_bf16 v[68:71], a[228:231], a[88:91], v[68:71]
    ds_read_b64_tr_b16 a[200:201], v218 offset:32768
    v_mfma_f32_16x16x32_bf16 v[100:103], a[228:231], a[92:95], v[100:103]
    ds_read_b64_tr_b16 a[202:203], v218 offset:33792
    v_mfma_f32_16x16x32_bf16 v[8:11], a[232:235], a[80:83], v[8:11]
    ds_read_b64_tr_b16 a[204:205], v218 offset:32776
    v_mfma_f32_16x16x32_bf16 v[40:43], a[232:235], a[84:87], v[40:43]
    ds_read_b64_tr_b16 a[206:207], v218 offset:33800
    buffer_load_dwordx4 v211, s[16:19], s39 offen offset:2048 lds
    v_mfma_f32_16x16x32_bf16 v[72:75], a[232:235], a[88:91], v[72:75]
    ds_read_b64_tr_b16 a[208:209], v219 offset:32768
    v_mfma_f32_16x16x32_bf16 v[104:107], a[232:235], a[92:95], v[104:107]
    ds_read_b64_tr_b16 a[210:211], v219 offset:33792
    v_mfma_f32_16x16x32_bf16 v[12:15], a[236:239], a[80:83], v[12:15]
    ds_read_b64_tr_b16 a[212:213], v219 offset:32776
    v_mfma_f32_16x16x32_bf16 v[44:47], a[236:239], a[84:87], v[44:47]
    ds_read_b64_tr_b16 a[214:215], v219 offset:33800
    buffer_load_dwordx4 a[16:19], v221, s[20:23], s42 offen offset:1024 sc1
    v_mfma_f32_16x16x32_bf16 v[76:79], a[236:239], a[88:91], v[76:79]
    ds_read_b64_tr_b16 a[216:217], v220 offset:32768
    v_mfma_f32_16x16x32_bf16 v[108:111], a[236:239], a[92:95], v[108:111]
    ds_read_b64_tr_b16 a[218:219], v220 offset:33792
    v_mfma_f32_16x16x32_bf16 v[16:19], a[240:243], a[80:83], v[16:19]
    ds_read_b64_tr_b16 a[220:221], v220 offset:32776
    v_mfma_f32_16x16x32_bf16 v[48:51], a[240:243], a[84:87], v[48:51]
    ds_read_b64_tr_b16 a[222:223], v220 offset:33800
    buffer_load_dwordx4 a[20:23], v221, s[20:23], s43 offen offset:1024 sc1
    v_mfma_f32_16x16x32_bf16 v[80:83], a[240:243], a[88:91], v[80:83]
    v_mfma_f32_16x16x32_bf16 v[112:115], a[240:243], a[92:95], v[112:115]
    v_mfma_f32_16x16x32_bf16 v[20:23], a[244:247], a[80:83], v[20:23]
    v_mfma_f32_16x16x32_bf16 v[52:55], a[244:247], a[84:87], v[52:55]
    buffer_load_dwordx4 v212, s[16:19], s39 offen offset:3072 lds
    v_mfma_f32_16x16x32_bf16 v[84:87], a[244:247], a[88:91], v[84:87]
    v_mfma_f32_16x16x32_bf16 v[116:119], a[244:247], a[92:95], v[116:119]
    v_mfma_f32_16x16x32_bf16 v[24:27], a[248:251], a[80:83], v[24:27]
    v_mfma_f32_16x16x32_bf16 v[56:59], a[248:251], a[84:87], v[56:59]
    buffer_load_dwordx4 a[24:27], v221, s[20:23], s44 offen offset:1024 sc1
    v_mfma_f32_16x16x32_bf16 v[88:91], a[248:251], a[88:91], v[88:91]
    v_mfma_f32_16x16x32_bf16 v[120:123], a[248:251], a[92:95], v[120:123]
    v_mfma_f32_16x16x32_bf16 v[28:31], a[252:255], a[80:83], v[28:31]
    v_mfma_f32_16x16x32_bf16 v[60:63], a[252:255], a[84:87], v[60:63]
    buffer_load_dwordx4 a[28:31], v221, s[20:23], s45 offen offset:1024 sc1
    s_add_u32 s48, s48, 1
    s_cmp_eq_u32 s48, 10
    s_cselect_b32 s48, 0, s48
    v_mfma_f32_16x16x32_bf16 v[92:95], a[252:255], a[88:91], v[92:95]
    v_mfma_f32_16x16x32_bf16 v[124:127], a[252:255], a[92:95], v[124:127]
    s_waitcnt lgkmcnt(0)
    v_mfma_f32_16x16x32_bf16 v[0:3], a[192:195], a[96:99], v[0:3]
    ds_read_b64_tr_b16 a[224:225], v217 offset:40960
    v_mfma_f32_16x16x32_bf16 v[32:35], a[192:195], a[100:103], v[32:35]
    ds_read_b64_tr_b16 a[226:227], v217 offset:41984
    v_mfma_f32_16x16x32_bf16 v[64:67], a[192:195], a[104:107], v[64:67]
    ds_read_b64_tr_b16 a[228:229], v217 offset:40968
    v_mfma_f32_16x16x32_bf16 v[96:99], a[192:195], a[108:111], v[96:99]
    ds_read_b64_tr_b16 a[230:231], v217 offset:41992
    v_mfma_f32_16x16x32_bf16 v[4:7], a[196:199], a[96:99], v[4:7]
    ds_read_b64_tr_b16 a[232:233], v218 offset:40960
    v_mfma_f32_16x16x32_bf16 v[36:39], a[196:199], a[100:103], v[36:39]
    ds_read_b64_tr_b16 a[234:235], v218 offset:41984
    v_mfma_f32_16x16x32_bf16 v[68:71], a[196:199], a[104:107], v[68:71]
    ds_read_b64_tr_b16 a[236:237], v218 offset:40968
    v_mfma_f32_16x16x32_bf16 v[100:103], a[196:199], a[108:111], v[100:103]
    ds_read_b64_tr_b16 a[238:239], v218 offset:41992
    v_mfma_f32_16x16x32_bf16 v[8:11], a[200:203], a[96:99], v[8:11]
    ds_read_b64_tr_b16 a[240:241], v219 offset:40960
    v_mfma_f32_16x16x32_bf16 v[40:43], a[200:203], a[100:103], v[40:43]
    ds_read_b64_tr_b16 a[242:243], v219 offset:41984
    s_add_u32 m0, s29, 0x1c000
    s_lshl_b32 s39, s48, 19
    buffer_load_dwordx4 v209, s[16:19], s39 offen offset:0 lds
    v_mfma_f32_16x16x32_bf16 v[72:75], a[200:203], a[104:107], v[72:75]
    ds_read_b64_tr_b16 a[244:245], v219 offset:40968
    v_mfma_f32_16x16x32_bf16 v[104:107], a[200:203], a[108:111], v[104:107]
    ds_read_b64_tr_b16 a[246:247], v219 offset:41992
    v_mfma_f32_16x16x32_bf16 v[12:15], a[204:207], a[96:99], v[12:15]
    ds_read_b64_tr_b16 a[248:249], v220 offset:40960
    v_mfma_f32_16x16x32_bf16 v[44:47], a[204:207], a[100:103], v[44:47]
    ds_read_b64_tr_b16 a[250:251], v220 offset:41984
    s_lshl_b32 s42, s48, 11
    s_add_u32 s43, s42, 0x5000
    s_add_u32 s44, s42, 0xa000
    s_add_u32 s45, s42, 0xf000
    buffer_load_dwordx4 a[32:35], v221, s[20:23], s42 offen offset:0 sc1
    v_mfma_f32_16x16x32_bf16 v[76:79], a[204:207], a[104:107], v[76:79]
    ds_read_b64_tr_b16 a[252:253], v220 offset:40968
    v_mfma_f32_16x16x32_bf16 v[108:111], a[204:207], a[108:111], v[108:111]
    ds_read_b64_tr_b16 a[254:255], v220 offset:41992
    v_mfma_f32_16x16x32_bf16 v[16:19], a[208:211], a[96:99], v[16:19]
    v_mfma_f32_16x16x32_bf16 v[48:51], a[208:211], a[100:103], v[48:51]
    buffer_load_dwordx4 a[36:39], v221, s[20:23], s43 offen offset:0 sc1
    v_mfma_f32_16x16x32_bf16 v[80:83], a[208:211], a[104:107], v[80:83]
    v_mfma_f32_16x16x32_bf16 v[112:115], a[208:211], a[108:111], v[112:115]
    v_mfma_f32_16x16x32_bf16 v[20:23], a[212:215], a[96:99], v[20:23]
    v_mfma_f32_16x16x32_bf16 v[52:55], a[212:215], a[100:103], v[52:55]
    buffer_load_dwordx4 v210, s[16:19], s39 offen offset:1024 lds
    v_mfma_f32_16x16x32_bf16 v[84:87], a[212:215], a[104:107], v[84:87]
    v_mfma_f32_16x16x32_bf16 v[116:119], a[212:215], a[108:111], v[116:119]
    v_mfma_f32_16x16x32_bf16 v[24:27], a[216:219], a[96:99], v[24:27]
    v_mfma_f32_16x16x32_bf16 v[56:59], a[216:219], a[100:103], v[56:59]
    buffer_load_dwordx4 a[40:43], v221, s[20:23], s44 offen offset:0 sc1
    v_mfma_f32_16x16x32_bf16 v[88:91], a[216:219], a[104:107], v[88:91]
    v_mfma_f32_16x16x32_bf16 v[120:123], a[216:219], a[108:111], v[120:123]
    v_mfma_f32_16x16x32_bf16 v[28:31], a[220:223], a[96:99], v[28:31]
    v_mfma_f32_16x16x32_bf16 v[60:63], a[220:223], a[100:103], v[60:63]
    buffer_load_dwordx4 a[44:47], v221, s[20:23], s45 offen offset:0 sc1
    v_mfma_f32_16x16x32_bf16 v[92:95], a[220:223], a[104:107], v[92:95]
    v_mfma_f32_16x16x32_bf16 v[124:127], a[220:223], a[108:111], v[124:127]
    s_waitcnt lgkmcnt(0)
    v_mfma_f32_16x16x32_bf16 v[0:3], a[224:227], a[112:115], v[0:3]
    v_mfma_f32_16x16x32_bf16 v[32:35], a[224:227], a[116:119], v[32:35]
    s_waitcnt vmcnt(6)
    s_barrier
    v_mfma_f32_16x16x32_bf16 v[64:67], a[224:227], a[120:123], v[64:67]
    ds_read_b64_tr_b16 a[192:193], v213 offset:49152
    v_mfma_f32_16x16x32_bf16 v[96:99], a[224:227], a[124:127], v[96:99]
    ds_read_b64_tr_b16 a[194:195], v213 offset:50176
    v_mfma_f32_16x16x32_bf16 v[4:7], a[228:231], a[112:115], v[4:7]
    ds_read_b64_tr_b16 a[196:197], v213 offset:49160
    v_mfma_f32_16x16x32_bf16 v[36:39], a[228:231], a[116:119], v[36:39]
    ds_read_b64_tr_b16 a[198:199], v213 offset:50184
    v_mfma_f32_16x16x32_bf16 v[68:71], a[228:231], a[120:123], v[68:71]
    ds_read_b64_tr_b16 a[200:201], v214 offset:49152
    v_mfma_f32_16x16x32_bf16 v[100:103], a[228:231], a[124:127], v[100:103]
    ds_read_b64_tr_b16 a[202:203], v214 offset:50176
    v_mfma_f32_16x16x32_bf16 v[8:11], a[232:235], a[112:115], v[8:11]
    ds_read_b64_tr_b16 a[204:205], v214 offset:49160
    v_mfma_f32_16x16x32_bf16 v[40:43], a[232:235], a[116:119], v[40:43]
    ds_read_b64_tr_b16 a[206:207], v214 offset:50184
    buffer_load_dwordx4 v211, s[16:19], s39 offen offset:2048 lds
    v_mfma_f32_16x16x32_bf16 v[72:75], a[232:235], a[120:123], v[72:75]
    ds_read_b64_tr_b16 a[208:209], v215 offset:49152
    v_mfma_f32_16x16x32_bf16 v[104:107], a[232:235], a[124:127], v[104:107]
    ds_read_b64_tr_b16 a[210:211], v215 offset:50176
    v_mfma_f32_16x16x32_bf16 v[12:15], a[236:239], a[112:115], v[12:15]
    ds_read_b64_tr_b16 a[212:213], v215 offset:49160
    v_mfma_f32_16x16x32_bf16 v[44:47], a[236:239], a[116:119], v[44:47]
    ds_read_b64_tr_b16 a[214:215], v215 offset:50184
    buffer_load_dwordx4 a[48:51], v221, s[20:23], s42 offen offset:1024 sc1
    v_mfma_f32_16x16x32_bf16 v[76:79], a[236:239], a[120:123], v[76:79]
    ds_read_b64_tr_b16 a[216:217], v216 offset:49152
    v_mfma_f32_16x16x32_bf16 v[108:111], a[236:239], a[124:127], v[108:111]
    ds_read_b64_tr_b16 a[218:219], v216 offset:50176
    v_mfma_f32_16x16x32_bf16 v[16:19], a[240:243], a[112:115], v[16:19]
    ds_read_b64_tr_b16 a[220:221], v216 offset:49160
    v_mfma_f32_16x16x32_bf16 v[48:51], a[240:243], a[116:119], v[48:51]
    ds_read_b64_tr_b16 a[222:223], v216 offset:50184
    buffer_load_dwordx4 a[52:55], v221, s[20:23], s43 offen offset:1024 sc1
    v_mfma_f32_16x16x32_bf16 v[80:83], a[240:243], a[120:123], v[80:83]
    v_mfma_f32_16x16x32_bf16 v[112:115], a[240:243], a[124:127], v[112:115]
    v_mfma_f32_16x16x32_bf16 v[20:23], a[244:247], a[112:115], v[20:23]
    v_mfma_f32_16x16x32_bf16 v[52:55], a[244:247], a[116:119], v[52:55]
    buffer_load_dwordx4 v212, s[16:19], s39 offen offset:3072 lds
    v_mfma_f32_16x16x32_bf16 v[84:87], a[244:247], a[120:123], v[84:87]
    v_mfma_f32_16x16x32_bf16 v[116:119], a[244:247], a[124:127], v[116:119]
    v_mfma_f32_16x16x32_bf16 v[24:27], a[248:251], a[112:115], v[24:27]
    v_mfma_f32_16x16x32_bf16 v[56:59], a[248:251], a[116:119], v[56:59]
    buffer_load_dwordx4 a[56:59], v221, s[20:23], s44 offen offset:1024 sc1
    v_mfma_f32_16x16x32_bf16 v[88:91], a[248:251], a[120:123], v[88:91]
    v_mfma_f32_16x16x32_bf16 v[120:123], a[248:251], a[124:127], v[120:123]
    v_mfma_f32_16x16x32_bf16 v[28:31], a[252:255], a[112:115], v[28:31]
    v_mfma_f32_16x16x32_bf16 v[60:63], a[252:255], a[116:119], v[60:63]
    buffer_load_dwordx4 a[60:63], v221, s[20:23], s45 offen offset:1024 sc1
    s_add_u32 s48, s48, 1
    s_cmp_eq_u32 s48, 10
    s_cselect_b32 s48, 0, s48
    v_mfma_f32_16x16x32_bf16 v[92:95], a[252:255], a[120:123], v[92:95]
    v_mfma_f32_16x16x32_bf16 v[124:127], a[252:255], a[124:127], v[124:127]
    s_waitcnt lgkmcnt(0)
    v_mfma_f32_16x16x32_bf16 v[0:3], a[192:195], a[0:3], v[0:3]
    ds_read_b64_tr_b16 a[224:225], v213 offset:57344
    v_mfma_f32_16x16x32_bf16 v[32:35], a[192:195], a[4:7], v[32:35]
    ds_read_b64_tr_b16 a[226:227], v213 offset:58368
    v_mfma_f32_16x16x32_bf16 v[64:67], a[192:195], a[8:11], v[64:67]
    ds_read_b64_tr_b16 a[228:229], v213 offset:57352
    v_mfma_f32_16x16x32_bf16 v[96:99], a[192:195], a[12:15], v[96:99]
    ds_read_b64_tr_b16 a[230:231], v213 offset:58376
    v_mfma_f32_16x16x32_bf16 v[4:7], a[196:199], a[0:3], v[4:7]
    ds_read_b64_tr_b16 a[232:233], v214 offset:57344
    v_mfma_f32_16x16x32_bf16 v[36:39], a[196:199], a[4:7], v[36:39]
    ds_read_b64_tr_b16 a[234:235], v214 offset:58368
    v_mfma_f32_16x16x32_bf16 v[68:71], a[196:199], a[8:11], v[68:71]
    ds_read_b64_tr_b16 a[236:237], v214 offset:57352
    v_mfma_f32_16x16x32_bf16 v[100:103], a[196:199], a[12:15], v[100:103]
    ds_read_b64_tr_b16 a[238:239], v214 offset:58376
    v_mfma_f32_16x16x32_bf16 v[8:11], a[200:203], a[0:3], v[8:11]
    ds_read_b64_tr_b16 a[240:241], v215 offset:57344
    v_mfma_f32_16x16x32_bf16 v[40:43], a[200:203], a[4:7], v[40:43]
    ds_read_b64_tr_b16 a[242:243], v215 offset:58368
    s_add_u32 m0, s29, 0x0
    s_nop 0
    buffer_load_dwordx4 v204, s[8:11], s32 offen offset:0 lds
    v_mfma_f32_16x16x32_bf16 v[72:75], a[200:203], a[8:11], v[72:75]
    ds_read_b64_tr_b16 a[244:245], v215 offset:57352
    v_mfma_f32_16x16x32_bf16 v[104:107], a[200:203], a[12:15], v[104:107]
    ds_read_b64_tr_b16 a[246:247], v215 offset:58376
    v_mfma_f32_16x16x32_bf16 v[12:15], a[204:207], a[0:3], v[12:15]
    ds_read_b64_tr_b16 a[248:249], v216 offset:57344
    v_mfma_f32_16x16x32_bf16 v[44:47], a[204:207], a[4:7], v[44:47]
    ds_read_b64_tr_b16 a[250:251], v216 offset:58368
    buffer_load_dwordx4 v205, s[8:11], s32 offen offset:1024 lds
    v_mfma_f32_16x16x32_bf16 v[76:79], a[204:207], a[8:11], v[76:79]
    ds_read_b64_tr_b16 a[252:253], v216 offset:57352
    v_mfma_f32_16x16x32_bf16 v[108:111], a[204:207], a[12:15], v[108:111]
    ds_read_b64_tr_b16 a[254:255], v216 offset:58376
    v_mfma_f32_16x16x32_bf16 v[16:19], a[208:211], a[0:3], v[16:19]
    v_mfma_f32_16x16x32_bf16 v[48:51], a[208:211], a[4:7], v[48:51]
    buffer_load_dwordx4 v206, s[8:11], s32 offen offset:2048 lds
    v_mfma_f32_16x16x32_bf16 v[80:83], a[208:211], a[8:11], v[80:83]
    v_mfma_f32_16x16x32_bf16 v[112:115], a[208:211], a[12:15], v[112:115]
    v_mfma_f32_16x16x32_bf16 v[20:23], a[212:215], a[0:3], v[20:23]
    v_mfma_f32_16x16x32_bf16 v[52:55], a[212:215], a[4:7], v[52:55]
    buffer_load_dwordx4 v207, s[8:11], s32 offen offset:3072 lds
    s_add_u32 s32, s32, 0x4000
    v_mfma_f32_16x16x32_bf16 v[84:87], a[212:215], a[8:11], v[84:87]
    v_mfma_f32_16x16x32_bf16 v[116:119], a[212:215], a[12:15], v[116:119]
    v_mfma_f32_16x16x32_bf16 v[24:27], a[216:219], a[0:3], v[24:27]
    v_mfma_f32_16x16x32_bf16 v[56:59], a[216:219], a[4:7], v[56:59]
    s_add_u32 m0, s29, 0x10000
    s_nop 0
    buffer_load_dwordx4 v208, s[12:15], s33 offen offset:0 lds
    v_mfma_f32_16x16x32_bf16 v[88:91], a[216:219], a[8:11], v[88:91]
    v_mfma_f32_16x16x32_bf16 v[120:123], a[216:219], a[12:15], v[120:123]
    v_mfma_f32_16x16x32_bf16 v[28:31], a[220:223], a[0:3], v[28:31]
    v_mfma_f32_16x16x32_bf16 v[60:63], a[220:223], a[4:7], v[60:63]
    buffer_load_dwordx4 v242, s[12:15], s33 offen offset:1024 lds
    v_mfma_f32_16x16x32_bf16 v[92:95], a[220:223], a[8:11], v[92:95]
    v_mfma_f32_16x16x32_bf16 v[124:127], a[220:223], a[12:15], v[124:127]
    s_waitcnt lgkmcnt(0)
    v_mfma_f32_16x16x32_bf16 v[0:3], a[224:227], a[16:19], v[0:3]
    v_mfma_f32_16x16x32_bf16 v[32:35], a[224:227], a[20:23], v[32:35]
    s_waitcnt vmcnt(6)
    s_barrier
    v_mfma_f32_16x16x32_bf16 v[64:67], a[224:227], a[24:27], v[64:67]
    ds_read_b64_tr_b16 a[192:193], v217 offset:49152
    v_mfma_f32_16x16x32_bf16 v[96:99], a[224:227], a[28:31], v[96:99]
    ds_read_b64_tr_b16 a[194:195], v217 offset:50176
    v_mfma_f32_16x16x32_bf16 v[4:7], a[228:231], a[16:19], v[4:7]
    ds_read_b64_tr_b16 a[196:197], v217 offset:49160
    v_mfma_f32_16x16x32_bf16 v[36:39], a[228:231], a[20:23], v[36:39]
    ds_read_b64_tr_b16 a[198:199], v217 offset:50184
    v_mfma_f32_16x16x32_bf16 v[68:71], a[228:231], a[24:27], v[68:71]
    ds_read_b64_tr_b16 a[200:201], v218 offset:49152
    v_mfma_f32_16x16x32_bf16 v[100:103], a[228:231], a[28:31], v[100:103]
    ds_read_b64_tr_b16 a[202:203], v218 offset:50176
    v_mfma_f32_16x16x32_bf16 v[8:11], a[232:235], a[16:19], v[8:11]
    ds_read_b64_tr_b16 a[204:205], v218 offset:49160
    v_mfma_f32_16x16x32_bf16 v[40:43], a[232:235], a[20:23], v[40:43]
    ds_read_b64_tr_b16 a[206:207], v218 offset:50184
    buffer_load_dwordx4 v208, s[12:15], s33 offen offset:2048 lds
    v_mfma_f32_16x16x32_bf16 v[72:75], a[232:235], a[24:27], v[72:75]
    ds_read_b64_tr_b16 a[208:209], v219 offset:49152
    v_mfma_f32_16x16x32_bf16 v[104:107], a[232:235], a[28:31], v[104:107]
    ds_read_b64_tr_b16 a[210:211], v219 offset:50176
    v_mfma_f32_16x16x32_bf16 v[12:15], a[236:239], a[16:19], v[12:15]
    ds_read_b64_tr_b16 a[212:213], v219 offset:49160
    v_mfma_f32_16x16x32_bf16 v[44:47], a[236:239], a[20:23], v[44:47]
    ds_read_b64_tr_b16 a[214:215], v219 offset:50184
    buffer_load_dwordx4 v242, s[12:15], s33 offen offset:3072 lds
    s_add_u32 s33, s33, 0x4000
    v_mfma_f32_16x16x32_bf16 v[76:79], a[236:239], a[24:27], v[76:79]
    ds_read_b64_tr_b16 a[216:217], v220 offset:49152
    v_mfma_f32_16x16x32_bf16 v[108:111], a[236:239], a[28:31], v[108:111]
    ds_read_b64_tr_b16 a[218:219], v220 offset:50176
    v_mfma_f32_16x16x32_bf16 v[16:19], a[240:243], a[16:19], v[16:19]
    ds_read_b64_tr_b16 a[220:221], v220 offset:49160
    v_mfma_f32_16x16x32_bf16 v[48:51], a[240:243], a[20:23], v[48:51]
    ds_read_b64_tr_b16 a[222:223], v220 offset:50184
    s_add_u32 m0, s29, 0x4000
    s_nop 0
    buffer_load_dwordx4 v204, s[8:11], s32 offen offset:0 lds
    v_mfma_f32_16x16x32_bf16 v[80:83], a[240:243], a[24:27], v[80:83]
    v_mfma_f32_16x16x32_bf16 v[112:115], a[240:243], a[28:31], v[112:115]
    v_mfma_f32_16x16x32_bf16 v[20:23], a[244:247], a[16:19], v[20:23]
    v_mfma_f32_16x16x32_bf16 v[52:55], a[244:247], a[20:23], v[52:55]
    buffer_load_dwordx4 v205, s[8:11], s32 offen offset:1024 lds
    v_mfma_f32_16x16x32_bf16 v[84:87], a[244:247], a[24:27], v[84:87]
    v_mfma_f32_16x16x32_bf16 v[116:119], a[244:247], a[28:31], v[116:119]
    v_mfma_f32_16x16x32_bf16 v[24:27], a[248:251], a[16:19], v[24:27]
    v_mfma_f32_16x16x32_bf16 v[56:59], a[248:251], a[20:23], v[56:59]
    buffer_load_dwordx4 v206, s[8:11], s32 offen offset:2048 lds
    v_mfma_f32_16x16x32_bf16 v[88:91], a[248:251], a[24:27], v[88:91]
    v_mfma_f32_16x16x32_bf16 v[120:123], a[248:251], a[28:31], v[120:123]
    v_mfma_f32_16x16x32_bf16 v[28:31], a[252:255], a[16:19], v[28:31]
    v_mfma_f32_16x16x32_bf16 v[60:63], a[252:255], a[20:23], v[60:63]
    buffer_load_dwordx4 v207, s[8:11], s32 offen offset:3072 lds
    s_add_u32 s32, s32, 0x4000
    v_mfma_f32_16x16x32_bf16 v[92:95], a[252:255], a[24:27], v[92:95]
    v_mfma_f32_16x16x32_bf16 v[124:127], a[252:255], a[28:31], v[124:127]
    s_waitcnt lgkmcnt(0)
    v_mfma_f32_16x16x32_bf16 v[0:3], a[192:195], a[32:35], v[0:3]
    ds_read_b64_tr_b16 a[224:225], v217 offset:57344
    v_mfma_f32_16x16x32_bf16 v[32:35], a[192:195], a[36:39], v[32:35]
    ds_read_b64_tr_b16 a[226:227], v217 offset:58368
    v_mfma_f32_16x16x32_bf16 v[64:67], a[192:195], a[40:43], v[64:67]
    ds_read_b64_tr_b16 a[228:229], v217 offset:57352
    v_mfma_f32_16x16x32_bf16 v[96:99], a[192:195], a[44:47], v[96:99]
    ds_read_b64_tr_b16 a[230:231], v217 offset:58376
    v_mfma_f32_16x16x32_bf16 v[4:7], a[196:199], a[32:35], v[4:7]
    ds_read_b64_tr_b16 a[232:233], v218 offset:57344
    v_mfma_f32_16x16x32_bf16 v[36:39], a[196:199], a[36:39], v[36:39]
    ds_read_b64_tr_b16 a[234:235], v218 offset:58368
    v_mfma_f32_16x16x32_bf16 v[68:71], a[196:199], a[40:43], v[68:71]
    ds_read_b64_tr_b16 a[236:237], v218 offset:57352
    v_mfma_f32_16x16x32_bf16 v[100:103], a[196:199], a[44:47], v[100:103]
    ds_read_b64_tr_b16 a[238:239], v218 offset:58376
    v_mfma_f32_16x16x32_bf16 v[8:11], a[200:203], a[32:35], v[8:11]
    ds_read_b64_tr_b16 a[240:241], v219 offset:57344
    v_mfma_f32_16x16x32_bf16 v[40:43], a[200:203], a[36:39], v[40:43]
    ds_read_b64_tr_b16 a[242:243], v219 offset:58368
    s_add_u32 m0, s29, 0x14000
    s_nop 0
    buffer_load_dwordx4 v208, s[12:15], s33 offen offset:0 lds
    v_mfma_f32_16x16x32_bf16 v[72:75], a[200:203], a[40:43], v[72:75]
    ds_read_b64_tr_b16 a[244:245], v219 offset:57352
    v_mfma_f32_16x16x32_bf16 v[104:107], a[200:203], a[44:47], v[104:107]
    ds_read_b64_tr_b16 a[246:247], v219 offset:58376
    v_mfma_f32_16x16x32_bf16 v[12:15], a[204:207], a[32:35], v[12:15]
    ds_read_b64_tr_b16 a[248:249], v220 offset:57344
    v_mfma_f32_16x16x32_bf16 v[44:47], a[204:207], a[36:39], v[44:47]
    ds_read_b64_tr_b16 a[250:251], v220 offset:58368
    buffer_load_dwordx4 v242, s[12:15], s33 offen offset:1024 lds
    v_mfma_f32_16x16x32_bf16 v[76:79], a[204:207], a[40:43], v[76:79]
    ds_read_b64_tr_b16 a[252:253], v220 offset:57352
    v_mfma_f32_16x16x32_bf16 v[108:111], a[204:207], a[44:47], v[108:111]
    ds_read_b64_tr_b16 a[254:255], v220 offset:58376
    v_mfma_f32_16x16x32_bf16 v[16:19], a[208:211], a[32:35], v[16:19]
    v_mfma_f32_16x16x32_bf16 v[48:51], a[208:211], a[36:39], v[48:51]
    buffer_load_dwordx4 v208, s[12:15], s33 offen offset:2048 lds
    v_mfma_f32_16x16x32_bf16 v[80:83], a[208:211], a[40:43], v[80:83]
    v_mfma_f32_16x16x32_bf16 v[112:115], a[208:211], a[44:47], v[112:115]
    v_mfma_f32_16x16x32_bf16 v[20:23], a[212:215], a[32:35], v[20:23]
    v_mfma_f32_16x16x32_bf16 v[52:55], a[212:215], a[36:39], v[52:55]
    buffer_load_dwordx4 v242, s[12:15], s33 offen offset:3072 lds
    s_add_u32 s33, s33, 0x4000
    v_mfma_f32_16x16x32_bf16 v[84:87], a[212:215], a[40:43], v[84:87]
    v_mfma_f32_16x16x32_bf16 v[116:119], a[212:215], a[44:47], v[116:119]
    v_mfma_f32_16x16x32_bf16 v[24:27], a[216:219], a[32:35], v[24:27]
    v_mfma_f32_16x16x32_bf16 v[56:59], a[216:219], a[36:39], v[56:59]
    s_add_u32 m0, s29, 0x8000
    s_nop 0
    buffer_load_dwordx4 v204, s[8:11], s32 offen offset:0 lds
    v_mfma_f32_16x16x32_bf16 v[88:91], a[216:219], a[40:43], v[88:91]
    v_mfma_f32_16x16x32_bf16 v[120:123], a[216:219], a[44:47], v[120:123]
    v_mfma_f32_16x16x32_bf16 v[28:31], a[220:223], a[32:35], v[28:31]
    v_mfma_f32_16x16x32_bf16 v[60:63], a[220:223], a[36:39], v[60:63]
    buffer_load_dwordx4 v205, s[8:11], s32 offen offset:1024 lds
    v_mfma_f32_16x16x32_bf16 v[92:95], a[220:223], a[40:43], v[92:95]
    v_mfma_f32_16x16x32_bf16 v[124:127], a[220:223], a[44:47], v[124:127]
    s_waitcnt lgkmcnt(0)
    v_mfma_f32_16x16x32_bf16 v[0:3], a[224:227], a[48:51], v[0:3]
    v_mfma_f32_16x16x32_bf16 v[4:7], a[228:231], a[48:51], v[4:7]
    v_mfma_f32_16x16x32_bf16 v[8:11], a[232:235], a[48:51], v[8:11]
    v_mfma_f32_16x16x32_bf16 v[12:15], a[236:239], a[48:51], v[12:15]
    v_mfma_f32_16x16x32_bf16 v[16:19], a[240:243], a[48:51], v[16:19]
    v_mfma_f32_16x16x32_bf16 v[20:23], a[244:247], a[48:51], v[20:23]
    v_mfma_f32_16x16x32_bf16 v[24:27], a[248:251], a[48:51], v[24:27]
    v_mfma_f32_16x16x32_bf16 v[28:31], a[252:255], a[48:51], v[28:31]
    v_mfma_f32_16x16x32_bf16 v[32:35], a[224:227], a[52:55], v[32:35]
    v_mfma_f32_16x16x32_bf16 v[36:39], a[228:231], a[52:55], v[36:39]
    buffer_load_dwordx4 v206, s[8:11], s32 offen offset:2048 lds
    v_pk_mul_f32 v[0:1], v[0:1], s[36:37]
    v_cvt_pk_bf16_f32 v0, v0, v1
    v_mfma_f32_16x16x32_bf16 v[40:43], a[232:235], a[52:55], v[40:43]
    v_pk_mul_f32 v[2:3], v[2:3], s[36:37]
    v_cvt_pk_bf16_f32 v1, v2, v3
    v_mfma_f32_16x16x32_bf16 v[44:47], a[236:239], a[52:55], v[44:47]
    v_pk_mul_f32 v[4:5], v[4:5], s[36:37]
    v_cvt_pk_bf16_f32 v2, v4, v5
    v_mfma_f32_16x16x32_bf16 v[48:51], a[240:243], a[52:55], v[48:51]
    v_pk_mul_f32 v[6:7], v[6:7], s[36:37]
    v_cvt_pk_bf16_f32 v3, v6, v7
    v_mfma_f32_16x16x32_bf16 v[52:55], a[244:247], a[52:55], v[52:55]
    buffer_load_dwordx4 v207, s[8:11], s32 offen offset:3072 lds
    s_add_u32 s32, s32, 0x4000
    v_pk_mul_f32 v[8:9], v[8:9], s[36:37]
    v_cvt_pk_bf16_f32 v4, v8, v9
    v_mfma_f32_16x16x32_bf16 v[56:59], a[248:251], a[52:55], v[56:59]
    v_pk_mul_f32 v[10:11], v[10:11], s[36:37]
    v_cvt_pk_bf16_f32 v5, v10, v11
    v_mfma_f32_16x16x32_bf16 v[60:63], a[252:255], a[52:55], v[60:63]
    v_pk_mul_f32 v[12:13], v[12:13], s[36:37]
    v_cvt_pk_bf16_f32 v6, v12, v13
    v_mfma_f32_16x16x32_bf16 v[64:67], a[224:227], a[56:59], v[64:67]
    v_pk_mul_f32 v[14:15], v[14:15], s[36:37]
    v_cvt_pk_bf16_f32 v7, v14, v15
    v_mfma_f32_16x16x32_bf16 v[68:71], a[228:231], a[56:59], v[68:71]
    s_add_u32 m0, s29, 0x18000
    s_nop 0
    buffer_load_dwordx4 v208, s[12:15], s33 offen offset:0 lds
    v_pk_mul_f32 v[16:17], v[16:17], s[36:37]
    v_cvt_pk_bf16_f32 v8, v16, v17
    v_mfma_f32_16x16x32_bf16 v[72:75], a[232:235], a[56:59], v[72:75]
    v_pk_mul_f32 v[18:19], v[18:19], s[36:37]
    v_cvt_pk_bf16_f32 v9, v18, v19
    v_mfma_f32_16x16x32_bf16 v[76:79], a[236:239], a[56:59], v[76:79]
    v_pk_mul_f32 v[20:21], v[20:21], s[36:37]
    v_cvt_pk_bf16_f32 v10, v20, v21
    v_mfma_f32_16x16x32_bf16 v[80:83], a[240:243], a[56:59], v[80:83]
    v_pk_mul_f32 v[22:23], v[22:23], s[36:37]
    v_cvt_pk_bf16_f32 v11, v22, v23
    v_mfma_f32_16x16x32_bf16 v[84:87], a[244:247], a[56:59], v[84:87]
    buffer_load_dwordx4 v242, s[12:15], s33 offen offset:1024 lds
    v_pk_mul_f32 v[24:25], v[24:25], s[36:37]
    v_cvt_pk_bf16_f32 v12, v24, v25
    v_mfma_f32_16x16x32_bf16 v[88:91], a[248:251], a[56:59], v[88:91]
    v_pk_mul_f32 v[26:27], v[26:27], s[36:37]
    v_cvt_pk_bf16_f32 v13, v26, v27
    v_mfma_f32_16x16x32_bf16 v[92:95], a[252:255], a[56:59], v[92:95]
    v_pk_mul_f32 v[28:29], v[28:29], s[36:37]
    v_cvt_pk_bf16_f32 v14, v28, v29
    v_mfma_f32_16x16x32_bf16 v[96:99], a[224:227], a[60:63], v[96:99]
    v_pk_mul_f32 v[30:31], v[30:31], s[36:37]
    v_cvt_pk_bf16_f32 v15, v30, v31
    v_mfma_f32_16x16x32_bf16 v[100:103], a[228:231], a[60:63], v[100:103]
    buffer_load_dwordx4 v208, s[12:15], s33 offen offset:2048 lds
    v_pk_mul_f32 v[32:33], v[32:33], s[36:37]
    v_cvt_pk_bf16_f32 v16, v32, v33
    v_mfma_f32_16x16x32_bf16 v[104:107], a[232:235], a[60:63], v[104:107]
    v_pk_mul_f32 v[34:35], v[34:35], s[36:37]
    v_cvt_pk_bf16_f32 v17, v34, v35
    v_mfma_f32_16x16x32_bf16 v[108:111], a[236:239], a[60:63], v[108:111]
    v_pk_mul_f32 v[36:37], v[36:37], s[36:37]
    v_cvt_pk_bf16_f32 v18, v36, v37
    v_mfma_f32_16x16x32_bf16 v[112:115], a[240:243], a[60:63], v[112:115]
    v_pk_mul_f32 v[38:39], v[38:39], s[36:37]
    v_cvt_pk_bf16_f32 v19, v38, v39
    v_mfma_f32_16x16x32_bf16 v[116:119], a[244:247], a[60:63], v[116:119]
    buffer_load_dwordx4 v242, s[12:15], s33 offen offset:3072 lds
    s_add_u32 s33, s33, 0x4000
    v_pk_mul_f32 v[40:41], v[40:41], s[36:37]
    v_cvt_pk_bf16_f32 v20, v40, v41
    v_mfma_f32_16x16x32_bf16 v[120:123], a[248:251], a[60:63], v[120:123]
    v_pk_mul_f32 v[42:43], v[42:43], s[36:37]
    v_cvt_pk_bf16_f32 v21, v42, v43
    v_mfma_f32_16x16x32_bf16 v[124:127], a[252:255], a[60:63], v[124:127]
    v_pk_mul_f32 v[44:45], v[44:45], s[36:37]
    v_cvt_pk_bf16_f32 v22, v44, v45
    s_add_u32 m0, s29, 0xc000
    s_nop 0
    buffer_load_dwordx4 v204, s[8:11], s32 offen offset:0 lds
    buffer_load_dwordx4 v205, s[8:11], s32 offen offset:1024 lds
    buffer_load_dwordx4 v206, s[8:11], s32 offen offset:2048 lds
    buffer_load_dwordx4 v207, s[8:11], s32 offen offset:3072 lds
    s_add_u32 s32, s32, 0x4000
    s_waitcnt vmcnt(24)
    s_barrier
    ds_read_b128 a[128:131], v192 offset:0
    ds_read_b128 a[132:135], v193 offset:0
    ds_read_b128 a[136:139], v194 offset:0
    ds_read_b128 a[140:143], v195 offset:0
    ds_read_b128 a[144:147], v192 offset:4096
    ds_read_b128 a[148:151], v193 offset:4096
    ds_read_b128 a[152:155], v194 offset:4096
    ds_read_b128 a[156:159], v195 offset:4096
    s_nop 7
    v_pk_mul_f32 v[46:47], v[46:47], s[36:37]
    v_pk_mul_f32 v[48:49], v[48:49], s[36:37]
    v_cvt_pk_bf16_f32 v23, v46, v47
    v_pk_mul_f32 v[50:51], v[50:51], s[36:37]
    v_cvt_pk_bf16_f32 v24, v48, v49
    v_pk_mul_f32 v[52:53], v[52:53], s[36:37]
    v_cvt_pk_bf16_f32 v25, v50, v51
    v_pk_mul_f32 v[54:55], v[54:55], s[36:37]
    v_cvt_pk_bf16_f32 v26, v52, v53
    v_pk_mul_f32 v[56:57], v[56:57], s[36:37]
    v_cvt_pk_bf16_f32 v27, v54, v55
    v_pk_mul_f32 v[58:59], v[58:59], s[36:37]
    v_cvt_pk_bf16_f32 v28, v56, v57
    v_pk_mul_f32 v[60:61], v[60:61], s[36:37]
    v_cvt_pk_bf16_f32 v29, v58, v59
    v_pk_mul_f32 v[62:63], v[62:63], s[36:37]
    v_cvt_pk_bf16_f32 v30, v60, v61
    v_pk_mul_f32 v[64:65], v[64:65], s[36:37]
    v_cvt_pk_bf16_f32 v31, v62, v63
    v_pk_mul_f32 v[66:67], v[66:67], s[36:37]
    v_cvt_pk_bf16_f32 v32, v64, v65
    v_pk_mul_f32 v[68:69], v[68:69], s[36:37]
    v_cvt_pk_bf16_f32 v33, v66, v67
    v_pk_mul_f32 v[70:71], v[70:71], s[36:37]
    v_cvt_pk_bf16_f32 v34, v68, v69
    v_pk_mul_f32 v[72:73], v[72:73], s[36:37]
    v_cvt_pk_bf16_f32 v35, v70, v71
    v_pk_mul_f32 v[74:75], v[74:75], s[36:37]
    v_cvt_pk_bf16_f32 v36, v72, v73
    v_pk_mul_f32 v[76:77], v[76:77], s[36:37]
    v_cvt_pk_bf16_f32 v37, v74, v75
    v_pk_mul_f32 v[78:79], v[78:79], s[36:37]
    v_cvt_pk_bf16_f32 v38, v76, v77
    v_pk_mul_f32 v[80:81], v[80:81], s[36:37]
    v_cvt_pk_bf16_f32 v39, v78, v79
    v_pk_mul_f32 v[82:83], v[82:83], s[36:37]
    v_cvt_pk_bf16_f32 v40, v80, v81
    v_pk_mul_f32 v[84:85], v[84:85], s[36:37]
    v_cvt_pk_bf16_f32 v41, v82, v83
    v_pk_mul_f32 v[86:87], v[86:87], s[36:37]
    v_cvt_pk_bf16_f32 v42, v84, v85
    v_pk_mul_f32 v[88:89], v[88:89], s[36:37]
    v_cvt_pk_bf16_f32 v43, v86, v87
    v_pk_mul_f32 v[90:91], v[90:91], s[36:37]
    v_cvt_pk_bf16_f32 v44, v88, v89
    v_pk_mul_f32 v[92:93], v[92:93], s[36:37]
    v_cvt_pk_bf16_f32 v45, v90, v91
    v_pk_mul_f32 v[94:95], v[94:95], s[36:37]
    v_cvt_pk_bf16_f32 v46, v92, v93
    v_pk_mul_f32 v[96:97], v[96:97], s[36:37]
    v_cvt_pk_bf16_f32 v47, v94, v95
    v_pk_mul_f32 v[98:99], v[98:99], s[36:37]
    v_cvt_pk_bf16_f32 v48, v96, v97
    v_pk_mul_f32 v[100:101], v[100:101], s[36:37]
    v_cvt_pk_bf16_f32 v49, v98, v99
    v_pk_mul_f32 v[102:103], v[102:103], s[36:37]
    v_cvt_pk_bf16_f32 v50, v100, v101
    v_pk_mul_f32 v[104:105], v[104:105], s[36:37]
    v_cvt_pk_bf16_f32 v51, v102, v103
    v_pk_mul_f32 v[106:107], v[106:107], s[36:37]
    v_cvt_pk_bf16_f32 v52, v104, v105
    v_pk_mul_f32 v[108:109], v[108:109], s[36:37]
    v_cvt_pk_bf16_f32 v53, v106, v107
    v_pk_mul_f32 v[110:111], v[110:111], s[36:37]
    v_cvt_pk_bf16_f32 v54, v108, v109
    v_pk_mul_f32 v[112:113], v[112:113], s[36:37]
    v_cvt_pk_bf16_f32 v55, v110, v111
    v_pk_mul_f32 v[114:115], v[114:115], s[36:37]
    v_cvt_pk_bf16_f32 v56, v112, v113
    v_pk_mul_f32 v[116:117], v[116:117], s[36:37]
    v_cvt_pk_bf16_f32 v57, v114, v115
    v_pk_mul_f32 v[118:119], v[118:119], s[36:37]
    v_cvt_pk_bf16_f32 v58, v116, v117
    v_pk_mul_f32 v[120:121], v[120:121], s[36:37]
    v_cvt_pk_bf16_f32 v59, v118, v119
    v_pk_mul_f32 v[122:123], v[122:123], s[36:37]
    v_cvt_pk_bf16_f32 v60, v120, v121
    v_pk_mul_f32 v[124:125], v[124:125], s[36:37]
    v_cvt_pk_bf16_f32 v61, v122, v123
    v_pk_mul_f32 v[126:127], v[126:127], s[36:37]
    v_cvt_pk_bf16_f32 v62, v124, v125
    v_cvt_pk_bf16_f32 v63, v126, v127
    v_mov_b32 v236, 0x3f803f80
    v_accvgpr_write_b32 a252, v236
    v_accvgpr_write_b32 a253, v236
    v_accvgpr_write_b32 a254, v236
    v_accvgpr_write_b32 a255, v236
    s_waitcnt lgkmcnt(0)
    v_mfma_f32_16x16x32_bf16 v[64:67], a[128:131], v[0:3], 0
    v_mfma_f32_16x16x32_bf16 v[64:67], a[132:135], v[4:7], v[64:67]
    v_mfma_f32_16x16x32_bf16 v[64:67], a[136:139], v[8:11], v[64:67]
    v_mfma_f32_16x16x32_bf16 v[64:67], a[140:143], v[12:15], v[64:67]
    v_mfma_f32_16x16x32_bf16 v[68:71], a[128:131], v[16:19], 0
    v_mfma_f32_16x16x32_bf16 v[68:71], a[132:135], v[20:23], v[68:71]
    v_mfma_f32_16x16x32_bf16 v[68:71], a[136:139], v[24:27], v[68:71]
    v_mfma_f32_16x16x32_bf16 v[68:71], a[140:143], v[28:31], v[68:71]
    v_mfma_f32_16x16x32_bf16 v[72:75], a[128:131], v[32:35], 0
    v_mfma_f32_16x16x32_bf16 v[72:75], a[132:135], v[36:39], v[72:75]
    v_mfma_f32_16x16x32_bf16 v[72:75], a[136:139], v[40:43], v[72:75]
    v_mfma_f32_16x16x32_bf16 v[72:75], a[140:143], v[44:47], v[72:75]
    v_mfma_f32_16x16x32_bf16 v[76:79], a[128:131], v[48:51], 0
    v_mfma_f32_16x16x32_bf16 v[76:79], a[132:135], v[52:55], v[76:79]
    v_mfma_f32_16x16x32_bf16 v[76:79], a[136:139], v[56:59], v[76:79]
    v_mfma_f32_16x16x32_bf16 v[76:79], a[140:143], v[60:63], v[76:79]
    v_mfma_f32_16x16x32_bf16 v[80:83], a[144:147], v[0:3], 0
    v_mfma_f32_16x16x32_bf16 v[80:83], a[148:151], v[4:7], v[80:83]
    v_mfma_f32_16x16x32_bf16 v[80:83], a[152:155], v[8:11], v[80:83]
    v_mfma_f32_16x16x32_bf16 v[80:83], a[156:159], v[12:15], v[80:83]
    v_mfma_f32_16x16x32_bf16 v[84:87], a[144:147], v[16:19], 0
    v_mfma_f32_16x16x32_bf16 v[84:87], a[148:151], v[20:23], v[84:87]
    v_mfma_f32_16x16x32_bf16 v[84:87], a[152:155], v[24:27], v[84:87]
    v_mfma_f32_16x16x32_bf16 v[84:87], a[156:159], v[28:31], v[84:87]
    v_mfma_f32_16x16x32_bf16 v[88:91], a[144:147], v[32:35], 0
    v_mfma_f32_16x16x32_bf16 v[88:91], a[148:151], v[36:39], v[88:91]
    v_mfma_f32_16x16x32_bf16 v[88:91], a[152:155], v[40:43], v[88:91]
    v_mfma_f32_16x16x32_bf16 v[88:91], a[156:159], v[44:47], v[88:91]
    v_mfma_f32_16x16x32_bf16 v[92:95], a[144:147], v[48:51], 0
    v_mfma_f32_16x16x32_bf16 v[92:95], a[148:151], v[52:55], v[92:95]
    v_mfma_f32_16x16x32_bf16 v[92:95], a[152:155], v[56:59], v[92:95]
    v_mfma_f32_16x16x32_bf16 v[92:95], a[156:159], v[60:63], v[92:95]
    ds_read_b128 a[128:131], v192 offset:8192
    ds_read_b128 a[132:135], v193 offset:8192
    ds_read_b128 a[136:139], v194 offset:8192
    ds_read_b128 a[140:143], v195 offset:8192
    ds_read_b128 a[144:147], v192 offset:12288
    ds_read_b128 a[148:151], v193 offset:12288
    ds_read_b128 a[152:155], v194 offset:12288
    ds_read_b128 a[156:159], v195 offset:12288
    s_nop 0
    v_max3_f32 v224, v64, v65, v66
    v_max3_f32 v224, v224, v67, v80
    v_max3_f32 v224, v224, v81, v82
    v_max_f32 v224, v224, v83
    v_max3_f32 v225, v68, v69, v70
    v_max3_f32 v225, v225, v71, v84
    v_max3_f32 v225, v225, v85, v86
    v_max_f32 v225, v225, v87
    v_max3_f32 v226, v72, v73, v74
    v_max3_f32 v226, v226, v75, v88
    v_max3_f32 v226, v226, v89, v90
    v_max_f32 v226, v226, v91
    v_max3_f32 v227, v76, v77, v78
    v_max3_f32 v227, v227, v79, v92
    v_max3_f32 v227, v227, v93, v94
    v_max_f32 v227, v227, v95
    v_mov_b32 v228, v224
    v_mov_b32 v229, v225
    v_mov_b32 v230, v226
    v_mov_b32 v231, v227
    s_nop 1
    v_permlane16_swap_b32 v224, v228
    v_permlane16_swap_b32 v225, v229
    v_permlane16_swap_b32 v226, v230
    v_permlane16_swap_b32 v227, v231
    v_max_f32 v224, v224, v228
    v_max_f32 v225, v225, v229
    v_max_f32 v226, v226, v230
    v_max_f32 v227, v227, v231
    v_mov_b32 v228, v224
    v_mov_b32 v229, v225
    v_mov_b32 v230, v226
    v_mov_b32 v231, v227
    s_nop 1
    v_permlane32_swap_b32 v224, v228
    v_permlane32_swap_b32 v225, v229
    v_permlane32_swap_b32 v226, v230
    v_permlane32_swap_b32 v227, v231
    v_max_f32 v224, v224, v228
    v_max_f32 v225, v225, v229
    v_max_f32 v226, v226, v230
    v_max_f32 v227, v227, v231
    v_sub_f32 v64, v64, v224
    v_sub_f32 v65, v65, v224
    v_sub_f32 v66, v66, v224
    v_sub_f32 v67, v67, v224
    v_sub_f32 v80, v80, v224
    v_sub_f32 v81, v81, v224
    v_sub_f32 v82, v82, v224
    v_sub_f32 v83, v83, v224
    v_sub_f32 v160, 0, v224
    v_sub_f32 v161, 0, v224
    v_sub_f32 v162, 0, v224
    v_sub_f32 v163, 0, v224
    v_sub_f32 v68, v68, v225
    v_sub_f32 v69, v69, v225
    v_sub_f32 v70, v70, v225
    v_sub_f32 v71, v71, v225
    v_sub_f32 v84, v84, v225
    v_sub_f32 v85, v85, v225
    v_sub_f32 v86, v86, v225
    v_sub_f32 v87, v87, v225
    v_sub_f32 v164, 0, v225
    v_sub_f32 v165, 0, v225
    v_sub_f32 v166, 0, v225
    v_sub_f32 v167, 0, v225
    v_sub_f32 v72, v72, v226
    v_sub_f32 v73, v73, v226
    v_sub_f32 v74, v74, v226
    v_sub_f32 v75, v75, v226
    v_sub_f32 v88, v88, v226
    v_sub_f32 v89, v89, v226
    v_sub_f32 v90, v90, v226
    v_sub_f32 v91, v91, v226
    v_sub_f32 v168, 0, v226
    v_sub_f32 v169, 0, v226
    v_sub_f32 v170, 0, v226
    v_sub_f32 v171, 0, v226
    v_sub_f32 v76, v76, v227
    v_sub_f32 v77, v77, v227
    v_sub_f32 v78, v78, v227
    v_sub_f32 v79, v79, v227
    v_sub_f32 v92, v92, v227
    v_sub_f32 v93, v93, v227
    v_sub_f32 v94, v94, v227
    v_sub_f32 v95, v95, v227
    v_sub_f32 v172, 0, v227
    v_sub_f32 v173, 0, v227
    v_sub_f32 v174, 0, v227
    v_sub_f32 v175, 0, v227
    s_waitcnt lgkmcnt(0)
    v_mfma_f32_16x16x32_bf16 v[96:99], a[128:131], v[0:3], v[160:163]
    v_exp_f32 v64, v64
    v_mfma_f32_16x16x32_bf16 v[96:99], a[132:135], v[4:7], v[96:99]
    v_mfma_f32_16x16x32_bf16 v[96:99], a[136:139], v[8:11], v[96:99]
    v_exp_f32 v65, v65
    v_mfma_f32_16x16x32_bf16 v[96:99], a[140:143], v[12:15], v[96:99]
    v_exp_f32 v66, v66
    v_mfma_f32_16x16x32_bf16 v[100:103], a[128:131], v[16:19], v[164:167]
    v_mfma_f32_16x16x32_bf16 v[100:103], a[132:135], v[20:23], v[100:103]
    v_cvt_pk_bf16_f32 v128, v64, v65
    v_mfma_f32_16x16x32_bf16 v[100:103], a[136:139], v[24:27], v[100:103]
    v_exp_f32 v67, v67
    v_mfma_f32_16x16x32_bf16 v[100:103], a[140:143], v[28:31], v[100:103]
    v_exp_f32 v80, v80
    v_mfma_f32_16x16x32_bf16 v[104:107], a[128:131], v[32:35], v[168:171]
    v_cvt_pk_bf16_f32 v129, v66, v67
    v_mfma_f32_16x16x32_bf16 v[104:107], a[132:135], v[36:39], v[104:107]
    v_mfma_f32_16x16x32_bf16 v[104:107], a[136:139], v[40:43], v[104:107]
    v_exp_f32 v81, v81
    v_mfma_f32_16x16x32_bf16 v[104:107], a[140:143], v[44:47], v[104:107]
    v_exp_f32 v82, v82
    v_mfma_f32_16x16x32_bf16 v[108:111], a[128:131], v[48:51], v[172:175]
    v_cvt_pk_bf16_f32 v130, v80, v81
    v_mfma_f32_16x16x32_bf16 v[108:111], a[132:135], v[52:55], v[108:111]
    v_mfma_f32_16x16x32_bf16 v[108:111], a[136:139], v[56:59], v[108:111]
    v_exp_f32 v83, v83
    v_mfma_f32_16x16x32_bf16 v[108:111], a[140:143], v[60:63], v[108:111]
    v_exp_f32 v68, v68
    v_mfma_f32_16x16x32_bf16 v[112:115], a[144:147], v[0:3], v[160:163]
    v_cvt_pk_bf16_f32 v131, v82, v83
    v_mfma_f32_16x16x32_bf16 v[112:115], a[148:151], v[4:7], v[112:115]
    v_exp_f32 v69, v69
    v_mfma_f32_16x16x32_bf16 v[112:115], a[152:155], v[8:11], v[112:115]
    v_mfma_f32_16x16x32_bf16 v[112:115], a[156:159], v[12:15], v[112:115]
    v_exp_f32 v70, v70
    v_mfma_f32_16x16x32_bf16 v[116:119], a[144:147], v[16:19], v[164:167]
    v_cvt_pk_bf16_f32 v132, v68, v69
    v_mfma_f32_16x16x32_bf16 v[116:119], a[148:151], v[20:23], v[116:119]
    v_exp_f32 v71, v71
    v_mfma_f32_16x16x32_bf16 v[116:119], a[152:155], v[24:27], v[116:119]
    v_mfma_f32_16x16x32_bf16 v[116:119], a[156:159], v[28:31], v[116:119]
    v_exp_f32 v84, v84
    v_mfma_f32_16x16x32_bf16 v[120:123], a[144:147], v[32:35], v[168:171]
    v_cvt_pk_bf16_f32 v133, v70, v71
    v_mfma_f32_16x16x32_bf16 v[120:123], a[148:151], v[36:39], v[120:123]
    v_exp_f32 v85, v85
    v_mfma_f32_16x16x32_bf16 v[120:123], a[152:155], v[40:43], v[120:123]
    v_mfma_f32_16x16x32_bf16 v[120:123], a[156:159], v[44:47], v[120:123]
    v_exp_f32 v86, v86
    v_mfma_f32_16x16x32_bf16 v[124:127], a[144:147], v[48:51], v[172:175]
    v_cvt_pk_bf16_f32 v134, v84, v85
    v_mfma_f32_16x16x32_bf16 v[124:127], a[148:151], v[52:55], v[124:127]
    v_exp_f32 v87, v87
    v_mfma_f32_16x16x32_bf16 v[124:127], a[152:155], v[56:59], v[124:127]
    v_mfma_f32_16x16x32_bf16 v[124:127], a[156:159], v[60:63], v[124:127]
    v_exp_f32 v72, v72
    s_waitcnt vmcnt(16) lgkmcnt(0)
    s_barrier
    ds_read_b128 a[128:131], v192 offset:16384
    ds_read_b128 a[132:135], v193 offset:16384
    ds_read_b128 a[136:139], v194 offset:16384
    ds_read_b128 a[140:143], v195 offset:16384
    ds_read_b128 a[144:147], v192 offset:20480
    ds_read_b128 a[148:151], v193 offset:20480
    ds_read_b128 a[152:155], v194 offset:20480
    ds_read_b128 a[156:159], v195 offset:20480
    s_add_u32 m0, s29, 0x0
    s_nop 0
    buffer_load_dwordx4 v204, s[8:11], s32 offen offset:0 lds
    buffer_load_dwordx4 v205, s[8:11], s32 offen offset:1024 lds
    buffer_load_dwordx4 v206, s[8:11], s32 offen offset:2048 lds
    buffer_load_dwordx4 v207, s[8:11], s32 offen offset:3072 lds
    s_add_u32 s32, s32, 0x4000
    v_cvt_pk_bf16_f32 v135, v86, v87
    v_exp_f32 v73, v73
    v_exp_f32 v74, v74
    v_cvt_pk_bf16_f32 v136, v72, v73
    v_exp_f32 v75, v75
    v_exp_f32 v88, v88
    v_cvt_pk_bf16_f32 v137, v74, v75
    v_exp_f32 v89, v89
    v_exp_f32 v90, v90
    v_cvt_pk_bf16_f32 v138, v88, v89
    v_exp_f32 v91, v91
    v_exp_f32 v76, v76
    v_cvt_pk_bf16_f32 v139, v90, v91
    v_exp_f32 v77, v77
    v_exp_f32 v78, v78
    v_cvt_pk_bf16_f32 v140, v76, v77
    v_exp_f32 v79, v79
    v_exp_f32 v92, v92
    v_cvt_pk_bf16_f32 v141, v78, v79
    v_exp_f32 v93, v93
    v_exp_f32 v94, v94
    v_cvt_pk_bf16_f32 v142, v92, v93
    v_exp_f32 v95, v95
    s_nop 0
    v_cvt_pk_bf16_f32 v143, v94, v95
    s_waitcnt lgkmcnt(0)
    v_mfma_f32_16x16x32_bf16 v[64:67], a[128:131], v[0:3], v[160:163]
    ds_read_b64_tr_b16 a[160:161], v196 offset:0
    v_mfma_f32_16x16x32_bf16 v[64:67], a[132:135], v[4:7], v[64:67]
    ds_read_b64_tr_b16 a[162:163], v196 offset:4096
    v_exp_f32 v96, v96
    v_mfma_f32_16x16x32_bf16 v[64:67], a[136:139], v[8:11], v[64:67]
    v_exp_f32 v97, v97
    v_mfma_f32_16x16x32_bf16 v[64:67], a[140:143], v[12:15], v[64:67]
    ds_read_b64_tr_b16 a[164:165], v197 offset:0
    v_mfma_f32_16x16x32_bf16 v[68:71], a[128:131], v[16:19], v[164:167]
    ds_read_b64_tr_b16 a[166:167], v197 offset:4096
    v_mfma_f32_16x16x32_bf16 v[68:71], a[132:135], v[20:23], v[68:71]
    v_exp_f32 v98, v98
    v_mfma_f32_16x16x32_bf16 v[68:71], a[136:139], v[24:27], v[68:71]
    ds_read_b64_tr_b16 a[168:169], v198 offset:0
    v_cvt_pk_bf16_f32 v144, v96, v97
    v_mfma_f32_16x16x32_bf16 v[68:71], a[140:143], v[28:31], v[68:71]
    ds_read_b64_tr_b16 a[170:171], v198 offset:4096
    v_mfma_f32_16x16x32_bf16 v[72:75], a[128:131], v[32:35], v[168:171]
    v_exp_f32 v99, v99
    v_mfma_f32_16x16x32_bf16 v[72:75], a[132:135], v[36:39], v[72:75]
    ds_read_b64_tr_b16 a[172:173], v199 offset:0
    v_exp_f32 v112, v112
    v_mfma_f32_16x16x32_bf16 v[72:75], a[136:139], v[40:43], v[72:75]
    ds_read_b64_tr_b16 a[174:175], v199 offset:4096
    v_mfma_f32_16x16x32_bf16 v[72:75], a[140:143], v[44:47], v[72:75]
    v_cvt_pk_bf16_f32 v145, v98, v99
    v_mfma_f32_16x16x32_bf16 v[76:79], a[128:131], v[48:51], v[172:175]
    ds_read_b64_tr_b16 a[176:177], v200 offset:0
    v_exp_f32 v113, v113
    v_mfma_f32_16x16x32_bf16 v[76:79], a[132:135], v[52:55], v[76:79]
    ds_read_b64_tr_b16 a[178:179], v200 offset:4096
    v_mfma_f32_16x16x32_bf16 v[76:79], a[136:139], v[56:59], v[76:79]
    v_exp_f32 v114, v114
    v_mfma_f32_16x16x32_bf16 v[76:79], a[140:143], v[60:63], v[76:79]
    ds_read_b64_tr_b16 a[180:181], v201 offset:0
    v_mfma_f32_16x16x32_bf16 v[80:83], a[144:147], v[0:3], v[160:163]
    ds_read_b64_tr_b16 a[182:183], v201 offset:4096
    v_cvt_pk_bf16_f32 v146, v112, v113
    v_mfma_f32_16x16x32_bf16 v[80:83], a[148:151], v[4:7], v[80:83]
    v_exp_f32 v115, v115
    v_mfma_f32_16x16x32_bf16 v[80:83], a[152:155], v[8:11], v[80:83]
    ds_read_b64_tr_b16 a[184:185], v202 offset:0
    v_mfma_f32_16x16x32_bf16 v[80:83], a[156:159], v[12:15], v[80:83]
    ds_read_b64_tr_b16 a[186:187], v202 offset:4096
    v_exp_f32 v100, v100
    v_mfma_f32_16x16x32_bf16 v[84:87], a[144:147], v[16:19], v[164:167]
    v_cvt_pk_bf16_f32 v147, v114, v115
    v_mfma_f32_16x16x32_bf16 v[84:87], a[148:151], v[20:23], v[84:87]
    ds_read_b64_tr_b16 a[188:189], v203 offset:0
    v_mfma_f32_16x16x32_bf16 v[84:87], a[152:155], v[24:27], v[84:87]
    ds_read_b64_tr_b16 a[190:191], v203 offset:4096
    v_exp_f32 v101, v101
    v_mfma_f32_16x16x32_bf16 v[84:87], a[156:159], v[28:31], v[84:87]
    v_mfma_f32_16x16x32_bf16 v[88:91], a[144:147], v[32:35], v[168:171]
    v_exp_f32 v102, v102
    v_cvt_pk_bf16_f32 v148, v100, v101
    v_mfma_f32_16x16x32_bf16 v[88:91], a[148:151], v[36:39], v[88:91]
    v_exp_f32 v103, v103
    v_mfma_f32_16x16x32_bf16 v[88:91], a[152:155], v[40:43], v[88:91]
    v_exp_f32 v116, v116
    v_mfma_f32_16x16x32_bf16 v[88:91], a[156:159], v[44:47], v[88:91]
    v_cvt_pk_bf16_f32 v149, v102, v103
    v_mfma_f32_16x16x32_bf16 v[92:95], a[144:147], v[48:51], v[172:175]
    v_exp_f32 v117, v117
    v_mfma_f32_16x16x32_bf16 v[92:95], a[148:151], v[52:55], v[92:95]
    v_exp_f32 v118, v118
    v_mfma_f32_16x16x32_bf16 v[92:95], a[152:155], v[56:59], v[92:95]
    v_cvt_pk_bf16_f32 v150, v116, v117
    v_mfma_f32_16x16x32_bf16 v[92:95], a[156:159], v[60:63], v[92:95]
    s_waitcnt lgkmcnt(0)
    v_mfma_f32_16x16x32_bf16 a[0:3], a[160:163], v[128:131], 0
    ds_read_b128 a[128:131], v192 offset:24576
    v_exp_f32 v119, v119
    v_mfma_f32_16x16x32_bf16 a[4:7], a[160:163], v[132:135], 0
    v_exp_f32 v104, v104
    v_mfma_f32_16x16x32_bf16 a[8:11], a[160:163], v[136:139], 0
    ds_read_b128 a[132:135], v193 offset:24576
    v_mfma_f32_16x16x32_bf16 a[12:15], a[160:163], v[140:143], 0
    v_cvt_pk_bf16_f32 v151, v118, v119
    v_mfma_f32_16x16x32_bf16 a[16:19], a[164:167], v[128:131], 0
    ds_read_b128 a[136:139], v194 offset:24576
    v_exp_f32 v105, v105
    v_mfma_f32_16x16x32_bf16 a[20:23], a[164:167], v[132:135], 0
    v_mfma_f32_16x16x32_bf16 a[24:27], a[164:167], v[136:139], 0
    ds_read_b128 a[140:143], v195 offset:24576
    v_exp_f32 v106, v106
    v_mfma_f32_16x16x32_bf16 a[28:31], a[164:167], v[140:143], 0
    v_cvt_pk_bf16_f32 v152, v104, v105
    v_mfma_f32_16x16x32_bf16 v[176:179], a[252:255], v[128:131], 0
    ds_read_b128 a[144:147], v192 offset:28672
    v_mfma_f32_16x16x32_bf16 a[32:35], a[168:171], v[128:131], 0
    v_exp_f32 v107, v107
    v_mfma_f32_16x16x32_bf16 a[36:39], a[168:171], v[132:135], 0
    ds_read_b128 a[148:151], v193 offset:28672
    v_exp_f32 v120, v120
    v_mfma_f32_16x16x32_bf16 a[40:43], a[168:171], v[136:139], 0
    v_cvt_pk_bf16_f32 v153, v106, v107
    v_mfma_f32_16x16x32_bf16 a[44:47], a[168:171], v[140:143], 0
    ds_read_b128 a[152:155], v194 offset:28672
    v_mfma_f32_16x16x32_bf16 a[48:51], a[172:175], v[128:131], 0
    v_exp_f32 v121, v121
    v_mfma_f32_16x16x32_bf16 a[52:55], a[172:175], v[132:135], 0
    ds_read_b128 a[156:159], v195 offset:28672
    v_exp_f32 v122, v122
    v_mfma_f32_16x16x32_bf16 a[56:59], a[172:175], v[136:139], 0
    v_cvt_pk_bf16_f32 v154, v120, v121
    v_mfma_f32_16x16x32_bf16 a[60:63], a[172:175], v[140:143], 0
    v_exp_f32 v123, v123
    v_mfma_f32_16x16x32_bf16 v[180:183], a[252:255], v[132:135], 0
    s_add_u32 m0, s29, 0x1c000
    v_mfma_f32_16x16x32_bf16 a[64:67], a[176:179], v[128:131], 0
    buffer_load_dwordx4 v208, s[12:15], s33 offen offset:0 lds
    v_mfma_f32_16x16x32_bf16 a[68:71], a[176:179], v[132:135], 0
    v_exp_f32 v108, v108
    v_mfma_f32_16x16x32_bf16 a[72:75], a[176:179], v[136:139], 0
    v_cvt_pk_bf16_f32 v155, v122, v123
    v_mfma_f32_16x16x32_bf16 a[76:79], a[176:179], v[140:143], 0
    v_exp_f32 v109, v109
    v_mfma_f32_16x16x32_bf16 a[80:83], a[180:183], v[128:131], 0
    buffer_load_dwordx4 v242, s[12:15], s33 offen offset:1024 lds
    v_mfma_f32_16x16x32_bf16 a[84:87], a[180:183], v[132:135], 0
    v_exp_f32 v110, v110
    v_mfma_f32_16x16x32_bf16 a[88:91], a[180:183], v[136:139], 0
    v_cvt_pk_bf16_f32 v156, v108, v109
    v_mfma_f32_16x16x32_bf16 a[92:95], a[180:183], v[140:143], 0
    v_exp_f32 v111, v111
    v_mfma_f32_16x16x32_bf16 v[184:187], a[252:255], v[136:139], 0
    buffer_load_dwordx4 v208, s[12:15], s33 offen offset:2048 lds
    v_mfma_f32_16x16x32_bf16 a[96:99], a[184:187], v[128:131], 0
    v_exp_f32 v124, v124
    v_mfma_f32_16x16x32_bf16 a[100:103], a[184:187], v[132:135], 0
    v_cvt_pk_bf16_f32 v157, v110, v111
    v_mfma_f32_16x16x32_bf16 a[104:107], a[184:187], v[136:139], 0
    v_exp_f32 v125, v125
    v_mfma_f32_16x16x32_bf16 a[108:111], a[184:187], v[140:143], 0
    buffer_load_dwordx4 v242, s[12:15], s33 offen offset:3072 lds
    v_mfma_f32_16x16x32_bf16 a[112:115], a[188:191], v[128:131], 0
    s_add_u32 s33, s33, 0x4000
    v_mfma_f32_16x16x32_bf16 a[116:119], a[188:191], v[132:135], 0
    v_exp_f32 v126, v126
    v_mfma_f32_16x16x32_bf16 a[120:123], a[188:191], v[136:139], 0
    v_cvt_pk_bf16_f32 v158, v124, v125
    v_mfma_f32_16x16x32_bf16 a[124:127], a[188:191], v[140:143], 0
    v_exp_f32 v127, v127
    v_mfma_f32_16x16x32_bf16 v[188:191], a[252:255], v[140:143], 0
    s_nop 0
    v_cvt_pk_bf16_f32 v159, v126, v127
    s_waitcnt lgkmcnt(0)
    v_mfma_f32_16x16x32_bf16 v[96:99], a[128:131], v[0:3], v[160:163]
    ds_read_b64_tr_b16 a[160:161], v196 offset:8192
    v_mfma_f32_16x16x32_bf16 v[96:99], a[132:135], v[4:7], v[96:99]
    ds_read_b64_tr_b16 a[162:163], v196 offset:12288
    v_exp_f32 v64, v64
    v_mfma_f32_16x16x32_bf16 v[96:99], a[136:139], v[8:11], v[96:99]
    v_exp_f32 v65, v65
    v_mfma_f32_16x16x32_bf16 v[96:99], a[140:143], v[12:15], v[96:99]
    ds_read_b64_tr_b16 a[164:165], v197 offset:8192
    v_mfma_f32_16x16x32_bf16 v[100:103], a[128:131], v[16:19], v[164:167]
    ds_read_b64_tr_b16 a[166:167], v197 offset:12288
    v_mfma_f32_16x16x32_bf16 v[100:103], a[132:135], v[20:23], v[100:103]
    v_exp_f32 v66, v66
    v_mfma_f32_16x16x32_bf16 v[100:103], a[136:139], v[24:27], v[100:103]
    ds_read_b64_tr_b16 a[168:169], v198 offset:8192
    v_cvt_pk_bf16_f32 v128, v64, v65
    v_mfma_f32_16x16x32_bf16 v[100:103], a[140:143], v[28:31], v[100:103]
    ds_read_b64_tr_b16 a[170:171], v198 offset:12288
    v_mfma_f32_16x16x32_bf16 v[104:107], a[128:131], v[32:35], v[168:171]
    v_exp_f32 v67, v67
    v_mfma_f32_16x16x32_bf16 v[104:107], a[132:135], v[36:39], v[104:107]
    ds_read_b64_tr_b16 a[172:173], v199 offset:8192
    v_exp_f32 v80, v80
    v_mfma_f32_16x16x32_bf16 v[104:107], a[136:139], v[40:43], v[104:107]
    ds_read_b64_tr_b16 a[174:175], v199 offset:12288
    v_mfma_f32_16x16x32_bf16 v[104:107], a[140:143], v[44:47], v[104:107]
    v_cvt_pk_bf16_f32 v129, v66, v67
    v_mfma_f32_16x16x32_bf16 v[108:111], a[128:131], v[48:51], v[172:175]
    ds_read_b64_tr_b16 a[176:177], v200 offset:8192
    v_exp_f32 v81, v81
    v_mfma_f32_16x16x32_bf16 v[108:111], a[132:135], v[52:55], v[108:111]
    ds_read_b64_tr_b16 a[178:179], v200 offset:12288
    v_mfma_f32_16x16x32_bf16 v[108:111], a[136:139], v[56:59], v[108:111]
    v_exp_f32 v82, v82
    v_mfma_f32_16x16x32_bf16 v[108:111], a[140:143], v[60:63], v[108:111]
    ds_read_b64_tr_b16 a[180:181], v201 offset:8192
    v_cvt_pk_bf16_f32 v130, v80, v81
    v_mfma_f32_16x16x32_bf16 v[112:115], a[144:147], v[0:3], v[160:163]
    ds_read_b64_tr_b16 a[182:183], v201 offset:12288
    v_mfma_f32_16x16x32_bf16 v[112:115], a[148:151], v[4:7], v[112:115]
    v_exp_f32 v83, v83
    v_mfma_f32_16x16x32_bf16 v[112:115], a[152:155], v[8:11], v[112:115]
    ds_read_b64_tr_b16 a[184:185], v202 offset:8192
    v_mfma_f32_16x16x32_bf16 v[112:115], a[156:159], v[12:15], v[112:115]
    ds_read_b64_tr_b16 a[186:187], v202 offset:12288
    v_exp_f32 v68, v68
    v_mfma_f32_16x16x32_bf16 v[116:119], a[144:147], v[16:19], v[164:167]
    v_cvt_pk_bf16_f32 v131, v82, v83
    v_mfma_f32_16x16x32_bf16 v[116:119], a[148:151], v[20:23], v[116:119]
    ds_read_b64_tr_b16 a[188:189], v203 offset:8192
    v_mfma_f32_16x16x32_bf16 v[116:119], a[152:155], v[24:27], v[116:119]
    ds_read_b64_tr_b16 a[190:191], v203 offset:12288
    v_exp_f32 v69, v69
    v_mfma_f32_16x16x32_bf16 v[116:119], a[156:159], v[28:31], v[116:119]
    v_exp_f32 v70, v70
    v_mfma_f32_16x16x32_bf16 v[120:123], a[144:147], v[32:35], v[168:171]
    v_cvt_pk_bf16_f32 v132, v68, v69
    v_mfma_f32_16x16x32_bf16 v[120:123], a[148:151], v[36:39], v[120:123]
    v_exp_f32 v71, v71
    v_mfma_f32_16x16x32_bf16 v[120:123], a[152:155], v[40:43], v[120:123]
    v_exp_f32 v84, v84
    v_mfma_f32_16x16x32_bf16 v[120:123], a[156:159], v[44:47], v[120:123]
    v_cvt_pk_bf16_f32 v133, v70, v71
    v_mfma_f32_16x16x32_bf16 v[124:127], a[144:147], v[48:51], v[172:175]
    v_exp_f32 v85, v85
    v_mfma_f32_16x16x32_bf16 v[124:127], a[148:151], v[52:55], v[124:127]
    v_exp_f32 v86, v86
    v_mfma_f32_16x16x32_bf16 v[124:127], a[152:155], v[56:59], v[124:127]
    v_cvt_pk_bf16_f32 v134, v84, v85
    v_mfma_f32_16x16x32_bf16 v[124:127], a[156:159], v[60:63], v[124:127]
    s_waitcnt vmcnt(16) lgkmcnt(0)
    s_barrier
    v_mfma_f32_16x16x32_bf16 a[0:3], a[160:163], v[144:147], a[0:3]
    ds_read_b128 a[128:131], v192 offset:32768
    v_mfma_f32_16x16x32_bf16 a[4:7], a[160:163], v[148:151], a[4:7]
    v_exp_f32 v87, v87
    v_mfma_f32_16x16x32_bf16 a[8:11], a[160:163], v[152:155], a[8:11]
    ds_read_b128 a[132:135], v193 offset:32768
    v_exp_f32 v72, v72
    v_mfma_f32_16x16x32_bf16 a[12:15], a[160:163], v[156:159], a[12:15]
    v_cvt_pk_bf16_f32 v135, v86, v87
    v_mfma_f32_16x16x32_bf16 a[16:19], a[164:167], v[144:147], a[16:19]
    ds_read_b128 a[136:139], v194 offset:32768
    v_mfma_f32_16x16x32_bf16 a[20:23], a[164:167], v[148:151], a[20:23]
    v_exp_f32 v73, v73
    v_mfma_f32_16x16x32_bf16 a[24:27], a[164:167], v[152:155], a[24:27]
    ds_read_b128 a[140:143], v195 offset:32768
    v_exp_f32 v74, v74
    v_mfma_f32_16x16x32_bf16 a[28:31], a[164:167], v[156:159], a[28:31]
    v_cvt_pk_bf16_f32 v136, v72, v73
    v_mfma_f32_16x16x32_bf16 v[176:179], a[252:255], v[144:147], v[176:179]
    ds_read_b128 a[144:147], v192 offset:36864
    v_mfma_f32_16x16x32_bf16 a[32:35], a[168:171], v[144:147], a[32:35]
    v_exp_f32 v75, v75
    v_mfma_f32_16x16x32_bf16 a[36:39], a[168:171], v[148:151], a[36:39]
    ds_read_b128 a[148:151], v193 offset:36864
    v_mfma_f32_16x16x32_bf16 a[40:43], a[168:171], v[152:155], a[40:43]
    v_exp_f32 v88, v88
    v_cvt_pk_bf16_f32 v137, v74, v75
    v_mfma_f32_16x16x32_bf16 a[44:47], a[168:171], v[156:159], a[44:47]
    ds_read_b128 a[152:155], v194 offset:36864
    v_mfma_f32_16x16x32_bf16 a[48:51], a[172:175], v[144:147], a[48:51]
    v_exp_f32 v89, v89
    v_mfma_f32_16x16x32_bf16 a[52:55], a[172:175], v[148:151], a[52:55]
    ds_read_b128 a[156:159], v195 offset:36864
    v_mfma_f32_16x16x32_bf16 a[56:59], a[172:175], v[152:155], a[56:59]
    v_exp_f32 v90, v90
    v_cvt_pk_bf16_f32 v138, v88, v89
    v_mfma_f32_16x16x32_bf16 a[60:63], a[172:175], v[156:159], a[60:63]
    v_exp_f32 v91, v91
    v_mfma_f32_16x16x32_bf16 v[180:183], a[252:255], v[148:151], v[180:183]
    s_add_u32 m0, s29, 0x4000
    v_mfma_f32_16x16x32_bf16 a[64:67], a[176:179], v[144:147], a[64:67]
    buffer_load_dwordx4 v204, s[8:11], s32 offen offset:0 lds
    v_mfma_f32_16x16x32_bf16 a[68:71], a[176:179], v[148:151], a[68:71]
    v_exp_f32 v76, v76
    v_mfma_f32_16x16x32_bf16 a[72:75], a[176:179], v[152:155], a[72:75]
    v_cvt_pk_bf16_f32 v139, v90, v91
    v_mfma_f32_16x16x32_bf16 a[76:79], a[176:179], v[156:159], a[76:79]
    v_exp_f32 v77, v77
    v_mfma_f32_16x16x32_bf16 a[80:83], a[180:183], v[144:147], a[80:83]
    buffer_load_dwordx4 v205, s[8:11], s32 offen offset:1024 lds
    v_mfma_f32_16x16x32_bf16 a[84:87], a[180:183], v[148:151], a[84:87]
    v_exp_f32 v78, v78
    v_mfma_f32_16x16x32_bf16 a[88:91], a[180:183], v[152:155], a[88:91]
    v_cvt_pk_bf16_f32 v140, v76, v77
    v_mfma_f32_16x16x32_bf16 a[92:95], a[180:183], v[156:159], a[92:95]
    v_exp_f32 v79, v79
    v_mfma_f32_16x16x32_bf16 v[184:187], a[252:255], v[152:155], v[184:187]
    buffer_load_dwordx4 v206, s[8:11], s32 offen offset:2048 lds
    v_mfma_f32_16x16x32_bf16 a[96:99], a[184:187], v[144:147], a[96:99]
    v_exp_f32 v92, v92
    v_mfma_f32_16x16x32_bf16 a[100:103], a[184:187], v[148:151], a[100:103]
    v_cvt_pk_bf16_f32 v141, v78, v79
    v_mfma_f32_16x16x32_bf16 a[104:107], a[184:187], v[152:155], a[104:107]
    v_exp_f32 v93, v93
    v_mfma_f32_16x16x32_bf16 a[108:111], a[184:187], v[156:159], a[108:111]
    buffer_load_dwordx4 v207, s[8:11], s32 offen offset:3072 lds
    v_mfma_f32_16x16x32_bf16 a[112:115], a[188:191], v[144:147], a[112:115]
    s_add_u32 s32, s32, 0x4000
    v_mfma_f32_16x16x32_bf16 a[116:119], a[188:191], v[148:151], a[116:119]
    v_exp_f32 v94, v94
    v_mfma_f32_16x16x32_bf16 a[120:123], a[188:191], v[152:155], a[120:123]
    v_cvt_pk_bf16_f32 v142, v92, v93
    v_mfma_f32_16x16x32_bf16 a[124:127], a[188:191], v[156:159], a[124:127]
    v_exp_f32 v95, v95
    v_mfma_f32_16x16x32_bf16 v[188:191], a[252:255], v[156:159], v[188:191]
    s_nop 0
    v_cvt_pk_bf16_f32 v143, v94, v95
    s_waitcnt lgkmcnt(0)
    v_mfma_f32_16x16x32_bf16 v[64:67], a[128:131], v[0:3], v[160:163]
    ds_read_b64_tr_b16 a[160:161], v196 offset:16384
    v_mfma_f32_16x16x32_bf16 v[64:67], a[132:135], v[4:7], v[64:67]
    ds_read_b64_tr_b16 a[162:163], v196 offset:20480
    v_exp_f32 v96, v96
    v_mfma_f32_16x16x32_bf16 v[64:67], a[136:139], v[8:11], v[64:67]
    v_exp_f32 v97, v97
    v_mfma_f32_16x16x32_bf16 v[64:67], a[140:143], v[12:15], v[64:67]
    ds_read_b64_tr_b16 a[164:165], v197 offset:16384
    v_mfma_f32_16x16x32_bf16 v[68:71], a[128:131], v[16:19], v[164:167]
    ds_read_b64_tr_b16 a[166:167], v197 offset:20480
    v_mfma_f32_16x16x32_bf16 v[68:71], a[132:135], v[20:23], v[68:71]
    v_exp_f32 v98, v98
    v_mfma_f32_16x16x32_bf16 v[68:71], a[136:139], v[24:27], v[68:71]
    ds_read_b64_tr_b16 a[168:169], v198 offset:16384
    v_cvt_pk_bf16_f32 v144, v96, v97
    v_mfma_f32_16x16x32_bf16 v[68:71], a[140:143], v[28:31], v[68:71]
    ds_read_b64_tr_b16 a[170:171], v198 offset:20480
    v_mfma_f32_16x16x32_bf16 v[72:75], a[128:131], v[32:35], v[168:171]
    v_exp_f32 v99, v99
    v_mfma_f32_16x16x32_bf16 v[72:75], a[132:135], v[36:39], v[72:75]
    ds_read_b64_tr_b16 a[172:173], v199 offset:16384
    v_exp_f32 v112, v112
    v_mfma_f32_16x16x32_bf16 v[72:75], a[136:139], v[40:43], v[72:75]
    ds_read_b64_tr_b16 a[174:175], v199 offset:20480
    v_mfma_f32_16x16x32_bf16 v[72:75], a[140:143], v[44:47], v[72:75]
    v_cvt_pk_bf16_f32 v145, v98, v99
    v_mfma_f32_16x16x32_bf16 v[76:79], a[128:131], v[48:51], v[172:175]
    ds_read_b64_tr_b16 a[176:177], v200 offset:16384
    v_exp_f32 v113, v113
    v_mfma_f32_16x16x32_bf16 v[76:79], a[132:135], v[52:55], v[76:79]
    ds_read_b64_tr_b16 a[178:179], v200 offset:20480
    v_mfma_f32_16x16x32_bf16 v[76:79], a[136:139], v[56:59], v[76:79]
    v_exp_f32 v114, v114
    v_mfma_f32_16x16x32_bf16 v[76:79], a[140:143], v[60:63], v[76:79]
    ds_read_b64_tr_b16 a[180:181], v201 offset:16384
    v_mfma_f32_16x16x32_bf16 v[80:83], a[144:147], v[0:3], v[160:163]
    ds_read_b64_tr_b16 a[182:183], v201 offset:20480
    v_cvt_pk_bf16_f32 v146, v112, v113
    v_mfma_f32_16x16x32_bf16 v[80:83], a[148:151], v[4:7], v[80:83]
    v_exp_f32 v115, v115
    v_mfma_f32_16x16x32_bf16 v[80:83], a[152:155], v[8:11], v[80:83]
    ds_read_b64_tr_b16 a[184:185], v202 offset:16384
    v_mfma_f32_16x16x32_bf16 v[80:83], a[156:159], v[12:15], v[80:83]
    ds_read_b64_tr_b16 a[186:187], v202 offset:20480
    v_exp_f32 v100, v100
    v_mfma_f32_16x16x32_bf16 v[84:87], a[144:147], v[16:19], v[164:167]
    v_cvt_pk_bf16_f32 v147, v114, v115
    v_mfma_f32_16x16x32_bf16 v[84:87], a[148:151], v[20:23], v[84:87]
    ds_read_b64_tr_b16 a[188:189], v203 offset:16384
    v_mfma_f32_16x16x32_bf16 v[84:87], a[152:155], v[24:27], v[84:87]
    ds_read_b64_tr_b16 a[190:191], v203 offset:20480
    v_exp_f32 v101, v101
    v_mfma_f32_16x16x32_bf16 v[84:87], a[156:159], v[28:31], v[84:87]
    v_mfma_f32_16x16x32_bf16 v[88:91], a[144:147], v[32:35], v[168:171]
    v_exp_f32 v102, v102
    v_cvt_pk_bf16_f32 v148, v100, v101
    v_mfma_f32_16x16x32_bf16 v[88:91], a[148:151], v[36:39], v[88:91]
    v_exp_f32 v103, v103
    v_mfma_f32_16x16x32_bf16 v[88:91], a[152:155], v[40:43], v[88:91]
    v_exp_f32 v116, v116
    v_mfma_f32_16x16x32_bf16 v[88:91], a[156:159], v[44:47], v[88:91]
    v_cvt_pk_bf16_f32 v149, v102, v103
    v_mfma_f32_16x16x32_bf16 v[92:95], a[144:147], v[48:51], v[172:175]
    v_exp_f32 v117, v117
    v_mfma_f32_16x16x32_bf16 v[92:95], a[148:151], v[52:55], v[92:95]
    v_exp_f32 v118, v118
    v_mfma_f32_16x16x32_bf16 v[92:95], a[152:155], v[56:59], v[92:95]
    v_cvt_pk_bf16_f32 v150, v116, v117
    v_mfma_f32_16x16x32_bf16 v[92:95], a[156:159], v[60:63], v[92:95]
    s_waitcnt lgkmcnt(0)
    v_mfma_f32_16x16x32_bf16 a[0:3], a[160:163], v[128:131], a[0:3]
    ds_read_b128 a[128:131], v192 offset:40960
    v_exp_f32 v119, v119
    v_mfma_f32_16x16x32_bf16 a[4:7], a[160:163], v[132:135], a[4:7]
    v_exp_f32 v104, v104
    v_mfma_f32_16x16x32_bf16 a[8:11], a[160:163], v[136:139], a[8:11]
    ds_read_b128 a[132:135], v193 offset:40960
    v_mfma_f32_16x16x32_bf16 a[12:15], a[160:163], v[140:143], a[12:15]
    v_cvt_pk_bf16_f32 v151, v118, v119
    v_mfma_f32_16x16x32_bf16 a[16:19], a[164:167], v[128:131], a[16:19]
    ds_read_b128 a[136:139], v194 offset:40960
    v_exp_f32 v105, v105
    v_mfma_f32_16x16x32_bf16 a[20:23], a[164:167], v[132:135], a[20:23]
    v_mfma_f32_16x16x32_bf16 a[24:27], a[164:167], v[136:139], a[24:27]
    ds_read_b128 a[140:143], v195 offset:40960
    v_exp_f32 v106, v106
    v_mfma_f32_16x16x32_bf16 a[28:31], a[164:167], v[140:143], a[28:31]
    v_cvt_pk_bf16_f32 v152, v104, v105
    v_mfma_f32_16x16x32_bf16 v[176:179], a[252:255], v[128:131], v[176:179]
    ds_read_b128 a[144:147], v192 offset:45056
    v_mfma_f32_16x16x32_bf16 a[32:35], a[168:171], v[128:131], a[32:35]
    v_exp_f32 v107, v107
    v_mfma_f32_16x16x32_bf16 a[36:39], a[168:171], v[132:135], a[36:39]
    ds_read_b128 a[148:151], v193 offset:45056
    v_exp_f32 v120, v120
    v_mfma_f32_16x16x32_bf16 a[40:43], a[168:171], v[136:139], a[40:43]
    v_cvt_pk_bf16_f32 v153, v106, v107
    v_mfma_f32_16x16x32_bf16 a[44:47], a[168:171], v[140:143], a[44:47]
    ds_read_b128 a[152:155], v194 offset:45056
    v_mfma_f32_16x16x32_bf16 a[48:51], a[172:175], v[128:131], a[48:51]
    v_exp_f32 v121, v121
    v_mfma_f32_16x16x32_bf16 a[52:55], a[172:175], v[132:135], a[52:55]
    ds_read_b128 a[156:159], v195 offset:45056
    v_exp_f32 v122, v122
    v_mfma_f32_16x16x32_bf16 a[56:59], a[172:175], v[136:139], a[56:59]
    v_cvt_pk_bf16_f32 v154, v120, v121
    v_mfma_f32_16x16x32_bf16 a[60:63], a[172:175], v[140:143], a[60:63]
    v_exp_f32 v123, v123
    v_mfma_f32_16x16x32_bf16 v[180:183], a[252:255], v[132:135], v[180:183]
    s_add_u32 m0, s29, 0x10000
    v_mfma_f32_16x16x32_bf16 a[64:67], a[176:179], v[128:131], a[64:67]
    buffer_load_dwordx4 v208, s[12:15], s33 offen offset:0 lds
    v_mfma_f32_16x16x32_bf16 a[68:71], a[176:179], v[132:135], a[68:71]
    v_exp_f32 v108, v108
    v_mfma_f32_16x16x32_bf16 a[72:75], a[176:179], v[136:139], a[72:75]
    v_cvt_pk_bf16_f32 v155, v122, v123
    v_mfma_f32_16x16x32_bf16 a[76:79], a[176:179], v[140:143], a[76:79]
    v_exp_f32 v109, v109
    v_mfma_f32_16x16x32_bf16 a[80:83], a[180:183], v[128:131], a[80:83]
    buffer_load_dwordx4 v242, s[12:15], s33 offen offset:1024 lds
    v_mfma_f32_16x16x32_bf16 a[84:87], a[180:183], v[132:135], a[84:87]
    v_exp_f32 v110, v110
    v_mfma_f32_16x16x32_bf16 a[88:91], a[180:183], v[136:139], a[88:91]
    v_cvt_pk_bf16_f32 v156, v108, v109
    v_mfma_f32_16x16x32_bf16 a[92:95], a[180:183], v[140:143], a[92:95]
    v_exp_f32 v111, v111
    v_mfma_f32_16x16x32_bf16 v[184:187], a[252:255], v[136:139], v[184:187]
    buffer_load_dwordx4 v208, s[12:15], s33 offen offset:2048 lds
    v_mfma_f32_16x16x32_bf16 a[96:99], a[184:187], v[128:131], a[96:99]
    v_exp_f32 v124, v124
    v_mfma_f32_16x16x32_bf16 a[100:103], a[184:187], v[132:135], a[100:103]
    v_cvt_pk_bf16_f32 v157, v110, v111
    v_mfma_f32_16x16x32_bf16 a[104:107], a[184:187], v[136:139], a[104:107]
    v_exp_f32 v125, v125
    v_mfma_f32_16x16x32_bf16 a[108:111], a[184:187], v[140:143], a[108:111]
    buffer_load_dwordx4 v242, s[12:15], s33 offen offset:3072 lds
    v_mfma_f32_16x16x32_bf16 a[112:115], a[188:191], v[128:131], a[112:115]
    s_add_u32 s33, s33, 0x4000
    v_mfma_f32_16x16x32_bf16 a[116:119], a[188:191], v[132:135], a[116:119]
    v_exp_f32 v126, v126
    v_mfma_f32_16x16x32_bf16 a[120:123], a[188:191], v[136:139], a[120:123]
    v_cvt_pk_bf16_f32 v158, v124, v125
    v_mfma_f32_16x16x32_bf16 a[124:127], a[188:191], v[140:143], a[124:127]
    v_exp_f32 v127, v127
    v_mfma_f32_16x16x32_bf16 v[188:191], a[252:255], v[140:143], v[188:191]
    s_nop 0
    v_cvt_pk_bf16_f32 v159, v126, v127
    s_waitcnt lgkmcnt(0)
    v_mfma_f32_16x16x32_bf16 v[96:99], a[128:131], v[0:3], v[160:163]
    ds_read_b64_tr_b16 a[160:161], v196 offset:24576
    v_mfma_f32_16x16x32_bf16 v[96:99], a[132:135], v[4:7], v[96:99]
    ds_read_b64_tr_b16 a[162:163], v196 offset:28672
    v_exp_f32 v64, v64
    v_mfma_f32_16x16x32_bf16 v[96:99], a[136:139], v[8:11], v[96:99]
    v_exp_f32 v65, v65
    v_mfma_f32_16x16x32_bf16 v[96:99], a[140:143], v[12:15], v[96:99]
    ds_read_b64_tr_b16 a[164:165], v197 offset:24576
    v_mfma_f32_16x16x32_bf16 v[100:103], a[128:131], v[16:19], v[164:167]
    ds_read_b64_tr_b16 a[166:167], v197 offset:28672
    v_mfma_f32_16x16x32_bf16 v[100:103], a[132:135], v[20:23], v[100:103]
    v_exp_f32 v66, v66
    v_mfma_f32_16x16x32_bf16 v[100:103], a[136:139], v[24:27], v[100:103]
    ds_read_b64_tr_b16 a[168:169], v198 offset:24576
    v_cvt_pk_bf16_f32 v128, v64, v65
    v_mfma_f32_16x16x32_bf16 v[100:103], a[140:143], v[28:31], v[100:103]
    ds_read_b64_tr_b16 a[170:171], v198 offset:28672
    v_mfma_f32_16x16x32_bf16 v[104:107], a[128:131], v[32:35], v[168:171]
    v_exp_f32 v67, v67
    v_mfma_f32_16x16x32_bf16 v[104:107], a[132:135], v[36:39], v[104:107]
    ds_read_b64_tr_b16 a[172:173], v199 offset:24576
    v_exp_f32 v80, v80
    v_mfma_f32_16x16x32_bf16 v[104:107], a[136:139], v[40:43], v[104:107]
    ds_read_b64_tr_b16 a[174:175], v199 offset:28672
    v_mfma_f32_16x16x32_bf16 v[104:107], a[140:143], v[44:47], v[104:107]
    v_cvt_pk_bf16_f32 v129, v66, v67
    v_mfma_f32_16x16x32_bf16 v[108:111], a[128:131], v[48:51], v[172:175]
    ds_read_b64_tr_b16 a[176:177], v200 offset:24576
    v_exp_f32 v81, v81
    v_mfma_f32_16x16x32_bf16 v[108:111], a[132:135], v[52:55], v[108:111]
    ds_read_b64_tr_b16 a[178:179], v200 offset:28672
    v_mfma_f32_16x16x32_bf16 v[108:111], a[136:139], v[56:59], v[108:111]
    v_exp_f32 v82, v82
    v_mfma_f32_16x16x32_bf16 v[108:111], a[140:143], v[60:63], v[108:111]
    ds_read_b64_tr_b16 a[180:181], v201 offset:24576
    v_cvt_pk_bf16_f32 v130, v80, v81
    v_mfma_f32_16x16x32_bf16 v[112:115], a[144:147], v[0:3], v[160:163]
    ds_read_b64_tr_b16 a[182:183], v201 offset:28672
    v_mfma_f32_16x16x32_bf16 v[112:115], a[148:151], v[4:7], v[112:115]
    v_exp_f32 v83, v83
    v_mfma_f32_16x16x32_bf16 v[112:115], a[152:155], v[8:11], v[112:115]
    ds_read_b64_tr_b16 a[184:185], v202 offset:24576
    v_mfma_f32_16x16x32_bf16 v[112:115], a[156:159], v[12:15], v[112:115]
    ds_read_b64_tr_b16 a[186:187], v202 offset:28672
    v_exp_f32 v68, v68
    v_mfma_f32_16x16x32_bf16 v[116:119], a[144:147], v[16:19], v[164:167]
    v_cvt_pk_bf16_f32 v131, v82, v83
    v_mfma_f32_16x16x32_bf16 v[116:119], a[148:151], v[20:23], v[116:119]
    ds_read_b64_tr_b16 a[188:189], v203 offset:24576
    v_mfma_f32_16x16x32_bf16 v[116:119], a[152:155], v[24:27], v[116:119]
    ds_read_b64_tr_b16 a[190:191], v203 offset:28672
    v_exp_f32 v69, v69
    v_mfma_f32_16x16x32_bf16 v[116:119], a[156:159], v[28:31], v[116:119]
    v_exp_f32 v70, v70
    v_mfma_f32_16x16x32_bf16 v[120:123], a[144:147], v[32:35], v[168:171]
    v_cvt_pk_bf16_f32 v132, v68, v69
    v_mfma_f32_16x16x32_bf16 v[120:123], a[148:151], v[36:39], v[120:123]
    v_exp_f32 v71, v71
    v_mfma_f32_16x16x32_bf16 v[120:123], a[152:155], v[40:43], v[120:123]
    v_exp_f32 v84, v84
    v_mfma_f32_16x16x32_bf16 v[120:123], a[156:159], v[44:47], v[120:123]
    v_cvt_pk_bf16_f32 v133, v70, v71
    v_mfma_f32_16x16x32_bf16 v[124:127], a[144:147], v[48:51], v[172:175]
    v_exp_f32 v85, v85
    v_mfma_f32_16x16x32_bf16 v[124:127], a[148:151], v[52:55], v[124:127]
    v_exp_f32 v86, v86
    v_mfma_f32_16x16x32_bf16 v[124:127], a[152:155], v[56:59], v[124:127]
    v_cvt_pk_bf16_f32 v134, v84, v85
    v_mfma_f32_16x16x32_bf16 v[124:127], a[156:159], v[60:63], v[124:127]
    s_waitcnt vmcnt(16) lgkmcnt(0)
    s_barrier
    v_mfma_f32_16x16x32_bf16 a[0:3], a[160:163], v[144:147], a[0:3]
    ds_read_b128 a[128:131], v192 offset:49152
    v_mfma_f32_16x16x32_bf16 a[4:7], a[160:163], v[148:151], a[4:7]
    v_exp_f32 v87, v87
    v_mfma_f32_16x16x32_bf16 a[8:11], a[160:163], v[152:155], a[8:11]
    ds_read_b128 a[132:135], v193 offset:49152
    v_exp_f32 v72, v72
    v_mfma_f32_16x16x32_bf16 a[12:15], a[160:163], v[156:159], a[12:15]
    v_cvt_pk_bf16_f32 v135, v86, v87
    v_mfma_f32_16x16x32_bf16 a[16:19], a[164:167], v[144:147], a[16:19]
    ds_read_b128 a[136:139], v194 offset:49152
    v_mfma_f32_16x16x32_bf16 a[20:23], a[164:167], v[148:151], a[20:23]
    v_exp_f32 v73, v73
    v_mfma_f32_16x16x32_bf16 a[24:27], a[164:167], v[152:155], a[24:27]
    ds_read_b128 a[140:143], v195 offset:49152
    v_exp_f32 v74, v74
    v_mfma_f32_16x16x32_bf16 a[28:31], a[164:167], v[156:159], a[28:31]
    v_cvt_pk_bf16_f32 v136, v72, v73
    v_mfma_f32_16x16x32_bf16 v[176:179], a[252:255], v[144:147], v[176:179]
    ds_read_b128 a[144:147], v192 offset:53248
    v_mfma_f32_16x16x32_bf16 a[32:35], a[168:171], v[144:147], a[32:35]
    v_exp_f32 v75, v75
    v_mfma_f32_16x16x32_bf16 a[36:39], a[168:171], v[148:151], a[36:39]
    ds_read_b128 a[148:151], v193 offset:53248
    v_mfma_f32_16x16x32_bf16 a[40:43], a[168:171], v[152:155], a[40:43]
    v_exp_f32 v88, v88
    v_cvt_pk_bf16_f32 v137, v74, v75
    v_mfma_f32_16x16x32_bf16 a[44:47], a[168:171], v[156:159], a[44:47]
    ds_read_b128 a[152:155], v194 offset:53248
    v_mfma_f32_16x16x32_bf16 a[48:51], a[172:175], v[144:147], a[48:51]
    v_exp_f32 v89, v89
    v_mfma_f32_16x16x32_bf16 a[52:55], a[172:175], v[148:151], a[52:55]
    ds_read_b128 a[156:159], v195 offset:53248
    v_mfma_f32_16x16x32_bf16 a[56:59], a[172:175], v[152:155], a[56:59]
    v_exp_f32 v90, v90
    v_cvt_pk_bf16_f32 v138, v88, v89
    v_mfma_f32_16x16x32_bf16 a[60:63], a[172:175], v[156:159], a[60:63]
    v_exp_f32 v91, v91
    v_mfma_f32_16x16x32_bf16 v[180:183], a[252:255], v[148:151], v[180:183]
    s_add_u32 m0, s29, 0x8000
    v_mfma_f32_16x16x32_bf16 a[64:67], a[176:179], v[144:147], a[64:67]
    buffer_load_dwordx4 v204, s[8:11], s32 offen offset:0 lds
    v_mfma_f32_16x16x32_bf16 a[68:71], a[176:179], v[148:151], a[68:71]
    v_exp_f32 v76, v76
    v_mfma_f32_16x16x32_bf16 a[72:75], a[176:179], v[152:155], a[72:75]
    v_cvt_pk_bf16_f32 v139, v90, v91
    v_mfma_f32_16x16x32_bf16 a[76:79], a[176:179], v[156:159], a[76:79]
    v_exp_f32 v77, v77
    v_mfma_f32_16x16x32_bf16 a[80:83], a[180:183], v[144:147], a[80:83]
    buffer_load_dwordx4 v205, s[8:11], s32 offen offset:1024 lds
    v_mfma_f32_16x16x32_bf16 a[84:87], a[180:183], v[148:151], a[84:87]
    v_exp_f32 v78, v78
    v_mfma_f32_16x16x32_bf16 a[88:91], a[180:183], v[152:155], a[88:91]
    v_cvt_pk_bf16_f32 v140, v76, v77
    v_mfma_f32_16x16x32_bf16 a[92:95], a[180:183], v[156:159], a[92:95]
    v_exp_f32 v79, v79
    v_mfma_f32_16x16x32_bf16 v[184:187], a[252:255], v[152:155], v[184:187]
    buffer_load_dwordx4 v206, s[8:11], s32 offen offset:2048 lds
    v_mfma_f32_16x16x32_bf16 a[96:99], a[184:187], v[144:147], a[96:99]
    v_exp_f32 v92, v92
    v_mfma_f32_16x16x32_bf16 a[100:103], a[184:187], v[148:151], a[100:103]
    v_cvt_pk_bf16_f32 v141, v78, v79
    v_mfma_f32_16x16x32_bf16 a[104:107], a[184:187], v[152:155], a[104:107]
    v_exp_f32 v93, v93
    v_mfma_f32_16x16x32_bf16 a[108:111], a[184:187], v[156:159], a[108:111]
    buffer_load_dwordx4 v207, s[8:11], s32 offen offset:3072 lds
    v_mfma_f32_16x16x32_bf16 a[112:115], a[188:191], v[144:147], a[112:115]
    s_add_u32 s32, s32, 0x4000
    v_mfma_f32_16x16x32_bf16 a[116:119], a[188:191], v[148:151], a[116:119]
    v_exp_f32 v94, v94
    v_mfma_f32_16x16x32_bf16 a[120:123], a[188:191], v[152:155], a[120:123]
    v_cvt_pk_bf16_f32 v142, v92, v93
    v_mfma_f32_16x16x32_bf16 a[124:127], a[188:191], v[156:159], a[124:127]
    v_exp_f32 v95, v95
    v_mfma_f32_16x16x32_bf16 v[188:191], a[252:255], v[156:159], v[188:191]
    s_nop 0
    v_cvt_pk_bf16_f32 v143, v94, v95
    s_waitcnt lgkmcnt(0)
    v_mfma_f32_16x16x32_bf16 v[64:67], a[128:131], v[0:3], v[160:163]
    ds_read_b64_tr_b16 a[160:161], v196 offset:32768
    v_mfma_f32_16x16x32_bf16 v[64:67], a[132:135], v[4:7], v[64:67]
    ds_read_b64_tr_b16 a[162:163], v196 offset:36864
    v_exp_f32 v96, v96
    v_mfma_f32_16x16x32_bf16 v[64:67], a[136:139], v[8:11], v[64:67]
    v_exp_f32 v97, v97
    v_mfma_f32_16x16x32_bf16 v[64:67], a[140:143], v[12:15], v[64:67]
    ds_read_b64_tr_b16 a[164:165], v197 offset:32768
    v_mfma_f32_16x16x32_bf16 v[68:71], a[128:131], v[16:19], v[164:167]
    ds_read_b64_tr_b16 a[166:167], v197 offset:36864
    v_mfma_f32_16x16x32_bf16 v[68:71], a[132:135], v[20:23], v[68:71]
    v_exp_f32 v98, v98
    v_mfma_f32_16x16x32_bf16 v[68:71], a[136:139], v[24:27], v[68:71]
    ds_read_b64_tr_b16 a[168:169], v198 offset:32768
    v_cvt_pk_bf16_f32 v144, v96, v97
    v_mfma_f32_16x16x32_bf16 v[68:71], a[140:143], v[28:31], v[68:71]
    ds_read_b64_tr_b16 a[170:171], v198 offset:36864
    v_mfma_f32_16x16x32_bf16 v[72:75], a[128:131], v[32:35], v[168:171]
    v_exp_f32 v99, v99
    v_mfma_f32_16x16x32_bf16 v[72:75], a[132:135], v[36:39], v[72:75]
    ds_read_b64_tr_b16 a[172:173], v199 offset:32768
    v_exp_f32 v112, v112
    v_mfma_f32_16x16x32_bf16 v[72:75], a[136:139], v[40:43], v[72:75]
    ds_read_b64_tr_b16 a[174:175], v199 offset:36864
    v_mfma_f32_16x16x32_bf16 v[72:75], a[140:143], v[44:47], v[72:75]
    v_cvt_pk_bf16_f32 v145, v98, v99
    v_mfma_f32_16x16x32_bf16 v[76:79], a[128:131], v[48:51], v[172:175]
    ds_read_b64_tr_b16 a[176:177], v200 offset:32768
    v_exp_f32 v113, v113
    v_mfma_f32_16x16x32_bf16 v[76:79], a[132:135], v[52:55], v[76:79]
    ds_read_b64_tr_b16 a[178:179], v200 offset:36864
    v_mfma_f32_16x16x32_bf16 v[76:79], a[136:139], v[56:59], v[76:79]
    v_exp_f32 v114, v114
    v_mfma_f32_16x16x32_bf16 v[76:79], a[140:143], v[60:63], v[76:79]
    ds_read_b64_tr_b16 a[180:181], v201 offset:32768
    v_mfma_f32_16x16x32_bf16 v[80:83], a[144:147], v[0:3], v[160:163]
    ds_read_b64_tr_b16 a[182:183], v201 offset:36864
    v_cvt_pk_bf16_f32 v146, v112, v113
    v_mfma_f32_16x16x32_bf16 v[80:83], a[148:151], v[4:7], v[80:83]
    v_exp_f32 v115, v115
    v_mfma_f32_16x16x32_bf16 v[80:83], a[152:155], v[8:11], v[80:83]
    ds_read_b64_tr_b16 a[184:185], v202 offset:32768
    v_mfma_f32_16x16x32_bf16 v[80:83], a[156:159], v[12:15], v[80:83]
    ds_read_b64_tr_b16 a[186:187], v202 offset:36864
    v_exp_f32 v100, v100
    v_mfma_f32_16x16x32_bf16 v[84:87], a[144:147], v[16:19], v[164:167]
    v_cvt_pk_bf16_f32 v147, v114, v115
    v_mfma_f32_16x16x32_bf16 v[84:87], a[148:151], v[20:23], v[84:87]
    ds_read_b64_tr_b16 a[188:189], v203 offset:32768
    v_mfma_f32_16x16x32_bf16 v[84:87], a[152:155], v[24:27], v[84:87]
    ds_read_b64_tr_b16 a[190:191], v203 offset:36864
    v_exp_f32 v101, v101
    v_mfma_f32_16x16x32_bf16 v[84:87], a[156:159], v[28:31], v[84:87]
    v_mfma_f32_16x16x32_bf16 v[88:91], a[144:147], v[32:35], v[168:171]
    v_exp_f32 v102, v102
    v_cvt_pk_bf16_f32 v148, v100, v101
    v_mfma_f32_16x16x32_bf16 v[88:91], a[148:151], v[36:39], v[88:91]
    v_exp_f32 v103, v103
    v_mfma_f32_16x16x32_bf16 v[88:91], a[152:155], v[40:43], v[88:91]
    v_exp_f32 v116, v116
    v_mfma_f32_16x16x32_bf16 v[88:91], a[156:159], v[44:47], v[88:91]
    v_cvt_pk_bf16_f32 v149, v102, v103
    v_mfma_f32_16x16x32_bf16 v[92:95], a[144:147], v[48:51], v[172:175]
    v_exp_f32 v117, v117
    v_mfma_f32_16x16x32_bf16 v[92:95], a[148:151], v[52:55], v[92:95]
    v_exp_f32 v118, v118
    v_mfma_f32_16x16x32_bf16 v[92:95], a[152:155], v[56:59], v[92:95]
    v_cvt_pk_bf16_f32 v150, v116, v117
    v_mfma_f32_16x16x32_bf16 v[92:95], a[156:159], v[60:63], v[92:95]
    s_waitcnt lgkmcnt(0)
    v_mfma_f32_16x16x32_bf16 a[0:3], a[160:163], v[128:131], a[0:3]
    ds_read_b128 a[128:131], v192 offset:57344
    v_exp_f32 v119, v119
    v_mfma_f32_16x16x32_bf16 a[4:7], a[160:163], v[132:135], a[4:7]
    v_exp_f32 v104, v104
    v_mfma_f32_16x16x32_bf16 a[8:11], a[160:163], v[136:139], a[8:11]
    ds_read_b128 a[132:135], v193 offset:57344
    v_mfma_f32_16x16x32_bf16 a[12:15], a[160:163], v[140:143], a[12:15]
    v_cvt_pk_bf16_f32 v151, v118, v119
    v_mfma_f32_16x16x32_bf16 a[16:19], a[164:167], v[128:131], a[16:19]
    ds_read_b128 a[136:139], v194 offset:57344
    v_exp_f32 v105, v105
    v_mfma_f32_16x16x32_bf16 a[20:23], a[164:167], v[132:135], a[20:23]
    v_mfma_f32_16x16x32_bf16 a[24:27], a[164:167], v[136:139], a[24:27]
    ds_read_b128 a[140:143], v195 offset:57344
    v_exp_f32 v106, v106
    v_mfma_f32_16x16x32_bf16 a[28:31], a[164:167], v[140:143], a[28:31]
    v_cvt_pk_bf16_f32 v152, v104, v105
    v_mfma_f32_16x16x32_bf16 v[176:179], a[252:255], v[128:131], v[176:179]
    ds_read_b128 a[144:147], v192 offset:61440
    v_mfma_f32_16x16x32_bf16 a[32:35], a[168:171], v[128:131], a[32:35]
    v_exp_f32 v107, v107
    v_mfma_f32_16x16x32_bf16 a[36:39], a[168:171], v[132:135], a[36:39]
    ds_read_b128 a[148:151], v193 offset:61440
    v_exp_f32 v120, v120
    v_mfma_f32_16x16x32_bf16 a[40:43], a[168:171], v[136:139], a[40:43]
    v_cvt_pk_bf16_f32 v153, v106, v107
    v_mfma_f32_16x16x32_bf16 a[44:47], a[168:171], v[140:143], a[44:47]
    ds_read_b128 a[152:155], v194 offset:61440
    v_mfma_f32_16x16x32_bf16 a[48:51], a[172:175], v[128:131], a[48:51]
    v_exp_f32 v121, v121
    v_mfma_f32_16x16x32_bf16 a[52:55], a[172:175], v[132:135], a[52:55]
    ds_read_b128 a[156:159], v195 offset:61440
    v_exp_f32 v122, v122
    v_mfma_f32_16x16x32_bf16 a[56:59], a[172:175], v[136:139], a[56:59]
    v_cvt_pk_bf16_f32 v154, v120, v121
    v_mfma_f32_16x16x32_bf16 a[60:63], a[172:175], v[140:143], a[60:63]
    v_exp_f32 v123, v123
    v_mfma_f32_16x16x32_bf16 v[180:183], a[252:255], v[132:135], v[180:183]
    s_add_u32 m0, s29, 0x14000
    v_mfma_f32_16x16x32_bf16 a[64:67], a[176:179], v[128:131], a[64:67]
    buffer_load_dwordx4 v208, s[12:15], s33 offen offset:0 lds
    v_mfma_f32_16x16x32_bf16 a[68:71], a[176:179], v[132:135], a[68:71]
    v_exp_f32 v108, v108
    v_mfma_f32_16x16x32_bf16 a[72:75], a[176:179], v[136:139], a[72:75]
    v_cvt_pk_bf16_f32 v155, v122, v123
    v_mfma_f32_16x16x32_bf16 a[76:79], a[176:179], v[140:143], a[76:79]
    v_exp_f32 v109, v109
    v_mfma_f32_16x16x32_bf16 a[80:83], a[180:183], v[128:131], a[80:83]
    buffer_load_dwordx4 v242, s[12:15], s33 offen offset:1024 lds
    v_mfma_f32_16x16x32_bf16 a[84:87], a[180:183], v[132:135], a[84:87]
    v_exp_f32 v110, v110
    v_mfma_f32_16x16x32_bf16 a[88:91], a[180:183], v[136:139], a[88:91]
    v_cvt_pk_bf16_f32 v156, v108, v109
    v_mfma_f32_16x16x32_bf16 a[92:95], a[180:183], v[140:143], a[92:95]
    v_exp_f32 v111, v111
    v_mfma_f32_16x16x32_bf16 v[184:187], a[252:255], v[136:139], v[184:187]
    buffer_load_dwordx4 v208, s[12:15], s33 offen offset:2048 lds
    v_mfma_f32_16x16x32_bf16 a[96:99], a[184:187], v[128:131], a[96:99]
    v_exp_f32 v124, v124
    v_mfma_f32_16x16x32_bf16 a[100:103], a[184:187], v[132:135], a[100:103]
    v_cvt_pk_bf16_f32 v157, v110, v111
    v_mfma_f32_16x16x32_bf16 a[104:107], a[184:187], v[136:139], a[104:107]
    v_exp_f32 v125, v125
    v_mfma_f32_16x16x32_bf16 a[108:111], a[184:187], v[140:143], a[108:111]
    buffer_load_dwordx4 v242, s[12:15], s33 offen offset:3072 lds
    v_mfma_f32_16x16x32_bf16 a[112:115], a[188:191], v[128:131], a[112:115]
    s_add_u32 s33, s33, 0x4000
    v_mfma_f32_16x16x32_bf16 a[116:119], a[188:191], v[132:135], a[116:119]
    v_exp_f32 v126, v126
    v_mfma_f32_16x16x32_bf16 a[120:123], a[188:191], v[136:139], a[120:123]
    v_cvt_pk_bf16_f32 v158, v124, v125
    v_mfma_f32_16x16x32_bf16 a[124:127], a[188:191], v[140:143], a[124:127]
    v_exp_f32 v127, v127
    v_mfma_f32_16x16x32_bf16 v[188:191], a[252:255], v[140:143], v[188:191]
    s_nop 0
    v_cvt_pk_bf16_f32 v159, v126, v127
    s_waitcnt lgkmcnt(0)
    v_mfma_f32_16x16x32_bf16 v[96:99], a[128:131], v[0:3], v[160:163]
    ds_read_b64_tr_b16 a[160:161], v196 offset:40960
    v_mfma_f32_16x16x32_bf16 v[96:99], a[132:135], v[4:7], v[96:99]
    ds_read_b64_tr_b16 a[162:163], v196 offset:45056
    v_exp_f32 v64, v64
    v_mfma_f32_16x16x32_bf16 v[96:99], a[136:139], v[8:11], v[96:99]
    v_exp_f32 v65, v65
    v_mfma_f32_16x16x32_bf16 v[96:99], a[140:143], v[12:15], v[96:99]
    ds_read_b64_tr_b16 a[164:165], v197 offset:40960
    v_mfma_f32_16x16x32_bf16 v[100:103], a[128:131], v[16:19], v[164:167]
    ds_read_b64_tr_b16 a[166:167], v197 offset:45056
    v_mfma_f32_16x16x32_bf16 v[100:103], a[132:135], v[20:23], v[100:103]
    v_exp_f32 v66, v66
    v_mfma_f32_16x16x32_bf16 v[100:103], a[136:139], v[24:27], v[100:103]
    ds_read_b64_tr_b16 a[168:169], v198 offset:40960
    v_cvt_pk_bf16_f32 v128, v64, v65
    v_mfma_f32_16x16x32_bf16 v[100:103], a[140:143], v[28:31], v[100:103]
    ds_read_b64_tr_b16 a[170:171], v198 offset:45056
    v_mfma_f32_16x16x32_bf16 v[104:107], a[128:131], v[32:35], v[168:171]
    v_exp_f32 v67, v67
    v_mfma_f32_16x16x32_bf16 v[104:107], a[132:135], v[36:39], v[104:107]
    ds_read_b64_tr_b16 a[172:173], v199 offset:40960
    v_exp_f32 v80, v80
    v_mfma_f32_16x16x32_bf16 v[104:107], a[136:139], v[40:43], v[104:107]
    ds_read_b64_tr_b16 a[174:175], v199 offset:45056
    v_mfma_f32_16x16x32_bf16 v[104:107], a[140:143], v[44:47], v[104:107]
    v_cvt_pk_bf16_f32 v129, v66, v67
    v_mfma_f32_16x16x32_bf16 v[108:111], a[128:131], v[48:51], v[172:175]
    ds_read_b64_tr_b16 a[176:177], v200 offset:40960
    v_exp_f32 v81, v81
    v_mfma_f32_16x16x32_bf16 v[108:111], a[132:135], v[52:55], v[108:111]
    ds_read_b64_tr_b16 a[178:179], v200 offset:45056
    v_mfma_f32_16x16x32_bf16 v[108:111], a[136:139], v[56:59], v[108:111]
    v_exp_f32 v82, v82
    v_mfma_f32_16x16x32_bf16 v[108:111], a[140:143], v[60:63], v[108:111]
    ds_read_b64_tr_b16 a[180:181], v201 offset:40960
    v_cvt_pk_bf16_f32 v130, v80, v81
    v_mfma_f32_16x16x32_bf16 v[112:115], a[144:147], v[0:3], v[160:163]
    ds_read_b64_tr_b16 a[182:183], v201 offset:45056
    v_mfma_f32_16x16x32_bf16 v[112:115], a[148:151], v[4:7], v[112:115]
    v_exp_f32 v83, v83
    v_mfma_f32_16x16x32_bf16 v[112:115], a[152:155], v[8:11], v[112:115]
    ds_read_b64_tr_b16 a[184:185], v202 offset:40960
    v_mfma_f32_16x16x32_bf16 v[112:115], a[156:159], v[12:15], v[112:115]
    ds_read_b64_tr_b16 a[186:187], v202 offset:45056
    v_exp_f32 v68, v68
    v_mfma_f32_16x16x32_bf16 v[116:119], a[144:147], v[16:19], v[164:167]
    v_cvt_pk_bf16_f32 v131, v82, v83
    v_mfma_f32_16x16x32_bf16 v[116:119], a[148:151], v[20:23], v[116:119]
    ds_read_b64_tr_b16 a[188:189], v203 offset:40960
    v_mfma_f32_16x16x32_bf16 v[116:119], a[152:155], v[24:27], v[116:119]
    ds_read_b64_tr_b16 a[190:191], v203 offset:45056
    v_exp_f32 v69, v69
    v_mfma_f32_16x16x32_bf16 v[116:119], a[156:159], v[28:31], v[116:119]
    v_exp_f32 v70, v70
    v_mfma_f32_16x16x32_bf16 v[120:123], a[144:147], v[32:35], v[168:171]
    v_cvt_pk_bf16_f32 v132, v68, v69
    v_mfma_f32_16x16x32_bf16 v[120:123], a[148:151], v[36:39], v[120:123]
    v_exp_f32 v71, v71
    v_mfma_f32_16x16x32_bf16 v[120:123], a[152:155], v[40:43], v[120:123]
    v_exp_f32 v84, v84
    v_mfma_f32_16x16x32_bf16 v[120:123], a[156:159], v[44:47], v[120:123]
    v_cvt_pk_bf16_f32 v133, v70, v71
    v_mfma_f32_16x16x32_bf16 v[124:127], a[144:147], v[48:51], v[172:175]
    v_exp_f32 v85, v85
    v_mfma_f32_16x16x32_bf16 v[124:127], a[148:151], v[52:55], v[124:127]
    v_exp_f32 v86, v86
    v_mfma_f32_16x16x32_bf16 v[124:127], a[152:155], v[56:59], v[124:127]
    v_cvt_pk_bf16_f32 v134, v84, v85
    v_mfma_f32_16x16x32_bf16 v[124:127], a[156:159], v[60:63], v[124:127]
    s_waitcnt vmcnt(16) lgkmcnt(0)
    s_barrier
    v_mfma_f32_16x16x32_bf16 a[0:3], a[160:163], v[144:147], a[0:3]
    ds_read_b128 a[128:131], v192 offset:0
    v_mfma_f32_16x16x32_bf16 a[4:7], a[160:163], v[148:151], a[4:7]
    v_exp_f32 v87, v87
    v_mfma_f32_16x16x32_bf16 a[8:11], a[160:163], v[152:155], a[8:11]
    ds_read_b128 a[132:135], v193 offset:0
    v_exp_f32 v72, v72
    v_mfma_f32_16x16x32_bf16 a[12:15], a[160:163], v[156:159], a[12:15]
    v_cvt_pk_bf16_f32 v135, v86, v87
    v_mfma_f32_16x16x32_bf16 a[16:19], a[164:167], v[144:147], a[16:19]
    ds_read_b128 a[136:139], v194 offset:0
    v_mfma_f32_16x16x32_bf16 a[20:23], a[164:167], v[148:151], a[20:23]
    v_exp_f32 v73, v73
    v_mfma_f32_16x16x32_bf16 a[24:27], a[164:167], v[152:155], a[24:27]
    ds_read_b128 a[140:143], v195 offset:0
    v_exp_f32 v74, v74
    v_mfma_f32_16x16x32_bf16 a[28:31], a[164:167], v[156:159], a[28:31]
    v_cvt_pk_bf16_f32 v136, v72, v73
    v_mfma_f32_16x16x32_bf16 v[176:179], a[252:255], v[144:147], v[176:179]
    ds_read_b128 a[144:147], v192 offset:4096
    v_mfma_f32_16x16x32_bf16 a[32:35], a[168:171], v[144:147], a[32:35]
    v_exp_f32 v75, v75
    v_mfma_f32_16x16x32_bf16 a[36:39], a[168:171], v[148:151], a[36:39]
    ds_read_b128 a[148:151], v193 offset:4096
    v_mfma_f32_16x16x32_bf16 a[40:43], a[168:171], v[152:155], a[40:43]
    v_exp_f32 v88, v88
    v_cvt_pk_bf16_f32 v137, v74, v75
    v_mfma_f32_16x16x32_bf16 a[44:47], a[168:171], v[156:159], a[44:47]
    ds_read_b128 a[152:155], v194 offset:4096
    v_mfma_f32_16x16x32_bf16 a[48:51], a[172:175], v[144:147], a[48:51]
    v_exp_f32 v89, v89
    v_mfma_f32_16x16x32_bf16 a[52:55], a[172:175], v[148:151], a[52:55]
    ds_read_b128 a[156:159], v195 offset:4096
    v_mfma_f32_16x16x32_bf16 a[56:59], a[172:175], v[152:155], a[56:59]
    v_exp_f32 v90, v90
    v_cvt_pk_bf16_f32 v138, v88, v89
    v_mfma_f32_16x16x32_bf16 a[60:63], a[172:175], v[156:159], a[60:63]
    v_exp_f32 v91, v91
    v_mfma_f32_16x16x32_bf16 v[180:183], a[252:255], v[148:151], v[180:183]
    s_add_u32 m0, s29, 0xc000
    v_mfma_f32_16x16x32_bf16 a[64:67], a[176:179], v[144:147], a[64:67]
    buffer_load_dwordx4 v204, s[8:11], s32 offen offset:0 lds
    v_mfma_f32_16x16x32_bf16 a[68:71], a[176:179], v[148:151], a[68:71]
    v_exp_f32 v76, v76
    v_mfma_f32_16x16x32_bf16 a[72:75], a[176:179], v[152:155], a[72:75]
    v_cvt_pk_bf16_f32 v139, v90, v91
    v_mfma_f32_16x16x32_bf16 a[76:79], a[176:179], v[156:159], a[76:79]
    v_exp_f32 v77, v77
    v_mfma_f32_16x16x32_bf16 a[80:83], a[180:183], v[144:147], a[80:83]
    buffer_load_dwordx4 v205, s[8:11], s32 offen offset:1024 lds
    v_mfma_f32_16x16x32_bf16 a[84:87], a[180:183], v[148:151], a[84:87]
    v_exp_f32 v78, v78
    v_mfma_f32_16x16x32_bf16 a[88:91], a[180:183], v[152:155], a[88:91]
    v_cvt_pk_bf16_f32 v140, v76, v77
    v_mfma_f32_16x16x32_bf16 a[92:95], a[180:183], v[156:159], a[92:95]
    v_exp_f32 v79, v79
    v_mfma_f32_16x16x32_bf16 v[184:187], a[252:255], v[152:155], v[184:187]
    buffer_load_dwordx4 v206, s[8:11], s32 offen offset:2048 lds
    v_mfma_f32_16x16x32_bf16 a[96:99], a[184:187], v[144:147], a[96:99]
    v_exp_f32 v92, v92
    v_mfma_f32_16x16x32_bf16 a[100:103], a[184:187], v[148:151], a[100:103]
    v_cvt_pk_bf16_f32 v141, v78, v79
    v_mfma_f32_16x16x32_bf16 a[104:107], a[184:187], v[152:155], a[104:107]
    v_exp_f32 v93, v93
    v_mfma_f32_16x16x32_bf16 a[108:111], a[184:187], v[156:159], a[108:111]
    buffer_load_dwordx4 v207, s[8:11], s32 offen offset:3072 lds
    v_mfma_f32_16x16x32_bf16 a[112:115], a[188:191], v[144:147], a[112:115]
    s_add_u32 s32, s32, 0x4000
    v_mfma_f32_16x16x32_bf16 a[116:119], a[188:191], v[148:151], a[116:119]
    v_exp_f32 v94, v94
    v_mfma_f32_16x16x32_bf16 a[120:123], a[188:191], v[152:155], a[120:123]
    v_cvt_pk_bf16_f32 v142, v92, v93
    v_mfma_f32_16x16x32_bf16 a[124:127], a[188:191], v[156:159], a[124:127]
    v_exp_f32 v95, v95
    v_mfma_f32_16x16x32_bf16 v[188:191], a[252:255], v[156:159], v[188:191]
    s_nop 0
    v_cvt_pk_bf16_f32 v143, v94, v95
    s_waitcnt lgkmcnt(0)
    v_mfma_f32_16x16x32_bf16 v[64:67], a[128:131], v[0:3], v[160:163]
    ds_read_b64_tr_b16 a[160:161], v196 offset:49152
    v_mfma_f32_16x16x32_bf16 v[64:67], a[132:135], v[4:7], v[64:67]
    ds_read_b64_tr_b16 a[162:163], v196 offset:53248
    v_exp_f32 v96, v96
    v_mfma_f32_16x16x32_bf16 v[64:67], a[136:139], v[8:11], v[64:67]
    v_exp_f32 v97, v97
    v_mfma_f32_16x16x32_bf16 v[64:67], a[140:143], v[12:15], v[64:67]
    ds_read_b64_tr_b16 a[164:165], v197 offset:49152
    v_mfma_f32_16x16x32_bf16 v[68:71], a[128:131], v[16:19], v[164:167]
    ds_read_b64_tr_b16 a[166:167], v197 offset:53248
    v_mfma_f32_16x16x32_bf16 v[68:71], a[132:135], v[20:23], v[68:71]
    v_exp_f32 v98, v98
    v_mfma_f32_16x16x32_bf16 v[68:71], a[136:139], v[24:27], v[68:71]
    ds_read_b64_tr_b16 a[168:169], v198 offset:49152
    v_cvt_pk_bf16_f32 v144, v96, v97
    v_mfma_f32_16x16x32_bf16 v[68:71], a[140:143], v[28:31], v[68:71]
    ds_read_b64_tr_b16 a[170:171], v198 offset:53248
    v_mfma_f32_16x16x32_bf16 v[72:75], a[128:131], v[32:35], v[168:171]
    v_exp_f32 v99, v99
    v_mfma_f32_16x16x32_bf16 v[72:75], a[132:135], v[36:39], v[72:75]
    ds_read_b64_tr_b16 a[172:173], v199 offset:49152
    v_exp_f32 v112, v112
    v_mfma_f32_16x16x32_bf16 v[72:75], a[136:139], v[40:43], v[72:75]
    ds_read_b64_tr_b16 a[174:175], v199 offset:53248
    v_mfma_f32_16x16x32_bf16 v[72:75], a[140:143], v[44:47], v[72:75]
    v_cvt_pk_bf16_f32 v145, v98, v99
    v_mfma_f32_16x16x32_bf16 v[76:79], a[128:131], v[48:51], v[172:175]
    ds_read_b64_tr_b16 a[176:177], v200 offset:49152
    v_exp_f32 v113, v113
    v_mfma_f32_16x16x32_bf16 v[76:79], a[132:135], v[52:55], v[76:79]
    ds_read_b64_tr_b16 a[178:179], v200 offset:53248
    v_mfma_f32_16x16x32_bf16 v[76:79], a[136:139], v[56:59], v[76:79]
    v_exp_f32 v114, v114
    v_mfma_f32_16x16x32_bf16 v[76:79], a[140:143], v[60:63], v[76:79]
    ds_read_b64_tr_b16 a[180:181], v201 offset:49152
    v_mfma_f32_16x16x32_bf16 v[80:83], a[144:147], v[0:3], v[160:163]
    ds_read_b64_tr_b16 a[182:183], v201 offset:53248
    v_cvt_pk_bf16_f32 v146, v112, v113
    v_mfma_f32_16x16x32_bf16 v[80:83], a[148:151], v[4:7], v[80:83]
    v_exp_f32 v115, v115
    v_mfma_f32_16x16x32_bf16 v[80:83], a[152:155], v[8:11], v[80:83]
    ds_read_b64_tr_b16 a[184:185], v202 offset:49152
    v_mfma_f32_16x16x32_bf16 v[80:83], a[156:159], v[12:15], v[80:83]
    ds_read_b64_tr_b16 a[186:187], v202 offset:53248
    v_exp_f32 v100, v100
    v_mfma_f32_16x16x32_bf16 v[84:87], a[144:147], v[16:19], v[164:167]
    v_cvt_pk_bf16_f32 v147, v114, v115
    v_mfma_f32_16x16x32_bf16 v[84:87], a[148:151], v[20:23], v[84:87]
    ds_read_b64_tr_b16 a[188:189], v203 offset:49152
    v_mfma_f32_16x16x32_bf16 v[84:87], a[152:155], v[24:27], v[84:87]
    ds_read_b64_tr_b16 a[190:191], v203 offset:53248
    v_exp_f32 v101, v101
    v_mfma_f32_16x16x32_bf16 v[84:87], a[156:159], v[28:31], v[84:87]
    v_mfma_f32_16x16x32_bf16 v[88:91], a[144:147], v[32:35], v[168:171]
    v_exp_f32 v102, v102
    v_cvt_pk_bf16_f32 v148, v100, v101
    v_mfma_f32_16x16x32_bf16 v[88:91], a[148:151], v[36:39], v[88:91]
    v_exp_f32 v103, v103
    v_mfma_f32_16x16x32_bf16 v[88:91], a[152:155], v[40:43], v[88:91]
    v_exp_f32 v116, v116
    v_mfma_f32_16x16x32_bf16 v[88:91], a[156:159], v[44:47], v[88:91]
    v_cvt_pk_bf16_f32 v149, v102, v103
    v_mfma_f32_16x16x32_bf16 v[92:95], a[144:147], v[48:51], v[172:175]
    v_exp_f32 v117, v117
    v_mfma_f32_16x16x32_bf16 v[92:95], a[148:151], v[52:55], v[92:95]
    v_exp_f32 v118, v118
    v_mfma_f32_16x16x32_bf16 v[92:95], a[152:155], v[56:59], v[92:95]
    v_cvt_pk_bf16_f32 v150, v116, v117
    v_mfma_f32_16x16x32_bf16 v[92:95], a[156:159], v[60:63], v[92:95]
    s_waitcnt lgkmcnt(0)
    v_mfma_f32_16x16x32_bf16 a[0:3], a[160:163], v[128:131], a[0:3]
    ds_read_b128 a[128:131], v192 offset:8192
    v_exp_f32 v119, v119
    v_mfma_f32_16x16x32_bf16 a[4:7], a[160:163], v[132:135], a[4:7]
    v_exp_f32 v104, v104
    v_mfma_f32_16x16x32_bf16 a[8:11], a[160:163], v[136:139], a[8:11]
    ds_read_b128 a[132:135], v193 offset:8192
    v_mfma_f32_16x16x32_bf16 a[12:15], a[160:163], v[140:143], a[12:15]
    v_cvt_pk_bf16_f32 v151, v118, v119
    v_mfma_f32_16x16x32_bf16 a[16:19], a[164:167], v[128:131], a[16:19]
    ds_read_b128 a[136:139], v194 offset:8192
    v_exp_f32 v105, v105
    v_mfma_f32_16x16x32_bf16 a[20:23], a[164:167], v[132:135], a[20:23]
    v_mfma_f32_16x16x32_bf16 a[24:27], a[164:167], v[136:139], a[24:27]
    ds_read_b128 a[140:143], v195 offset:8192
    v_exp_f32 v106, v106
    v_mfma_f32_16x16x32_bf16 a[28:31], a[164:167], v[140:143], a[28:31]
    v_cvt_pk_bf16_f32 v152, v104, v105
    v_mfma_f32_16x16x32_bf16 v[176:179], a[252:255], v[128:131], v[176:179]
    ds_read_b128 a[144:147], v192 offset:12288
    v_mfma_f32_16x16x32_bf16 a[32:35], a[168:171], v[128:131], a[32:35]
    v_exp_f32 v107, v107
    v_mfma_f32_16x16x32_bf16 a[36:39], a[168:171], v[132:135], a[36:39]
    ds_read_b128 a[148:151], v193 offset:12288
    v_exp_f32 v120, v120
    v_mfma_f32_16x16x32_bf16 a[40:43], a[168:171], v[136:139], a[40:43]
    v_cvt_pk_bf16_f32 v153, v106, v107
    v_mfma_f32_16x16x32_bf16 a[44:47], a[168:171], v[140:143], a[44:47]
    ds_read_b128 a[152:155], v194 offset:12288
    v_mfma_f32_16x16x32_bf16 a[48:51], a[172:175], v[128:131], a[48:51]
    v_exp_f32 v121, v121
    v_mfma_f32_16x16x32_bf16 a[52:55], a[172:175], v[132:135], a[52:55]
    ds_read_b128 a[156:159], v195 offset:12288
    v_exp_f32 v122, v122
    v_mfma_f32_16x16x32_bf16 a[56:59], a[172:175], v[136:139], a[56:59]
    v_cvt_pk_bf16_f32 v154, v120, v121
    v_mfma_f32_16x16x32_bf16 a[60:63], a[172:175], v[140:143], a[60:63]
    v_exp_f32 v123, v123
    v_mfma_f32_16x16x32_bf16 v[180:183], a[252:255], v[132:135], v[180:183]
    s_add_u32 m0, s29, 0x18000
    v_mfma_f32_16x16x32_bf16 a[64:67], a[176:179], v[128:131], a[64:67]
    buffer_load_dwordx4 v208, s[12:15], s33 offen offset:0 lds
    v_mfma_f32_16x16x32_bf16 a[68:71], a[176:179], v[132:135], a[68:71]
    v_exp_f32 v108, v108
    v_mfma_f32_16x16x32_bf16 a[72:75], a[176:179], v[136:139], a[72:75]
    v_cvt_pk_bf16_f32 v155, v122, v123
    v_mfma_f32_16x16x32_bf16 a[76:79], a[176:179], v[140:143], a[76:79]
    v_exp_f32 v109, v109
    v_mfma_f32_16x16x32_bf16 a[80:83], a[180:183], v[128:131], a[80:83]
    buffer_load_dwordx4 v242, s[12:15], s33 offen offset:1024 lds
    v_mfma_f32_16x16x32_bf16 a[84:87], a[180:183], v[132:135], a[84:87]
    v_exp_f32 v110, v110
    v_mfma_f32_16x16x32_bf16 a[88:91], a[180:183], v[136:139], a[88:91]
    v_cvt_pk_bf16_f32 v156, v108, v109
    v_mfma_f32_16x16x32_bf16 a[92:95], a[180:183], v[140:143], a[92:95]
    v_exp_f32 v111, v111
    v_mfma_f32_16x16x32_bf16 v[184:187], a[252:255], v[136:139], v[184:187]
    buffer_load_dwordx4 v208, s[12:15], s33 offen offset:2048 lds
    v_mfma_f32_16x16x32_bf16 a[96:99], a[184:187], v[128:131], a[96:99]
    v_exp_f32 v124, v124
    v_mfma_f32_16x16x32_bf16 a[100:103], a[184:187], v[132:135], a[100:103]
    v_cvt_pk_bf16_f32 v157, v110, v111
    v_mfma_f32_16x16x32_bf16 a[104:107], a[184:187], v[136:139], a[104:107]
    v_exp_f32 v125, v125
    v_mfma_f32_16x16x32_bf16 a[108:111], a[184:187], v[140:143], a[108:111]
    buffer_load_dwordx4 v242, s[12:15], s33 offen offset:3072 lds
    v_mfma_f32_16x16x32_bf16 a[112:115], a[188:191], v[128:131], a[112:115]
    s_add_u32 s33, s33, 0x4000
    v_mfma_f32_16x16x32_bf16 a[116:119], a[188:191], v[132:135], a[116:119]
    v_exp_f32 v126, v126
    v_mfma_f32_16x16x32_bf16 a[120:123], a[188:191], v[136:139], a[120:123]
    v_cvt_pk_bf16_f32 v158, v124, v125
    v_mfma_f32_16x16x32_bf16 a[124:127], a[188:191], v[140:143], a[124:127]
    v_exp_f32 v127, v127
    v_mfma_f32_16x16x32_bf16 v[188:191], a[252:255], v[140:143], v[188:191]
    s_nop 0
    v_cvt_pk_bf16_f32 v159, v126, v127
    s_waitcnt lgkmcnt(0)
    v_mfma_f32_16x16x32_bf16 v[96:99], a[128:131], v[0:3], v[160:163]
    ds_read_b64_tr_b16 a[160:161], v196 offset:57344
    v_mfma_f32_16x16x32_bf16 v[96:99], a[132:135], v[4:7], v[96:99]
    ds_read_b64_tr_b16 a[162:163], v196 offset:61440
    v_exp_f32 v64, v64
    v_mfma_f32_16x16x32_bf16 v[96:99], a[136:139], v[8:11], v[96:99]
    v_exp_f32 v65, v65
    v_mfma_f32_16x16x32_bf16 v[96:99], a[140:143], v[12:15], v[96:99]
    ds_read_b64_tr_b16 a[164:165], v197 offset:57344
    v_mfma_f32_16x16x32_bf16 v[100:103], a[128:131], v[16:19], v[164:167]
    ds_read_b64_tr_b16 a[166:167], v197 offset:61440
    v_mfma_f32_16x16x32_bf16 v[100:103], a[132:135], v[20:23], v[100:103]
    v_exp_f32 v66, v66
    v_mfma_f32_16x16x32_bf16 v[100:103], a[136:139], v[24:27], v[100:103]
    ds_read_b64_tr_b16 a[168:169], v198 offset:57344
    v_cvt_pk_bf16_f32 v128, v64, v65
    v_mfma_f32_16x16x32_bf16 v[100:103], a[140:143], v[28:31], v[100:103]
    ds_read_b64_tr_b16 a[170:171], v198 offset:61440
    v_mfma_f32_16x16x32_bf16 v[104:107], a[128:131], v[32:35], v[168:171]
    v_exp_f32 v67, v67
    v_mfma_f32_16x16x32_bf16 v[104:107], a[132:135], v[36:39], v[104:107]
    ds_read_b64_tr_b16 a[172:173], v199 offset:57344
    v_exp_f32 v80, v80
    v_mfma_f32_16x16x32_bf16 v[104:107], a[136:139], v[40:43], v[104:107]
    ds_read_b64_tr_b16 a[174:175], v199 offset:61440
    v_mfma_f32_16x16x32_bf16 v[104:107], a[140:143], v[44:47], v[104:107]
    v_cvt_pk_bf16_f32 v129, v66, v67
    v_mfma_f32_16x16x32_bf16 v[108:111], a[128:131], v[48:51], v[172:175]
    ds_read_b64_tr_b16 a[176:177], v200 offset:57344
    v_exp_f32 v81, v81
    v_mfma_f32_16x16x32_bf16 v[108:111], a[132:135], v[52:55], v[108:111]
    ds_read_b64_tr_b16 a[178:179], v200 offset:61440
    v_mfma_f32_16x16x32_bf16 v[108:111], a[136:139], v[56:59], v[108:111]
    v_exp_f32 v82, v82
    v_mfma_f32_16x16x32_bf16 v[108:111], a[140:143], v[60:63], v[108:111]
    ds_read_b64_tr_b16 a[180:181], v201 offset:57344
    v_cvt_pk_bf16_f32 v130, v80, v81
    v_mfma_f32_16x16x32_bf16 v[112:115], a[144:147], v[0:3], v[160:163]
    ds_read_b64_tr_b16 a[182:183], v201 offset:61440
    v_mfma_f32_16x16x32_bf16 v[112:115], a[148:151], v[4:7], v[112:115]
    v_exp_f32 v83, v83
    v_mfma_f32_16x16x32_bf16 v[112:115], a[152:155], v[8:11], v[112:115]
    ds_read_b64_tr_b16 a[184:185], v202 offset:57344
    v_mfma_f32_16x16x32_bf16 v[112:115], a[156:159], v[12:15], v[112:115]
    ds_read_b64_tr_b16 a[186:187], v202 offset:61440
    v_exp_f32 v68, v68
    v_mfma_f32_16x16x32_bf16 v[116:119], a[144:147], v[16:19], v[164:167]
    v_cvt_pk_bf16_f32 v131, v82, v83
    v_mfma_f32_16x16x32_bf16 v[116:119], a[148:151], v[20:23], v[116:119]
    ds_read_b64_tr_b16 a[188:189], v203 offset:57344
    v_mfma_f32_16x16x32_bf16 v[116:119], a[152:155], v[24:27], v[116:119]
    ds_read_b64_tr_b16 a[190:191], v203 offset:61440
    v_exp_f32 v69, v69
    v_mfma_f32_16x16x32_bf16 v[116:119], a[156:159], v[28:31], v[116:119]
    v_exp_f32 v70, v70
    v_mfma_f32_16x16x32_bf16 v[120:123], a[144:147], v[32:35], v[168:171]
    v_cvt_pk_bf16_f32 v132, v68, v69
    v_mfma_f32_16x16x32_bf16 v[120:123], a[148:151], v[36:39], v[120:123]
    v_exp_f32 v71, v71
    v_mfma_f32_16x16x32_bf16 v[120:123], a[152:155], v[40:43], v[120:123]
    v_exp_f32 v84, v84
    v_mfma_f32_16x16x32_bf16 v[120:123], a[156:159], v[44:47], v[120:123]
    v_cvt_pk_bf16_f32 v133, v70, v71
    v_mfma_f32_16x16x32_bf16 v[124:127], a[144:147], v[48:51], v[172:175]
    v_exp_f32 v85, v85
    v_mfma_f32_16x16x32_bf16 v[124:127], a[148:151], v[52:55], v[124:127]
    v_exp_f32 v86, v86
    v_mfma_f32_16x16x32_bf16 v[124:127], a[152:155], v[56:59], v[124:127]
    v_cvt_pk_bf16_f32 v134, v84, v85
    v_mfma_f32_16x16x32_bf16 v[124:127], a[156:159], v[60:63], v[124:127]
    s_waitcnt vmcnt(16) lgkmcnt(0)
    s_barrier
    v_mfma_f32_16x16x32_bf16 a[0:3], a[160:163], v[144:147], a[0:3]
    ds_read_b128 a[128:131], v192 offset:16384
    v_mfma_f32_16x16x32_bf16 a[4:7], a[160:163], v[148:151], a[4:7]
    v_exp_f32 v87, v87
    v_mfma_f32_16x16x32_bf16 a[8:11], a[160:163], v[152:155], a[8:11]
    ds_read_b128 a[132:135], v193 offset:16384
    v_exp_f32 v72, v72
    v_mfma_f32_16x16x32_bf16 a[12:15], a[160:163], v[156:159], a[12:15]
    v_cvt_pk_bf16_f32 v135, v86, v87
    v_mfma_f32_16x16x32_bf16 a[16:19], a[164:167], v[144:147], a[16:19]
    ds_read_b128 a[136:139], v194 offset:16384
    v_mfma_f32_16x16x32_bf16 a[20:23], a[164:167], v[148:151], a[20:23]
    v_exp_f32 v73, v73
    v_mfma_f32_16x16x32_bf16 a[24:27], a[164:167], v[152:155], a[24:27]
    ds_read_b128 a[140:143], v195 offset:16384
    v_exp_f32 v74, v74
    v_mfma_f32_16x16x32_bf16 a[28:31], a[164:167], v[156:159], a[28:31]
    v_cvt_pk_bf16_f32 v136, v72, v73
    v_mfma_f32_16x16x32_bf16 v[176:179], a[252:255], v[144:147], v[176:179]
    ds_read_b128 a[144:147], v192 offset:20480
    v_mfma_f32_16x16x32_bf16 a[32:35], a[168:171], v[144:147], a[32:35]
    v_exp_f32 v75, v75
    v_mfma_f32_16x16x32_bf16 a[36:39], a[168:171], v[148:151], a[36:39]
    ds_read_b128 a[148:151], v193 offset:20480
    v_mfma_f32_16x16x32_bf16 a[40:43], a[168:171], v[152:155], a[40:43]
    v_exp_f32 v88, v88
    v_cvt_pk_bf16_f32 v137, v74, v75
    v_mfma_f32_16x16x32_bf16 a[44:47], a[168:171], v[156:159], a[44:47]
    ds_read_b128 a[152:155], v194 offset:20480
    v_mfma_f32_16x16x32_bf16 a[48:51], a[172:175], v[144:147], a[48:51]
    v_exp_f32 v89, v89
    v_mfma_f32_16x16x32_bf16 a[52:55], a[172:175], v[148:151], a[52:55]
    ds_read_b128 a[156:159], v195 offset:20480
    v_mfma_f32_16x16x32_bf16 a[56:59], a[172:175], v[152:155], a[56:59]
    v_exp_f32 v90, v90
    v_cvt_pk_bf16_f32 v138, v88, v89
    v_mfma_f32_16x16x32_bf16 a[60:63], a[172:175], v[156:159], a[60:63]
    v_exp_f32 v91, v91
    v_mfma_f32_16x16x32_bf16 v[180:183], a[252:255], v[148:151], v[180:183]
    s_add_u32 m0, s29, 0x0
    v_mfma_f32_16x16x32_bf16 a[64:67], a[176:179], v[144:147], a[64:67]
    buffer_load_dwordx4 v204, s[8:11], s32 offen offset:0 lds
    v_mfma_f32_16x16x32_bf16 a[68:71], a[176:179], v[148:151], a[68:71]
    v_exp_f32 v76, v76
    v_mfma_f32_16x16x32_bf16 a[72:75], a[176:179], v[152:155], a[72:75]
    v_cvt_pk_bf16_f32 v139, v90, v91
    v_mfma_f32_16x16x32_bf16 a[76:79], a[176:179], v[156:159], a[76:79]
    v_exp_f32 v77, v77
    v_mfma_f32_16x16x32_bf16 a[80:83], a[180:183], v[144:147], a[80:83]
    buffer_load_dwordx4 v205, s[8:11], s32 offen offset:1024 lds
    v_mfma_f32_16x16x32_bf16 a[84:87], a[180:183], v[148:151], a[84:87]
    v_exp_f32 v78, v78
    v_mfma_f32_16x16x32_bf16 a[88:91], a[180:183], v[152:155], a[88:91]
    v_cvt_pk_bf16_f32 v140, v76, v77
    v_mfma_f32_16x16x32_bf16 a[92:95], a[180:183], v[156:159], a[92:95]
    v_exp_f32 v79, v79
    v_mfma_f32_16x16x32_bf16 v[184:187], a[252:255], v[152:155], v[184:187]
    buffer_load_dwordx4 v206, s[8:11], s32 offen offset:2048 lds
    v_mfma_f32_16x16x32_bf16 a[96:99], a[184:187], v[144:147], a[96:99]
    v_exp_f32 v92, v92
    v_mfma_f32_16x16x32_bf16 a[100:103], a[184:187], v[148:151], a[100:103]
    v_cvt_pk_bf16_f32 v141, v78, v79
    v_mfma_f32_16x16x32_bf16 a[104:107], a[184:187], v[152:155], a[104:107]
    v_exp_f32 v93, v93
    v_mfma_f32_16x16x32_bf16 a[108:111], a[184:187], v[156:159], a[108:111]
    buffer_load_dwordx4 v207, s[8:11], s32 offen offset:3072 lds
    v_mfma_f32_16x16x32_bf16 a[112:115], a[188:191], v[144:147], a[112:115]
    s_add_u32 s32, s32, 0x4000
    v_mfma_f32_16x16x32_bf16 a[116:119], a[188:191], v[148:151], a[116:119]
    v_exp_f32 v94, v94
    v_mfma_f32_16x16x32_bf16 a[120:123], a[188:191], v[152:155], a[120:123]
    v_cvt_pk_bf16_f32 v142, v92, v93
    v_mfma_f32_16x16x32_bf16 a[124:127], a[188:191], v[156:159], a[124:127]
    v_exp_f32 v95, v95
    v_mfma_f32_16x16x32_bf16 v[188:191], a[252:255], v[156:159], v[188:191]
    s_nop 0
    v_cvt_pk_bf16_f32 v143, v94, v95
    s_mov_b32 s34, 6
    s_mul_hi_u32 s35, s2, 0x2aaaaaab
    s_mul_i32 s35, s35, 6
    s_sub_u32 s100, s2, s35
    s_add_u32 s100, s100, 1
.p2align 6
L_attn_loop:
    s_waitcnt lgkmcnt(0)
    v_mfma_f32_16x16x32_bf16 v[64:67], a[128:131], v[0:3], v[160:163]
    ds_read_b64_tr_b16 a[160:161], v196 offset:0
    v_mfma_f32_16x16x32_bf16 v[64:67], a[132:135], v[4:7], v[64:67]
    ds_read_b64_tr_b16 a[162:163], v196 offset:4096
    v_exp_f32 v96, v96
    v_mfma_f32_16x16x32_bf16 v[64:67], a[136:139], v[8:11], v[64:67]
    v_exp_f32 v97, v97
    v_mfma_f32_16x16x32_bf16 v[64:67], a[140:143], v[12:15], v[64:67]
    ds_read_b64_tr_b16 a[164:165], v197 offset:0
    v_mfma_f32_16x16x32_bf16 v[68:71], a[128:131], v[16:19], v[164:167]
    ds_read_b64_tr_b16 a[166:167], v197 offset:4096
    v_mfma_f32_16x16x32_bf16 v[68:71], a[132:135], v[20:23], v[68:71]
    v_exp_f32 v98, v98
    v_cvt_pk_bf16_f32 v144, v96, v97
    v_mfma_f32_16x16x32_bf16 v[68:71], a[136:139], v[24:27], v[68:71]
    ds_read_b64_tr_b16 a[168:169], v198 offset:0
    v_mfma_f32_16x16x32_bf16 v[68:71], a[140:143], v[28:31], v[68:71]
    ds_read_b64_tr_b16 a[170:171], v198 offset:4096
    v_exp_f32 v99, v99
    v_mfma_f32_16x16x32_bf16 v[72:75], a[128:131], v[32:35], v[168:171]
    v_mfma_f32_16x16x32_bf16 v[72:75], a[132:135], v[36:39], v[72:75]
    ds_read_b64_tr_b16 a[172:173], v199 offset:0
    v_exp_f32 v112, v112
    v_mfma_f32_16x16x32_bf16 v[72:75], a[136:139], v[40:43], v[72:75]
    ds_read_b64_tr_b16 a[174:175], v199 offset:4096
    v_mfma_f32_16x16x32_bf16 v[72:75], a[140:143], v[44:47], v[72:75]
    v_cvt_pk_bf16_f32 v145, v98, v99
    v_exp_f32 v113, v113
    v_mfma_f32_16x16x32_bf16 v[76:79], a[128:131], v[48:51], v[172:175]
    ds_read_b64_tr_b16 a[176:177], v200 offset:0
    v_mfma_f32_16x16x32_bf16 v[76:79], a[132:135], v[52:55], v[76:79]
    ds_read_b64_tr_b16 a[178:179], v200 offset:4096
    v_mfma_f32_16x16x32_bf16 v[76:79], a[136:139], v[56:59], v[76:79]
    v_exp_f32 v114, v114
    v_mfma_f32_16x16x32_bf16 v[76:79], a[140:143], v[60:63], v[76:79]
    ds_read_b64_tr_b16 a[180:181], v201 offset:0
    v_cvt_pk_bf16_f32 v146, v112, v113
    v_mfma_f32_16x16x32_bf16 v[80:83], a[144:147], v[0:3], v[160:163]
    ds_read_b64_tr_b16 a[182:183], v201 offset:4096
    v_exp_f32 v115, v115
    v_mfma_f32_16x16x32_bf16 v[80:83], a[148:151], v[4:7], v[80:83]
    v_mfma_f32_16x16x32_bf16 v[80:83], a[152:155], v[8:11], v[80:83]
    ds_read_b64_tr_b16 a[184:185], v202 offset:0
    v_exp_f32 v100, v100
    v_mfma_f32_16x16x32_bf16 v[80:83], a[156:159], v[12:15], v[80:83]
    ds_read_b64_tr_b16 a[186:187], v202 offset:4096
    v_mfma_f32_16x16x32_bf16 v[84:87], a[144:147], v[16:19], v[164:167]
    s_cmp_lg_u32 s34, s100
    s_cbranch_scc1 L_rel_skip1
    s_lshl_b32 s35, s2, 1
    s_add_u32 s35, s35, s28
    s_mul_hi_u32 s38, s35, 0x4bda130
    s_mul_i32 s39, s38, 54
    s_sub_u32 s39, s35, s39
    s_mul_i32 s39, s39, 40960
    s_mul_i32 s38, s38, 160
    s_add_u32 s50, s39, s38
    s_mov_b32 s52, s98
    s_and_b32 s53, s99, 0xffff
    s_mov_b32 s54, 0x21c000
    s_mov_b32 s55, 0x20000
    s_cmp_lt_u32 s35, 432
    s_cselect_b32 s54, s54, 0
    s_and_b32 s49, s28, 1
    s_mul_i32 s49, s49, 5120
    s_add_u32 s49, s49, 0x25000
    s_cmp_ge_u32 s28, 2
    s_cbranch_scc1 L_rel_now2
    s_add_u32 m0, s49, 0
    s_nop 0
    buffer_load_dwordx4 v244, s[52:55], s50 offen lds
    s_add_u32 m0, s49, 1024
    s_nop 0
    buffer_load_dwordx4 v245, s[52:55], s50 offen lds
    s_add_u32 m0, s49, 2048
    s_nop 0
    buffer_load_dwordx4 v246, s[52:55], s50 offen lds
    s_add_u32 m0, s49, 3072
    s_nop 0
    buffer_load_dwordx4 v247, s[52:55], s50 offen lds
    s_add_u32 m0, s49, 4096
    s_nop 0
    buffer_load_dwordx4 v250, s[52:55], s50 offen lds
L_rel_now2:
L_rel_skip1:
    v_mfma_f32_16x16x32_bf16 v[84:87], a[148:151], v[20:23], v[84:87]
    ds_read_b64_tr_b16 a[188:189], v203 offset:0
    v_cvt_pk_bf16_f32 v147, v114, v115
    v_mfma_f32_16x16x32_bf16 v[84:87], a[152:155], v[24:27], v[84:87]
    ds_read_b64_tr_b16 a[190:191], v203 offset:4096
    v_mfma_f32_16x16x32_bf16 v[84:87], a[156:159], v[28:31], v[84:87]
    v_exp_f32 v101, v101
    v_mfma_f32_16x16x32_bf16 v[88:91], a[144:147], v[32:35], v[168:171]
    v_exp_f32 v102, v102
    v_mfma_f32_16x16x32_bf16 v[88:91], a[148:151], v[36:39], v[88:91]
    v_cvt_pk_bf16_f32 v148, v100, v101
    v_mfma_f32_16x16x32_bf16 v[88:91], a[152:155], v[40:43], v[88:91]
    v_exp_f32 v103, v103
    v_mfma_f32_16x16x32_bf16 v[88:91], a[156:159], v[44:47], v[88:91]
    v_exp_f32 v116, v116
    v_mfma_f32_16x16x32_bf16 v[92:95], a[144:147], v[48:51], v[172:175]
    v_cvt_pk_bf16_f32 v149, v102, v103
    v_exp_f32 v117, v117
    v_mfma_f32_16x16x32_bf16 v[92:95], a[148:151], v[52:55], v[92:95]
    v_mfma_f32_16x16x32_bf16 v[92:95], a[152:155], v[56:59], v[92:95]
    v_exp_f32 v118, v118
    v_cvt_pk_bf16_f32 v150, v116, v117
    v_mfma_f32_16x16x32_bf16 v[92:95], a[156:159], v[60:63], v[92:95]
    s_waitcnt lgkmcnt(0)
    v_mfma_f32_16x16x32_bf16 a[0:3], a[160:163], v[128:131], a[0:3]
    ds_read_b128 a[128:131], v192 offset:24576
    v_exp_f32 v119, v119
    v_mfma_f32_16x16x32_bf16 a[4:7], a[160:163], v[132:135], a[4:7]
    v_exp_f32 v104, v104
    v_mfma_f32_16x16x32_bf16 a[8:11], a[160:163], v[136:139], a[8:11]
    ds_read_b128 a[132:135], v193 offset:24576
    v_mfma_f32_16x16x32_bf16 a[12:15], a[160:163], v[140:143], a[12:15]
    v_cvt_pk_bf16_f32 v151, v118, v119
    v_mfma_f32_16x16x32_bf16 a[16:19], a[164:167], v[128:131], a[16:19]
    ds_read_b128 a[136:139], v194 offset:24576
    v_exp_f32 v105, v105
    v_mfma_f32_16x16x32_bf16 a[20:23], a[164:167], v[132:135], a[20:23]
    v_exp_f32 v106, v106
    v_mfma_f32_16x16x32_bf16 a[24:27], a[164:167], v[136:139], a[24:27]
    ds_read_b128 a[140:143], v195 offset:24576
    v_mfma_f32_16x16x32_bf16 a[28:31], a[164:167], v[140:143], a[28:31]
    v_cvt_pk_bf16_f32 v152, v104, v105
    v_mfma_f32_16x16x32_bf16 v[176:179], a[252:255], v[128:131], v[176:179]
    ds_read_b128 a[144:147], v192 offset:28672
    s_cmp_lg_u32 s34, s100
    s_cbranch_scc1 L_rel_skip2
    s_lshl_b32 s35, s2, 2
    s_add_u32 s35, s35, s28
    s_lshr_b32 s38, s35, 7
    s_and_b32 s39, s35, 127
    s_mul_i32 s39, s39, 40960
    s_mul_i32 s38, s38, 160
    s_add_u32 s50, s39, s38
    s_mov_b32 s52, s96
    s_and_b32 s53, s97, 0xffff
    s_mov_b32 s54, 0x500000
    s_mov_b32 s55, 0x20000
    s_mul_i32 s49, s28, 5120
    s_add_u32 s49, s49, 0x20000
    s_add_u32 m0, s49, 0
    s_nop 0
    buffer_load_dwordx4 v244, s[52:55], s50 offen lds
    s_add_u32 m0, s49, 1024
    s_nop 0
    buffer_load_dwordx4 v245, s[52:55], s50 offen lds
    s_add_u32 m0, s49, 2048
    s_nop 0
    buffer_load_dwordx4 v246, s[52:55], s50 offen lds
    s_add_u32 m0, s49, 3072
    s_nop 0
    buffer_load_dwordx4 v247, s[52:55], s50 offen lds
    s_add_u32 m0, s49, 4096
    s_nop 0
    buffer_load_dwordx4 v250, s[52:55], s50 offen lds
L_rel_skip2:
    v_mfma_f32_16x16x32_bf16 a[32:35], a[168:171], v[128:131], a[32:35]
    v_exp_f32 v107, v107
    v_mfma_f32_16x16x32_bf16 a[36:39], a[168:171], v[132:135], a[36:39]
    ds_read_b128 a[148:151], v193 offset:28672
    v_mfma_f32_16x16x32_bf16 a[40:43], a[168:171], v[136:139], a[40:43]
    v_exp_f32 v120, v120
    v_mfma_f32_16x16x32_bf16 a[44:47], a[168:171], v[140:143], a[44:47]
    ds_read_b128 a[152:155], v194 offset:28672
    v_mfma_f32_16x16x32_bf16 a[48:51], a[172:175], v[128:131], a[48:51]
    v_cvt_pk_bf16_f32 v153, v106, v107
    v_exp_f32 v121, v121
    v_mfma_f32_16x16x32_bf16 a[52:55], a[172:175], v[132:135], a[52:55]
    ds_read_b128 a[156:159], v195 offset:28672
    v_mfma_f32_16x16x32_bf16 a[56:59], a[172:175], v[136:139], a[56:59]
    v_exp_f32 v122, v122
    v_mfma_f32_16x16x32_bf16 a[60:63], a[172:175], v[140:143], a[60:63]
    v_cvt_pk_bf16_f32 v154, v120, v121
    v_mfma_f32_16x16x32_bf16 v[180:183], a[252:255], v[132:135], v[180:183]
    s_add_u32 m0, s29, 0x1c000
    v_exp_f32 v123, v123
    v_mfma_f32_16x16x32_bf16 a[64:67], a[176:179], v[128:131], a[64:67]
    buffer_load_dwordx4 v208, s[12:15], s33 offen offset:0 lds
    v_mfma_f32_16x16x32_bf16 a[68:71], a[176:179], v[132:135], a[68:71]
    v_mfma_f32_16x16x32_bf16 a[72:75], a[176:179], v[136:139], a[72:75]
    v_exp_f32 v108, v108
    v_cvt_pk_bf16_f32 v155, v122, v123
    v_mfma_f32_16x16x32_bf16 a[76:79], a[176:179], v[140:143], a[76:79]
    v_exp_f32 v109, v109
    v_mfma_f32_16x16x32_bf16 a[80:83], a[180:183], v[128:131], a[80:83]
    buffer_load_dwordx4 v242, s[12:15], s33 offen offset:1024 lds
    v_mfma_f32_16x16x32_bf16 a[84:87], a[180:183], v[132:135], a[84:87]
    v_mfma_f32_16x16x32_bf16 a[88:91], a[180:183], v[136:139], a[88:91]
    v_exp_f32 v110, v110
    v_cvt_pk_bf16_f32 v156, v108, v109
    v_mfma_f32_16x16x32_bf16 a[92:95], a[180:183], v[140:143], a[92:95]
    v_exp_f32 v111, v111
    v_mfma_f32_16x16x32_bf16 v[184:187], a[252:255], v[136:139], v[184:187]
    buffer_load_dwordx4 v208, s[12:15], s33 offen offset:2048 lds
    v_mfma_f32_16x16x32_bf16 a[96:99], a[184:187], v[128:131], a[96:99]
    v_mfma_f32_16x16x32_bf16 a[100:103], a[184:187], v[132:135], a[100:103]
    v_exp_f32 v124, v124
    v_cvt_pk_bf16_f32 v157, v110, v111
    v_mfma_f32_16x16x32_bf16 a[104:107], a[184:187], v[136:139], a[104:107]
    v_exp_f32 v125, v125
    v_mfma_f32_16x16x32_bf16 a[108:111], a[184:187], v[140:143], a[108:111]
    buffer_load_dwordx4 v242, s[12:15], s33 offen offset:3072 lds
    v_mfma_f32_16x16x32_bf16 a[112:115], a[188:191], v[128:131], a[112:115]
    s_add_u32 s33, s33, 0x4000
    v_mfma_f32_16x16x32_bf16 a[116:119], a[188:191], v[132:135], a[116:119]
    v_exp_f32 v126, v126
    v_mfma_f32_16x16x32_bf16 a[120:123], a[188:191], v[136:139], a[120:123]
    v_cvt_pk_bf16_f32 v158, v124, v125
    v_mfma_f32_16x16x32_bf16 a[124:127], a[188:191], v[140:143], a[124:127]
    v_exp_f32 v127, v127
    v_mfma_f32_16x16x32_bf16 v[188:191], a[252:255], v[140:143], v[188:191]
    s_nop 0
    v_cvt_pk_bf16_f32 v159, v126, v127
    s_waitcnt lgkmcnt(0)
    v_mfma_f32_16x16x32_bf16 v[96:99], a[128:131], v[0:3], v[160:163]
    ds_read_b64_tr_b16 a[160:161], v196 offset:8192
    v_mfma_f32_16x16x32_bf16 v[96:99], a[132:135], v[4:7], v[96:99]
    ds_read_b64_tr_b16 a[162:163], v196 offset:12288
    v_exp_f32 v64, v64
    v_mfma_f32_16x16x32_bf16 v[96:99], a[136:139], v[8:11], v[96:99]
    v_exp_f32 v65, v65
    v_mfma_f32_16x16x32_bf16 v[96:99], a[140:143], v[12:15], v[96:99]
    ds_read_b64_tr_b16 a[164:165], v197 offset:8192
    v_mfma_f32_16x16x32_bf16 v[100:103], a[128:131], v[16:19], v[164:167]
    ds_read_b64_tr_b16 a[166:167], v197 offset:12288
    v_mfma_f32_16x16x32_bf16 v[100:103], a[132:135], v[20:23], v[100:103]
    v_exp_f32 v66, v66
    v_mfma_f32_16x16x32_bf16 v[100:103], a[136:139], v[24:27], v[100:103]
    ds_read_b64_tr_b16 a[168:169], v198 offset:8192
    v_cvt_pk_bf16_f32 v128, v64, v65
    v_mfma_f32_16x16x32_bf16 v[100:103], a[140:143], v[28:31], v[100:103]
    ds_read_b64_tr_b16 a[170:171], v198 offset:12288
    v_mfma_f32_16x16x32_bf16 v[104:107], a[128:131], v[32:35], v[168:171]
    v_exp_f32 v67, v67
    v_mfma_f32_16x16x32_bf16 v[104:107], a[132:135], v[36:39], v[104:107]
    ds_read_b64_tr_b16 a[172:173], v199 offset:8192
    v_exp_f32 v80, v80
    v_mfma_f32_16x16x32_bf16 v[104:107], a[136:139], v[40:43], v[104:107]
    ds_read_b64_tr_b16 a[174:175], v199 offset:12288
    v_mfma_f32_16x16x32_bf16 v[104:107], a[140:143], v[44:47], v[104:107]
    v_cvt_pk_bf16_f32 v129, v66, v67
    v_mfma_f32_16x16x32_bf16 v[108:111], a[128:131], v[48:51], v[172:175]
    ds_read_b64_tr_b16 a[176:177], v200 offset:8192
    v_exp_f32 v81, v81
    v_mfma_f32_16x16x32_bf16 v[108:111], a[132:135], v[52:55], v[108:111]
    ds_read_b64_tr_b16 a[178:179], v200 offset:12288
    v_mfma_f32_16x16x32_bf16 v[108:111], a[136:139], v[56:59], v[108:111]
    v_exp_f32 v82, v82
    v_mfma_f32_16x16x32_bf16 v[108:111], a[140:143], v[60:63], v[108:111]
    ds_read_b64_tr_b16 a[180:181], v201 offset:8192
    v_cvt_pk_bf16_f32 v130, v80, v81
    v_mfma_f32_16x16x32_bf16 v[112:115], a[144:147], v[0:3], v[160:163]
    ds_read_b64_tr_b16 a[182:183], v201 offset:12288
    v_mfma_f32_16x16x32_bf16 v[112:115], a[148:151], v[4:7], v[112:115]
    v_exp_f32 v83, v83
    v_mfma_f32_16x16x32_bf16 v[112:115], a[152:155], v[8:11], v[112:115]
    ds_read_b64_tr_b16 a[184:185], v202 offset:8192
    v_mfma_f32_16x16x32_bf16 v[112:115], a[156:159], v[12:15], v[112:115]
    ds_read_b64_tr_b16 a[186:187], v202 offset:12288
    v_exp_f32 v68, v68
    v_mfma_f32_16x16x32_bf16 v[116:119], a[144:147], v[16:19], v[164:167]
    v_cvt_pk_bf16_f32 v131, v82, v83
    v_mfma_f32_16x16x32_bf16 v[116:119], a[148:151], v[20:23], v[116:119]
    ds_read_b64_tr_b16 a[188:189], v203 offset:8192
    v_mfma_f32_16x16x32_bf16 v[116:119], a[152:155], v[24:27], v[116:119]
    ds_read_b64_tr_b16 a[190:191], v203 offset:12288
    v_exp_f32 v69, v69
    v_mfma_f32_16x16x32_bf16 v[116:119], a[156:159], v[28:31], v[116:119]
    v_exp_f32 v70, v70
    v_mfma_f32_16x16x32_bf16 v[120:123], a[144:147], v[32:35], v[168:171]
    v_cvt_pk_bf16_f32 v132, v68, v69
    v_mfma_f32_16x16x32_bf16 v[120:123], a[148:151], v[36:39], v[120:123]
    v_exp_f32 v71, v71
    v_mfma_f32_16x16x32_bf16 v[120:123], a[152:155], v[40:43], v[120:123]
    v_exp_f32 v84, v84
    v_mfma_f32_16x16x32_bf16 v[120:123], a[156:159], v[44:47], v[120:123]
    v_cvt_pk_bf16_f32 v133, v70, v71
    v_mfma_f32_16x16x32_bf16 v[124:127], a[144:147], v[48:51], v[172:175]
    v_exp_f32 v85, v85
    v_mfma_f32_16x16x32_bf16 v[124:127], a[148:151], v[52:55], v[124:127]
    v_exp_f32 v86, v86
    v_mfma_f32_16x16x32_bf16 v[124:127], a[152:155], v[56:59], v[124:127]
    v_cvt_pk_bf16_f32 v134, v84, v85
    v_mfma_f32_16x16x32_bf16 v[124:127], a[156:159], v[60:63], v[124:127]
    s_waitcnt vmcnt(16) lgkmcnt(0)
    s_barrier
    v_mfma_f32_16x16x32_bf16 a[0:3], a[160:163], v[144:147], a[0:3]
    ds_read_b128 a[128:131], v192 offset:32768
    v_mfma_f32_16x16x32_bf16 a[4:7], a[160:163], v[148:151], a[4:7]
    v_exp_f32 v87, v87
    v_mfma_f32_16x16x32_bf16 a[8:11], a[160:163], v[152:155], a[8:11]
    ds_read_b128 a[132:135], v193 offset:32768
    v_exp_f32 v72, v72
    v_mfma_f32_16x16x32_bf16 a[12:15], a[160:163], v[156:159], a[12:15]
    v_cvt_pk_bf16_f32 v135, v86, v87
    v_mfma_f32_16x16x32_bf16 a[16:19], a[164:167], v[144:147], a[16:19]
    ds_read_b128 a[136:139], v194 offset:32768
    v_mfma_f32_16x16x32_bf16 a[20:23], a[164:167], v[148:151], a[20:23]
    v_exp_f32 v73, v73
    v_mfma_f32_16x16x32_bf16 a[24:27], a[164:167], v[152:155], a[24:27]
    ds_read_b128 a[140:143], v195 offset:32768
    v_exp_f32 v74, v74
    v_mfma_f32_16x16x32_bf16 a[28:31], a[164:167], v[156:159], a[28:31]
    v_cvt_pk_bf16_f32 v136, v72, v73
    v_mfma_f32_16x16x32_bf16 v[176:179], a[252:255], v[144:147], v[176:179]
    ds_read_b128 a[144:147], v192 offset:36864
    v_mfma_f32_16x16x32_bf16 a[32:35], a[168:171], v[144:147], a[32:35]
    v_exp_f32 v75, v75
    v_mfma_f32_16x16x32_bf16 a[36:39], a[168:171], v[148:151], a[36:39]
    ds_read_b128 a[148:151], v193 offset:36864
    v_mfma_f32_16x16x32_bf16 a[40:43], a[168:171], v[152:155], a[40:43]
    v_exp_f32 v88, v88
    v_cvt_pk_bf16_f32 v137, v74, v75
    v_mfma_f32_16x16x32_bf16 a[44:47], a[168:171], v[156:159], a[44:47]
    ds_read_b128 a[152:155], v194 offset:36864
    v_mfma_f32_16x16x32_bf16 a[48:51], a[172:175], v[144:147], a[48:51]
    v_exp_f32 v89, v89
    v_mfma_f32_16x16x32_bf16 a[52:55], a[172:175], v[148:151], a[52:55]
    ds_read_b128 a[156:159], v195 offset:36864
    v_mfma_f32_16x16x32_bf16 a[56:59], a[172:175], v[152:155], a[56:59]
    v_exp_f32 v90, v90
    v_cvt_pk_bf16_f32 v138, v88, v89
    v_mfma_f32_16x16x32_bf16 a[60:63], a[172:175], v[156:159], a[60:63]
    v_exp_f32 v91, v91
    v_mfma_f32_16x16x32_bf16 v[180:183], a[252:255], v[148:151], v[180:183]
    s_add_u32 m0, s29, 0x4000
    v_mfma_f32_16x16x32_bf16 a[64:67], a[176:179], v[144:147], a[64:67]
    buffer_load_dwordx4 v204, s[8:11], s32 offen offset:0 lds
    v_mfma_f32_16x16x32_bf16 a[68:71], a[176:179], v[148:151], a[68:71]
    v_exp_f32 v76, v76
    v_mfma_f32_16x16x32_bf16 a[72:75], a[176:179], v[152:155], a[72:75]
    v_cvt_pk_bf16_f32 v139, v90, v91
    v_mfma_f32_16x16x32_bf16 a[76:79], a[176:179], v[156:159], a[76:79]
    v_exp_f32 v77, v77
    v_mfma_f32_16x16x32_bf16 a[80:83], a[180:183], v[144:147], a[80:83]
    buffer_load_dwordx4 v205, s[8:11], s32 offen offset:1024 lds
    v_mfma_f32_16x16x32_bf16 a[84:87], a[180:183], v[148:151], a[84:87]
    v_exp_f32 v78, v78
    v_mfma_f32_16x16x32_bf16 a[88:91], a[180:183], v[152:155], a[88:91]
    v_cvt_pk_bf16_f32 v140, v76, v77
    v_mfma_f32_16x16x32_bf16 a[92:95], a[180:183], v[156:159], a[92:95]
    v_exp_f32 v79, v79
    v_mfma_f32_16x16x32_bf16 v[184:187], a[252:255], v[152:155], v[184:187]
    buffer_load_dwordx4 v206, s[8:11], s32 offen offset:2048 lds
    v_mfma_f32_16x16x32_bf16 a[96:99], a[184:187], v[144:147], a[96:99]
    v_exp_f32 v92, v92
    v_mfma_f32_16x16x32_bf16 a[100:103], a[184:187], v[148:151], a[100:103]
    v_cvt_pk_bf16_f32 v141, v78, v79
    v_mfma_f32_16x16x32_bf16 a[104:107], a[184:187], v[152:155], a[104:107]
    v_exp_f32 v93, v93
    v_mfma_f32_16x16x32_bf16 a[108:111], a[184:187], v[156:159], a[108:111]
    buffer_load_dwordx4 v207, s[8:11], s32 offen offset:3072 lds
    v_mfma_f32_16x16x32_bf16 a[112:115], a[188:191], v[144:147], a[112:115]
    s_add_u32 s32, s32, 0x4000
    v_mfma_f32_16x16x32_bf16 a[116:119], a[188:191], v[148:151], a[116:119]
    v_exp_f32 v94, v94
    v_mfma_f32_16x16x32_bf16 a[120:123], a[188:191], v[152:155], a[120:123]
    v_cvt_pk_bf16_f32 v142, v92, v93
    v_mfma_f32_16x16x32_bf16 a[124:127], a[188:191], v[156:159], a[124:127]
    v_exp_f32 v95, v95
    v_mfma_f32_16x16x32_bf16 v[188:191], a[252:255], v[156:159], v[188:191]
    s_nop 0
    v_cvt_pk_bf16_f32 v143, v94, v95
    s_waitcnt lgkmcnt(0)
    v_mfma_f32_16x16x32_bf16 v[64:67], a[128:131], v[0:3], v[160:163]
    ds_read_b64_tr_b16 a[160:161], v196 offset:16384
    v_mfma_f32_16x16x32_bf16 v[64:67], a[132:135], v[4:7], v[64:67]
    ds_read_b64_tr_b16 a[162:163], v196 offset:20480
    v_exp_f32 v96, v96
    v_mfma_f32_16x16x32_bf16 v[64:67], a[136:139], v[8:11], v[64:67]
    v_exp_f32 v97, v97
    v_mfma_f32_16x16x32_bf16 v[64:67], a[140:143], v[12:15], v[64:67]
    ds_read_b64_tr_b16 a[164:165], v197 offset:16384
    v_mfma_f32_16x16x32_bf16 v[68:71], a[128:131], v[16:19], v[164:167]
    ds_read_b64_tr_b16 a[166:167], v197 offset:20480
    v_mfma_f32_16x16x32_bf16 v[68:71], a[132:135], v[20:23], v[68:71]
    v_exp_f32 v98, v98
    v_mfma_f32_16x16x32_bf16 v[68:71], a[136:139], v[24:27], v[68:71]
    ds_read_b64_tr_b16 a[168:169], v198 offset:16384
    v_cvt_pk_bf16_f32 v144, v96, v97
    v_mfma_f32_16x16x32_bf16 v[68:71], a[140:143], v[28:31], v[68:71]
    ds_read_b64_tr_b16 a[170:171], v198 offset:20480
    v_mfma_f32_16x16x32_bf16 v[72:75], a[128:131], v[32:35], v[168:171]
    v_exp_f32 v99, v99
    v_mfma_f32_16x16x32_bf16 v[72:75], a[132:135], v[36:39], v[72:75]
    ds_read_b64_tr_b16 a[172:173], v199 offset:16384
    v_exp_f32 v112, v112
    v_mfma_f32_16x16x32_bf16 v[72:75], a[136:139], v[40:43], v[72:75]
    ds_read_b64_tr_b16 a[174:175], v199 offset:20480
    v_mfma_f32_16x16x32_bf16 v[72:75], a[140:143], v[44:47], v[72:75]
    v_cvt_pk_bf16_f32 v145, v98, v99
    v_mfma_f32_16x16x32_bf16 v[76:79], a[128:131], v[48:51], v[172:175]
    ds_read_b64_tr_b16 a[176:177], v200 offset:16384
    v_exp_f32 v113, v113
    v_mfma_f32_16x16x32_bf16 v[76:79], a[132:135], v[52:55], v[76:79]
    ds_read_b64_tr_b16 a[178:179], v200 offset:20480
    v_mfma_f32_16x16x32_bf16 v[76:79], a[136:139], v[56:59], v[76:79]
    v_exp_f32 v114, v114
    v_mfma_f32_16x16x32_bf16 v[76:79], a[140:143], v[60:63], v[76:79]
    ds_read_b64_tr_b16 a[180:181], v201 offset:16384
    v_mfma_f32_16x16x32_bf16 v[80:83], a[144:147], v[0:3], v[160:163]
    ds_read_b64_tr_b16 a[182:183], v201 offset:20480
    v_cvt_pk_bf16_f32 v146, v112, v113
    v_mfma_f32_16x16x32_bf16 v[80:83], a[148:151], v[4:7], v[80:83]
    v_exp_f32 v115, v115
    v_mfma_f32_16x16x32_bf16 v[80:83], a[152:155], v[8:11], v[80:83]
    ds_read_b64_tr_b16 a[184:185], v202 offset:16384
    v_mfma_f32_16x16x32_bf16 v[80:83], a[156:159], v[12:15], v[80:83]
    ds_read_b64_tr_b16 a[186:187], v202 offset:20480
    v_exp_f32 v100, v100
    v_mfma_f32_16x16x32_bf16 v[84:87], a[144:147], v[16:19], v[164:167]
    v_cvt_pk_bf16_f32 v147, v114, v115
    v_mfma_f32_16x16x32_bf16 v[84:87], a[148:151], v[20:23], v[84:87]
    ds_read_b64_tr_b16 a[188:189], v203 offset:16384
    v_mfma_f32_16x16x32_bf16 v[84:87], a[152:155], v[24:27], v[84:87]
    ds_read_b64_tr_b16 a[190:191], v203 offset:20480
    v_exp_f32 v101, v101
    v_mfma_f32_16x16x32_bf16 v[84:87], a[156:159], v[28:31], v[84:87]
    v_mfma_f32_16x16x32_bf16 v[88:91], a[144:147], v[32:35], v[168:171]
    v_exp_f32 v102, v102
    v_cvt_pk_bf16_f32 v148, v100, v101
    v_mfma_f32_16x16x32_bf16 v[88:91], a[148:151], v[36:39], v[88:91]
    v_exp_f32 v103, v103
    v_mfma_f32_16x16x32_bf16 v[88:91], a[152:155], v[40:43], v[88:91]
    v_exp_f32 v116, v116
    v_mfma_f32_16x16x32_bf16 v[88:91], a[156:159], v[44:47], v[88:91]
    v_cvt_pk_bf16_f32 v149, v102, v103
    v_mfma_f32_16x16x32_bf16 v[92:95], a[144:147], v[48:51], v[172:175]
    v_exp_f32 v117, v117
    v_mfma_f32_16x16x32_bf16 v[92:95], a[148:151], v[52:55], v[92:95]
    v_exp_f32 v118, v118
    v_mfma_f32_16x16x32_bf16 v[92:95], a[152:155], v[56:59], v[92:95]
    v_cvt_pk_bf16_f32 v150, v116, v117
    v_mfma_f32_16x16x32_bf16 v[92:95], a[156:159], v[60:63], v[92:95]
    s_waitcnt lgkmcnt(0)
    v_mfma_f32_16x16x32_bf16 a[0:3], a[160:163], v[128:131], a[0:3]
    ds_read_b128 a[128:131], v192 offset:40960
    v_exp_f32 v119, v119
    v_mfma_f32_16x16x32_bf16 a[4:7], a[160:163], v[132:135], a[4:7]
    v_exp_f32 v104, v104
    v_mfma_f32_16x16x32_bf16 a[8:11], a[160:163], v[136:139], a[8:11]
    ds_read_b128 a[132:135], v193 offset:40960
    v_mfma_f32_16x16x32_bf16 a[12:15], a[160:163], v[140:143], a[12:15]
    v_cvt_pk_bf16_f32 v151, v118, v119
    v_mfma_f32_16x16x32_bf16 a[16:19], a[164:167], v[128:131], a[16:19]
    ds_read_b128 a[136:139], v194 offset:40960
    v_exp_f32 v105, v105
    v_mfma_f32_16x16x32_bf16 a[20:23], a[164:167], v[132:135], a[20:23]
    v_mfma_f32_16x16x32_bf16 a[24:27], a[164:167], v[136:139], a[24:27]
    ds_read_b128 a[140:143], v195 offset:40960
    v_exp_f32 v106, v106
    v_mfma_f32_16x16x32_bf16 a[28:31], a[164:167], v[140:143], a[28:31]
    v_cvt_pk_bf16_f32 v152, v104, v105
    v_mfma_f32_16x16x32_bf16 v[176:179], a[252:255], v[128:131], v[176:179]
    ds_read_b128 a[144:147], v192 offset:45056
    v_mfma_f32_16x16x32_bf16 a[32:35], a[168:171], v[128:131], a[32:35]
    v_exp_f32 v107, v107
    v_mfma_f32_16x16x32_bf16 a[36:39], a[168:171], v[132:135], a[36:39]
    ds_read_b128 a[148:151], v193 offset:45056
    v_exp_f32 v120, v120
    v_mfma_f32_16x16x32_bf16 a[40:43], a[168:171], v[136:139], a[40:43]
    v_cvt_pk_bf16_f32 v153, v106, v107
    v_mfma_f32_16x16x32_bf16 a[44:47], a[168:171], v[140:143], a[44:47]
    ds_read_b128 a[152:155], v194 offset:45056
    v_mfma_f32_16x16x32_bf16 a[48:51], a[172:175], v[128:131], a[48:51]
    v_exp_f32 v121, v121
    v_mfma_f32_16x16x32_bf16 a[52:55], a[172:175], v[132:135], a[52:55]
    ds_read_b128 a[156:159], v195 offset:45056
    v_exp_f32 v122, v122
    v_mfma_f32_16x16x32_bf16 a[56:59], a[172:175], v[136:139], a[56:59]
    v_cvt_pk_bf16_f32 v154, v120, v121
    v_mfma_f32_16x16x32_bf16 a[60:63], a[172:175], v[140:143], a[60:63]
    v_exp_f32 v123, v123
    v_mfma_f32_16x16x32_bf16 v[180:183], a[252:255], v[132:135], v[180:183]
    s_add_u32 m0, s29, 0x10000
    v_mfma_f32_16x16x32_bf16 a[64:67], a[176:179], v[128:131], a[64:67]
    buffer_load_dwordx4 v208, s[12:15], s33 offen offset:0 lds
    v_mfma_f32_16x16x32_bf16 a[68:71], a[176:179], v[132:135], a[68:71]
    v_exp_f32 v108, v108
    v_mfma_f32_16x16x32_bf16 a[72:75], a[176:179], v[136:139], a[72:75]
    v_cvt_pk_bf16_f32 v155, v122, v123
    v_mfma_f32_16x16x32_bf16 a[76:79], a[176:179], v[140:143], a[76:79]
    v_exp_f32 v109, v109
    v_mfma_f32_16x16x32_bf16 a[80:83], a[180:183], v[128:131], a[80:83]
    buffer_load_dwordx4 v242, s[12:15], s33 offen offset:1024 lds
    v_mfma_f32_16x16x32_bf16 a[84:87], a[180:183], v[132:135], a[84:87]
    v_exp_f32 v110, v110
    v_mfma_f32_16x16x32_bf16 a[88:91], a[180:183], v[136:139], a[88:91]
    v_cvt_pk_bf16_f32 v156, v108, v109
    v_mfma_f32_16x16x32_bf16 a[92:95], a[180:183], v[140:143], a[92:95]
    v_exp_f32 v111, v111
    v_mfma_f32_16x16x32_bf16 v[184:187], a[252:255], v[136:139], v[184:187]
    buffer_load_dwordx4 v208, s[12:15], s33 offen offset:2048 lds
    v_mfma_f32_16x16x32_bf16 a[96:99], a[184:187], v[128:131], a[96:99]
    v_exp_f32 v124, v124
    v_mfma_f32_16x16x32_bf16 a[100:103], a[184:187], v[132:135], a[100:103]
    v_cvt_pk_bf16_f32 v157, v110, v111
    v_mfma_f32_16x16x32_bf16 a[104:107], a[184:187], v[136:139], a[104:107]
    v_exp_f32 v125, v125
    v_mfma_f32_16x16x32_bf16 a[108:111], a[184:187], v[140:143], a[108:111]
    buffer_load_dwordx4 v242, s[12:15], s33 offen offset:3072 lds
    v_mfma_f32_16x16x32_bf16 a[112:115], a[188:191], v[128:131], a[112:115]
    s_add_u32 s33, s33, 0x4000
    v_mfma_f32_16x16x32_bf16 a[116:119], a[188:191], v[132:135], a[116:119]
    v_exp_f32 v126, v126
    v_mfma_f32_16x16x32_bf16 a[120:123], a[188:191], v[136:139], a[120:123]
    v_cvt_pk_bf16_f32 v158, v124, v125
    v_mfma_f32_16x16x32_bf16 a[124:127], a[188:191], v[140:143], a[124:127]
    v_exp_f32 v127, v127
    v_mfma_f32_16x16x32_bf16 v[188:191], a[252:255], v[140:143], v[188:191]
    s_nop 0
    v_cvt_pk_bf16_f32 v159, v126, v127
    s_waitcnt lgkmcnt(0)
    v_mfma_f32_16x16x32_bf16 v[96:99], a[128:131], v[0:3], v[160:163]
    ds_read_b64_tr_b16 a[160:161], v196 offset:24576
    v_mfma_f32_16x16x32_bf16 v[96:99], a[132:135], v[4:7], v[96:99]
    ds_read_b64_tr_b16 a[162:163], v196 offset:28672
    v_exp_f32 v64, v64
    v_mfma_f32_16x16x32_bf16 v[96:99], a[136:139], v[8:11], v[96:99]
    v_exp_f32 v65, v65
    v_mfma_f32_16x16x32_bf16 v[96:99], a[140:143], v[12:15], v[96:99]
    ds_read_b64_tr_b16 a[164:165], v197 offset:24576
    v_mfma_f32_16x16x32_bf16 v[100:103], a[128:131], v[16:19], v[164:167]
    ds_read_b64_tr_b16 a[166:167], v197 offset:28672
    v_mfma_f32_16x16x32_bf16 v[100:103], a[132:135], v[20:23], v[100:103]
    v_exp_f32 v66, v66
    v_mfma_f32_16x16x32_bf16 v[100:103], a[136:139], v[24:27], v[100:103]
    ds_read_b64_tr_b16 a[168:169], v198 offset:24576
    v_cvt_pk_bf16_f32 v128, v64, v65
    v_mfma_f32_16x16x32_bf16 v[100:103], a[140:143], v[28:31], v[100:103]
    ds_read_b64_tr_b16 a[170:171], v198 offset:28672
    v_mfma_f32_16x16x32_bf16 v[104:107], a[128:131], v[32:35], v[168:171]
    v_exp_f32 v67, v67
    v_mfma_f32_16x16x32_bf16 v[104:107], a[132:135], v[36:39], v[104:107]
    ds_read_b64_tr_b16 a[172:173], v199 offset:24576
    v_exp_f32 v80, v80
    v_mfma_f32_16x16x32_bf16 v[104:107], a[136:139], v[40:43], v[104:107]
    ds_read_b64_tr_b16 a[174:175], v199 offset:28672
    v_mfma_f32_16x16x32_bf16 v[104:107], a[140:143], v[44:47], v[104:107]
    v_cvt_pk_bf16_f32 v129, v66, v67
    v_mfma_f32_16x16x32_bf16 v[108:111], a[128:131], v[48:51], v[172:175]
    ds_read_b64_tr_b16 a[176:177], v200 offset:24576
    v_exp_f32 v81, v81
    v_mfma_f32_16x16x32_bf16 v[108:111], a[132:135], v[52:55], v[108:111]
    ds_read_b64_tr_b16 a[178:179], v200 offset:28672
    v_mfma_f32_16x16x32_bf16 v[108:111], a[136:139], v[56:59], v[108:111]
    v_exp_f32 v82, v82
    v_mfma_f32_16x16x32_bf16 v[108:111], a[140:143], v[60:63], v[108:111]
    ds_read_b64_tr_b16 a[180:181], v201 offset:24576
    v_cvt_pk_bf16_f32 v130, v80, v81
    v_mfma_f32_16x16x32_bf16 v[112:115], a[144:147], v[0:3], v[160:163]
    ds_read_b64_tr_b16 a[182:183], v201 offset:28672
    v_mfma_f32_16x16x32_bf16 v[112:115], a[148:151], v[4:7], v[112:115]
    v_exp_f32 v83, v83
    v_mfma_f32_16x16x32_bf16 v[112:115], a[152:155], v[8:11], v[112:115]
    ds_read_b64_tr_b16 a[184:185], v202 offset:24576
    v_mfma_f32_16x16x32_bf16 v[112:115], a[156:159], v[12:15], v[112:115]
    ds_read_b64_tr_b16 a[186:187], v202 offset:28672
    v_exp_f32 v68, v68
    v_mfma_f32_16x16x32_bf16 v[116:119], a[144:147], v[16:19], v[164:167]
    v_cvt_pk_bf16_f32 v131, v82, v83
    v_mfma_f32_16x16x32_bf16 v[116:119], a[148:151], v[20:23], v[116:119]
    ds_read_b64_tr_b16 a[188:189], v203 offset:24576
    v_mfma_f32_16x16x32_bf16 v[116:119], a[152:155], v[24:27], v[116:119]
    ds_read_b64_tr_b16 a[190:191], v203 offset:28672
    v_exp_f32 v69, v69
    v_mfma_f32_16x16x32_bf16 v[116:119], a[156:159], v[28:31], v[116:119]
    v_exp_f32 v70, v70
    v_mfma_f32_16x16x32_bf16 v[120:123], a[144:147], v[32:35], v[168:171]
    v_cvt_pk_bf16_f32 v132, v68, v69
    v_mfma_f32_16x16x32_bf16 v[120:123], a[148:151], v[36:39], v[120:123]
    v_exp_f32 v71, v71
    v_mfma_f32_16x16x32_bf16 v[120:123], a[152:155], v[40:43], v[120:123]
    v_exp_f32 v84, v84
    v_mfma_f32_16x16x32_bf16 v[120:123], a[156:159], v[44:47], v[120:123]
    v_cvt_pk_bf16_f32 v133, v70, v71
    v_mfma_f32_16x16x32_bf16 v[124:127], a[144:147], v[48:51], v[172:175]
    v_exp_f32 v85, v85
    v_mfma_f32_16x16x32_bf16 v[124:127], a[148:151], v[52:55], v[124:127]
    v_exp_f32 v86, v86
    v_mfma_f32_16x16x32_bf16 v[124:127], a[152:155], v[56:59], v[124:127]
    v_cvt_pk_bf16_f32 v134, v84, v85
    v_mfma_f32_16x16x32_bf16 v[124:127], a[156:159], v[60:63], v[124:127]
    s_waitcnt vmcnt(16) lgkmcnt(0)
    s_barrier
    v_mfma_f32_16x16x32_bf16 a[0:3], a[160:163], v[144:147], a[0:3]
    ds_read_b128 a[128:131], v192 offset:49152
    v_mfma_f32_16x16x32_bf16 a[4:7], a[160:163], v[148:151], a[4:7]
    v_exp_f32 v87, v87
    v_mfma_f32_16x16x32_bf16 a[8:11], a[160:163], v[152:155], a[8:11]
    ds_read_b128 a[132:135], v193 offset:49152
    v_exp_f32 v72, v72
    v_mfma_f32_16x16x32_bf16 a[12:15], a[160:163], v[156:159], a[12:15]
    v_cvt_pk_bf16_f32 v135, v86, v87
    v_mfma_f32_16x16x32_bf16 a[16:19], a[164:167], v[144:147], a[16:19]
    ds_read_b128 a[136:139], v194 offset:49152
    v_mfma_f32_16x16x32_bf16 a[20:23], a[164:167], v[148:151], a[20:23]
    v_exp_f32 v73, v73
    v_mfma_f32_16x16x32_bf16 a[24:27], a[164:167], v[152:155], a[24:27]
    ds_read_b128 a[140:143], v195 offset:49152
    v_exp_f32 v74, v74
    v_mfma_f32_16x16x32_bf16 a[28:31], a[164:167], v[156:159], a[28:31]
    v_cvt_pk_bf16_f32 v136, v72, v73
    v_mfma_f32_16x16x32_bf16 v[176:179], a[252:255], v[144:147], v[176:179]
    ds_read_b128 a[144:147], v192 offset:53248
    v_mfma_f32_16x16x32_bf16 a[32:35], a[168:171], v[144:147], a[32:35]
    v_exp_f32 v75, v75
    v_mfma_f32_16x16x32_bf16 a[36:39], a[168:171], v[148:151], a[36:39]
    ds_read_b128 a[148:151], v193 offset:53248
    v_mfma_f32_16x16x32_bf16 a[40:43], a[168:171], v[152:155], a[40:43]
    v_exp_f32 v88, v88
    v_cvt_pk_bf16_f32 v137, v74, v75
    v_mfma_f32_16x16x32_bf16 a[44:47], a[168:171], v[156:159], a[44:47]
    ds_read_b128 a[152:155], v194 offset:53248
    v_mfma_f32_16x16x32_bf16 a[48:51], a[172:175], v[144:147], a[48:51]
    v_exp_f32 v89, v89
    v_mfma_f32_16x16x32_bf16 a[52:55], a[172:175], v[148:151], a[52:55]
    ds_read_b128 a[156:159], v195 offset:53248
    v_mfma_f32_16x16x32_bf16 a[56:59], a[172:175], v[152:155], a[56:59]
    v_exp_f32 v90, v90
    v_cvt_pk_bf16_f32 v138, v88, v89
    v_mfma_f32_16x16x32_bf16 a[60:63], a[172:175], v[156:159], a[60:63]
    v_exp_f32 v91, v91
    v_mfma_f32_16x16x32_bf16 v[180:183], a[252:255], v[148:151], v[180:183]
    s_add_u32 m0, s29, 0x8000
    v_mfma_f32_16x16x32_bf16 a[64:67], a[176:179], v[144:147], a[64:67]
    buffer_load_dwordx4 v204, s[8:11], s32 offen offset:0 lds
    v_mfma_f32_16x16x32_bf16 a[68:71], a[176:179], v[148:151], a[68:71]
    v_exp_f32 v76, v76
    v_mfma_f32_16x16x32_bf16 a[72:75], a[176:179], v[152:155], a[72:75]
    v_cvt_pk_bf16_f32 v139, v90, v91
    v_mfma_f32_16x16x32_bf16 a[76:79], a[176:179], v[156:159], a[76:79]
    v_exp_f32 v77, v77
    v_mfma_f32_16x16x32_bf16 a[80:83], a[180:183], v[144:147], a[80:83]
    buffer_load_dwordx4 v205, s[8:11], s32 offen offset:1024 lds
    v_mfma_f32_16x16x32_bf16 a[84:87], a[180:183], v[148:151], a[84:87]
    v_exp_f32 v78, v78
    v_mfma_f32_16x16x32_bf16 a[88:91], a[180:183], v[152:155], a[88:91]
    v_cvt_pk_bf16_f32 v140, v76, v77
    v_mfma_f32_16x16x32_bf16 a[92:95], a[180:183], v[156:159], a[92:95]
    v_exp_f32 v79, v79
    v_mfma_f32_16x16x32_bf16 v[184:187], a[252:255], v[152:155], v[184:187]
    buffer_load_dwordx4 v206, s[8:11], s32 offen offset:2048 lds
    v_mfma_f32_16x16x32_bf16 a[96:99], a[184:187], v[144:147], a[96:99]
    v_exp_f32 v92, v92
    v_mfma_f32_16x16x32_bf16 a[100:103], a[184:187], v[148:151], a[100:103]
    v_cvt_pk_bf16_f32 v141, v78, v79
    v_mfma_f32_16x16x32_bf16 a[104:107], a[184:187], v[152:155], a[104:107]
    v_exp_f32 v93, v93
    v_mfma_f32_16x16x32_bf16 a[108:111], a[184:187], v[156:159], a[108:111]
    buffer_load_dwordx4 v207, s[8:11], s32 offen offset:3072 lds
    v_mfma_f32_16x16x32_bf16 a[112:115], a[188:191], v[144:147], a[112:115]
    s_add_u32 s32, s32, 0x4000
    v_mfma_f32_16x16x32_bf16 a[116:119], a[188:191], v[148:151], a[116:119]
    v_exp_f32 v94, v94
    v_mfma_f32_16x16x32_bf16 a[120:123], a[188:191], v[152:155], a[120:123]
    v_cvt_pk_bf16_f32 v142, v92, v93
    v_mfma_f32_16x16x32_bf16 a[124:127], a[188:191], v[156:159], a[124:127]
    v_exp_f32 v95, v95
    v_mfma_f32_16x16x32_bf16 v[188:191], a[252:255], v[156:159], v[188:191]
    s_nop 0
    v_cvt_pk_bf16_f32 v143, v94, v95
    s_waitcnt lgkmcnt(0)
    v_mfma_f32_16x16x32_bf16 v[64:67], a[128:131], v[0:3], v[160:163]
    ds_read_b64_tr_b16 a[160:161], v196 offset:32768
    v_mfma_f32_16x16x32_bf16 v[64:67], a[132:135], v[4:7], v[64:67]
    ds_read_b64_tr_b16 a[162:163], v196 offset:36864
    v_exp_f32 v96, v96
    v_mfma_f32_16x16x32_bf16 v[64:67], a[136:139], v[8:11], v[64:67]
    v_exp_f32 v97, v97
    v_mfma_f32_16x16x32_bf16 v[64:67], a[140:143], v[12:15], v[64:67]
    ds_read_b64_tr_b16 a[164:165], v197 offset:32768
    v_mfma_f32_16x16x32_bf16 v[68:71], a[128:131], v[16:19], v[164:167]
    ds_read_b64_tr_b16 a[166:167], v197 offset:36864
    v_mfma_f32_16x16x32_bf16 v[68:71], a[132:135], v[20:23], v[68:71]
    v_exp_f32 v98, v98
    v_mfma_f32_16x16x32_bf16 v[68:71], a[136:139], v[24:27], v[68:71]
    ds_read_b64_tr_b16 a[168:169], v198 offset:32768
    v_cvt_pk_bf16_f32 v144, v96, v97
    v_mfma_f32_16x16x32_bf16 v[68:71], a[140:143], v[28:31], v[68:71]
    ds_read_b64_tr_b16 a[170:171], v198 offset:36864
    v_mfma_f32_16x16x32_bf16 v[72:75], a[128:131], v[32:35], v[168:171]
    v_exp_f32 v99, v99
    v_mfma_f32_16x16x32_bf16 v[72:75], a[132:135], v[36:39], v[72:75]
    ds_read_b64_tr_b16 a[172:173], v199 offset:32768
    v_exp_f32 v112, v112
    v_mfma_f32_16x16x32_bf16 v[72:75], a[136:139], v[40:43], v[72:75]
    ds_read_b64_tr_b16 a[174:175], v199 offset:36864
    v_mfma_f32_16x16x32_bf16 v[72:75], a[140:143], v[44:47], v[72:75]
    v_cvt_pk_bf16_f32 v145, v98, v99
    v_mfma_f32_16x16x32_bf16 v[76:79], a[128:131], v[48:51], v[172:175]
    ds_read_b64_tr_b16 a[176:177], v200 offset:32768
    v_exp_f32 v113, v113
    v_mfma_f32_16x16x32_bf16 v[76:79], a[132:135], v[52:55], v[76:79]
    ds_read_b64_tr_b16 a[178:179], v200 offset:36864
    v_mfma_f32_16x16x32_bf16 v[76:79], a[136:139], v[56:59], v[76:79]
    v_exp_f32 v114, v114
    v_mfma_f32_16x16x32_bf16 v[76:79], a[140:143], v[60:63], v[76:79]
    ds_read_b64_tr_b16 a[180:181], v201 offset:32768
    v_mfma_f32_16x16x32_bf16 v[80:83], a[144:147], v[0:3], v[160:163]
    ds_read_b64_tr_b16 a[182:183], v201 offset:36864
    v_cvt_pk_bf16_f32 v146, v112, v113
    v_mfma_f32_16x16x32_bf16 v[80:83], a[148:151], v[4:7], v[80:83]
    v_exp_f32 v115, v115
    v_mfma_f32_16x16x32_bf16 v[80:83], a[152:155], v[8:11], v[80:83]
    ds_read_b64_tr_b16 a[184:185], v202 offset:32768
    v_mfma_f32_16x16x32_bf16 v[80:83], a[156:159], v[12:15], v[80:83]
    ds_read_b64_tr_b16 a[186:187], v202 offset:36864
    v_exp_f32 v100, v100
    v_mfma_f32_16x16x32_bf16 v[84:87], a[144:147], v[16:19], v[164:167]
    v_cvt_pk_bf16_f32 v147, v114, v115
    v_mfma_f32_16x16x32_bf16 v[84:87], a[148:151], v[20:23], v[84:87]
    ds_read_b64_tr_b16 a[188:189], v203 offset:32768
    v_mfma_f32_16x16x32_bf16 v[84:87], a[152:155], v[24:27], v[84:87]
    ds_read_b64_tr_b16 a[190:191], v203 offset:36864
    v_exp_f32 v101, v101
    v_mfma_f32_16x16x32_bf16 v[84:87], a[156:159], v[28:31], v[84:87]
    v_mfma_f32_16x16x32_bf16 v[88:91], a[144:147], v[32:35], v[168:171]
    v_exp_f32 v102, v102
    v_cvt_pk_bf16_f32 v148, v100, v101
    v_mfma_f32_16x16x32_bf16 v[88:91], a[148:151], v[36:39], v[88:91]
    v_exp_f32 v103, v103
    v_mfma_f32_16x16x32_bf16 v[88:91], a[152:155], v[40:43], v[88:91]
    v_exp_f32 v116, v116
    v_mfma_f32_16x16x32_bf16 v[88:91], a[156:159], v[44:47], v[88:91]
    v_cvt_pk_bf16_f32 v149, v102, v103
    v_mfma_f32_16x16x32_bf16 v[92:95], a[144:147], v[48:51], v[172:175]
    v_exp_f32 v117, v117
    v_mfma_f32_16x16x32_bf16 v[92:95], a[148:151], v[52:55], v[92:95]
    v_exp_f32 v118, v118
    v_mfma_f32_16x16x32_bf16 v[92:95], a[152:155], v[56:59], v[92:95]
    v_cvt_pk_bf16_f32 v150, v116, v117
    v_mfma_f32_16x16x32_bf16 v[92:95], a[156:159], v[60:63], v[92:95]
    s_waitcnt lgkmcnt(0)
    v_mfma_f32_16x16x32_bf16 a[0:3], a[160:163], v[128:131], a[0:3]
    ds_read_b128 a[128:131], v192 offset:57344
    v_exp_f32 v119, v119
    v_mfma_f32_16x16x32_bf16 a[4:7], a[160:163], v[132:135], a[4:7]
    v_exp_f32 v104, v104
    v_mfma_f32_16x16x32_bf16 a[8:11], a[160:163], v[136:139], a[8:11]
    ds_read_b128 a[132:135], v193 offset:57344
    v_mfma_f32_16x16x32_bf16 a[12:15], a[160:163], v[140:143], a[12:15]
    v_cvt_pk_bf16_f32 v151, v118, v119
    v_mfma_f32_16x16x32_bf16 a[16:19], a[164:167], v[128:131], a[16:19]
    ds_read_b128 a[136:139], v194 offset:57344
    v_exp_f32 v105, v105
    v_mfma_f32_16x16x32_bf16 a[20:23], a[164:167], v[132:135], a[20:23]
    v_mfma_f32_16x16x32_bf16 a[24:27], a[164:167], v[136:139], a[24:27]
    ds_read_b128 a[140:143], v195 offset:57344
    v_exp_f32 v106, v106
    v_mfma_f32_16x16x32_bf16 a[28:31], a[164:167], v[140:143], a[28:31]
    v_cvt_pk_bf16_f32 v152, v104, v105
    v_mfma_f32_16x16x32_bf16 v[176:179], a[252:255], v[128:131], v[176:179]
    ds_read_b128 a[144:147], v192 offset:61440
    v_mfma_f32_16x16x32_bf16 a[32:35], a[168:171], v[128:131], a[32:35]
    v_exp_f32 v107, v107
    v_mfma_f32_16x16x32_bf16 a[36:39], a[168:171], v[132:135], a[36:39]
    ds_read_b128 a[148:151], v193 offset:61440
    v_exp_f32 v120, v120
    v_mfma_f32_16x16x32_bf16 a[40:43], a[168:171], v[136:139], a[40:43]
    v_cvt_pk_bf16_f32 v153, v106, v107
    v_mfma_f32_16x16x32_bf16 a[44:47], a[168:171], v[140:143], a[44:47]
    ds_read_b128 a[152:155], v194 offset:61440
    v_mfma_f32_16x16x32_bf16 a[48:51], a[172:175], v[128:131], a[48:51]
    v_exp_f32 v121, v121
    v_mfma_f32_16x16x32_bf16 a[52:55], a[172:175], v[132:135], a[52:55]
    ds_read_b128 a[156:159], v195 offset:61440
    v_exp_f32 v122, v122
    v_mfma_f32_16x16x32_bf16 a[56:59], a[172:175], v[136:139], a[56:59]
    v_cvt_pk_bf16_f32 v154, v120, v121
    v_mfma_f32_16x16x32_bf16 a[60:63], a[172:175], v[140:143], a[60:63]
    v_exp_f32 v123, v123
    v_mfma_f32_16x16x32_bf16 v[180:183], a[252:255], v[132:135], v[180:183]
    s_add_u32 m0, s29, 0x14000
    v_mfma_f32_16x16x32_bf16 a[64:67], a[176:179], v[128:131], a[64:67]
    buffer_load_dwordx4 v208, s[12:15], s33 offen offset:0 lds
    v_mfma_f32_16x16x32_bf16 a[68:71], a[176:179], v[132:135], a[68:71]
    v_exp_f32 v108, v108
    v_mfma_f32_16x16x32_bf16 a[72:75], a[176:179], v[136:139], a[72:75]
    v_cvt_pk_bf16_f32 v155, v122, v123
    v_mfma_f32_16x16x32_bf16 a[76:79], a[176:179], v[140:143], a[76:79]
    v_exp_f32 v109, v109
    v_mfma_f32_16x16x32_bf16 a[80:83], a[180:183], v[128:131], a[80:83]
    buffer_load_dwordx4 v242, s[12:15], s33 offen offset:1024 lds
    v_mfma_f32_16x16x32_bf16 a[84:87], a[180:183], v[132:135], a[84:87]
    v_exp_f32 v110, v110
    v_mfma_f32_16x16x32_bf16 a[88:91], a[180:183], v[136:139], a[88:91]
    v_cvt_pk_bf16_f32 v156, v108, v109
    v_mfma_f32_16x16x32_bf16 a[92:95], a[180:183], v[140:143], a[92:95]
    v_exp_f32 v111, v111
    v_mfma_f32_16x16x32_bf16 v[184:187], a[252:255], v[136:139], v[184:187]
    buffer_load_dwordx4 v208, s[12:15], s33 offen offset:2048 lds
    v_mfma_f32_16x16x32_bf16 a[96:99], a[184:187], v[128:131], a[96:99]
    v_exp_f32 v124, v124
    v_mfma_f32_16x16x32_bf16 a[100:103], a[184:187], v[132:135], a[100:103]
    v_cvt_pk_bf16_f32 v157, v110, v111
    v_mfma_f32_16x16x32_bf16 a[104:107], a[184:187], v[136:139], a[104:107]
    v_exp_f32 v125, v125
    v_mfma_f32_16x16x32_bf16 a[108:111], a[184:187], v[140:143], a[108:111]
    buffer_load_dwordx4 v242, s[12:15], s33 offen offset:3072 lds
    v_mfma_f32_16x16x32_bf16 a[112:115], a[188:191], v[128:131], a[112:115]
    s_add_u32 s33, s33, 0x4000
    v_mfma_f32_16x16x32_bf16 a[116:119], a[188:191], v[132:135], a[116:119]
    v_exp_f32 v126, v126
    v_mfma_f32_16x16x32_bf16 a[120:123], a[188:191], v[136:139], a[120:123]
    v_cvt_pk_bf16_f32 v158, v124, v125
    v_mfma_f32_16x16x32_bf16 a[124:127], a[188:191], v[140:143], a[124:127]
    v_exp_f32 v127, v127
    v_mfma_f32_16x16x32_bf16 v[188:191], a[252:255], v[140:143], v[188:191]
    s_nop 0
    v_cvt_pk_bf16_f32 v159, v126, v127
    s_waitcnt lgkmcnt(0)
    v_mfma_f32_16x16x32_bf16 v[96:99], a[128:131], v[0:3], v[160:163]
    ds_read_b64_tr_b16 a[160:161], v196 offset:40960
    v_mfma_f32_16x16x32_bf16 v[96:99], a[132:135], v[4:7], v[96:99]
    ds_read_b64_tr_b16 a[162:163], v196 offset:45056
    v_exp_f32 v64, v64
    v_mfma_f32_16x16x32_bf16 v[96:99], a[136:139], v[8:11], v[96:99]
    v_exp_f32 v65, v65
    v_mfma_f32_16x16x32_bf16 v[96:99], a[140:143], v[12:15], v[96:99]
    ds_read_b64_tr_b16 a[164:165], v197 offset:40960
    v_mfma_f32_16x16x32_bf16 v[100:103], a[128:131], v[16:19], v[164:167]
    ds_read_b64_tr_b16 a[166:167], v197 offset:45056
    v_mfma_f32_16x16x32_bf16 v[100:103], a[132:135], v[20:23], v[100:103]
    v_exp_f32 v66, v66
    v_cvt_pk_bf16_f32 v128, v64, v65
    v_mfma_f32_16x16x32_bf16 v[100:103], a[136:139], v[24:27], v[100:103]
    ds_read_b64_tr_b16 a[168:169], v198 offset:40960
    v_mfma_f32_16x16x32_bf16 v[100:103], a[140:143], v[28:31], v[100:103]
    ds_read_b64_tr_b16 a[170:171], v198 offset:45056
    v_exp_f32 v67, v67
    v_mfma_f32_16x16x32_bf16 v[104:107], a[128:131], v[32:35], v[168:171]
    v_mfma_f32_16x16x32_bf16 v[104:107], a[132:135], v[36:39], v[104:107]
    ds_read_b64_tr_b16 a[172:173], v199 offset:40960
    v_exp_f32 v80, v80
    v_mfma_f32_16x16x32_bf16 v[104:107], a[136:139], v[40:43], v[104:107]
    ds_read_b64_tr_b16 a[174:175], v199 offset:45056
    v_mfma_f32_16x16x32_bf16 v[104:107], a[140:143], v[44:47], v[104:107]
    v_cvt_pk_bf16_f32 v129, v66, v67
    v_exp_f32 v81, v81
    v_mfma_f32_16x16x32_bf16 v[108:111], a[128:131], v[48:51], v[172:175]
    ds_read_b64_tr_b16 a[176:177], v200 offset:40960
    v_mfma_f32_16x16x32_bf16 v[108:111], a[132:135], v[52:55], v[108:111]
    ds_read_b64_tr_b16 a[178:179], v200 offset:45056
    v_mfma_f32_16x16x32_bf16 v[108:111], a[136:139], v[56:59], v[108:111]
    v_exp_f32 v82, v82
    v_mfma_f32_16x16x32_bf16 v[108:111], a[140:143], v[60:63], v[108:111]
    ds_read_b64_tr_b16 a[180:181], v201 offset:40960
    v_cvt_pk_bf16_f32 v130, v80, v81
    v_mfma_f32_16x16x32_bf16 v[112:115], a[144:147], v[0:3], v[160:163]
    ds_read_b64_tr_b16 a[182:183], v201 offset:45056
    v_mfma_f32_16x16x32_bf16 v[112:115], a[148:151], v[4:7], v[112:115]
    v_exp_f32 v83, v83
    v_mfma_f32_16x16x32_bf16 v[112:115], a[152:155], v[8:11], v[112:115]
    ds_read_b64_tr_b16 a[184:185], v202 offset:40960
    v_exp_f32 v68, v68
    v_mfma_f32_16x16x32_bf16 v[112:115], a[156:159], v[12:15], v[112:115]
    ds_read_b64_tr_b16 a[186:187], v202 offset:45056
    v_mfma_f32_16x16x32_bf16 v[116:119], a[144:147], v[16:19], v[164:167]
    v_cvt_pk_bf16_f32 v131, v82, v83
    v_mfma_f32_16x16x32_bf16 v[116:119], a[148:151], v[20:23], v[116:119]
    ds_read_b64_tr_b16 a[188:189], v203 offset:40960
    v_exp_f32 v69, v69
    v_mfma_f32_16x16x32_bf16 v[116:119], a[152:155], v[24:27], v[116:119]
    ds_read_b64_tr_b16 a[190:191], v203 offset:45056
    v_mfma_f32_16x16x32_bf16 v[116:119], a[156:159], v[28:31], v[116:119]
    v_exp_f32 v70, v70
    v_mfma_f32_16x16x32_bf16 v[120:123], a[144:147], v[32:35], v[168:171]
    s_cmp_lg_u32 s34, s100
    s_cbranch_scc1 L_rel_skip3
    s_waitcnt vmcnt(20)
    ds_read_b64_tr_b16 a[192:193], v254 offset:0
    ds_read_b64_tr_b16 a[194:195], v254 offset:2560
    ds_read_b64_tr_b16 a[196:197], v254 offset:32
    ds_read_b64_tr_b16 a[198:199], v254 offset:2592
    ds_read_b64_tr_b16 a[200:201], v254 offset:64
    ds_read_b64_tr_b16 a[202:203], v254 offset:2624
    ds_read_b64_tr_b16 a[204:205], v254 offset:96
    ds_read_b64_tr_b16 a[206:207], v254 offset:2656
    ds_read_b64_tr_b16 a[208:209], v254 offset:128
    ds_read_b64_tr_b16 a[210:211], v254 offset:2688
L_rel_skip3:
    v_mfma_f32_16x16x32_bf16 v[120:123], a[148:151], v[36:39], v[120:123]
    v_cvt_pk_bf16_f32 v132, v68, v69
    v_mfma_f32_16x16x32_bf16 v[120:123], a[152:155], v[40:43], v[120:123]
    v_exp_f32 v71, v71
    v_mfma_f32_16x16x32_bf16 v[120:123], a[156:159], v[44:47], v[120:123]
    v_exp_f32 v84, v84
    v_mfma_f32_16x16x32_bf16 v[124:127], a[144:147], v[48:51], v[172:175]
    v_cvt_pk_bf16_f32 v133, v70, v71
    v_mfma_f32_16x16x32_bf16 v[124:127], a[148:151], v[52:55], v[124:127]
    v_exp_f32 v85, v85
    v_mfma_f32_16x16x32_bf16 v[124:127], a[152:155], v[56:59], v[124:127]
    v_exp_f32 v86, v86
    v_mfma_f32_16x16x32_bf16 v[124:127], a[156:159], v[60:63], v[124:127]
    s_waitcnt vmcnt(16) lgkmcnt(0)
    s_barrier
    v_mfma_f32_16x16x32_bf16 a[0:3], a[160:163], v[144:147], a[0:3]
    ds_read_b128 a[128:131], v192 offset:0
    v_cvt_pk_bf16_f32 v134, v84, v85
    v_mfma_f32_16x16x32_bf16 a[4:7], a[160:163], v[148:151], a[4:7]
    v_exp_f32 v87, v87
    v_mfma_f32_16x16x32_bf16 a[8:11], a[160:163], v[152:155], a[8:11]
    ds_read_b128 a[132:135], v193 offset:0
    v_mfma_f32_16x16x32_bf16 a[12:15], a[160:163], v[156:159], a[12:15]
    v_exp_f32 v72, v72
    v_mfma_f32_16x16x32_bf16 a[16:19], a[164:167], v[144:147], a[16:19]
    ds_read_b128 a[136:139], v194 offset:0
    v_cvt_pk_bf16_f32 v135, v86, v87
    v_mfma_f32_16x16x32_bf16 a[20:23], a[164:167], v[148:151], a[20:23]
    v_exp_f32 v73, v73
    v_mfma_f32_16x16x32_bf16 a[24:27], a[164:167], v[152:155], a[24:27]
    ds_read_b128 a[140:143], v195 offset:0
    v_mfma_f32_16x16x32_bf16 a[28:31], a[164:167], v[156:159], a[28:31]
    v_exp_f32 v74, v74
    v_mfma_f32_16x16x32_bf16 v[176:179], a[252:255], v[144:147], v[176:179]
    ds_read_b128 a[144:147], v192 offset:4096
    v_cvt_pk_bf16_f32 v136, v72, v73
    v_mfma_f32_16x16x32_bf16 a[32:35], a[168:171], v[144:147], a[32:35]
    v_exp_f32 v75, v75
    v_mfma_f32_16x16x32_bf16 a[36:39], a[168:171], v[148:151], a[36:39]
    ds_read_b128 a[148:151], v193 offset:4096
    v_mfma_f32_16x16x32_bf16 a[40:43], a[168:171], v[152:155], a[40:43]
    v_exp_f32 v88, v88
    v_mfma_f32_16x16x32_bf16 a[44:47], a[168:171], v[156:159], a[44:47]
    ds_read_b128 a[152:155], v194 offset:4096
    v_cvt_pk_bf16_f32 v137, v74, v75
    v_mfma_f32_16x16x32_bf16 a[48:51], a[172:175], v[144:147], a[48:51]
    v_exp_f32 v89, v89
    v_mfma_f32_16x16x32_bf16 a[52:55], a[172:175], v[148:151], a[52:55]
    ds_read_b128 a[156:159], v195 offset:4096
    v_mfma_f32_16x16x32_bf16 a[56:59], a[172:175], v[152:155], a[56:59]
    v_exp_f32 v90, v90
    v_mfma_f32_16x16x32_bf16 a[60:63], a[172:175], v[156:159], a[60:63]
    v_cvt_pk_bf16_f32 v138, v88, v89
    v_mfma_f32_16x16x32_bf16 v[180:183], a[252:255], v[148:151], v[180:183]
    s_add_u32 m0, s29, 0xc000
    v_exp_f32 v91, v91
    v_mfma_f32_16x16x32_bf16 a[64:67], a[176:179], v[144:147], a[64:67]
    buffer_load_dwordx4 v204, s[8:11], s32 offen offset:0 lds
    v_mfma_f32_16x16x32_bf16 a[68:71], a[176:179], v[148:151], a[68:71]
    v_exp_f32 v76, v76
    v_mfma_f32_16x16x32_bf16 a[72:75], a[176:179], v[152:155], a[72:75]
    v_cvt_pk_bf16_f32 v139, v90, v91
    v_mfma_f32_16x16x32_bf16 a[76:79], a[176:179], v[156:159], a[76:79]
    v_exp_f32 v77, v77
    v_mfma_f32_16x16x32_bf16 a[80:83], a[180:183], v[144:147], a[80:83]
    buffer_load_dwordx4 v205, s[8:11], s32 offen offset:1024 lds
    v_mfma_f32_16x16x32_bf16 a[84:87], a[180:183], v[148:151], a[84:87]
    v_exp_f32 v78, v78
    v_mfma_f32_16x16x32_bf16 a[88:91], a[180:183], v[152:155], a[88:91]
    v_cvt_pk_bf16_f32 v140, v76, v77
    v_mfma_f32_16x16x32_bf16 a[92:95], a[180:183], v[156:159], a[92:95]
    v_exp_f32 v79, v79
    v_mfma_f32_16x16x32_bf16 v[184:187], a[252:255], v[152:155], v[184:187]
    buffer_load_dwordx4 v206, s[8:11], s32 offen offset:2048 lds
    v_mfma_f32_16x16x32_bf16 a[96:99], a[184:187], v[144:147], a[96:99]
    v_exp_f32 v92, v92
    v_mfma_f32_16x16x32_bf16 a[100:103], a[184:187], v[148:151], a[100:103]
    v_cvt_pk_bf16_f32 v141, v78, v79
    v_mfma_f32_16x16x32_bf16 a[104:107], a[184:187], v[152:155], a[104:107]
    v_exp_f32 v93, v93
    v_mfma_f32_16x16x32_bf16 a[108:111], a[184:187], v[156:159], a[108:111]
    buffer_load_dwordx4 v207, s[8:11], s32 offen offset:3072 lds
    v_mfma_f32_16x16x32_bf16 a[112:115], a[188:191], v[144:147], a[112:115]
    s_add_u32 s32, s32, 0x4000
    v_mfma_f32_16x16x32_bf16 a[116:119], a[188:191], v[148:151], a[116:119]
    v_exp_f32 v94, v94
    v_mfma_f32_16x16x32_bf16 a[120:123], a[188:191], v[152:155], a[120:123]
    v_cvt_pk_bf16_f32 v142, v92, v93
    v_mfma_f32_16x16x32_bf16 a[124:127], a[188:191], v[156:159], a[124:127]
    v_exp_f32 v95, v95
    v_mfma_f32_16x16x32_bf16 v[188:191], a[252:255], v[156:159], v[188:191]
    s_nop 0
    v_cvt_pk_bf16_f32 v143, v94, v95
    s_waitcnt lgkmcnt(0)
    v_mfma_f32_16x16x32_bf16 v[64:67], a[128:131], v[0:3], v[160:163]
    ds_read_b64_tr_b16 a[160:161], v196 offset:49152
    v_mfma_f32_16x16x32_bf16 v[64:67], a[132:135], v[4:7], v[64:67]
    ds_read_b64_tr_b16 a[162:163], v196 offset:53248
    v_exp_f32 v96, v96
    v_mfma_f32_16x16x32_bf16 v[64:67], a[136:139], v[8:11], v[64:67]
    v_exp_f32 v97, v97
    v_mfma_f32_16x16x32_bf16 v[64:67], a[140:143], v[12:15], v[64:67]
    ds_read_b64_tr_b16 a[164:165], v197 offset:49152
    v_mfma_f32_16x16x32_bf16 v[68:71], a[128:131], v[16:19], v[164:167]
    ds_read_b64_tr_b16 a[166:167], v197 offset:53248
    s_cmp_lg_u32 s34, s100
    s_cbranch_scc1 L_rel_skip4
    ds_read_b64_tr_b16 a[212:213], v255 offset:0
    ds_read_b64_tr_b16 a[214:215], v255 offset:2560
    ds_read_b64_tr_b16 a[216:217], v255 offset:32
    ds_read_b64_tr_b16 a[218:219], v255 offset:2592
    ds_read_b64_tr_b16 a[220:221], v255 offset:64
    ds_read_b64_tr_b16 a[222:223], v255 offset:2624
    ds_read_b64_tr_b16 a[224:225], v255 offset:96
    ds_read_b64_tr_b16 a[226:227], v255 offset:2656
    ds_read_b64_tr_b16 a[228:229], v255 offset:128
    ds_read_b64_tr_b16 a[230:231], v255 offset:2688
L_rel_skip4:
    v_mfma_f32_16x16x32_bf16 v[68:71], a[132:135], v[20:23], v[68:71]
    v_mfma_f32_16x16x32_bf16 v[68:71], a[136:139], v[24:27], v[68:71]
    ds_read_b64_tr_b16 a[168:169], v198 offset:49152
    v_exp_f32 v98, v98
    v_mfma_f32_16x16x32_bf16 v[68:71], a[140:143], v[28:31], v[68:71]
    ds_read_b64_tr_b16 a[170:171], v198 offset:53248
    v_mfma_f32_16x16x32_bf16 v[72:75], a[128:131], v[32:35], v[168:171]
    v_cvt_pk_bf16_f32 v144, v96, v97
    v_mfma_f32_16x16x32_bf16 v[72:75], a[132:135], v[36:39], v[72:75]
    ds_read_b64_tr_b16 a[172:173], v199 offset:49152
    v_exp_f32 v99, v99
    v_mfma_f32_16x16x32_bf16 v[72:75], a[136:139], v[40:43], v[72:75]
    ds_read_b64_tr_b16 a[174:175], v199 offset:53248
    v_mfma_f32_16x16x32_bf16 v[72:75], a[140:143], v[44:47], v[72:75]
    v_exp_f32 v112, v112
    v_mfma_f32_16x16x32_bf16 v[76:79], a[128:131], v[48:51], v[172:175]
    ds_read_b64_tr_b16 a[176:177], v200 offset:49152
    v_cvt_pk_bf16_f32 v145, v98, v99
    v_mfma_f32_16x16x32_bf16 v[76:79], a[132:135], v[52:55], v[76:79]
    ds_read_b64_tr_b16 a[178:179], v200 offset:53248
    v_mfma_f32_16x16x32_bf16 v[76:79], a[136:139], v[56:59], v[76:79]
    v_exp_f32 v113, v113
    v_mfma_f32_16x16x32_bf16 v[76:79], a[140:143], v[60:63], v[76:79]
    ds_read_b64_tr_b16 a[180:181], v201 offset:49152
    v_exp_f32 v114, v114
    v_mfma_f32_16x16x32_bf16 v[80:83], a[144:147], v[0:3], v[160:163]
    ds_read_b64_tr_b16 a[182:183], v201 offset:53248
    v_mfma_f32_16x16x32_bf16 v[80:83], a[148:151], v[4:7], v[80:83]
    v_cvt_pk_bf16_f32 v146, v112, v113
    v_mfma_f32_16x16x32_bf16 v[80:83], a[152:155], v[8:11], v[80:83]
    ds_read_b64_tr_b16 a[184:185], v202 offset:49152
    v_exp_f32 v115, v115
    v_mfma_f32_16x16x32_bf16 v[80:83], a[156:159], v[12:15], v[80:83]
    ds_read_b64_tr_b16 a[186:187], v202 offset:53248
    v_mfma_f32_16x16x32_bf16 v[84:87], a[144:147], v[16:19], v[164:167]
    v_exp_f32 v100, v100
    v_mfma_f32_16x16x32_bf16 v[84:87], a[148:151], v[20:23], v[84:87]
    ds_read_b64_tr_b16 a[188:189], v203 offset:49152
    v_cvt_pk_bf16_f32 v147, v114, v115
    v_mfma_f32_16x16x32_bf16 v[84:87], a[152:155], v[24:27], v[84:87]
    ds_read_b64_tr_b16 a[190:191], v203 offset:53248
    v_mfma_f32_16x16x32_bf16 v[84:87], a[156:159], v[28:31], v[84:87]
    v_exp_f32 v101, v101
    v_mfma_f32_16x16x32_bf16 v[88:91], a[144:147], v[32:35], v[168:171]
    v_exp_f32 v102, v102
    v_mfma_f32_16x16x32_bf16 v[88:91], a[148:151], v[36:39], v[88:91]
    v_cvt_pk_bf16_f32 v148, v100, v101
    v_mfma_f32_16x16x32_bf16 v[88:91], a[152:155], v[40:43], v[88:91]
    v_exp_f32 v103, v103
    v_mfma_f32_16x16x32_bf16 v[88:91], a[156:159], v[44:47], v[88:91]
    v_exp_f32 v116, v116
    v_mfma_f32_16x16x32_bf16 v[92:95], a[144:147], v[48:51], v[172:175]
    v_cvt_pk_bf16_f32 v149, v102, v103
    v_exp_f32 v117, v117
    v_mfma_f32_16x16x32_bf16 v[92:95], a[148:151], v[52:55], v[92:95]
    v_mfma_f32_16x16x32_bf16 v[92:95], a[152:155], v[56:59], v[92:95]
    v_exp_f32 v118, v118
    v_cvt_pk_bf16_f32 v150, v116, v117
    v_mfma_f32_16x16x32_bf16 v[92:95], a[156:159], v[60:63], v[92:95]
    s_waitcnt lgkmcnt(0)
    v_mfma_f32_16x16x32_bf16 a[0:3], a[160:163], v[128:131], a[0:3]
    ds_read_b128 a[128:131], v192 offset:8192
    v_exp_f32 v119, v119
    v_mfma_f32_16x16x32_bf16 a[4:7], a[160:163], v[132:135], a[4:7]
    v_exp_f32 v104, v104
    v_mfma_f32_16x16x32_bf16 a[8:11], a[160:163], v[136:139], a[8:11]
    ds_read_b128 a[132:135], v193 offset:8192
    v_mfma_f32_16x16x32_bf16 a[12:15], a[160:163], v[140:143], a[12:15]
    v_cvt_pk_bf16_f32 v151, v118, v119
    v_mfma_f32_16x16x32_bf16 a[16:19], a[164:167], v[128:131], a[16:19]
    ds_read_b128 a[136:139], v194 offset:8192
    v_exp_f32 v105, v105
    v_mfma_f32_16x16x32_bf16 a[20:23], a[164:167], v[132:135], a[20:23]
    v_exp_f32 v106, v106
    v_mfma_f32_16x16x32_bf16 a[24:27], a[164:167], v[136:139], a[24:27]
    ds_read_b128 a[140:143], v195 offset:8192
    v_mfma_f32_16x16x32_bf16 a[28:31], a[164:167], v[140:143], a[28:31]
    v_cvt_pk_bf16_f32 v152, v104, v105
    v_mfma_f32_16x16x32_bf16 v[176:179], a[252:255], v[128:131], v[176:179]
    ds_read_b128 a[144:147], v192 offset:12288
    s_cmp_lg_u32 s34, s100
    s_cbranch_scc1 L_rel_skip5
    s_lshl_b32 s35, s2, 2
    s_add_u32 s35, s35, s28
    s_mul_i32 s51, s35, 5120
    s_add_u32 s56, s46, 0x2000000
    s_addc_u32 s57, s47, 0
    s_and_b32 s57, s57, 0xffff
    s_mov_b32 s58, 0x500000
    s_mov_b32 s59, 0x20000
    buffer_store_dwordx4 a[192:195], v221, s[56:59], s51 offen offset:0 sc1
    buffer_store_dwordx4 a[196:199], v221, s[56:59], s51 offen offset:1024 sc1
    buffer_store_dwordx4 a[200:203], v221, s[56:59], s51 offen offset:2048 sc1
    buffer_store_dwordx4 a[204:207], v221, s[56:59], s51 offen offset:3072 sc1
    s_add_u32 s51, s51, 0x1000
    buffer_store_dwordx4 a[208:211], v221, s[56:59], s51 offen offset:0 sc1
L_rel_skip5:
    v_mfma_f32_16x16x32_bf16 a[32:35], a[168:171], v[128:131], a[32:35]
    v_exp_f32 v107, v107
    v_mfma_f32_16x16x32_bf16 a[36:39], a[168:171], v[132:135], a[36:39]
    ds_read_b128 a[148:151], v193 offset:12288
    v_mfma_f32_16x16x32_bf16 a[40:43], a[168:171], v[136:139], a[40:43]
    v_exp_f32 v120, v120
    v_mfma_f32_16x16x32_bf16 a[44:47], a[168:171], v[140:143], a[44:47]
    ds_read_b128 a[152:155], v194 offset:12288
    v_mfma_f32_16x16x32_bf16 a[48:51], a[172:175], v[128:131], a[48:51]
    v_cvt_pk_bf16_f32 v153, v106, v107
    v_exp_f32 v121, v121
    v_mfma_f32_16x16x32_bf16 a[52:55], a[172:175], v[132:135], a[52:55]
    ds_read_b128 a[156:159], v195 offset:12288
    v_mfma_f32_16x16x32_bf16 a[56:59], a[172:175], v[136:139], a[56:59]
    v_exp_f32 v122, v122
    v_mfma_f32_16x16x32_bf16 a[60:63], a[172:175], v[140:143], a[60:63]
    v_cvt_pk_bf16_f32 v154, v120, v121
    v_mfma_f32_16x16x32_bf16 v[180:183], a[252:255], v[132:135], v[180:183]
    s_add_u32 m0, s29, 0x18000
    v_exp_f32 v123, v123
    v_mfma_f32_16x16x32_bf16 a[64:67], a[176:179], v[128:131], a[64:67]
    buffer_load_dwordx4 v208, s[12:15], s33 offen offset:0 lds
    v_mfma_f32_16x16x32_bf16 a[68:71], a[176:179], v[132:135], a[68:71]
    v_mfma_f32_16x16x32_bf16 a[72:75], a[176:179], v[136:139], a[72:75]
    v_exp_f32 v108, v108
    v_cvt_pk_bf16_f32 v155, v122, v123
    v_mfma_f32_16x16x32_bf16 a[76:79], a[176:179], v[140:143], a[76:79]
    v_exp_f32 v109, v109
    v_mfma_f32_16x16x32_bf16 a[80:83], a[180:183], v[128:131], a[80:83]
    buffer_load_dwordx4 v242, s[12:15], s33 offen offset:1024 lds
    v_mfma_f32_16x16x32_bf16 a[84:87], a[180:183], v[132:135], a[84:87]
    v_mfma_f32_16x16x32_bf16 a[88:91], a[180:183], v[136:139], a[88:91]
    v_exp_f32 v110, v110
    v_cvt_pk_bf16_f32 v156, v108, v109
    v_mfma_f32_16x16x32_bf16 a[92:95], a[180:183], v[140:143], a[92:95]
    v_exp_f32 v111, v111
    v_mfma_f32_16x16x32_bf16 v[184:187], a[252:255], v[136:139], v[184:187]
    buffer_load_dwordx4 v208, s[12:15], s33 offen offset:2048 lds
    v_mfma_f32_16x16x32_bf16 a[96:99], a[184:187], v[128:131], a[96:99]
    v_mfma_f32_16x16x32_bf16 a[100:103], a[184:187], v[132:135], a[100:103]
    v_exp_f32 v124, v124
    v_cvt_pk_bf16_f32 v157, v110, v111
    v_mfma_f32_16x16x32_bf16 a[104:107], a[184:187], v[136:139], a[104:107]
    v_exp_f32 v125, v125
    v_mfma_f32_16x16x32_bf16 a[108:111], a[184:187], v[140:143], a[108:111]
    buffer_load_dwordx4 v242, s[12:15], s33 offen offset:3072 lds
    v_mfma_f32_16x16x32_bf16 a[112:115], a[188:191], v[128:131], a[112:115]
    s_add_u32 s33, s33, 0x4000
    v_mfma_f32_16x16x32_bf16 a[116:119], a[188:191], v[132:135], a[116:119]
    v_exp_f32 v126, v126
    v_mfma_f32_16x16x32_bf16 a[120:123], a[188:191], v[136:139], a[120:123]
    v_cvt_pk_bf16_f32 v158, v124, v125
    v_mfma_f32_16x16x32_bf16 a[124:127], a[188:191], v[140:143], a[124:127]
    v_exp_f32 v127, v127
    v_mfma_f32_16x16x32_bf16 v[188:191], a[252:255], v[140:143], v[188:191]
    s_nop 0
    v_cvt_pk_bf16_f32 v159, v126, v127
    s_waitcnt lgkmcnt(0)
    v_mfma_f32_16x16x32_bf16 v[96:99], a[128:131], v[0:3], v[160:163]
    ds_read_b64_tr_b16 a[160:161], v196 offset:57344
    v_mfma_f32_16x16x32_bf16 v[96:99], a[132:135], v[4:7], v[96:99]
    ds_read_b64_tr_b16 a[162:163], v196 offset:61440
    v_exp_f32 v64, v64
    v_mfma_f32_16x16x32_bf16 v[96:99], a[136:139], v[8:11], v[96:99]
    v_exp_f32 v65, v65
    v_mfma_f32_16x16x32_bf16 v[96:99], a[140:143], v[12:15], v[96:99]
    ds_read_b64_tr_b16 a[164:165], v197 offset:57344
    v_mfma_f32_16x16x32_bf16 v[100:103], a[128:131], v[16:19], v[164:167]
    ds_read_b64_tr_b16 a[166:167], v197 offset:61440
    v_mfma_f32_16x16x32_bf16 v[100:103], a[132:135], v[20:23], v[100:103]
    v_exp_f32 v66, v66
    v_cvt_pk_bf16_f32 v128, v64, v65
    v_mfma_f32_16x16x32_bf16 v[100:103], a[136:139], v[24:27], v[100:103]
    ds_read_b64_tr_b16 a[168:169], v198 offset:57344
    v_mfma_f32_16x16x32_bf16 v[100:103], a[140:143], v[28:31], v[100:103]
    ds_read_b64_tr_b16 a[170:171], v198 offset:61440
    v_exp_f32 v67, v67
    v_mfma_f32_16x16x32_bf16 v[104:107], a[128:131], v[32:35], v[168:171]
    v_mfma_f32_16x16x32_bf16 v[104:107], a[132:135], v[36:39], v[104:107]
    ds_read_b64_tr_b16 a[172:173], v199 offset:57344
    v_exp_f32 v80, v80
    v_mfma_f32_16x16x32_bf16 v[104:107], a[136:139], v[40:43], v[104:107]
    ds_read_b64_tr_b16 a[174:175], v199 offset:61440
    v_mfma_f32_16x16x32_bf16 v[104:107], a[140:143], v[44:47], v[104:107]
    v_cvt_pk_bf16_f32 v129, v66, v67
    v_exp_f32 v81, v81
    v_mfma_f32_16x16x32_bf16 v[108:111], a[128:131], v[48:51], v[172:175]
    ds_read_b64_tr_b16 a[176:177], v200 offset:57344
    v_mfma_f32_16x16x32_bf16 v[108:111], a[132:135], v[52:55], v[108:111]
    ds_read_b64_tr_b16 a[178:179], v200 offset:61440
    v_mfma_f32_16x16x32_bf16 v[108:111], a[136:139], v[56:59], v[108:111]
    v_exp_f32 v82, v82
    v_mfma_f32_16x16x32_bf16 v[108:111], a[140:143], v[60:63], v[108:111]
    ds_read_b64_tr_b16 a[180:181], v201 offset:57344
    v_cvt_pk_bf16_f32 v130, v80, v81
    v_mfma_f32_16x16x32_bf16 v[112:115], a[144:147], v[0:3], v[160:163]
    ds_read_b64_tr_b16 a[182:183], v201 offset:61440
    v_mfma_f32_16x16x32_bf16 v[112:115], a[148:151], v[4:7], v[112:115]
    v_exp_f32 v83, v83
    v_mfma_f32_16x16x32_bf16 v[112:115], a[152:155], v[8:11], v[112:115]
    ds_read_b64_tr_b16 a[184:185], v202 offset:57344
    v_exp_f32 v68, v68
    v_mfma_f32_16x16x32_bf16 v[112:115], a[156:159], v[12:15], v[112:115]
    ds_read_b64_tr_b16 a[186:187], v202 offset:61440
    v_mfma_f32_16x16x32_bf16 v[116:119], a[144:147], v[16:19], v[164:167]
    v_cvt_pk_bf16_f32 v131, v82, v83
    v_mfma_f32_16x16x32_bf16 v[116:119], a[148:151], v[20:23], v[116:119]
    ds_read_b64_tr_b16 a[188:189], v203 offset:57344
    v_exp_f32 v69, v69
    v_mfma_f32_16x16x32_bf16 v[116:119], a[152:155], v[24:27], v[116:119]
    ds_read_b64_tr_b16 a[190:191], v203 offset:61440
    v_mfma_f32_16x16x32_bf16 v[116:119], a[156:159], v[28:31], v[116:119]
    v_exp_f32 v70, v70
    v_mfma_f32_16x16x32_bf16 v[120:123], a[144:147], v[32:35], v[168:171]
    s_cmp_lg_u32 s34, s100
    s_cbranch_scc1 L_rel_skip6
    s_lshl_b32 s35, s2, 1
    s_add_u32 s35, s35, s28
    s_mul_i32 s51, s35, 5120
    s_add_u32 s56, s46, 0x2600000
    s_addc_u32 s57, s47, 0
    s_and_b32 s57, s57, 0xffff
    s_mov_b32 s58, 0x21c000
    s_mov_b32 s59, 0x20000
    s_cmp_lt_u32 s28, 2
    s_cselect_b32 s58, s58, 0
    buffer_store_dwordx4 a[212:215], v221, s[56:59], s51 offen offset:0 sc1
    buffer_store_dwordx4 a[216:219], v221, s[56:59], s51 offen offset:1024 sc1
    buffer_store_dwordx4 a[220:223], v221, s[56:59], s51 offen offset:2048 sc1
    buffer_store_dwordx4 a[224:227], v221, s[56:59], s51 offen offset:3072 sc1
    s_add_u32 s51, s51, 0x1000
    buffer_store_dwordx4 a[228:231], v221, s[56:59], s51 offen offset:0 sc1
L_rel_skip6:
    v_mfma_f32_16x16x32_bf16 v[120:123], a[148:151], v[36:39], v[120:123]
    v_cvt_pk_bf16_f32 v132, v68, v69
    v_mfma_f32_16x16x32_bf16 v[120:123], a[152:155], v[40:43], v[120:123]
    v_exp_f32 v71, v71
    v_mfma_f32_16x16x32_bf16 v[120:123], a[156:159], v[44:47], v[120:123]
    v_exp_f32 v84, v84
    v_mfma_f32_16x16x32_bf16 v[124:127], a[144:147], v[48:51], v[172:175]
    v_cvt_pk_bf16_f32 v133, v70, v71
    v_mfma_f32_16x16x32_bf16 v[124:127], a[148:151], v[52:55], v[124:127]
    v_exp_f32 v85, v85
    v_mfma_f32_16x16x32_bf16 v[124:127], a[152:155], v[56:59], v[124:127]
    v_exp_f32 v86, v86
    v_mfma_f32_16x16x32_bf16 v[124:127], a[156:159], v[60:63], v[124:127]
    s_waitcnt vmcnt(16) lgkmcnt(0)
    s_barrier
    v_mfma_f32_16x16x32_bf16 a[0:3], a[160:163], v[144:147], a[0:3]
    ds_read_b128 a[128:131], v192 offset:16384
    v_cvt_pk_bf16_f32 v134, v84, v85
    v_mfma_f32_16x16x32_bf16 a[4:7], a[160:163], v[148:151], a[4:7]
    v_exp_f32 v87, v87
    v_mfma_f32_16x16x32_bf16 a[8:11], a[160:163], v[152:155], a[8:11]
    ds_read_b128 a[132:135], v193 offset:16384
    v_mfma_f32_16x16x32_bf16 a[12:15], a[160:163], v[156:159], a[12:15]
    v_exp_f32 v72, v72
    v_mfma_f32_16x16x32_bf16 a[16:19], a[164:167], v[144:147], a[16:19]
    ds_read_b128 a[136:139], v194 offset:16384
    v_cvt_pk_bf16_f32 v135, v86, v87
    v_mfma_f32_16x16x32_bf16 a[20:23], a[164:167], v[148:151], a[20:23]
    v_exp_f32 v73, v73
    v_mfma_f32_16x16x32_bf16 a[24:27], a[164:167], v[152:155], a[24:27]
    ds_read_b128 a[140:143], v195 offset:16384
    v_mfma_f32_16x16x32_bf16 a[28:31], a[164:167], v[156:159], a[28:31]
    v_exp_f32 v74, v74
    v_mfma_f32_16x16x32_bf16 v[176:179], a[252:255], v[144:147], v[176:179]
    ds_read_b128 a[144:147], v192 offset:20480
    v_cvt_pk_bf16_f32 v136, v72, v73
    v_mfma_f32_16x16x32_bf16 a[32:35], a[168:171], v[144:147], a[32:35]
    v_exp_f32 v75, v75
    v_mfma_f32_16x16x32_bf16 a[36:39], a[168:171], v[148:151], a[36:39]
    ds_read_b128 a[148:151], v193 offset:20480
    v_mfma_f32_16x16x32_bf16 a[40:43], a[168:171], v[152:155], a[40:43]
    v_exp_f32 v88, v88
    v_mfma_f32_16x16x32_bf16 a[44:47], a[168:171], v[156:159], a[44:47]
    ds_read_b128 a[152:155], v194 offset:20480
    v_cvt_pk_bf16_f32 v137, v74, v75
    v_mfma_f32_16x16x32_bf16 a[48:51], a[172:175], v[144:147], a[48:51]
    v_exp_f32 v89, v89
    v_mfma_f32_16x16x32_bf16 a[52:55], a[172:175], v[148:151], a[52:55]
    ds_read_b128 a[156:159], v195 offset:20480
    v_mfma_f32_16x16x32_bf16 a[56:59], a[172:175], v[152:155], a[56:59]
    v_exp_f32 v90, v90
    v_mfma_f32_16x16x32_bf16 a[60:63], a[172:175], v[156:159], a[60:63]
    v_cvt_pk_bf16_f32 v138, v88, v89
    v_mfma_f32_16x16x32_bf16 v[180:183], a[252:255], v[148:151], v[180:183]
    s_add_u32 m0, s29, 0x0
    v_exp_f32 v91, v91
    v_mfma_f32_16x16x32_bf16 a[64:67], a[176:179], v[144:147], a[64:67]
    buffer_load_dwordx4 v204, s[8:11], s32 offen offset:0 lds
    v_mfma_f32_16x16x32_bf16 a[68:71], a[176:179], v[148:151], a[68:71]
    v_exp_f32 v76, v76
    v_mfma_f32_16x16x32_bf16 a[72:75], a[176:179], v[152:155], a[72:75]
    v_cvt_pk_bf16_f32 v139, v90, v91
    v_mfma_f32_16x16x32_bf16 a[76:79], a[176:179], v[156:159], a[76:79]
    v_exp_f32 v77, v77
    v_mfma_f32_16x16x32_bf16 a[80:83], a[180:183], v[144:147], a[80:83]
    buffer_load_dwordx4 v205, s[8:11], s32 offen offset:1024 lds
    v_mfma_f32_16x16x32_bf16 a[84:87], a[180:183], v[148:151], a[84:87]
    v_exp_f32 v78, v78
    v_mfma_f32_16x16x32_bf16 a[88:91], a[180:183], v[152:155], a[88:91]
    v_cvt_pk_bf16_f32 v140, v76, v77
    v_mfma_f32_16x16x32_bf16 a[92:95], a[180:183], v[156:159], a[92:95]
    v_exp_f32 v79, v79
    v_mfma_f32_16x16x32_bf16 v[184:187], a[252:255], v[152:155], v[184:187]
    buffer_load_dwordx4 v206, s[8:11], s32 offen offset:2048 lds
    v_mfma_f32_16x16x32_bf16 a[96:99], a[184:187], v[144:147], a[96:99]
    v_exp_f32 v92, v92
    v_mfma_f32_16x16x32_bf16 a[100:103], a[184:187], v[148:151], a[100:103]
    v_cvt_pk_bf16_f32 v141, v78, v79
    v_mfma_f32_16x16x32_bf16 a[104:107], a[184:187], v[152:155], a[104:107]
    v_exp_f32 v93, v93
    v_mfma_f32_16x16x32_bf16 a[108:111], a[184:187], v[156:159], a[108:111]
    buffer_load_dwordx4 v207, s[8:11], s32 offen offset:3072 lds
    v_mfma_f32_16x16x32_bf16 a[112:115], a[188:191], v[144:147], a[112:115]
    s_add_u32 s32, s32, 0x4000
    v_mfma_f32_16x16x32_bf16 a[116:119], a[188:191], v[148:151], a[116:119]
    v_exp_f32 v94, v94
    v_mfma_f32_16x16x32_bf16 a[120:123], a[188:191], v[152:155], a[120:123]
    v_cvt_pk_bf16_f32 v142, v92, v93
    v_mfma_f32_16x16x32_bf16 a[124:127], a[188:191], v[156:159], a[124:127]
    v_exp_f32 v95, v95
    v_mfma_f32_16x16x32_bf16 v[188:191], a[252:255], v[156:159], v[188:191]
    s_nop 0
    v_cvt_pk_bf16_f32 v143, v94, v95
    s_sub_u32 s34, s34, 1
    s_cmp_lg_u32 s34, 0
    s_cbranch_scc1 L_attn_loop
    s_waitcnt lgkmcnt(0)
    v_mfma_f32_16x16x32_bf16 v[64:67], a[128:131], v[0:3], v[160:163]
    ds_read_b64_tr_b16 a[160:161], v196 offset:0
    v_mfma_f32_16x16x32_bf16 v[64:67], a[132:135], v[4:7], v[64:67]
    ds_read_b64_tr_b16 a[162:163], v196 offset:4096
    v_exp_f32 v96, v96
    v_mfma_f32_16x16x32_bf16 v[64:67], a[136:139], v[8:11], v[64:67]
    v_exp_f32 v97, v97
    v_mfma_f32_16x16x32_bf16 v[64:67], a[140:143], v[12:15], v[64:67]
    ds_read_b64_tr_b16 a[164:165], v197 offset:0
    v_mfma_f32_16x16x32_bf16 v[68:71], a[128:131], v[16:19], v[164:167]
    ds_read_b64_tr_b16 a[166:167], v197 offset:4096
    v_mfma_f32_16x16x32_bf16 v[68:71], a[132:135], v[20:23], v[68:71]
    v_exp_f32 v98, v98
    v_mfma_f32_16x16x32_bf16 v[68:71], a[136:139], v[24:27], v[68:71]
    ds_read_b64_tr_b16 a[168:169], v198 offset:0
    v_cvt_pk_bf16_f32 v144, v96, v97
    v_mfma_f32_16x16x32_bf16 v[68:71], a[140:143], v[28:31], v[68:71]
    ds_read_b64_tr_b16 a[170:171], v198 offset:4096
    v_mfma_f32_16x16x32_bf16 v[72:75], a[128:131], v[32:35], v[168:171]
    v_exp_f32 v99, v99
    v_mfma_f32_16x16x32_bf16 v[72:75], a[132:135], v[36:39], v[72:75]
    ds_read_b64_tr_b16 a[172:173], v199 offset:0
    v_exp_f32 v112, v112
    v_mfma_f32_16x16x32_bf16 v[72:75], a[136:139], v[40:43], v[72:75]
    ds_read_b64_tr_b16 a[174:175], v199 offset:4096
    v_mfma_f32_16x16x32_bf16 v[72:75], a[140:143], v[44:47], v[72:75]
    v_cvt_pk_bf16_f32 v145, v98, v99
    v_mfma_f32_16x16x32_bf16 v[76:79], a[128:131], v[48:51], v[172:175]
    ds_read_b64_tr_b16 a[176:177], v200 offset:0
    v_exp_f32 v113, v113
    v_mfma_f32_16x16x32_bf16 v[76:79], a[132:135], v[52:55], v[76:79]
    ds_read_b64_tr_b16 a[178:179], v200 offset:4096
    v_mfma_f32_16x16x32_bf16 v[76:79], a[136:139], v[56:59], v[76:79]
    v_exp_f32 v114, v114
    v_mfma_f32_16x16x32_bf16 v[76:79], a[140:143], v[60:63], v[76:79]
    ds_read_b64_tr_b16 a[180:181], v201 offset:0
    v_mfma_f32_16x16x32_bf16 v[80:83], a[144:147], v[0:3], v[160:163]
    ds_read_b64_tr_b16 a[182:183], v201 offset:4096
    v_cvt_pk_bf16_f32 v146, v112, v113
    v_mfma_f32_16x16x32_bf16 v[80:83], a[148:151], v[4:7], v[80:83]
    v_exp_f32 v115, v115
    v_mfma_f32_16x16x32_bf16 v[80:83], a[152:155], v[8:11], v[80:83]
    ds_read_b64_tr_b16 a[184:185], v202 offset:0
    v_mfma_f32_16x16x32_bf16 v[80:83], a[156:159], v[12:15], v[80:83]
    ds_read_b64_tr_b16 a[186:187], v202 offset:4096
    v_exp_f32 v100, v100
    v_mfma_f32_16x16x32_bf16 v[84:87], a[144:147], v[16:19], v[164:167]
    v_cvt_pk_bf16_f32 v147, v114, v115
    v_mfma_f32_16x16x32_bf16 v[84:87], a[148:151], v[20:23], v[84:87]
    ds_read_b64_tr_b16 a[188:189], v203 offset:0
    v_mfma_f32_16x16x32_bf16 v[84:87], a[152:155], v[24:27], v[84:87]
    ds_read_b64_tr_b16 a[190:191], v203 offset:4096
    v_exp_f32 v101, v101
    v_mfma_f32_16x16x32_bf16 v[84:87], a[156:159], v[28:31], v[84:87]
    v_mfma_f32_16x16x32_bf16 v[88:91], a[144:147], v[32:35], v[168:171]
    v_exp_f32 v102, v102
    v_cvt_pk_bf16_f32 v148, v100, v101
    v_mfma_f32_16x16x32_bf16 v[88:91], a[148:151], v[36:39], v[88:91]
    v_exp_f32 v103, v103
    v_mfma_f32_16x16x32_bf16 v[88:91], a[152:155], v[40:43], v[88:91]
    v_exp_f32 v116, v116
    v_mfma_f32_16x16x32_bf16 v[88:91], a[156:159], v[44:47], v[88:91]
    v_cvt_pk_bf16_f32 v149, v102, v103
    v_mfma_f32_16x16x32_bf16 v[92:95], a[144:147], v[48:51], v[172:175]
    v_exp_f32 v117, v117
    v_mfma_f32_16x16x32_bf16 v[92:95], a[148:151], v[52:55], v[92:95]
    v_exp_f32 v118, v118
    v_mfma_f32_16x16x32_bf16 v[92:95], a[152:155], v[56:59], v[92:95]
    v_cvt_pk_bf16_f32 v150, v116, v117
    v_mfma_f32_16x16x32_bf16 v[92:95], a[156:159], v[60:63], v[92:95]
    s_waitcnt lgkmcnt(0)
    v_mfma_f32_16x16x32_bf16 a[0:3], a[160:163], v[128:131], a[0:3]
    ds_read_b128 a[128:131], v192 offset:24576
    v_exp_f32 v119, v119
    v_mfma_f32_16x16x32_bf16 a[4:7], a[160:163], v[132:135], a[4:7]
    v_exp_f32 v104, v104
    v_mfma_f32_16x16x32_bf16 a[8:11], a[160:163], v[136:139], a[8:11]
    ds_read_b128 a[132:135], v193 offset:24576
    v_mfma_f32_16x16x32_bf16 a[12:15], a[160:163], v[140:143], a[12:15]
    v_cvt_pk_bf16_f32 v151, v118, v119
    v_mfma_f32_16x16x32_bf16 a[16:19], a[164:167], v[128:131], a[16:19]
    ds_read_b128 a[136:139], v194 offset:24576
    v_exp_f32 v105, v105
    v_mfma_f32_16x16x32_bf16 a[20:23], a[164:167], v[132:135], a[20:23]
    v_mfma_f32_16x16x32_bf16 a[24:27], a[164:167], v[136:139], a[24:27]
    ds_read_b128 a[140:143], v195 offset:24576
    v_exp_f32 v106, v106
    v_mfma_f32_16x16x32_bf16 a[28:31], a[164:167], v[140:143], a[28:31]
    v_cvt_pk_bf16_f32 v152, v104, v105
    v_mfma_f32_16x16x32_bf16 v[176:179], a[252:255], v[128:131], v[176:179]
    ds_read_b128 a[144:147], v192 offset:28672
    v_mfma_f32_16x16x32_bf16 a[32:35], a[168:171], v[128:131], a[32:35]
    v_exp_f32 v107, v107
    v_mfma_f32_16x16x32_bf16 a[36:39], a[168:171], v[132:135], a[36:39]
    ds_read_b128 a[148:151], v193 offset:28672
    v_exp_f32 v120, v120
    v_mfma_f32_16x16x32_bf16 a[40:43], a[168:171], v[136:139], a[40:43]
    v_cvt_pk_bf16_f32 v153, v106, v107
    v_mfma_f32_16x16x32_bf16 a[44:47], a[168:171], v[140:143], a[44:47]
    ds_read_b128 a[152:155], v194 offset:28672
    v_mfma_f32_16x16x32_bf16 a[48:51], a[172:175], v[128:131], a[48:51]
    v_exp_f32 v121, v121
    v_mfma_f32_16x16x32_bf16 a[52:55], a[172:175], v[132:135], a[52:55]
    ds_read_b128 a[156:159], v195 offset:28672
    v_exp_f32 v122, v122
    v_mfma_f32_16x16x32_bf16 a[56:59], a[172:175], v[136:139], a[56:59]
    v_cvt_pk_bf16_f32 v154, v120, v121
    v_mfma_f32_16x16x32_bf16 a[60:63], a[172:175], v[140:143], a[60:63]
    v_exp_f32 v123, v123
    v_mfma_f32_16x16x32_bf16 v[180:183], a[252:255], v[132:135], v[180:183]
    s_add_u32 m0, s29, 0x1c000
    v_mfma_f32_16x16x32_bf16 a[64:67], a[176:179], v[128:131], a[64:67]
    buffer_load_dwordx4 v208, s[12:15], s33 offen offset:0 lds
    v_mfma_f32_16x16x32_bf16 a[68:71], a[176:179], v[132:135], a[68:71]
    v_exp_f32 v108, v108
    v_mfma_f32_16x16x32_bf16 a[72:75], a[176:179], v[136:139], a[72:75]
    v_cvt_pk_bf16_f32 v155, v122, v123
    v_mfma_f32_16x16x32_bf16 a[76:79], a[176:179], v[140:143], a[76:79]
    v_exp_f32 v109, v109
    v_mfma_f32_16x16x32_bf16 a[80:83], a[180:183], v[128:131], a[80:83]
    buffer_load_dwordx4 v242, s[12:15], s33 offen offset:1024 lds
    v_mfma_f32_16x16x32_bf16 a[84:87], a[180:183], v[132:135], a[84:87]
    v_exp_f32 v110, v110
    v_mfma_f32_16x16x32_bf16 a[88:91], a[180:183], v[136:139], a[88:91]
    v_cvt_pk_bf16_f32 v156, v108, v109
    v_mfma_f32_16x16x32_bf16 a[92:95], a[180:183], v[140:143], a[92:95]
    v_exp_f32 v111, v111
    v_mfma_f32_16x16x32_bf16 v[184:187], a[252:255], v[136:139], v[184:187]
    buffer_load_dwordx4 v208, s[12:15], s33 offen offset:2048 lds
    v_mfma_f32_16x16x32_bf16 a[96:99], a[184:187], v[128:131], a[96:99]
    v_exp_f32 v124, v124
    v_mfma_f32_16x16x32_bf16 a[100:103], a[184:187], v[132:135], a[100:103]
    v_cvt_pk_bf16_f32 v157, v110, v111
    v_mfma_f32_16x16x32_bf16 a[104:107], a[184:187], v[136:139], a[104:107]
    v_exp_f32 v125, v125
    v_mfma_f32_16x16x32_bf16 a[108:111], a[184:187], v[140:143], a[108:111]
    buffer_load_dwordx4 v242, s[12:15], s33 offen offset:3072 lds
    v_mfma_f32_16x16x32_bf16 a[112:115], a[188:191], v[128:131], a[112:115]
    s_add_u32 s33, s33, 0x4000
    v_mfma_f32_16x16x32_bf16 a[116:119], a[188:191], v[132:135], a[116:119]
    v_exp_f32 v126, v126
    v_mfma_f32_16x16x32_bf16 a[120:123], a[188:191], v[136:139], a[120:123]
    v_cvt_pk_bf16_f32 v158, v124, v125
    v_mfma_f32_16x16x32_bf16 a[124:127], a[188:191], v[140:143], a[124:127]
    v_exp_f32 v127, v127
    v_mfma_f32_16x16x32_bf16 v[188:191], a[252:255], v[140:143], v[188:191]
    s_nop 0
    v_cvt_pk_bf16_f32 v159, v126, v127
    s_waitcnt lgkmcnt(0)
    v_mfma_f32_16x16x32_bf16 v[96:99], a[128:131], v[0:3], v[160:163]
    ds_read_b64_tr_b16 a[160:161], v196 offset:8192
    v_mfma_f32_16x16x32_bf16 v[96:99], a[132:135], v[4:7], v[96:99]
    ds_read_b64_tr_b16 a[162:163], v196 offset:12288
    v_exp_f32 v64, v64
    v_mfma_f32_16x16x32_bf16 v[96:99], a[136:139], v[8:11], v[96:99]
    v_mfma_f32_16x16x32_bf16 v[96:99], a[140:143], v[12:15], v[96:99]
    ds_read_b64_tr_b16 a[164:165], v197 offset:8192
    v_exp_f32 v65, v65
    v_mfma_f32_16x16x32_bf16 v[100:103], a[128:131], v[16:19], v[164:167]
    ds_read_b64_tr_b16 a[166:167], v197 offset:12288
    v_mfma_f32_16x16x32_bf16 v[100:103], a[132:135], v[20:23], v[100:103]
    v_exp_f32 v66, v66
    v_mfma_f32_16x16x32_bf16 v[100:103], a[136:139], v[24:27], v[100:103]
    ds_read_b64_tr_b16 a[168:169], v198 offset:8192
    v_mfma_f32_16x16x32_bf16 v[100:103], a[140:143], v[28:31], v[100:103]
    ds_read_b64_tr_b16 a[170:171], v198 offset:12288
    v_cvt_pk_bf16_f32 v128, v64, v65
    v_mfma_f32_16x16x32_bf16 v[104:107], a[128:131], v[32:35], v[168:171]
    v_exp_f32 v67, v67
    v_mfma_f32_16x16x32_bf16 v[104:107], a[132:135], v[36:39], v[104:107]
    ds_read_b64_tr_b16 a[172:173], v199 offset:8192
    v_mfma_f32_16x16x32_bf16 v[104:107], a[136:139], v[40:43], v[104:107]
    ds_read_b64_tr_b16 a[174:175], v199 offset:12288
    v_mfma_f32_16x16x32_bf16 v[104:107], a[140:143], v[44:47], v[104:107]
    v_exp_f32 v80, v80
    v_mfma_f32_16x16x32_bf16 v[108:111], a[128:131], v[48:51], v[172:175]
    ds_read_b64_tr_b16 a[176:177], v200 offset:8192
    v_mfma_f32_16x16x32_bf16 v[108:111], a[132:135], v[52:55], v[108:111]
    ds_read_b64_tr_b16 a[178:179], v200 offset:12288
    v_cvt_pk_bf16_f32 v129, v66, v67
    v_mfma_f32_16x16x32_bf16 v[108:111], a[136:139], v[56:59], v[108:111]
    v_exp_f32 v81, v81
    v_mfma_f32_16x16x32_bf16 v[108:111], a[140:143], v[60:63], v[108:111]
    ds_read_b64_tr_b16 a[180:181], v201 offset:8192
    v_mfma_f32_16x16x32_bf16 v[112:115], a[144:147], v[0:3], v[160:163]
    ds_read_b64_tr_b16 a[182:183], v201 offset:12288
    v_mfma_f32_16x16x32_bf16 v[112:115], a[148:151], v[4:7], v[112:115]
    v_exp_f32 v82, v82
    v_mfma_f32_16x16x32_bf16 v[112:115], a[152:155], v[8:11], v[112:115]
    ds_read_b64_tr_b16 a[184:185], v202 offset:8192
    v_cvt_pk_bf16_f32 v130, v80, v81
    v_mfma_f32_16x16x32_bf16 v[112:115], a[156:159], v[12:15], v[112:115]
    ds_read_b64_tr_b16 a[186:187], v202 offset:12288
    v_mfma_f32_16x16x32_bf16 v[116:119], a[144:147], v[16:19], v[164:167]
    v_exp_f32 v83, v83
    v_mfma_f32_16x16x32_bf16 v[116:119], a[148:151], v[20:23], v[116:119]
    ds_read_b64_tr_b16 a[188:189], v203 offset:8192
    v_mfma_f32_16x16x32_bf16 v[116:119], a[152:155], v[24:27], v[116:119]
    ds_read_b64_tr_b16 a[190:191], v203 offset:12288
    v_exp_f32 v68, v68
    v_mfma_f32_16x16x32_bf16 v[116:119], a[156:159], v[28:31], v[116:119]
    v_cvt_pk_bf16_f32 v131, v82, v83
    v_mfma_f32_16x16x32_bf16 v[120:123], a[144:147], v[32:35], v[168:171]
    v_exp_f32 v69, v69
    v_mfma_f32_16x16x32_bf16 v[120:123], a[148:151], v[36:39], v[120:123]
    v_mfma_f32_16x16x32_bf16 v[120:123], a[152:155], v[40:43], v[120:123]
    v_exp_f32 v70, v70
    v_mfma_f32_16x16x32_bf16 v[120:123], a[156:159], v[44:47], v[120:123]
    v_cvt_pk_bf16_f32 v132, v68, v69
    v_exp_f32 v71, v71
    v_mfma_f32_16x16x32_bf16 v[124:127], a[144:147], v[48:51], v[172:175]
    v_mfma_f32_16x16x32_bf16 v[124:127], a[148:151], v[52:55], v[124:127]
    v_exp_f32 v84, v84
    v_mfma_f32_16x16x32_bf16 v[124:127], a[152:155], v[56:59], v[124:127]
    v_cvt_pk_bf16_f32 v133, v70, v71
    v_mfma_f32_16x16x32_bf16 v[124:127], a[156:159], v[60:63], v[124:127]
    s_waitcnt vmcnt(16) lgkmcnt(0)
    s_barrier
    v_mfma_f32_16x16x32_bf16 a[0:3], a[160:163], v[144:147], a[0:3]
    ds_read_b128 a[128:131], v192 offset:32768
    v_mfma_f32_16x16x32_bf16 a[4:7], a[160:163], v[148:151], a[4:7]
    v_exp_f32 v85, v85
    v_mfma_f32_16x16x32_bf16 a[8:11], a[160:163], v[152:155], a[8:11]
    ds_read_b128 a[132:135], v193 offset:32768
    v_exp_f32 v86, v86
    v_mfma_f32_16x16x32_bf16 a[12:15], a[160:163], v[156:159], a[12:15]
    v_cvt_pk_bf16_f32 v134, v84, v85
    v_mfma_f32_16x16x32_bf16 a[16:19], a[164:167], v[144:147], a[16:19]
    ds_read_b128 a[136:139], v194 offset:32768
    v_mfma_f32_16x16x32_bf16 a[20:23], a[164:167], v[148:151], a[20:23]
    v_exp_f32 v87, v87
    v_mfma_f32_16x16x32_bf16 a[24:27], a[164:167], v[152:155], a[24:27]
    ds_read_b128 a[140:143], v195 offset:32768
    v_mfma_f32_16x16x32_bf16 a[28:31], a[164:167], v[156:159], a[28:31]
    v_exp_f32 v72, v72
    v_mfma_f32_16x16x32_bf16 v[176:179], a[252:255], v[144:147], v[176:179]
    ds_read_b128 a[144:147], v192 offset:36864
    v_cvt_pk_bf16_f32 v135, v86, v87
    v_mfma_f32_16x16x32_bf16 a[32:35], a[168:171], v[144:147], a[32:35]
    v_exp_f32 v73, v73
    v_mfma_f32_16x16x32_bf16 a[36:39], a[168:171], v[148:151], a[36:39]
    ds_read_b128 a[148:151], v193 offset:36864
    v_mfma_f32_16x16x32_bf16 a[40:43], a[168:171], v[152:155], a[40:43]
    v_exp_f32 v74, v74
    v_mfma_f32_16x16x32_bf16 a[44:47], a[168:171], v[156:159], a[44:47]
    ds_read_b128 a[152:155], v194 offset:36864
    v_mfma_f32_16x16x32_bf16 a[48:51], a[172:175], v[144:147], a[48:51]
    v_cvt_pk_bf16_f32 v136, v72, v73
    v_mfma_f32_16x16x32_bf16 a[52:55], a[172:175], v[148:151], a[52:55]
    ds_read_b128 a[156:159], v195 offset:36864
    v_mfma_f32_16x16x32_bf16 a[56:59], a[172:175], v[152:155], a[56:59]
    v_exp_f32 v75, v75
    v_mfma_f32_16x16x32_bf16 a[60:63], a[172:175], v[156:159], a[60:63]
    v_exp_f32 v88, v88
    v_mfma_f32_16x16x32_bf16 v[180:183], a[252:255], v[148:151], v[180:183]
    v_cvt_pk_bf16_f32 v137, v74, v75
    v_mfma_f32_16x16x32_bf16 a[64:67], a[176:179], v[144:147], a[64:67]
    v_exp_f32 v89, v89
    v_mfma_f32_16x16x32_bf16 a[68:71], a[176:179], v[148:151], a[68:71]
    v_exp_f32 v90, v90
    v_mfma_f32_16x16x32_bf16 a[72:75], a[176:179], v[152:155], a[72:75]
    v_cvt_pk_bf16_f32 v138, v88, v89
    v_mfma_f32_16x16x32_bf16 a[76:79], a[176:179], v[156:159], a[76:79]
    v_exp_f32 v91, v91
    v_mfma_f32_16x16x32_bf16 a[80:83], a[180:183], v[144:147], a[80:83]
    v_exp_f32 v76, v76
    v_mfma_f32_16x16x32_bf16 a[84:87], a[180:183], v[148:151], a[84:87]
    v_cvt_pk_bf16_f32 v139, v90, v91
    v_mfma_f32_16x16x32_bf16 a[88:91], a[180:183], v[152:155], a[88:91]
    v_exp_f32 v77, v77
    v_mfma_f32_16x16x32_bf16 a[92:95], a[180:183], v[156:159], a[92:95]
    v_exp_f32 v78, v78
    v_mfma_f32_16x16x32_bf16 v[184:187], a[252:255], v[152:155], v[184:187]
    v_cvt_pk_bf16_f32 v140, v76, v77
    v_mfma_f32_16x16x32_bf16 a[96:99], a[184:187], v[144:147], a[96:99]
    v_exp_f32 v79, v79
    v_mfma_f32_16x16x32_bf16 a[100:103], a[184:187], v[148:151], a[100:103]
    v_mfma_f32_16x16x32_bf16 a[104:107], a[184:187], v[152:155], a[104:107]
    v_exp_f32 v92, v92
    v_cvt_pk_bf16_f32 v141, v78, v79
    v_mfma_f32_16x16x32_bf16 a[108:111], a[184:187], v[156:159], a[108:111]
    v_exp_f32 v93, v93
    v_mfma_f32_16x16x32_bf16 a[112:115], a[188:191], v[144:147], a[112:115]
    v_mfma_f32_16x16x32_bf16 a[116:119], a[188:191], v[148:151], a[116:119]
    v_exp_f32 v94, v94
    v_mfma_f32_16x16x32_bf16 a[120:123], a[188:191], v[152:155], a[120:123]
    v_cvt_pk_bf16_f32 v142, v92, v93
    v_mfma_f32_16x16x32_bf16 a[124:127], a[188:191], v[156:159], a[124:127]
    v_exp_f32 v95, v95
    v_mfma_f32_16x16x32_bf16 v[188:191], a[252:255], v[156:159], v[188:191]
    s_nop 0
    v_cvt_pk_bf16_f32 v143, v94, v95
    s_waitcnt lgkmcnt(0)
    v_mfma_f32_16x16x32_bf16 v[64:67], a[128:131], v[0:3], v[160:163]
    ds_read_b64_tr_b16 a[160:161], v196 offset:16384
    v_mfma_f32_16x16x32_bf16 v[64:67], a[132:135], v[4:7], v[64:67]
    ds_read_b64_tr_b16 a[162:163], v196 offset:20480
    v_exp_f32 v96, v96
    v_mfma_f32_16x16x32_bf16 v[64:67], a[136:139], v[8:11], v[64:67]
    v_mfma_f32_16x16x32_bf16 v[64:67], a[140:143], v[12:15], v[64:67]
    ds_read_b64_tr_b16 a[164:165], v197 offset:16384
    v_exp_f32 v97, v97
    v_mfma_f32_16x16x32_bf16 v[68:71], a[128:131], v[16:19], v[164:167]
    ds_read_b64_tr_b16 a[166:167], v197 offset:20480
    v_mfma_f32_16x16x32_bf16 v[68:71], a[132:135], v[20:23], v[68:71]
    v_exp_f32 v98, v98
    v_mfma_f32_16x16x32_bf16 v[68:71], a[136:139], v[24:27], v[68:71]
    ds_read_b64_tr_b16 a[168:169], v198 offset:16384
    v_mfma_f32_16x16x32_bf16 v[68:71], a[140:143], v[28:31], v[68:71]
    ds_read_b64_tr_b16 a[170:171], v198 offset:20480
    v_mfma_f32_16x16x32_bf16 v[72:75], a[128:131], v[32:35], v[168:171]
    v_cvt_pk_bf16_f32 v144, v96, v97
    v_exp_f32 v99, v99
    v_mfma_f32_16x16x32_bf16 v[72:75], a[132:135], v[36:39], v[72:75]
    ds_read_b64_tr_b16 a[172:173], v199 offset:16384
    v_mfma_f32_16x16x32_bf16 v[72:75], a[136:139], v[40:43], v[72:75]
    ds_read_b64_tr_b16 a[174:175], v199 offset:20480
    v_mfma_f32_16x16x32_bf16 v[72:75], a[140:143], v[44:47], v[72:75]
    v_exp_f32 v112, v112
    v_mfma_f32_16x16x32_bf16 v[76:79], a[128:131], v[48:51], v[172:175]
    ds_read_b64_tr_b16 a[176:177], v200 offset:16384
    v_mfma_f32_16x16x32_bf16 v[76:79], a[132:135], v[52:55], v[76:79]
    ds_read_b64_tr_b16 a[178:179], v200 offset:20480
    v_cvt_pk_bf16_f32 v145, v98, v99
    v_mfma_f32_16x16x32_bf16 v[76:79], a[136:139], v[56:59], v[76:79]
    v_exp_f32 v113, v113
    v_mfma_f32_16x16x32_bf16 v[76:79], a[140:143], v[60:63], v[76:79]
    ds_read_b64_tr_b16 a[180:181], v201 offset:16384
    v_mfma_f32_16x16x32_bf16 v[80:83], a[144:147], v[0:3], v[160:163]
    ds_read_b64_tr_b16 a[182:183], v201 offset:20480
    v_mfma_f32_16x16x32_bf16 v[80:83], a[148:151], v[4:7], v[80:83]
    v_exp_f32 v114, v114
    v_mfma_f32_16x16x32_bf16 v[80:83], a[152:155], v[8:11], v[80:83]
    ds_read_b64_tr_b16 a[184:185], v202 offset:16384
    v_cvt_pk_bf16_f32 v146, v112, v113
    v_mfma_f32_16x16x32_bf16 v[80:83], a[156:159], v[12:15], v[80:83]
    ds_read_b64_tr_b16 a[186:187], v202 offset:20480
    v_mfma_f32_16x16x32_bf16 v[84:87], a[144:147], v[16:19], v[164:167]
    v_exp_f32 v115, v115
    v_mfma_f32_16x16x32_bf16 v[84:87], a[148:151], v[20:23], v[84:87]
    ds_read_b64_tr_b16 a[188:189], v203 offset:16384
    v_mfma_f32_16x16x32_bf16 v[84:87], a[152:155], v[24:27], v[84:87]
    ds_read_b64_tr_b16 a[190:191], v203 offset:20480
    v_mfma_f32_16x16x32_bf16 v[84:87], a[156:159], v[28:31], v[84:87]
    v_exp_f32 v100, v100
    v_mfma_f32_16x16x32_bf16 v[88:91], a[144:147], v[32:35], v[168:171]
    v_cvt_pk_bf16_f32 v147, v114, v115
    v_mfma_f32_16x16x32_bf16 v[88:91], a[148:151], v[36:39], v[88:91]
    v_exp_f32 v101, v101
    v_mfma_f32_16x16x32_bf16 v[88:91], a[152:155], v[40:43], v[88:91]
    v_exp_f32 v102, v102
    v_mfma_f32_16x16x32_bf16 v[88:91], a[156:159], v[44:47], v[88:91]
    v_cvt_pk_bf16_f32 v148, v100, v101
    v_mfma_f32_16x16x32_bf16 v[92:95], a[144:147], v[48:51], v[172:175]
    v_exp_f32 v103, v103
    v_mfma_f32_16x16x32_bf16 v[92:95], a[148:151], v[52:55], v[92:95]
    v_exp_f32 v116, v116
    v_mfma_f32_16x16x32_bf16 v[92:95], a[152:155], v[56:59], v[92:95]
    v_cvt_pk_bf16_f32 v149, v102, v103
    v_mfma_f32_16x16x32_bf16 v[92:95], a[156:159], v[60:63], v[92:95]
    s_waitcnt lgkmcnt(0)
    v_mfma_f32_16x16x32_bf16 a[0:3], a[160:163], v[128:131], a[0:3]
    ds_read_b128 a[128:131], v192 offset:40960
    v_exp_f32 v117, v117
    v_mfma_f32_16x16x32_bf16 a[4:7], a[160:163], v[132:135], a[4:7]
    v_exp_f32 v118, v118
    v_mfma_f32_16x16x32_bf16 a[8:11], a[160:163], v[136:139], a[8:11]
    ds_read_b128 a[132:135], v193 offset:40960
    v_mfma_f32_16x16x32_bf16 a[12:15], a[160:163], v[140:143], a[12:15]
    v_cvt_pk_bf16_f32 v150, v116, v117
    v_mfma_f32_16x16x32_bf16 a[16:19], a[164:167], v[128:131], a[16:19]
    ds_read_b128 a[136:139], v194 offset:40960
    v_mfma_f32_16x16x32_bf16 a[20:23], a[164:167], v[132:135], a[20:23]
    v_exp_f32 v119, v119
    v_mfma_f32_16x16x32_bf16 a[24:27], a[164:167], v[136:139], a[24:27]
    ds_read_b128 a[140:143], v195 offset:40960
    v_mfma_f32_16x16x32_bf16 a[28:31], a[164:167], v[140:143], a[28:31]
    v_exp_f32 v104, v104
    v_mfma_f32_16x16x32_bf16 v[176:179], a[252:255], v[128:131], v[176:179]
    ds_read_b128 a[144:147], v192 offset:45056
    v_cvt_pk_bf16_f32 v151, v118, v119
    v_mfma_f32_16x16x32_bf16 a[32:35], a[168:171], v[128:131], a[32:35]
    v_exp_f32 v105, v105
    v_mfma_f32_16x16x32_bf16 a[36:39], a[168:171], v[132:135], a[36:39]
    ds_read_b128 a[148:151], v193 offset:45056
    v_mfma_f32_16x16x32_bf16 a[40:43], a[168:171], v[136:139], a[40:43]
    v_exp_f32 v106, v106
    v_mfma_f32_16x16x32_bf16 a[44:47], a[168:171], v[140:143], a[44:47]
    ds_read_b128 a[152:155], v194 offset:45056
    v_mfma_f32_16x16x32_bf16 a[48:51], a[172:175], v[128:131], a[48:51]
    v_cvt_pk_bf16_f32 v152, v104, v105
    v_mfma_f32_16x16x32_bf16 a[52:55], a[172:175], v[132:135], a[52:55]
    ds_read_b128 a[156:159], v195 offset:45056
    v_exp_f32 v107, v107
    v_mfma_f32_16x16x32_bf16 a[56:59], a[172:175], v[136:139], a[56:59]
    v_mfma_f32_16x16x32_bf16 a[60:63], a[172:175], v[140:143], a[60:63]
    v_exp_f32 v120, v120
    v_mfma_f32_16x16x32_bf16 v[180:183], a[252:255], v[132:135], v[180:183]
    v_cvt_pk_bf16_f32 v153, v106, v107
    v_mfma_f32_16x16x32_bf16 a[64:67], a[176:179], v[128:131], a[64:67]
    v_exp_f32 v121, v121
    v_mfma_f32_16x16x32_bf16 a[68:71], a[176:179], v[132:135], a[68:71]
    v_exp_f32 v122, v122
    v_mfma_f32_16x16x32_bf16 a[72:75], a[176:179], v[136:139], a[72:75]
    v_cvt_pk_bf16_f32 v154, v120, v121
    v_mfma_f32_16x16x32_bf16 a[76:79], a[176:179], v[140:143], a[76:79]
    v_exp_f32 v123, v123
    v_mfma_f32_16x16x32_bf16 a[80:83], a[180:183], v[128:131], a[80:83]
    v_exp_f32 v108, v108
    v_mfma_f32_16x16x32_bf16 a[84:87], a[180:183], v[132:135], a[84:87]
    v_cvt_pk_bf16_f32 v155, v122, v123
    v_mfma_f32_16x16x32_bf16 a[88:91], a[180:183], v[136:139], a[88:91]
    v_exp_f32 v109, v109
    v_mfma_f32_16x16x32_bf16 a[92:95], a[180:183], v[140:143], a[92:95]
    v_exp_f32 v110, v110
    v_mfma_f32_16x16x32_bf16 v[184:187], a[252:255], v[136:139], v[184:187]
    v_cvt_pk_bf16_f32 v156, v108, v109
    v_mfma_f32_16x16x32_bf16 a[96:99], a[184:187], v[128:131], a[96:99]
    v_exp_f32 v111, v111
    v_mfma_f32_16x16x32_bf16 a[100:103], a[184:187], v[132:135], a[100:103]
    v_exp_f32 v124, v124
    v_mfma_f32_16x16x32_bf16 a[104:107], a[184:187], v[136:139], a[104:107]
    v_cvt_pk_bf16_f32 v157, v110, v111
    v_mfma_f32_16x16x32_bf16 a[108:111], a[184:187], v[140:143], a[108:111]
    v_exp_f32 v125, v125
    v_mfma_f32_16x16x32_bf16 a[112:115], a[188:191], v[128:131], a[112:115]
    v_mfma_f32_16x16x32_bf16 a[116:119], a[188:191], v[132:135], a[116:119]
    v_exp_f32 v126, v126
    v_mfma_f32_16x16x32_bf16 a[120:123], a[188:191], v[136:139], a[120:123]
    v_cvt_pk_bf16_f32 v158, v124, v125
    v_mfma_f32_16x16x32_bf16 a[124:127], a[188:191], v[140:143], a[124:127]
    v_exp_f32 v127, v127
    v_mfma_f32_16x16x32_bf16 v[188:191], a[252:255], v[140:143], v[188:191]
    s_nop 0
    v_cvt_pk_bf16_f32 v159, v126, v127
    s_waitcnt lgkmcnt(0)
    v_mfma_f32_16x16x32_bf16 v[96:99], a[128:131], v[0:3], v[160:163]
    ds_read_b64_tr_b16 a[160:161], v196 offset:24576
    v_mfma_f32_16x16x32_bf16 v[96:99], a[132:135], v[4:7], v[96:99]
    ds_read_b64_tr_b16 a[162:163], v196 offset:28672
    v_exp_f32 v64, v64
    v_mfma_f32_16x16x32_bf16 v[96:99], a[136:139], v[8:11], v[96:99]
    v_mfma_f32_16x16x32_bf16 v[96:99], a[140:143], v[12:15], v[96:99]
    ds_read_b64_tr_b16 a[164:165], v197 offset:24576
    v_exp_f32 v65, v65
    v_mfma_f32_16x16x32_bf16 v[100:103], a[128:131], v[16:19], v[164:167]
    ds_read_b64_tr_b16 a[166:167], v197 offset:28672
    v_mfma_f32_16x16x32_bf16 v[100:103], a[132:135], v[20:23], v[100:103]
    v_exp_f32 v66, v66
    v_mfma_f32_16x16x32_bf16 v[100:103], a[136:139], v[24:27], v[100:103]
    ds_read_b64_tr_b16 a[168:169], v198 offset:24576
    v_mfma_f32_16x16x32_bf16 v[100:103], a[140:143], v[28:31], v[100:103]
    ds_read_b64_tr_b16 a[170:171], v198 offset:28672
    v_cvt_pk_bf16_f32 v128, v64, v65
    v_mfma_f32_16x16x32_bf16 v[104:107], a[128:131], v[32:35], v[168:171]
    v_exp_f32 v67, v67
    v_mfma_f32_16x16x32_bf16 v[104:107], a[132:135], v[36:39], v[104:107]
    ds_read_b64_tr_b16 a[172:173], v199 offset:24576
    v_mfma_f32_16x16x32_bf16 v[104:107], a[136:139], v[40:43], v[104:107]
    ds_read_b64_tr_b16 a[174:175], v199 offset:28672
    v_mfma_f32_16x16x32_bf16 v[104:107], a[140:143], v[44:47], v[104:107]
    v_exp_f32 v80, v80
    v_mfma_f32_16x16x32_bf16 v[108:111], a[128:131], v[48:51], v[172:175]
    ds_read_b64_tr_b16 a[176:177], v200 offset:24576
    v_mfma_f32_16x16x32_bf16 v[108:111], a[132:135], v[52:55], v[108:111]
    ds_read_b64_tr_b16 a[178:179], v200 offset:28672
    v_cvt_pk_bf16_f32 v129, v66, v67
    v_mfma_f32_16x16x32_bf16 v[108:111], a[136:139], v[56:59], v[108:111]
    v_exp_f32 v81, v81
    v_mfma_f32_16x16x32_bf16 v[108:111], a[140:143], v[60:63], v[108:111]
    ds_read_b64_tr_b16 a[180:181], v201 offset:24576
    v_mfma_f32_16x16x32_bf16 v[112:115], a[144:147], v[0:3], v[160:163]
    ds_read_b64_tr_b16 a[182:183], v201 offset:28672
    v_mfma_f32_16x16x32_bf16 v[112:115], a[148:151], v[4:7], v[112:115]
    v_exp_f32 v82, v82
    v_mfma_f32_16x16x32_bf16 v[112:115], a[152:155], v[8:11], v[112:115]
    ds_read_b64_tr_b16 a[184:185], v202 offset:24576
    v_cvt_pk_bf16_f32 v130, v80, v81
    v_mfma_f32_16x16x32_bf16 v[112:115], a[156:159], v[12:15], v[112:115]
    ds_read_b64_tr_b16 a[186:187], v202 offset:28672
    v_mfma_f32_16x16x32_bf16 v[116:119], a[144:147], v[16:19], v[164:167]
    v_exp_f32 v83, v83
    v_mfma_f32_16x16x32_bf16 v[116:119], a[148:151], v[20:23], v[116:119]
    ds_read_b64_tr_b16 a[188:189], v203 offset:24576
    v_mfma_f32_16x16x32_bf16 v[116:119], a[152:155], v[24:27], v[116:119]
    ds_read_b64_tr_b16 a[190:191], v203 offset:28672
    v_exp_f32 v68, v68
    v_mfma_f32_16x16x32_bf16 v[116:119], a[156:159], v[28:31], v[116:119]
    v_cvt_pk_bf16_f32 v131, v82, v83
    v_mfma_f32_16x16x32_bf16 v[120:123], a[144:147], v[32:35], v[168:171]
    v_exp_f32 v69, v69
    v_mfma_f32_16x16x32_bf16 v[120:123], a[148:151], v[36:39], v[120:123]
    v_mfma_f32_16x16x32_bf16 v[120:123], a[152:155], v[40:43], v[120:123]
    v_exp_f32 v70, v70
    v_mfma_f32_16x16x32_bf16 v[120:123], a[156:159], v[44:47], v[120:123]
    v_cvt_pk_bf16_f32 v132, v68, v69
    v_exp_f32 v71, v71
    v_mfma_f32_16x16x32_bf16 v[124:127], a[144:147], v[48:51], v[172:175]
    v_mfma_f32_16x16x32_bf16 v[124:127], a[148:151], v[52:55], v[124:127]
    v_exp_f32 v84, v84
    v_mfma_f32_16x16x32_bf16 v[124:127], a[152:155], v[56:59], v[124:127]
    v_cvt_pk_bf16_f32 v133, v70, v71
    v_mfma_f32_16x16x32_bf16 v[124:127], a[156:159], v[60:63], v[124:127]
    s_waitcnt vmcnt(8) lgkmcnt(0)
    s_barrier
    v_mfma_f32_16x16x32_bf16 a[0:3], a[160:163], v[144:147], a[0:3]
    ds_read_b128 a[128:131], v192 offset:49152
    v_mfma_f32_16x16x32_bf16 a[4:7], a[160:163], v[148:151], a[4:7]
    v_exp_f32 v85, v85
    v_mfma_f32_16x16x32_bf16 a[8:11], a[160:163], v[152:155], a[8:11]
    ds_read_b128 a[132:135], v193 offset:49152
    v_exp_f32 v86, v86
    v_mfma_f32_16x16x32_bf16 a[12:15], a[160:163], v[156:159], a[12:15]
    v_cvt_pk_bf16_f32 v134, v84, v85
    v_mfma_f32_16x16x32_bf16 a[16:19], a[164:167], v[144:147], a[16:19]
    ds_read_b128 a[136:139], v194 offset:49152
    v_mfma_f32_16x16x32_bf16 a[20:23], a[164:167], v[148:151], a[20:23]
    v_exp_f32 v87, v87
    v_mfma_f32_16x16x32_bf16 a[24:27], a[164:167], v[152:155], a[24:27]
    ds_read_b128 a[140:143], v195 offset:49152
    v_mfma_f32_16x16x32_bf16 a[28:31], a[164:167], v[156:159], a[28:31]
    v_exp_f32 v72, v72
    v_mfma_f32_16x16x32_bf16 v[176:179], a[252:255], v[144:147], v[176:179]
    ds_read_b128 a[144:147], v192 offset:53248
    v_cvt_pk_bf16_f32 v135, v86, v87
    v_mfma_f32_16x16x32_bf16 a[32:35], a[168:171], v[144:147], a[32:35]
    v_exp_f32 v73, v73
    v_mfma_f32_16x16x32_bf16 a[36:39], a[168:171], v[148:151], a[36:39]
    ds_read_b128 a[148:151], v193 offset:53248
    v_mfma_f32_16x16x32_bf16 a[40:43], a[168:171], v[152:155], a[40:43]
    v_exp_f32 v74, v74
    v_mfma_f32_16x16x32_bf16 a[44:47], a[168:171], v[156:159], a[44:47]
    ds_read_b128 a[152:155], v194 offset:53248
    v_mfma_f32_16x16x32_bf16 a[48:51], a[172:175], v[144:147], a[48:51]
    v_cvt_pk_bf16_f32 v136, v72, v73
    v_mfma_f32_16x16x32_bf16 a[52:55], a[172:175], v[148:151], a[52:55]
    ds_read_b128 a[156:159], v195 offset:53248
    v_mfma_f32_16x16x32_bf16 a[56:59], a[172:175], v[152:155], a[56:59]
    v_exp_f32 v75, v75
    v_mfma_f32_16x16x32_bf16 a[60:63], a[172:175], v[156:159], a[60:63]
    v_exp_f32 v88, v88
    v_mfma_f32_16x16x32_bf16 v[180:183], a[252:255], v[148:151], v[180:183]
    v_cvt_pk_bf16_f32 v137, v74, v75
    v_mfma_f32_16x16x32_bf16 a[64:67], a[176:179], v[144:147], a[64:67]
    v_exp_f32 v89, v89
    v_mfma_f32_16x16x32_bf16 a[68:71], a[176:179], v[148:151], a[68:71]
    v_exp_f32 v90, v90
    v_mfma_f32_16x16x32_bf16 a[72:75], a[176:179], v[152:155], a[72:75]
    v_cvt_pk_bf16_f32 v138, v88, v89
    v_mfma_f32_16x16x32_bf16 a[76:79], a[176:179], v[156:159], a[76:79]
    v_exp_f32 v91, v91
    v_mfma_f32_16x16x32_bf16 a[80:83], a[180:183], v[144:147], a[80:83]
    v_exp_f32 v76, v76
    v_mfma_f32_16x16x32_bf16 a[84:87], a[180:183], v[148:151], a[84:87]
    v_cvt_pk_bf16_f32 v139, v90, v91
    v_mfma_f32_16x16x32_bf16 a[88:91], a[180:183], v[152:155], a[88:91]
    v_exp_f32 v77, v77
    v_mfma_f32_16x16x32_bf16 a[92:95], a[180:183], v[156:159], a[92:95]
    v_exp_f32 v78, v78
    v_mfma_f32_16x16x32_bf16 v[184:187], a[252:255], v[152:155], v[184:187]
    v_cvt_pk_bf16_f32 v140, v76, v77
    v_mfma_f32_16x16x32_bf16 a[96:99], a[184:187], v[144:147], a[96:99]
    v_exp_f32 v79, v79
    v_mfma_f32_16x16x32_bf16 a[100:103], a[184:187], v[148:151], a[100:103]
    v_mfma_f32_16x16x32_bf16 a[104:107], a[184:187], v[152:155], a[104:107]
    v_exp_f32 v92, v92
    v_cvt_pk_bf16_f32 v141, v78, v79
    v_mfma_f32_16x16x32_bf16 a[108:111], a[184:187], v[156:159], a[108:111]
    v_exp_f32 v93, v93
    v_mfma_f32_16x16x32_bf16 a[112:115], a[188:191], v[144:147], a[112:115]
    v_mfma_f32_16x16x32_bf16 a[116:119], a[188:191], v[148:151], a[116:119]
    v_exp_f32 v94, v94
    v_mfma_f32_16x16x32_bf16 a[120:123], a[188:191], v[152:155], a[120:123]
    v_cvt_pk_bf16_f32 v142, v92, v93
    v_mfma_f32_16x16x32_bf16 a[124:127], a[188:191], v[156:159], a[124:127]
    v_exp_f32 v95, v95
    v_mfma_f32_16x16x32_bf16 v[188:191], a[252:255], v[156:159], v[188:191]
    s_nop 0
    v_cvt_pk_bf16_f32 v143, v94, v95
    s_lshr_b32 s59, s2, 5
    s_lshl_b32 s59, s59, 7
    s_add_u32 s59, s59, 5120
    s_cmp_lg_u32 s28, 0
    s_cbranch_scc1 L_arr_R
    s_add_u32 s56, s88, 0x60000
    s_addc_u32 s57, s89, 0
    v_mov_b32 v248, s59
    v_mov_b32 v249, 1
    s_mov_b64 exec, 1
    global_atomic_add v248, v249, s[56:57] sc1
    s_mov_b64 exec, -1
L_arr_R:
    s_waitcnt lgkmcnt(0)
    v_mfma_f32_16x16x32_bf16 v[64:67], a[128:131], v[0:3], v[160:163]
    ds_read_b64_tr_b16 a[160:161], v196 offset:32768
    v_mfma_f32_16x16x32_bf16 v[64:67], a[132:135], v[4:7], v[64:67]
    ds_read_b64_tr_b16 a[162:163], v196 offset:36864
    v_exp_f32 v96, v96
    v_mfma_f32_16x16x32_bf16 v[64:67], a[136:139], v[8:11], v[64:67]
    v_mfma_f32_16x16x32_bf16 v[64:67], a[140:143], v[12:15], v[64:67]
    ds_read_b64_tr_b16 a[164:165], v197 offset:32768
    v_exp_f32 v97, v97
    v_mfma_f32_16x16x32_bf16 v[68:71], a[128:131], v[16:19], v[164:167]
    ds_read_b64_tr_b16 a[166:167], v197 offset:36864
    v_mfma_f32_16x16x32_bf16 v[68:71], a[132:135], v[20:23], v[68:71]
    v_exp_f32 v98, v98
    v_mfma_f32_16x16x32_bf16 v[68:71], a[136:139], v[24:27], v[68:71]
    ds_read_b64_tr_b16 a[168:169], v198 offset:32768
    v_mfma_f32_16x16x32_bf16 v[68:71], a[140:143], v[28:31], v[68:71]
    ds_read_b64_tr_b16 a[170:171], v198 offset:36864
    v_mfma_f32_16x16x32_bf16 v[72:75], a[128:131], v[32:35], v[168:171]
    v_cvt_pk_bf16_f32 v144, v96, v97
    v_exp_f32 v99, v99
    v_mfma_f32_16x16x32_bf16 v[72:75], a[132:135], v[36:39], v[72:75]
    ds_read_b64_tr_b16 a[172:173], v199 offset:32768
    v_mfma_f32_16x16x32_bf16 v[72:75], a[136:139], v[40:43], v[72:75]
    ds_read_b64_tr_b16 a[174:175], v199 offset:36864
    v_mfma_f32_16x16x32_bf16 v[72:75], a[140:143], v[44:47], v[72:75]
    v_exp_f32 v112, v112
    v_mfma_f32_16x16x32_bf16 v[76:79], a[128:131], v[48:51], v[172:175]
    ds_read_b64_tr_b16 a[176:177], v200 offset:32768
    v_mfma_f32_16x16x32_bf16 v[76:79], a[132:135], v[52:55], v[76:79]
    ds_read_b64_tr_b16 a[178:179], v200 offset:36864
    v_cvt_pk_bf16_f32 v145, v98, v99
    v_mfma_f32_16x16x32_bf16 v[76:79], a[136:139], v[56:59], v[76:79]
    v_exp_f32 v113, v113
    v_mfma_f32_16x16x32_bf16 v[76:79], a[140:143], v[60:63], v[76:79]
    ds_read_b64_tr_b16 a[180:181], v201 offset:32768
    v_mfma_f32_16x16x32_bf16 v[80:83], a[144:147], v[0:3], v[160:163]
    ds_read_b64_tr_b16 a[182:183], v201 offset:36864
    v_mfma_f32_16x16x32_bf16 v[80:83], a[148:151], v[4:7], v[80:83]
    v_exp_f32 v114, v114
    v_mfma_f32_16x16x32_bf16 v[80:83], a[152:155], v[8:11], v[80:83]
    ds_read_b64_tr_b16 a[184:185], v202 offset:32768
    v_cvt_pk_bf16_f32 v146, v112, v113
    v_mfma_f32_16x16x32_bf16 v[80:83], a[156:159], v[12:15], v[80:83]
    ds_read_b64_tr_b16 a[186:187], v202 offset:36864
    v_mfma_f32_16x16x32_bf16 v[84:87], a[144:147], v[16:19], v[164:167]
    v_exp_f32 v115, v115
    v_mfma_f32_16x16x32_bf16 v[84:87], a[148:151], v[20:23], v[84:87]
    ds_read_b64_tr_b16 a[188:189], v203 offset:32768
    v_mfma_f32_16x16x32_bf16 v[84:87], a[152:155], v[24:27], v[84:87]
    ds_read_b64_tr_b16 a[190:191], v203 offset:36864
    v_mfma_f32_16x16x32_bf16 v[84:87], a[156:159], v[28:31], v[84:87]
    v_exp_f32 v100, v100
    v_mfma_f32_16x16x32_bf16 v[88:91], a[144:147], v[32:35], v[168:171]
    v_cvt_pk_bf16_f32 v147, v114, v115
    v_mfma_f32_16x16x32_bf16 v[88:91], a[148:151], v[36:39], v[88:91]
    v_exp_f32 v101, v101
    v_mfma_f32_16x16x32_bf16 v[88:91], a[152:155], v[40:43], v[88:91]
    v_exp_f32 v102, v102
    v_mfma_f32_16x16x32_bf16 v[88:91], a[156:159], v[44:47], v[88:91]
    v_cvt_pk_bf16_f32 v148, v100, v101
    v_mfma_f32_16x16x32_bf16 v[92:95], a[144:147], v[48:51], v[172:175]
    v_exp_f32 v103, v103
    v_mfma_f32_16x16x32_bf16 v[92:95], a[148:151], v[52:55], v[92:95]
    v_exp_f32 v116, v116
    v_mfma_f32_16x16x32_bf16 v[92:95], a[152:155], v[56:59], v[92:95]
    v_cvt_pk_bf16_f32 v149, v102, v103
    v_mfma_f32_16x16x32_bf16 v[92:95], a[156:159], v[60:63], v[92:95]
    s_waitcnt lgkmcnt(0)
    v_mfma_f32_16x16x32_bf16 a[0:3], a[160:163], v[128:131], a[0:3]
    ds_read_b128 a[128:131], v192 offset:57344
    v_exp_f32 v117, v117
    v_mfma_f32_16x16x32_bf16 a[4:7], a[160:163], v[132:135], a[4:7]
    v_exp_f32 v118, v118
    v_mfma_f32_16x16x32_bf16 a[8:11], a[160:163], v[136:139], a[8:11]
    ds_read_b128 a[132:135], v193 offset:57344
    v_mfma_f32_16x16x32_bf16 a[12:15], a[160:163], v[140:143], a[12:15]
    v_cvt_pk_bf16_f32 v150, v116, v117
    v_mfma_f32_16x16x32_bf16 a[16:19], a[164:167], v[128:131], a[16:19]
    ds_read_b128 a[136:139], v194 offset:57344
    v_mfma_f32_16x16x32_bf16 a[20:23], a[164:167], v[132:135], a[20:23]
    v_exp_f32 v119, v119
    v_mfma_f32_16x16x32_bf16 a[24:27], a[164:167], v[136:139], a[24:27]
    ds_read_b128 a[140:143], v195 offset:57344
    v_mfma_f32_16x16x32_bf16 a[28:31], a[164:167], v[140:143], a[28:31]
    v_exp_f32 v104, v104
    v_mfma_f32_16x16x32_bf16 v[176:179], a[252:255], v[128:131], v[176:179]
    ds_read_b128 a[144:147], v192 offset:61440
    v_cvt_pk_bf16_f32 v151, v118, v119
    v_mfma_f32_16x16x32_bf16 a[32:35], a[168:171], v[128:131], a[32:35]
    v_exp_f32 v105, v105
    v_mfma_f32_16x16x32_bf16 a[36:39], a[168:171], v[132:135], a[36:39]
    ds_read_b128 a[148:151], v193 offset:61440
    v_mfma_f32_16x16x32_bf16 a[40:43], a[168:171], v[136:139], a[40:43]
    v_exp_f32 v106, v106
    v_mfma_f32_16x16x32_bf16 a[44:47], a[168:171], v[140:143], a[44:47]
    ds_read_b128 a[152:155], v194 offset:61440
    v_mfma_f32_16x16x32_bf16 a[48:51], a[172:175], v[128:131], a[48:51]
    v_cvt_pk_bf16_f32 v152, v104, v105
    v_mfma_f32_16x16x32_bf16 a[52:55], a[172:175], v[132:135], a[52:55]
    ds_read_b128 a[156:159], v195 offset:61440
    v_exp_f32 v107, v107
    v_mfma_f32_16x16x32_bf16 a[56:59], a[172:175], v[136:139], a[56:59]
    v_mfma_f32_16x16x32_bf16 a[60:63], a[172:175], v[140:143], a[60:63]
    v_exp_f32 v120, v120
    v_mfma_f32_16x16x32_bf16 v[180:183], a[252:255], v[132:135], v[180:183]
    v_cvt_pk_bf16_f32 v153, v106, v107
    v_mfma_f32_16x16x32_bf16 a[64:67], a[176:179], v[128:131], a[64:67]
    v_exp_f32 v121, v121
    v_mfma_f32_16x16x32_bf16 a[68:71], a[176:179], v[132:135], a[68:71]
    v_exp_f32 v122, v122
    v_mfma_f32_16x16x32_bf16 a[72:75], a[176:179], v[136:139], a[72:75]
    v_cvt_pk_bf16_f32 v154, v120, v121
    v_mfma_f32_16x16x32_bf16 a[76:79], a[176:179], v[140:143], a[76:79]
    v_exp_f32 v123, v123
    v_mfma_f32_16x16x32_bf16 a[80:83], a[180:183], v[128:131], a[80:83]
    v_exp_f32 v108, v108
    v_mfma_f32_16x16x32_bf16 a[84:87], a[180:183], v[132:135], a[84:87]
    v_cvt_pk_bf16_f32 v155, v122, v123
    v_mfma_f32_16x16x32_bf16 a[88:91], a[180:183], v[136:139], a[88:91]
    v_exp_f32 v109, v109
    v_mfma_f32_16x16x32_bf16 a[92:95], a[180:183], v[140:143], a[92:95]
    v_exp_f32 v110, v110
    v_mfma_f32_16x16x32_bf16 v[184:187], a[252:255], v[136:139], v[184:187]
    v_cvt_pk_bf16_f32 v156, v108, v109
    v_mfma_f32_16x16x32_bf16 a[96:99], a[184:187], v[128:131], a[96:99]
    v_exp_f32 v111, v111
    v_mfma_f32_16x16x32_bf16 a[100:103], a[184:187], v[132:135], a[100:103]
    v_exp_f32 v124, v124
    v_mfma_f32_16x16x32_bf16 a[104:107], a[184:187], v[136:139], a[104:107]
    v_cvt_pk_bf16_f32 v157, v110, v111
    v_mfma_f32_16x16x32_bf16 a[108:111], a[184:187], v[140:143], a[108:111]
    v_exp_f32 v125, v125
    v_mfma_f32_16x16x32_bf16 a[112:115], a[188:191], v[128:131], a[112:115]
    v_mfma_f32_16x16x32_bf16 a[116:119], a[188:191], v[132:135], a[116:119]
    v_exp_f32 v126, v126
    v_mfma_f32_16x16x32_bf16 a[120:123], a[188:191], v[136:139], a[120:123]
    v_cvt_pk_bf16_f32 v158, v124, v125
    v_mfma_f32_16x16x32_bf16 a[124:127], a[188:191], v[140:143], a[124:127]
    v_exp_f32 v127, v127
    v_mfma_f32_16x16x32_bf16 v[188:191], a[252:255], v[140:143], v[188:191]
    s_nop 0
    v_cvt_pk_bf16_f32 v159, v126, v127
    s_waitcnt lgkmcnt(0)
    v_mfma_f32_16x16x32_bf16 v[96:99], a[128:131], v[0:3], v[160:163]
    ds_read_b64_tr_b16 a[160:161], v196 offset:40960
    v_mfma_f32_16x16x32_bf16 v[96:99], a[132:135], v[4:7], v[96:99]
    ds_read_b64_tr_b16 a[162:163], v196 offset:45056
    v_exp_f32 v64, v64
    v_mfma_f32_16x16x32_bf16 v[96:99], a[136:139], v[8:11], v[96:99]
    v_exp_f32 v65, v65
    v_mfma_f32_16x16x32_bf16 v[96:99], a[140:143], v[12:15], v[96:99]
    ds_read_b64_tr_b16 a[164:165], v197 offset:40960
    v_mfma_f32_16x16x32_bf16 v[100:103], a[128:131], v[16:19], v[164:167]
    ds_read_b64_tr_b16 a[166:167], v197 offset:45056
    v_mfma_f32_16x16x32_bf16 v[100:103], a[132:135], v[20:23], v[100:103]
    v_exp_f32 v66, v66
    v_mfma_f32_16x16x32_bf16 v[100:103], a[136:139], v[24:27], v[100:103]
    ds_read_b64_tr_b16 a[168:169], v198 offset:40960
    v_cvt_pk_bf16_f32 v128, v64, v65
    v_mfma_f32_16x16x32_bf16 v[100:103], a[140:143], v[28:31], v[100:103]
    ds_read_b64_tr_b16 a[170:171], v198 offset:45056
    v_mfma_f32_16x16x32_bf16 v[104:107], a[128:131], v[32:35], v[168:171]
    v_exp_f32 v67, v67
    v_mfma_f32_16x16x32_bf16 v[104:107], a[132:135], v[36:39], v[104:107]
    ds_read_b64_tr_b16 a[172:173], v199 offset:40960
    v_mfma_f32_16x16x32_bf16 v[104:107], a[136:139], v[40:43], v[104:107]
    ds_read_b64_tr_b16 a[174:175], v199 offset:45056
    v_exp_f32 v80, v80
    v_mfma_f32_16x16x32_bf16 v[104:107], a[140:143], v[44:47], v[104:107]
    v_cvt_pk_bf16_f32 v129, v66, v67
    v_mfma_f32_16x16x32_bf16 v[108:111], a[128:131], v[48:51], v[172:175]
    ds_read_b64_tr_b16 a[176:177], v200 offset:40960
    v_mfma_f32_16x16x32_bf16 v[108:111], a[132:135], v[52:55], v[108:111]
    ds_read_b64_tr_b16 a[178:179], v200 offset:45056
    v_exp_f32 v81, v81
    v_mfma_f32_16x16x32_bf16 v[108:111], a[136:139], v[56:59], v[108:111]
    v_exp_f32 v82, v82
    v_mfma_f32_16x16x32_bf16 v[108:111], a[140:143], v[60:63], v[108:111]
    ds_read_b64_tr_b16 a[180:181], v201 offset:40960
    v_mfma_f32_16x16x32_bf16 v[112:115], a[144:147], v[0:3], v[160:163]
    ds_read_b64_tr_b16 a[182:183], v201 offset:45056
    v_cvt_pk_bf16_f32 v130, v80, v81
    v_mfma_f32_16x16x32_bf16 v[112:115], a[148:151], v[4:7], v[112:115]
    v_exp_f32 v83, v83
    v_mfma_f32_16x16x32_bf16 v[112:115], a[152:155], v[8:11], v[112:115]
    ds_read_b64_tr_b16 a[184:185], v202 offset:40960
    v_mfma_f32_16x16x32_bf16 v[112:115], a[156:159], v[12:15], v[112:115]
    ds_read_b64_tr_b16 a[186:187], v202 offset:45056
    v_mfma_f32_16x16x32_bf16 v[116:119], a[144:147], v[16:19], v[164:167]
    v_exp_f32 v68, v68
    v_cvt_pk_bf16_f32 v131, v82, v83
    v_mfma_f32_16x16x32_bf16 v[116:119], a[148:151], v[20:23], v[116:119]
    ds_read_b64_tr_b16 a[188:189], v203 offset:40960
    v_mfma_f32_16x16x32_bf16 v[116:119], a[152:155], v[24:27], v[116:119]
    ds_read_b64_tr_b16 a[190:191], v203 offset:45056
    v_mfma_f32_16x16x32_bf16 v[116:119], a[156:159], v[28:31], v[116:119]
    v_exp_f32 v69, v69
    v_mfma_f32_16x16x32_bf16 v[120:123], a[144:147], v[32:35], v[168:171]
    v_exp_f32 v70, v70
    v_mfma_f32_16x16x32_bf16 v[120:123], a[148:151], v[36:39], v[120:123]
    v_cvt_pk_bf16_f32 v132, v68, v69
    v_mfma_f32_16x16x32_bf16 v[120:123], a[152:155], v[40:43], v[120:123]
    v_exp_f32 v71, v71
    v_mfma_f32_16x16x32_bf16 v[120:123], a[156:159], v[44:47], v[120:123]
    v_exp_f32 v84, v84
    v_mfma_f32_16x16x32_bf16 v[124:127], a[144:147], v[48:51], v[172:175]
    v_cvt_pk_bf16_f32 v133, v70, v71
    v_exp_f32 v85, v85
    v_mfma_f32_16x16x32_bf16 v[124:127], a[148:151], v[52:55], v[124:127]
    v_mfma_f32_16x16x32_bf16 v[124:127], a[152:155], v[56:59], v[124:127]
    v_exp_f32 v86, v86
    v_mfma_f32_16x16x32_bf16 v[124:127], a[156:159], v[60:63], v[124:127]
    s_waitcnt vmcnt(0) lgkmcnt(0)
    s_barrier
    v_mfma_f32_16x16x32_bf16 a[0:3], a[160:163], v[144:147], a[0:3]
    v_cvt_pk_bf16_f32 v134, v84, v85
    v_mfma_f32_16x16x32_bf16 a[4:7], a[160:163], v[148:151], a[4:7]
    ds_read_b64_tr_b16 a[128:129], v196 offset:49152
    v_exp_f32 v87, v87
    v_mfma_f32_16x16x32_bf16 a[8:11], a[160:163], v[152:155], a[8:11]
    v_exp_f32 v72, v72
    v_mfma_f32_16x16x32_bf16 a[12:15], a[160:163], v[156:159], a[12:15]
    ds_read_b64_tr_b16 a[130:131], v196 offset:53248
    v_mfma_f32_16x16x32_bf16 a[16:19], a[164:167], v[144:147], a[16:19]
    v_cvt_pk_bf16_f32 v135, v86, v87
    v_mfma_f32_16x16x32_bf16 a[20:23], a[164:167], v[148:151], a[20:23]
    ds_read_b64_tr_b16 a[132:133], v197 offset:49152
    v_exp_f32 v73, v73
    v_mfma_f32_16x16x32_bf16 a[24:27], a[164:167], v[152:155], a[24:27]
    v_mfma_f32_16x16x32_bf16 a[28:31], a[164:167], v[156:159], a[28:31]
    ds_read_b64_tr_b16 a[134:135], v197 offset:53248
    v_exp_f32 v74, v74
    v_mfma_f32_16x16x32_bf16 v[176:179], a[252:255], v[144:147], v[176:179]
    v_cvt_pk_bf16_f32 v136, v72, v73
    v_mfma_f32_16x16x32_bf16 a[32:35], a[168:171], v[144:147], a[32:35]
    ds_read_b64_tr_b16 a[136:137], v198 offset:49152
    v_exp_f32 v75, v75
    v_mfma_f32_16x16x32_bf16 a[36:39], a[168:171], v[148:151], a[36:39]
    v_mfma_f32_16x16x32_bf16 a[40:43], a[168:171], v[152:155], a[40:43]
    ds_read_b64_tr_b16 a[138:139], v198 offset:53248
    v_exp_f32 v88, v88
    v_mfma_f32_16x16x32_bf16 a[44:47], a[168:171], v[156:159], a[44:47]
    v_cvt_pk_bf16_f32 v137, v74, v75
    v_mfma_f32_16x16x32_bf16 a[48:51], a[172:175], v[144:147], a[48:51]
    ds_read_b64_tr_b16 a[140:141], v199 offset:49152
    v_mfma_f32_16x16x32_bf16 a[52:55], a[172:175], v[148:151], a[52:55]
    v_exp_f32 v89, v89
    v_mfma_f32_16x16x32_bf16 a[56:59], a[172:175], v[152:155], a[56:59]
    ds_read_b64_tr_b16 a[142:143], v199 offset:53248
    v_exp_f32 v90, v90
    v_mfma_f32_16x16x32_bf16 a[60:63], a[172:175], v[156:159], a[60:63]
    v_cvt_pk_bf16_f32 v138, v88, v89
    v_mfma_f32_16x16x32_bf16 v[180:183], a[252:255], v[148:151], v[180:183]
    ds_read_b64_tr_b16 a[144:145], v200 offset:49152
    v_mfma_f32_16x16x32_bf16 a[64:67], a[176:179], v[144:147], a[64:67]
    v_exp_f32 v91, v91
    v_mfma_f32_16x16x32_bf16 a[68:71], a[176:179], v[148:151], a[68:71]
    ds_read_b64_tr_b16 a[146:147], v200 offset:53248
    v_mfma_f32_16x16x32_bf16 a[72:75], a[176:179], v[152:155], a[72:75]
    v_exp_f32 v76, v76
    v_cvt_pk_bf16_f32 v139, v90, v91
    v_mfma_f32_16x16x32_bf16 a[76:79], a[176:179], v[156:159], a[76:79]
    ds_read_b64_tr_b16 a[148:149], v201 offset:49152
    v_mfma_f32_16x16x32_bf16 a[80:83], a[180:183], v[144:147], a[80:83]
    v_exp_f32 v77, v77
    v_mfma_f32_16x16x32_bf16 a[84:87], a[180:183], v[148:151], a[84:87]
    ds_read_b64_tr_b16 a[150:151], v201 offset:53248
    v_mfma_f32_16x16x32_bf16 a[88:91], a[180:183], v[152:155], a[88:91]
    v_exp_f32 v78, v78
    v_mfma_f32_16x16x32_bf16 a[92:95], a[180:183], v[156:159], a[92:95]
    ds_read_b64_tr_b16 a[152:153], v202 offset:49152
    v_cvt_pk_bf16_f32 v140, v76, v77
    v_mfma_f32_16x16x32_bf16 v[184:187], a[252:255], v[152:155], v[184:187]
    v_exp_f32 v79, v79
    v_mfma_f32_16x16x32_bf16 a[96:99], a[184:187], v[144:147], a[96:99]
    ds_read_b64_tr_b16 a[154:155], v202 offset:53248
    v_mfma_f32_16x16x32_bf16 a[100:103], a[184:187], v[148:151], a[100:103]
    v_exp_f32 v92, v92
    v_mfma_f32_16x16x32_bf16 a[104:107], a[184:187], v[152:155], a[104:107]
    ds_read_b64_tr_b16 a[156:157], v203 offset:49152
    v_cvt_pk_bf16_f32 v141, v78, v79
    v_mfma_f32_16x16x32_bf16 a[108:111], a[184:187], v[156:159], a[108:111]
    v_exp_f32 v93, v93
    v_mfma_f32_16x16x32_bf16 a[112:115], a[188:191], v[144:147], a[112:115]
    ds_read_b64_tr_b16 a[158:159], v203 offset:53248
    v_mfma_f32_16x16x32_bf16 a[116:119], a[188:191], v[148:151], a[116:119]
    v_exp_f32 v94, v94
    v_mfma_f32_16x16x32_bf16 a[120:123], a[188:191], v[152:155], a[120:123]
    v_cvt_pk_bf16_f32 v142, v92, v93
    v_mfma_f32_16x16x32_bf16 a[124:127], a[188:191], v[156:159], a[124:127]
    v_exp_f32 v95, v95
    v_mfma_f32_16x16x32_bf16 v[188:191], a[252:255], v[156:159], v[188:191]
    s_nop 0
    v_cvt_pk_bf16_f32 v143, v94, v95
    s_waitcnt lgkmcnt(0)
    v_mfma_f32_16x16x32_bf16 a[0:3], a[128:131], v[128:131], a[0:3]
    v_exp_f32 v96, v96
    v_mfma_f32_16x16x32_bf16 a[4:7], a[128:131], v[132:135], a[4:7]
    ds_read_b64_tr_b16 a[160:161], v196 offset:57344
    v_exp_f32 v97, v97
    v_mfma_f32_16x16x32_bf16 a[8:11], a[128:131], v[136:139], a[8:11]
    v_exp_f32 v98, v98
    v_cvt_pk_bf16_f32 v144, v96, v97
    v_mfma_f32_16x16x32_bf16 a[12:15], a[128:131], v[140:143], a[12:15]
    ds_read_b64_tr_b16 a[162:163], v196 offset:61440
    v_exp_f32 v99, v99
    v_mfma_f32_16x16x32_bf16 a[16:19], a[132:135], v[128:131], a[16:19]
    v_exp_f32 v112, v112
    v_mfma_f32_16x16x32_bf16 a[20:23], a[132:135], v[132:135], a[20:23]
    ds_read_b64_tr_b16 a[164:165], v197 offset:57344
    v_cvt_pk_bf16_f32 v145, v98, v99
    v_exp_f32 v113, v113
    v_mfma_f32_16x16x32_bf16 a[24:27], a[132:135], v[136:139], a[24:27]
    v_exp_f32 v114, v114
    v_mfma_f32_16x16x32_bf16 a[28:31], a[132:135], v[140:143], a[28:31]
    ds_read_b64_tr_b16 a[166:167], v197 offset:61440
    v_cvt_pk_bf16_f32 v146, v112, v113
    v_mfma_f32_16x16x32_bf16 v[176:179], a[252:255], v[128:131], v[176:179]
    v_exp_f32 v115, v115
    v_exp_f32 v100, v100
    v_mfma_f32_16x16x32_bf16 a[32:35], a[136:139], v[128:131], a[32:35]
    ds_read_b64_tr_b16 a[168:169], v198 offset:57344
    v_cvt_pk_bf16_f32 v147, v114, v115
    v_mfma_f32_16x16x32_bf16 a[36:39], a[136:139], v[132:135], a[36:39]
    v_exp_f32 v101, v101
    v_mfma_f32_16x16x32_bf16 a[40:43], a[136:139], v[136:139], a[40:43]
    ds_read_b64_tr_b16 a[170:171], v198 offset:61440
    v_exp_f32 v102, v102
    v_mfma_f32_16x16x32_bf16 a[44:47], a[136:139], v[140:143], a[44:47]
    v_cvt_pk_bf16_f32 v148, v100, v101
    v_exp_f32 v103, v103
    v_mfma_f32_16x16x32_bf16 a[48:51], a[140:143], v[128:131], a[48:51]
    ds_read_b64_tr_b16 a[172:173], v199 offset:57344
    v_exp_f32 v116, v116
    v_mfma_f32_16x16x32_bf16 a[52:55], a[140:143], v[132:135], a[52:55]
    v_cvt_pk_bf16_f32 v149, v102, v103
    v_exp_f32 v117, v117
    v_mfma_f32_16x16x32_bf16 a[56:59], a[140:143], v[136:139], a[56:59]
    ds_read_b64_tr_b16 a[174:175], v199 offset:61440
    v_exp_f32 v118, v118
    v_mfma_f32_16x16x32_bf16 a[60:63], a[140:143], v[140:143], a[60:63]
    v_cvt_pk_bf16_f32 v150, v116, v117
    v_mfma_f32_16x16x32_bf16 v[180:183], a[252:255], v[132:135], v[180:183]
    ds_read_b64_tr_b16 a[176:177], v200 offset:57344
    v_exp_f32 v119, v119
    v_mfma_f32_16x16x32_bf16 a[64:67], a[144:147], v[128:131], a[64:67]
    v_exp_f32 v104, v104
    v_cvt_pk_bf16_f32 v151, v118, v119
    v_mfma_f32_16x16x32_bf16 a[68:71], a[144:147], v[132:135], a[68:71]
    ds_read_b64_tr_b16 a[178:179], v200 offset:61440
    v_exp_f32 v105, v105
    v_mfma_f32_16x16x32_bf16 a[72:75], a[144:147], v[136:139], a[72:75]
    v_exp_f32 v106, v106
    v_cvt_pk_bf16_f32 v152, v104, v105
    v_mfma_f32_16x16x32_bf16 a[76:79], a[144:147], v[140:143], a[76:79]
    ds_read_b64_tr_b16 a[180:181], v201 offset:57344
    v_exp_f32 v107, v107
    v_mfma_f32_16x16x32_bf16 a[80:83], a[148:151], v[128:131], a[80:83]
    v_exp_f32 v120, v120
    v_mfma_f32_16x16x32_bf16 a[84:87], a[148:151], v[132:135], a[84:87]
    ds_read_b64_tr_b16 a[182:183], v201 offset:61440
    v_cvt_pk_bf16_f32 v153, v106, v107
    v_mfma_f32_16x16x32_bf16 a[88:91], a[148:151], v[136:139], a[88:91]
    v_exp_f32 v121, v121
    v_exp_f32 v122, v122
    v_mfma_f32_16x16x32_bf16 a[92:95], a[148:151], v[140:143], a[92:95]
    ds_read_b64_tr_b16 a[184:185], v202 offset:57344
    v_cvt_pk_bf16_f32 v154, v120, v121
    v_mfma_f32_16x16x32_bf16 v[184:187], a[252:255], v[136:139], v[184:187]
    v_exp_f32 v123, v123
    v_mfma_f32_16x16x32_bf16 a[96:99], a[152:155], v[128:131], a[96:99]
    ds_read_b64_tr_b16 a[186:187], v202 offset:61440
    v_exp_f32 v108, v108
    v_mfma_f32_16x16x32_bf16 a[100:103], a[152:155], v[132:135], a[100:103]
    v_cvt_pk_bf16_f32 v155, v122, v123
    v_exp_f32 v109, v109
    v_mfma_f32_16x16x32_bf16 a[104:107], a[152:155], v[136:139], a[104:107]
    ds_read_b64_tr_b16 a[188:189], v203 offset:57344
    v_exp_f32 v110, v110
    v_mfma_f32_16x16x32_bf16 a[108:111], a[152:155], v[140:143], a[108:111]
    v_cvt_pk_bf16_f32 v156, v108, v109
    v_exp_f32 v111, v111
    v_mfma_f32_16x16x32_bf16 a[112:115], a[156:159], v[128:131], a[112:115]
    ds_read_b64_tr_b16 a[190:191], v203 offset:61440
    v_exp_f32 v124, v124
    v_mfma_f32_16x16x32_bf16 a[116:119], a[156:159], v[132:135], a[116:119]
    v_cvt_pk_bf16_f32 v157, v110, v111
    v_mfma_f32_16x16x32_bf16 a[120:123], a[156:159], v[136:139], a[120:123]
    v_exp_f32 v125, v125
    v_exp_f32 v126, v126
    v_mfma_f32_16x16x32_bf16 a[124:127], a[156:159], v[140:143], a[124:127]
    v_cvt_pk_bf16_f32 v158, v124, v125
    v_exp_f32 v127, v127
    v_mfma_f32_16x16x32_bf16 v[188:191], a[252:255], v[140:143], v[188:191]
    s_nop 0
    v_cvt_pk_bf16_f32 v159, v126, v127
    s_waitcnt lgkmcnt(0)
    v_mfma_f32_16x16x32_bf16 a[0:3], a[160:163], v[144:147], a[0:3]
    v_mfma_f32_16x16x32_bf16 a[4:7], a[160:163], v[148:151], a[4:7]
    v_mfma_f32_16x16x32_bf16 a[8:11], a[160:163], v[152:155], a[8:11]
    v_mfma_f32_16x16x32_bf16 a[12:15], a[160:163], v[156:159], a[12:15]
    v_mfma_f32_16x16x32_bf16 a[16:19], a[164:167], v[144:147], a[16:19]
    v_mfma_f32_16x16x32_bf16 a[20:23], a[164:167], v[148:151], a[20:23]
    v_mfma_f32_16x16x32_bf16 a[24:27], a[164:167], v[152:155], a[24:27]
    v_mfma_f32_16x16x32_bf16 a[28:31], a[164:167], v[156:159], a[28:31]
    v_mfma_f32_16x16x32_bf16 v[176:179], a[252:255], v[144:147], v[176:179]
    v_mfma_f32_16x16x32_bf16 a[32:35], a[168:171], v[144:147], a[32:35]
    v_mfma_f32_16x16x32_bf16 a[36:39], a[168:171], v[148:151], a[36:39]
    v_mfma_f32_16x16x32_bf16 a[40:43], a[168:171], v[152:155], a[40:43]
    v_mfma_f32_16x16x32_bf16 a[44:47], a[168:171], v[156:159], a[44:47]
    v_mfma_f32_16x16x32_bf16 a[48:51], a[172:175], v[144:147], a[48:51]
    v_mfma_f32_16x16x32_bf16 a[52:55], a[172:175], v[148:151], a[52:55]
    v_mfma_f32_16x16x32_bf16 a[56:59], a[172:175], v[152:155], a[56:59]
    v_mfma_f32_16x16x32_bf16 a[60:63], a[172:175], v[156:159], a[60:63]
    v_mfma_f32_16x16x32_bf16 v[180:183], a[252:255], v[148:151], v[180:183]
    v_mfma_f32_16x16x32_bf16 a[64:67], a[176:179], v[144:147], a[64:67]
    v_mfma_f32_16x16x32_bf16 a[68:71], a[176:179], v[148:151], a[68:71]
    v_mfma_f32_16x16x32_bf16 a[72:75], a[176:179], v[152:155], a[72:75]
    v_mfma_f32_16x16x32_bf16 a[76:79], a[176:179], v[156:159], a[76:79]
    v_mfma_f32_16x16x32_bf16 a[80:83], a[180:183], v[144:147], a[80:83]
    v_mfma_f32_16x16x32_bf16 a[84:87], a[180:183], v[148:151], a[84:87]
    v_mfma_f32_16x16x32_bf16 a[88:91], a[180:183], v[152:155], a[88:91]
    v_mfma_f32_16x16x32_bf16 a[92:95], a[180:183], v[156:159], a[92:95]
    v_mfma_f32_16x16x32_bf16 v[184:187], a[252:255], v[152:155], v[184:187]
    v_mfma_f32_16x16x32_bf16 a[96:99], a[184:187], v[144:147], a[96:99]
    v_mfma_f32_16x16x32_bf16 a[100:103], a[184:187], v[148:151], a[100:103]
    v_mfma_f32_16x16x32_bf16 a[104:107], a[184:187], v[152:155], a[104:107]
    v_mfma_f32_16x16x32_bf16 a[108:111], a[184:187], v[156:159], a[108:111]
    v_mfma_f32_16x16x32_bf16 a[112:115], a[188:191], v[144:147], a[112:115]
    v_mfma_f32_16x16x32_bf16 a[116:119], a[188:191], v[148:151], a[116:119]
    v_mfma_f32_16x16x32_bf16 a[120:123], a[188:191], v[152:155], a[120:123]
    v_mfma_f32_16x16x32_bf16 a[124:127], a[188:191], v[156:159], a[124:127]
    v_mfma_f32_16x16x32_bf16 v[188:191], a[252:255], v[156:159], v[188:191]
    s_nop 7
    v_mov_b32 v177, v180
    v_mov_b32 v178, v184
    v_mov_b32 v179, v188
    v_add_f32 v224, v176, v177
    v_add_f32 v225, v178, v179
    v_add_f32 v225, v225, v224
    s_mov_b32 s35, 0x5d800000
    v_cmp_nlt_f32 vcc, v225, s35
    s_nop 1
    s_cmp_lg_u64 vcc, 0
    s_cselect_b32 s38, 1, 0
    v_mov_b32 v226, s38
    s_lshl_b32 s35, s28, 2
    s_add_u32 s35, s35, 0x20000
    v_mov_b32 v227, s35
    ds_write_b32 v227, v226
    s_mov_b32 s94, 0
L_attn_epi:
    v_rcp_f32 v228, v176
    v_rcp_f32 v230, v177
    v_rcp_f32 v232, v178
    v_rcp_f32 v234, v179
    s_nop 0
    v_mov_b32 v229, v228
    v_mov_b32 v231, v230
    v_mov_b32 v233, v232
    v_mov_b32 v235, v234
    s_mov_b32 s35, 0x0
    v_accvgpr_read_b32 v64, a0
    v_accvgpr_read_b32 v65, a1
    v_accvgpr_read_b32 v66, a2
    v_accvgpr_read_b32 v67, a3
    v_accvgpr_read_b32 v68, a16
    v_accvgpr_read_b32 v69, a17
    v_accvgpr_read_b32 v70, a18
    v_accvgpr_read_b32 v71, a19
    v_pk_mul_f32 v[64:65], v[64:65], v[228:229]
    v_pk_mul_f32 v[66:67], v[66:67], v[228:229]
    v_pk_mul_f32 v[68:69], v[68:69], v[228:229]
    v_pk_mul_f32 v[70:71], v[70:71], v[228:229]
    v_cvt_pk_bf16_f32 v72, v64, v65
    v_cvt_pk_bf16_f32 v73, v66, v67
    v_cvt_pk_bf16_f32 v74, v68, v69
    v_cvt_pk_bf16_f32 v75, v70, v71
    buffer_store_dwordx4 v[72:75], v221, s[24:27], s35 offen offset:0 sc1
    v_accvgpr_read_b32 v80, a4
    v_accvgpr_read_b32 v81, a5
    v_accvgpr_read_b32 v82, a6
    v_accvgpr_read_b32 v83, a7
    v_accvgpr_read_b32 v84, a20
    v_accvgpr_read_b32 v85, a21
    v_accvgpr_read_b32 v86, a22
    v_accvgpr_read_b32 v87, a23
    v_pk_mul_f32 v[80:81], v[80:81], v[230:231]
    v_pk_mul_f32 v[82:83], v[82:83], v[230:231]
    v_pk_mul_f32 v[84:85], v[84:85], v[230:231]
    v_pk_mul_f32 v[86:87], v[86:87], v[230:231]
    v_cvt_pk_bf16_f32 v88, v80, v81
    v_cvt_pk_bf16_f32 v89, v82, v83
    v_cvt_pk_bf16_f32 v90, v84, v85
    v_cvt_pk_bf16_f32 v91, v86, v87
    buffer_store_dwordx4 v[88:91], v221, s[24:27], s35 offen offset:1024 sc1
    v_accvgpr_read_b32 v64, a8
    v_accvgpr_read_b32 v65, a9
    v_accvgpr_read_b32 v66, a10
    v_accvgpr_read_b32 v67, a11
    v_accvgpr_read_b32 v68, a24
    v_accvgpr_read_b32 v69, a25
    v_accvgpr_read_b32 v70, a26
    v_accvgpr_read_b32 v71, a27
    v_pk_mul_f32 v[64:65], v[64:65], v[232:233]
    v_pk_mul_f32 v[66:67], v[66:67], v[232:233]
    v_pk_mul_f32 v[68:69], v[68:69], v[232:233]
    v_pk_mul_f32 v[70:71], v[70:71], v[232:233]
    v_cvt_pk_bf16_f32 v72, v64, v65
    v_cvt_pk_bf16_f32 v73, v66, v67
    v_cvt_pk_bf16_f32 v74, v68, v69
    v_cvt_pk_bf16_f32 v75, v70, v71
    buffer_store_dwordx4 v[72:75], v221, s[24:27], s35 offen offset:2048 sc1
    v_accvgpr_read_b32 v80, a12
    v_accvgpr_read_b32 v81, a13
    v_accvgpr_read_b32 v82, a14
    v_accvgpr_read_b32 v83, a15
    v_accvgpr_read_b32 v84, a28
    v_accvgpr_read_b32 v85, a29
    v_accvgpr_read_b32 v86, a30
    v_accvgpr_read_b32 v87, a31
    v_pk_mul_f32 v[80:81], v[80:81], v[234:235]
    v_pk_mul_f32 v[82:83], v[82:83], v[234:235]
    v_pk_mul_f32 v[84:85], v[84:85], v[234:235]
    v_pk_mul_f32 v[86:87], v[86:87], v[234:235]
    v_cvt_pk_bf16_f32 v88, v80, v81
    v_cvt_pk_bf16_f32 v89, v82, v83
    v_cvt_pk_bf16_f32 v90, v84, v85
    v_cvt_pk_bf16_f32 v91, v86, v87
    buffer_store_dwordx4 v[88:91], v221, s[24:27], s35 offen offset:3072 sc1
    s_mov_b32 s35, 0x1000
    v_accvgpr_read_b32 v64, a32
    v_accvgpr_read_b32 v65, a33
    v_accvgpr_read_b32 v66, a34
    v_accvgpr_read_b32 v67, a35
    v_accvgpr_read_b32 v68, a48
    v_accvgpr_read_b32 v69, a49
    v_accvgpr_read_b32 v70, a50
    v_accvgpr_read_b32 v71, a51
    v_pk_mul_f32 v[64:65], v[64:65], v[228:229]
    v_pk_mul_f32 v[66:67], v[66:67], v[228:229]
    v_pk_mul_f32 v[68:69], v[68:69], v[228:229]
    v_pk_mul_f32 v[70:71], v[70:71], v[228:229]
    v_cvt_pk_bf16_f32 v72, v64, v65
    v_cvt_pk_bf16_f32 v73, v66, v67
    v_cvt_pk_bf16_f32 v74, v68, v69
    v_cvt_pk_bf16_f32 v75, v70, v71
    buffer_store_dwordx4 v[72:75], v221, s[24:27], s35 offen offset:0 sc1
    v_accvgpr_read_b32 v80, a36
    v_accvgpr_read_b32 v81, a37
    v_accvgpr_read_b32 v82, a38
    v_accvgpr_read_b32 v83, a39
    v_accvgpr_read_b32 v84, a52
    v_accvgpr_read_b32 v85, a53
    v_accvgpr_read_b32 v86, a54
    v_accvgpr_read_b32 v87, a55
    v_pk_mul_f32 v[80:81], v[80:81], v[230:231]
    v_pk_mul_f32 v[82:83], v[82:83], v[230:231]
    v_pk_mul_f32 v[84:85], v[84:85], v[230:231]
    v_pk_mul_f32 v[86:87], v[86:87], v[230:231]
    v_cvt_pk_bf16_f32 v88, v80, v81
    v_cvt_pk_bf16_f32 v89, v82, v83
    v_cvt_pk_bf16_f32 v90, v84, v85
    v_cvt_pk_bf16_f32 v91, v86, v87
    buffer_store_dwordx4 v[88:91], v221, s[24:27], s35 offen offset:1024 sc1
    v_accvgpr_read_b32 v64, a40
    v_accvgpr_read_b32 v65, a41
    v_accvgpr_read_b32 v66, a42
    v_accvgpr_read_b32 v67, a43
    v_accvgpr_read_b32 v68, a56
    v_accvgpr_read_b32 v69, a57
    v_accvgpr_read_b32 v70, a58
    v_accvgpr_read_b32 v71, a59
    v_pk_mul_f32 v[64:65], v[64:65], v[232:233]
    v_pk_mul_f32 v[66:67], v[66:67], v[232:233]
    v_pk_mul_f32 v[68:69], v[68:69], v[232:233]
    v_pk_mul_f32 v[70:71], v[70:71], v[232:233]
    v_cvt_pk_bf16_f32 v72, v64, v65
    v_cvt_pk_bf16_f32 v73, v66, v67
    v_cvt_pk_bf16_f32 v74, v68, v69
    v_cvt_pk_bf16_f32 v75, v70, v71
    buffer_store_dwordx4 v[72:75], v221, s[24:27], s35 offen offset:2048 sc1
    v_accvgpr_read_b32 v80, a44
    v_accvgpr_read_b32 v81, a45
    v_accvgpr_read_b32 v82, a46
    v_accvgpr_read_b32 v83, a47
    v_accvgpr_read_b32 v84, a60
    v_accvgpr_read_b32 v85, a61
    v_accvgpr_read_b32 v86, a62
    v_accvgpr_read_b32 v87, a63
    v_pk_mul_f32 v[80:81], v[80:81], v[234:235]
    v_pk_mul_f32 v[82:83], v[82:83], v[234:235]
    v_pk_mul_f32 v[84:85], v[84:85], v[234:235]
    v_pk_mul_f32 v[86:87], v[86:87], v[234:235]
    v_cvt_pk_bf16_f32 v88, v80, v81
    v_cvt_pk_bf16_f32 v89, v82, v83
    v_cvt_pk_bf16_f32 v90, v84, v85
    v_cvt_pk_bf16_f32 v91, v86, v87
    buffer_store_dwordx4 v[88:91], v221, s[24:27], s35 offen offset:3072 sc1
    s_mov_b32 s35, 0x2000
    v_accvgpr_read_b32 v64, a64
    v_accvgpr_read_b32 v65, a65
    v_accvgpr_read_b32 v66, a66
    v_accvgpr_read_b32 v67, a67
    v_accvgpr_read_b32 v68, a80
    v_accvgpr_read_b32 v69, a81
    v_accvgpr_read_b32 v70, a82
    v_accvgpr_read_b32 v71, a83
    v_pk_mul_f32 v[64:65], v[64:65], v[228:229]
    v_pk_mul_f32 v[66:67], v[66:67], v[228:229]
    v_pk_mul_f32 v[68:69], v[68:69], v[228:229]
    v_pk_mul_f32 v[70:71], v[70:71], v[228:229]
    v_cvt_pk_bf16_f32 v72, v64, v65
    v_cvt_pk_bf16_f32 v73, v66, v67
    v_cvt_pk_bf16_f32 v74, v68, v69
    v_cvt_pk_bf16_f32 v75, v70, v71
    buffer_store_dwordx4 v[72:75], v221, s[24:27], s35 offen offset:0 sc1
    v_accvgpr_read_b32 v80, a68
    v_accvgpr_read_b32 v81, a69
    v_accvgpr_read_b32 v82, a70
    v_accvgpr_read_b32 v83, a71
    v_accvgpr_read_b32 v84, a84
    v_accvgpr_read_b32 v85, a85
    v_accvgpr_read_b32 v86, a86
    v_accvgpr_read_b32 v87, a87
    v_pk_mul_f32 v[80:81], v[80:81], v[230:231]
    v_pk_mul_f32 v[82:83], v[82:83], v[230:231]
    v_pk_mul_f32 v[84:85], v[84:85], v[230:231]
    v_pk_mul_f32 v[86:87], v[86:87], v[230:231]
    v_cvt_pk_bf16_f32 v88, v80, v81
    v_cvt_pk_bf16_f32 v89, v82, v83
    v_cvt_pk_bf16_f32 v90, v84, v85
    v_cvt_pk_bf16_f32 v91, v86, v87
    buffer_store_dwordx4 v[88:91], v221, s[24:27], s35 offen offset:1024 sc1
    v_accvgpr_read_b32 v64, a72
    v_accvgpr_read_b32 v65, a73
    v_accvgpr_read_b32 v66, a74
    v_accvgpr_read_b32 v67, a75
    v_accvgpr_read_b32 v68, a88
    v_accvgpr_read_b32 v69, a89
    v_accvgpr_read_b32 v70, a90
    v_accvgpr_read_b32 v71, a91
    v_pk_mul_f32 v[64:65], v[64:65], v[232:233]
    v_pk_mul_f32 v[66:67], v[66:67], v[232:233]
    v_pk_mul_f32 v[68:69], v[68:69], v[232:233]
    v_pk_mul_f32 v[70:71], v[70:71], v[232:233]
    v_cvt_pk_bf16_f32 v72, v64, v65
    v_cvt_pk_bf16_f32 v73, v66, v67
    v_cvt_pk_bf16_f32 v74, v68, v69
    v_cvt_pk_bf16_f32 v75, v70, v71
    buffer_store_dwordx4 v[72:75], v221, s[24:27], s35 offen offset:2048 sc1
    v_accvgpr_read_b32 v80, a76
    v_accvgpr_read_b32 v81, a77
    v_accvgpr_read_b32 v82, a78
    v_accvgpr_read_b32 v83, a79
    v_accvgpr_read_b32 v84, a92
    v_accvgpr_read_b32 v85, a93
    v_accvgpr_read_b32 v86, a94
    v_accvgpr_read_b32 v87, a95
    v_pk_mul_f32 v[80:81], v[80:81], v[234:235]
    v_pk_mul_f32 v[82:83], v[82:83], v[234:235]
    v_pk_mul_f32 v[84:85], v[84:85], v[234:235]
    v_pk_mul_f32 v[86:87], v[86:87], v[234:235]
    v_cvt_pk_bf16_f32 v88, v80, v81
    v_cvt_pk_bf16_f32 v89, v82, v83
    v_cvt_pk_bf16_f32 v90, v84, v85
    v_cvt_pk_bf16_f32 v91, v86, v87
    buffer_store_dwordx4 v[88:91], v221, s[24:27], s35 offen offset:3072 sc1
    s_mov_b32 s35, 0x3000
    v_accvgpr_read_b32 v64, a96
    v_accvgpr_read_b32 v65, a97
    v_accvgpr_read_b32 v66, a98
    v_accvgpr_read_b32 v67, a99
    v_accvgpr_read_b32 v68, a112
    v_accvgpr_read_b32 v69, a113
    v_accvgpr_read_b32 v70, a114
    v_accvgpr_read_b32 v71, a115
    v_pk_mul_f32 v[64:65], v[64:65], v[228:229]
    v_pk_mul_f32 v[66:67], v[66:67], v[228:229]
    v_pk_mul_f32 v[68:69], v[68:69], v[228:229]
    v_pk_mul_f32 v[70:71], v[70:71], v[228:229]
    v_cvt_pk_bf16_f32 v72, v64, v65
    v_cvt_pk_bf16_f32 v73, v66, v67
    v_cvt_pk_bf16_f32 v74, v68, v69
    v_cvt_pk_bf16_f32 v75, v70, v71
    buffer_store_dwordx4 v[72:75], v221, s[24:27], s35 offen offset:0 sc1
    v_accvgpr_read_b32 v80, a100
    v_accvgpr_read_b32 v81, a101
    v_accvgpr_read_b32 v82, a102
    v_accvgpr_read_b32 v83, a103
    v_accvgpr_read_b32 v84, a116
    v_accvgpr_read_b32 v85, a117
    v_accvgpr_read_b32 v86, a118
    v_accvgpr_read_b32 v87, a119
    v_pk_mul_f32 v[80:81], v[80:81], v[230:231]
    v_pk_mul_f32 v[82:83], v[82:83], v[230:231]
    v_pk_mul_f32 v[84:85], v[84:85], v[230:231]
    v_pk_mul_f32 v[86:87], v[86:87], v[230:231]
    v_cvt_pk_bf16_f32 v88, v80, v81
    v_cvt_pk_bf16_f32 v89, v82, v83
    v_cvt_pk_bf16_f32 v90, v84, v85
    v_cvt_pk_bf16_f32 v91, v86, v87
    buffer_store_dwordx4 v[88:91], v221, s[24:27], s35 offen offset:1024 sc1
    v_accvgpr_read_b32 v64, a104
    v_accvgpr_read_b32 v65, a105
    v_accvgpr_read_b32 v66, a106
    v_accvgpr_read_b32 v67, a107
    v_accvgpr_read_b32 v68, a120
    v_accvgpr_read_b32 v69, a121
    v_accvgpr_read_b32 v70, a122
    v_accvgpr_read_b32 v71, a123
    v_pk_mul_f32 v[64:65], v[64:65], v[232:233]
    v_pk_mul_f32 v[66:67], v[66:67], v[232:233]
    v_pk_mul_f32 v[68:69], v[68:69], v[232:233]
    v_pk_mul_f32 v[70:71], v[70:71], v[232:233]
    v_cvt_pk_bf16_f32 v72, v64, v65
    v_cvt_pk_bf16_f32 v73, v66, v67
    v_cvt_pk_bf16_f32 v74, v68, v69
    v_cvt_pk_bf16_f32 v75, v70, v71
    buffer_store_dwordx4 v[72:75], v221, s[24:27], s35 offen offset:2048 sc1
    v_accvgpr_read_b32 v80, a108
    v_accvgpr_read_b32 v81, a109
    v_accvgpr_read_b32 v82, a110
    v_accvgpr_read_b32 v83, a111
    v_accvgpr_read_b32 v84, a124
    v_accvgpr_read_b32 v85, a125
    v_accvgpr_read_b32 v86, a126
    v_accvgpr_read_b32 v87, a127
    v_pk_mul_f32 v[80:81], v[80:81], v[234:235]
    v_pk_mul_f32 v[82:83], v[82:83], v[234:235]
    v_pk_mul_f32 v[84:85], v[84:85], v[234:235]
    v_pk_mul_f32 v[86:87], v[86:87], v[234:235]
    v_cvt_pk_bf16_f32 v88, v80, v81
    v_cvt_pk_bf16_f32 v89, v82, v83
    v_cvt_pk_bf16_f32 v90, v84, v85
    v_cvt_pk_bf16_f32 v91, v86, v87
    buffer_store_dwordx4 v[88:91], v221, s[24:27], s35 offen offset:3072 sc1
    s_cmp_lg_u32 s28, 0
    s_cbranch_scc1 L_wt_R_done
    s_add_u32 s56, s88, 0x61400
    s_addc_u32 s57, s89, 0
    v_mbcnt_lo_u32_b32 v248, -1, 0
    v_mbcnt_hi_u32_b32 v248, -1, v248
    v_min_u32 v248, 7, v248
    v_lshlrev_b32 v248, 7, v248
    s_mov_b32 s58, 60000
    global_load_dword v249, v248, s[56:57] sc1
L_wt_R_loop:
    global_load_dword v251, v248, s[56:57] sc1
    s_waitcnt vmcnt(1)
    v_cmp_gt_u32 vcc, 32, v249
    s_sub_u32 s58, s58, 1
    s_cmp_eq_u32 s58, 0
    s_cbranch_scc1 L_wt_R_done
    s_cmp_eq_u64 vcc, 0
    s_cbranch_scc1 L_wt_R_done
    s_sleep 2
    global_load_dword v249, v248, s[56:57] sc1
    s_waitcnt vmcnt(1)
    v_cmp_gt_u32 vcc, 32, v251
    s_sub_u32 s58, s58, 1
    s_cmp_eq_u32 s58, 0
    s_cbranch_scc1 L_wt_R_done
    s_cmp_eq_u64 vcc, 0
    s_cbranch_scc1 L_wt_R_done
    s_sleep 2
    s_branch L_wt_R_loop
L_wt_R_done:
    s_waitcnt vmcnt(0) lgkmcnt(0)
    s_barrier
    v_mov_b32 v227, 0x20000
    ds_read_b128 v[228:231], v227
    s_waitcnt lgkmcnt(0)
    v_or_b32 v228, v228, v229
    v_or_b32 v230, v230, v231
    v_or_b32 v228, v228, v230
    s_nop 0
    v_readfirstlane_b32 s38, v228
    s_nop 3
    s_andn2_b32 s38, s38, s94
    s_cmp_lg_u32 s38, 0
    s_cbranch_scc1 L_attn_slow
    s_lshr_b32 s59, s2, 5
    s_lshl_b32 s59, s59, 7
    s_cmp_lg_u32 s28, 0
    s_cbranch_scc1 L_arr_A
    s_add_u32 s56, s88, 0x60000
    s_addc_u32 s57, s89, 0
    v_mov_b32 v248, s59
    v_mov_b32 v249, 1
    s_mov_b64 exec, 1
    global_atomic_add v248, v249, s[56:57] sc1
    s_mov_b64 exec, -1
L_arr_A:
    s_and_b32 s30, s2, 7
    s_lshr_b32 s31, s2, 3
    s_and_b32 s32, s30, 1
    s_lshl_b32 s32, s32, 2
    s_lshr_b32 s34, s31, 3
    s_add_u32 s33, s32, s34
    s_mul_i32 s34, s33, 655360
    s_add_u32 s34, s34, 0x2000000
    s_add_u32 s8, s88, s34
    s_addc_u32 s9, s89, 0
    s_and_b32 s9, s9, 0xffff
    s_mov_b32 s10, 0xa0000
    s_mov_b32 s11, 0x20000
    s_mul_i32 s53, s28, 163840
    v_mbcnt_lo_u32_b32 v252, -1, 0
    v_mbcnt_hi_u32_b32 v252, -1, v252
    v_lshlrev_b32 v252, 4, v252
    v_add_u32 v253, 0x1000, v252
    buffer_load_dwordx4 a[128:131], v252, s[8:11], s53 offen offset:0 sc1
    buffer_load_dwordx4 a[132:135], v252, s[8:11], s53 offen offset:1024 sc1
    buffer_load_dwordx4 a[136:139], v252, s[8:11], s53 offen offset:2048 sc1
    buffer_load_dwordx4 a[140:143], v252, s[8:11], s53 offen offset:3072 sc1
    buffer_load_dwordx4 a[144:147], v253, s[8:11], s53 offen offset:0 sc1
    s_add_u32 s53, s53, 5120
    buffer_load_dwordx4 a[148:151], v252, s[8:11], s53 offen offset:0 sc1
    buffer_load_dwordx4 a[152:155], v252, s[8:11], s53 offen offset:1024 sc1
    buffer_load_dwordx4 a[156:159], v252, s[8:11], s53 offen offset:2048 sc1
    buffer_load_dwordx4 a[160:163], v252, s[8:11], s53 offen offset:3072 sc1
    buffer_load_dwordx4 a[164:167], v253, s[8:11], s53 offen offset:0 sc1
    s_add_u32 s53, s53, 5120
    buffer_load_dwordx4 a[168:171], v252, s[8:11], s53 offen offset:0 sc1
    buffer_load_dwordx4 a[172:175], v252, s[8:11], s53 offen offset:1024 sc1
    buffer_load_dwordx4 a[176:179], v252, s[8:11], s53 offen offset:2048 sc1
    buffer_load_dwordx4 a[180:183], v252, s[8:11], s53 offen offset:3072 sc1
    buffer_load_dwordx4 a[184:187], v253, s[8:11], s53 offen offset:0 sc1
    s_add_u32 s53, s53, 5120
    buffer_load_dwordx4 a[188:191], v252, s[8:11], s53 offen offset:0 sc1
    buffer_load_dwordx4 a[192:195], v252, s[8:11], s53 offen offset:1024 sc1
    buffer_load_dwordx4 a[196:199], v252, s[8:11], s53 offen offset:2048 sc1
    buffer_load_dwordx4 a[200:203], v252, s[8:11], s53 offen offset:3072 sc1
    buffer_load_dwordx4 a[204:207], v253, s[8:11], s53 offen offset:0 sc1
    s_add_u32 s53, s53, 5120
    buffer_load_dwordx4 a[208:211], v252, s[8:11], s53 offen offset:0 sc1
    buffer_load_dwordx4 a[212:215], v252, s[8:11], s53 offen offset:1024 sc1
    buffer_load_dwordx4 a[216:219], v252, s[8:11], s53 offen offset:2048 sc1
    buffer_load_dwordx4 a[220:223], v252, s[8:11], s53 offen offset:3072 sc1
    buffer_load_dwordx4 a[224:227], v253, s[8:11], s53 offen offset:0 sc1
    s_add_u32 s53, s53, 5120
    buffer_load_dwordx4 a[228:231], v252, s[8:11], s53 offen offset:0 sc1
    buffer_load_dwordx4 a[232:235], v252, s[8:11], s53 offen offset:1024 sc1
    buffer_load_dwordx4 a[236:239], v252, s[8:11], s53 offen offset:2048 sc1
    buffer_load_dwordx4 a[240:243], v252, s[8:11], s53 offen offset:3072 sc1
    buffer_load_dwordx4 a[244:247], v253, s[8:11], s53 offen offset:0 sc1
    s_add_u32 s53, s53, 5120
    s_mov_b64 s[4:5], s[88:89]
    s_mov_b64 s[6:7], s[90:91]
    v_mbcnt_lo_u32_b32 v228, -1, 0
    v_mbcnt_hi_u32_b32 v228, -1, v228
    s_and_b32 s30, s2, 7
    s_lshr_b32 s31, s2, 3
    s_lshr_b32 s32, s30, 1
    s_lshl_b32 s32, s32, 3
    s_and_b32 s33, s31, 7
    s_add_u32 s29, s32, s33
    s_and_b32 s32, s30, 1
    s_lshl_b32 s32, s32, 2
    s_lshr_b32 s34, s31, 3
    s_add_u32 s35, s32, s34
    v_lshlrev_b32 v224, 4, v228
    v_add_u32 v225, 0x1000, v224
    v_lshrrev_b32 v229, 4, v228
    v_lshlrev_b32 v227, 4, v229
    v_and_b32 v230, 15, v228
    s_lshl_b32 s37, s28, 4
    v_add_u32 v230, s37, v230
    s_mov_b32 s38, 1280
    v_mul_lo_u32 v226, v230, s38
    v_lshl_add_u32 v226, v229, 3, v226
    s_mul_i32 s46, s35, 655360
    s_add_u32 s46, s46, 0x2000000
    s_mul_i32 s47, s29, 524288
    s_add_u32 s47, s47, 0x400000
    s_mul_i32 s37, s28, 32
    s_mul_i32 s39, s37, 5120
    s_lshl_b32 s38, s37, 12
    s_add_u32 s44, s4, s46
    s_addc_u32 s45, s5, 0
    s_mov_b32 s8, s44
    s_and_b32 s9, s45, 0xffff
    s_mov_b32 s10, 0xa0000
    s_mov_b32 s11, 0x20000
    s_add_u32 s44, s4, s47
    s_addc_u32 s45, s5, 0
    s_mov_b32 s12, s44
    s_and_b32 s13, s45, 0xffff
    s_mov_b32 s14, 0x80000
    s_mov_b32 s15, 0x20000
    s_mul_i32 s46, s29, 81920
    s_mul_i32 s47, s35, 160
    s_add_u32 s46, s46, s47
    s_add_u32 s44, s6, s46
    s_addc_u32 s45, s7, 0
    s_mov_b32 s16, s44
    s_and_b32 s17, s45, 0xffff
    s_mov_b32 s18, 0x0
    s_mov_b32 s19, 0x20000
    s_sub_u32 s18, 0x280000, s46
    s_add_u32 s20, s4, 0x0
    s_addc_u32 s21, s5, 0
    s_and_b32 s21, s21, 0xffff
    s_mov_b32 s22, 0x3c00
    s_mov_b32 s23, 0x20000
    s_add_u32 s24, s4, 0x1400000
    s_addc_u32 s25, s5, 0
    s_and_b32 s25, s25, 0xffff
    s_mov_b32 s26, 0x280000
    s_mov_b32 s27, 0x20000
    s_add_u32 s40, s4, 0x8000
    s_addc_u32 s41, s5, 0
    s_and_b32 s41, s41, 0xffff
    s_mov_b32 s42, 0x20000
    s_mov_b32 s43, 0x20000
    s_lshl_b32 s46, s29, 2
    s_add_u32 s46, s46, s28
    s_mul_i32 s46, s46, 20
    s_mul_i32 s47, s35, 5
    s_add_u32 s47, s47, 0
    s_lshr_b32 s48, s47, 1
    s_and_b32 s47, s47, 1
    s_add_u32 s48, s48, s46
    s_lshl_b32 s48, s48, 10
    s_lshl_b32 s47, s47, 3
    s_add_u32 s50, s48, s47
    s_mul_i32 s47, s35, 5
    s_add_u32 s47, s47, 1
    s_lshr_b32 s48, s47, 1
    s_and_b32 s47, s47, 1
    s_add_u32 s48, s48, s46
    s_lshl_b32 s48, s48, 10
    s_lshl_b32 s47, s47, 3
    s_add_u32 s51, s48, s47
    s_mul_i32 s47, s35, 5
    s_add_u32 s47, s47, 2
    s_lshr_b32 s48, s47, 1
    s_and_b32 s47, s47, 1
    s_add_u32 s48, s48, s46
    s_lshl_b32 s48, s48, 10
    s_lshl_b32 s47, s47, 3
    s_add_u32 s52, s48, s47
    s_mul_i32 s47, s35, 5
    s_add_u32 s47, s47, 3
    s_lshr_b32 s48, s47, 1
    s_and_b32 s47, s47, 1
    s_add_u32 s48, s48, s46
    s_lshl_b32 s48, s48, 10
    s_lshl_b32 s47, s47, 3
    s_add_u32 s53, s48, s47
    s_mul_i32 s47, s35, 5
    s_add_u32 s47, s47, 4
    s_lshr_b32 s48, s47, 1
    s_and_b32 s47, s47, 1
    s_add_u32 s48, s48, s46
    s_lshl_b32 s48, s48, 10
    s_lshl_b32 s47, s47, 3
    s_add_u32 s54, s48, s47
    buffer_load_dwordx2 v[232:233], v226, s[16:19], 0 offen offset:0
    buffer_load_dwordx2 v[234:235], v226, s[16:19], 0 offen offset:32
    buffer_load_dwordx2 v[236:237], v226, s[16:19], 0 offen offset:64
    buffer_load_dwordx2 v[238:239], v226, s[16:19], 0 offen offset:96
    buffer_load_dwordx2 v[240:241], v226, s[16:19], 0 offen offset:128
    s_mul_i32 s49, s35, 320
    s_add_u32 s49, s49, 5120
    s_lshr_b32 s59, s29, 2
    s_lshl_b32 s59, s59, 7
    s_cmp_lg_u32 s28, 0
    s_cbranch_scc1 L_wt_A_done
    s_add_u32 s56, s88, 0x60000
    s_addc_u32 s57, s89, 0
    v_mbcnt_lo_u32_b32 v248, -1, 0
    v_mbcnt_hi_u32_b32 v248, -1, v248
    v_min_u32 v248, 0, v248
    v_lshlrev_b32 v248, 7, v248
    v_add_u32 v248, s59, v248
    s_mov_b32 s58, 60000
    global_load_dword v249, v248, s[56:57] sc1
L_wt_A_loop:
    global_load_dword v251, v248, s[56:57] sc1
    s_waitcnt vmcnt(1)
    v_cmp_gt_u32 vcc, 32, v249
    s_sub_u32 s58, s58, 1
    s_cmp_eq_u32 s58, 0
    s_cbranch_scc1 L_wt_A_done
    s_cmp_eq_u64 vcc, 0
    s_cbranch_scc1 L_wt_A_done
    s_sleep 2
    global_load_dword v249, v248, s[56:57] sc1
    s_waitcnt vmcnt(1)
    v_cmp_gt_u32 vcc, 32, v251
    s_sub_u32 s58, s58, 1
    s_cmp_eq_u32 s58, 0
    s_cbranch_scc1 L_wt_A_done
    s_cmp_eq_u64 vcc, 0
    s_cbranch_scc1 L_wt_A_done
    s_sleep 2
    s_branch L_wt_A_loop
L_wt_A_done:
    s_barrier
    buffer_load_dwordx4 v[100:103], v224, s[12:15], s38 offen offset:0 sc1
    buffer_load_dwordx4 v[104:107], v224, s[12:15], s38 offen offset:1024 sc1
    buffer_load_dwordx4 v[108:111], v224, s[12:15], s38 offen offset:2048 sc1
    buffer_load_dwordx4 v[112:115], v224, s[12:15], s38 offen offset:3072 sc1
    s_add_u32 s39, s39, 5120
    s_add_u32 s38, s38, 4096
    buffer_load_dwordx4 v[136:139], v224, s[12:15], s38 offen offset:0 sc1
    buffer_load_dwordx4 v[140:143], v224, s[12:15], s38 offen offset:1024 sc1
    buffer_load_dwordx4 v[144:147], v224, s[12:15], s38 offen offset:2048 sc1
    buffer_load_dwordx4 v[148:151], v224, s[12:15], s38 offen offset:3072 sc1
    s_add_u32 s39, s39, 5120
    s_add_u32 s38, s38, 4096
    buffer_load_dwordx4 v[172:175], v224, s[12:15], s38 offen offset:0 sc1
    buffer_load_dwordx4 v[176:179], v224, s[12:15], s38 offen offset:1024 sc1
    buffer_load_dwordx4 v[180:183], v224, s[12:15], s38 offen offset:2048 sc1
    buffer_load_dwordx4 v[184:187], v224, s[12:15], s38 offen offset:3072 sc1
    s_add_u32 s39, s39, 5120
    s_add_u32 s38, s38, 4096
    s_waitcnt vmcnt(8)
    v_mfma_f32_16x16x32_bf16 v[0:3], a[128:131], v[100:103], 0
    v_mfma_f32_16x16x32_bf16 v[4:7], a[128:131], v[104:107], 0
    buffer_load_dwordx4 v[208:211], v224, s[12:15], s38 offen offset:0 sc1
    v_mfma_f32_16x16x32_bf16 v[8:11], a[128:131], v[108:111], 0
    v_mfma_f32_16x16x32_bf16 v[12:15], a[128:131], v[112:115], 0
    buffer_load_dwordx4 v[212:215], v224, s[12:15], s38 offen offset:1024 sc1
    v_mfma_f32_16x16x32_bf16 v[16:19], a[132:135], v[100:103], 0
    v_mfma_f32_16x16x32_bf16 v[20:23], a[132:135], v[104:107], 0
    buffer_load_dwordx4 v[216:219], v224, s[12:15], s38 offen offset:2048 sc1
    v_mfma_f32_16x16x32_bf16 v[24:27], a[132:135], v[108:111], 0
    v_mfma_f32_16x16x32_bf16 v[28:31], a[132:135], v[112:115], 0
    buffer_load_dwordx4 v[220:223], v224, s[12:15], s38 offen offset:3072 sc1
    v_mfma_f32_16x16x32_bf16 v[32:35], a[136:139], v[100:103], 0
    v_mfma_f32_16x16x32_bf16 v[36:39], a[136:139], v[104:107], 0
    v_mfma_f32_16x16x32_bf16 v[40:43], a[136:139], v[108:111], 0
    v_mfma_f32_16x16x32_bf16 v[44:47], a[136:139], v[112:115], 0
    v_mfma_f32_16x16x32_bf16 v[48:51], a[140:143], v[100:103], 0
    v_mfma_f32_16x16x32_bf16 v[52:55], a[140:143], v[104:107], 0
    v_mfma_f32_16x16x32_bf16 v[56:59], a[140:143], v[108:111], 0
    v_mfma_f32_16x16x32_bf16 v[60:63], a[140:143], v[112:115], 0
    v_mfma_f32_16x16x32_bf16 v[64:67], a[144:147], v[100:103], 0
    v_mfma_f32_16x16x32_bf16 v[68:71], a[144:147], v[104:107], 0
    v_mfma_f32_16x16x32_bf16 v[72:75], a[144:147], v[108:111], 0
    v_mfma_f32_16x16x32_bf16 v[76:79], a[144:147], v[112:115], 0
    s_add_u32 s39, s39, 5120
    s_add_u32 s38, s38, 4096
    s_waitcnt vmcnt(8)
    v_mfma_f32_16x16x32_bf16 v[0:3], a[148:151], v[136:139], v[0:3]
    v_mfma_f32_16x16x32_bf16 v[4:7], a[148:151], v[140:143], v[4:7]
    buffer_load_dwordx4 v[100:103], v224, s[12:15], s38 offen offset:0 sc1
    v_mfma_f32_16x16x32_bf16 v[8:11], a[148:151], v[144:147], v[8:11]
    v_mfma_f32_16x16x32_bf16 v[12:15], a[148:151], v[148:151], v[12:15]
    buffer_load_dwordx4 v[104:107], v224, s[12:15], s38 offen offset:1024 sc1
    v_mfma_f32_16x16x32_bf16 v[16:19], a[152:155], v[136:139], v[16:19]
    v_mfma_f32_16x16x32_bf16 v[20:23], a[152:155], v[140:143], v[20:23]
    buffer_load_dwordx4 v[108:111], v224, s[12:15], s38 offen offset:2048 sc1
    v_mfma_f32_16x16x32_bf16 v[24:27], a[152:155], v[144:147], v[24:27]
    v_mfma_f32_16x16x32_bf16 v[28:31], a[152:155], v[148:151], v[28:31]
    buffer_load_dwordx4 v[112:115], v224, s[12:15], s38 offen offset:3072 sc1
    v_mfma_f32_16x16x32_bf16 v[32:35], a[156:159], v[136:139], v[32:35]
    v_mfma_f32_16x16x32_bf16 v[36:39], a[156:159], v[140:143], v[36:39]
    v_mfma_f32_16x16x32_bf16 v[40:43], a[156:159], v[144:147], v[40:43]
    v_mfma_f32_16x16x32_bf16 v[44:47], a[156:159], v[148:151], v[44:47]
    v_mfma_f32_16x16x32_bf16 v[48:51], a[160:163], v[136:139], v[48:51]
    v_mfma_f32_16x16x32_bf16 v[52:55], a[160:163], v[140:143], v[52:55]
    v_mfma_f32_16x16x32_bf16 v[56:59], a[160:163], v[144:147], v[56:59]
    v_mfma_f32_16x16x32_bf16 v[60:63], a[160:163], v[148:151], v[60:63]
    v_mfma_f32_16x16x32_bf16 v[64:67], a[164:167], v[136:139], v[64:67]
    v_mfma_f32_16x16x32_bf16 v[68:71], a[164:167], v[140:143], v[68:71]
    v_mfma_f32_16x16x32_bf16 v[72:75], a[164:167], v[144:147], v[72:75]
    v_mfma_f32_16x16x32_bf16 v[76:79], a[164:167], v[148:151], v[76:79]
    s_add_u32 s39, s39, 5120
    s_add_u32 s38, s38, 4096
    s_waitcnt vmcnt(8)
    v_mfma_f32_16x16x32_bf16 v[0:3], a[168:171], v[172:175], v[0:3]
    v_mfma_f32_16x16x32_bf16 v[4:7], a[168:171], v[176:179], v[4:7]
    buffer_load_dwordx4 v[136:139], v224, s[12:15], s38 offen offset:0 sc1
    v_mfma_f32_16x16x32_bf16 v[8:11], a[168:171], v[180:183], v[8:11]
    v_mfma_f32_16x16x32_bf16 v[12:15], a[168:171], v[184:187], v[12:15]
    buffer_load_dwordx4 v[140:143], v224, s[12:15], s38 offen offset:1024 sc1
    v_mfma_f32_16x16x32_bf16 v[16:19], a[172:175], v[172:175], v[16:19]
    v_mfma_f32_16x16x32_bf16 v[20:23], a[172:175], v[176:179], v[20:23]
    buffer_load_dwordx4 v[144:147], v224, s[12:15], s38 offen offset:2048 sc1
    v_mfma_f32_16x16x32_bf16 v[24:27], a[172:175], v[180:183], v[24:27]
    v_mfma_f32_16x16x32_bf16 v[28:31], a[172:175], v[184:187], v[28:31]
    buffer_load_dwordx4 v[148:151], v224, s[12:15], s38 offen offset:3072 sc1
    v_mfma_f32_16x16x32_bf16 v[32:35], a[176:179], v[172:175], v[32:35]
    v_mfma_f32_16x16x32_bf16 v[36:39], a[176:179], v[176:179], v[36:39]
    v_mfma_f32_16x16x32_bf16 v[40:43], a[176:179], v[180:183], v[40:43]
    v_mfma_f32_16x16x32_bf16 v[44:47], a[176:179], v[184:187], v[44:47]
    v_mfma_f32_16x16x32_bf16 v[48:51], a[180:183], v[172:175], v[48:51]
    v_mfma_f32_16x16x32_bf16 v[52:55], a[180:183], v[176:179], v[52:55]
    v_mfma_f32_16x16x32_bf16 v[56:59], a[180:183], v[180:183], v[56:59]
    v_mfma_f32_16x16x32_bf16 v[60:63], a[180:183], v[184:187], v[60:63]
    v_mfma_f32_16x16x32_bf16 v[64:67], a[184:187], v[172:175], v[64:67]
    v_mfma_f32_16x16x32_bf16 v[68:71], a[184:187], v[176:179], v[68:71]
    v_mfma_f32_16x16x32_bf16 v[72:75], a[184:187], v[180:183], v[72:75]
    v_mfma_f32_16x16x32_bf16 v[76:79], a[184:187], v[184:187], v[76:79]
    s_add_u32 s39, s39, 5120
    s_add_u32 s38, s38, 4096
    s_waitcnt vmcnt(8)
    v_mfma_f32_16x16x32_bf16 v[0:3], a[188:191], v[208:211], v[0:3]
    v_mfma_f32_16x16x32_bf16 v[4:7], a[188:191], v[212:215], v[4:7]
    buffer_load_dwordx4 v[152:155], v224, s[8:11], s39 offen offset:0 sc1
    v_mfma_f32_16x16x32_bf16 v[8:11], a[188:191], v[216:219], v[8:11]
    v_mfma_f32_16x16x32_bf16 v[12:15], a[188:191], v[220:223], v[12:15]
    buffer_load_dwordx4 v[172:175], v224, s[12:15], s38 offen offset:0 sc1
    v_mfma_f32_16x16x32_bf16 v[16:19], a[192:195], v[208:211], v[16:19]
    v_mfma_f32_16x16x32_bf16 v[20:23], a[192:195], v[212:215], v[20:23]
    buffer_load_dwordx4 v[156:159], v224, s[8:11], s39 offen offset:1024 sc1
    v_mfma_f32_16x16x32_bf16 v[24:27], a[192:195], v[216:219], v[24:27]
    v_mfma_f32_16x16x32_bf16 v[28:31], a[192:195], v[220:223], v[28:31]
    buffer_load_dwordx4 v[176:179], v224, s[12:15], s38 offen offset:1024 sc1
    v_mfma_f32_16x16x32_bf16 v[32:35], a[196:199], v[208:211], v[32:35]
    v_mfma_f32_16x16x32_bf16 v[36:39], a[196:199], v[212:215], v[36:39]
    buffer_load_dwordx4 v[160:163], v224, s[8:11], s39 offen offset:2048 sc1
    v_mfma_f32_16x16x32_bf16 v[40:43], a[196:199], v[216:219], v[40:43]
    v_mfma_f32_16x16x32_bf16 v[44:47], a[196:199], v[220:223], v[44:47]
    buffer_load_dwordx4 v[180:183], v224, s[12:15], s38 offen offset:2048 sc1
    v_mfma_f32_16x16x32_bf16 v[48:51], a[200:203], v[208:211], v[48:51]
    v_mfma_f32_16x16x32_bf16 v[52:55], a[200:203], v[212:215], v[52:55]
    buffer_load_dwordx4 v[164:167], v224, s[8:11], s39 offen offset:3072 sc1
    v_mfma_f32_16x16x32_bf16 v[56:59], a[200:203], v[216:219], v[56:59]
    v_mfma_f32_16x16x32_bf16 v[60:63], a[200:203], v[220:223], v[60:63]
    buffer_load_dwordx4 v[184:187], v224, s[12:15], s38 offen offset:3072 sc1
    v_mfma_f32_16x16x32_bf16 v[64:67], a[204:207], v[208:211], v[64:67]
    v_mfma_f32_16x16x32_bf16 v[68:71], a[204:207], v[212:215], v[68:71]
    buffer_load_dwordx4 v[168:171], v225, s[8:11], s39 offen offset:0 sc1
    v_mfma_f32_16x16x32_bf16 v[72:75], a[204:207], v[216:219], v[72:75]
    v_mfma_f32_16x16x32_bf16 v[76:79], a[204:207], v[220:223], v[76:79]
    s_add_u32 s39, s39, 5120
    s_add_u32 s38, s38, 4096
    s_waitcnt vmcnt(13)
    v_mfma_f32_16x16x32_bf16 v[0:3], a[208:211], v[100:103], v[0:3]
    v_mfma_f32_16x16x32_bf16 v[4:7], a[208:211], v[104:107], v[4:7]
    buffer_load_dwordx4 v[188:191], v224, s[8:11], s39 offen offset:0 sc1
    v_mfma_f32_16x16x32_bf16 v[8:11], a[208:211], v[108:111], v[8:11]
    v_mfma_f32_16x16x32_bf16 v[12:15], a[208:211], v[112:115], v[12:15]
    buffer_load_dwordx4 v[208:211], v224, s[12:15], s38 offen offset:0 sc1
    v_mfma_f32_16x16x32_bf16 v[16:19], a[212:215], v[100:103], v[16:19]
    v_mfma_f32_16x16x32_bf16 v[20:23], a[212:215], v[104:107], v[20:23]
    buffer_load_dwordx4 v[192:195], v224, s[8:11], s39 offen offset:1024 sc1
    v_mfma_f32_16x16x32_bf16 v[24:27], a[212:215], v[108:111], v[24:27]
    v_mfma_f32_16x16x32_bf16 v[28:31], a[212:215], v[112:115], v[28:31]
    buffer_load_dwordx4 v[212:215], v224, s[12:15], s38 offen offset:1024 sc1
    v_mfma_f32_16x16x32_bf16 v[32:35], a[216:219], v[100:103], v[32:35]
    v_mfma_f32_16x16x32_bf16 v[36:39], a[216:219], v[104:107], v[36:39]
    buffer_load_dwordx4 v[196:199], v224, s[8:11], s39 offen offset:2048 sc1
    v_mfma_f32_16x16x32_bf16 v[40:43], a[216:219], v[108:111], v[40:43]
    v_mfma_f32_16x16x32_bf16 v[44:47], a[216:219], v[112:115], v[44:47]
    buffer_load_dwordx4 v[216:219], v224, s[12:15], s38 offen offset:2048 sc1
    v_mfma_f32_16x16x32_bf16 v[48:51], a[220:223], v[100:103], v[48:51]
    v_mfma_f32_16x16x32_bf16 v[52:55], a[220:223], v[104:107], v[52:55]
    buffer_load_dwordx4 v[200:203], v224, s[8:11], s39 offen offset:3072 sc1
    v_mfma_f32_16x16x32_bf16 v[56:59], a[220:223], v[108:111], v[56:59]
    v_mfma_f32_16x16x32_bf16 v[60:63], a[220:223], v[112:115], v[60:63]
    buffer_load_dwordx4 v[220:223], v224, s[12:15], s38 offen offset:3072 sc1
    v_mfma_f32_16x16x32_bf16 v[64:67], a[224:227], v[100:103], v[64:67]
    v_mfma_f32_16x16x32_bf16 v[68:71], a[224:227], v[104:107], v[68:71]
    buffer_load_dwordx4 v[204:207], v225, s[8:11], s39 offen offset:0 sc1
    v_mfma_f32_16x16x32_bf16 v[72:75], a[224:227], v[108:111], v[72:75]
    v_mfma_f32_16x16x32_bf16 v[76:79], a[224:227], v[112:115], v[76:79]
    s_add_u32 s39, s39, 5120
    s_add_u32 s38, s38, 4096
    s_waitcnt vmcnt(18)
    v_mfma_f32_16x16x32_bf16 v[0:3], a[228:231], v[136:139], v[0:3]
    v_mfma_f32_16x16x32_bf16 v[4:7], a[228:231], v[140:143], v[4:7]
    buffer_load_dwordx4 v[80:83], v224, s[8:11], s39 offen offset:0 sc1
    v_mfma_f32_16x16x32_bf16 v[8:11], a[228:231], v[144:147], v[8:11]
    v_mfma_f32_16x16x32_bf16 v[12:15], a[228:231], v[148:151], v[12:15]
    buffer_load_dwordx4 v[100:103], v224, s[12:15], s38 offen offset:0 sc1
    v_mfma_f32_16x16x32_bf16 v[16:19], a[232:235], v[136:139], v[16:19]
    v_mfma_f32_16x16x32_bf16 v[20:23], a[232:235], v[140:143], v[20:23]
    buffer_load_dwordx4 v[84:87], v224, s[8:11], s39 offen offset:1024 sc1
    v_mfma_f32_16x16x32_bf16 v[24:27], a[232:235], v[144:147], v[24:27]
    v_mfma_f32_16x16x32_bf16 v[28:31], a[232:235], v[148:151], v[28:31]
    buffer_load_dwordx4 v[104:107], v224, s[12:15], s38 offen offset:1024 sc1
    v_mfma_f32_16x16x32_bf16 v[32:35], a[236:239], v[136:139], v[32:35]
    v_mfma_f32_16x16x32_bf16 v[36:39], a[236:239], v[140:143], v[36:39]
    buffer_load_dwordx4 v[88:91], v224, s[8:11], s39 offen offset:2048 sc1
    v_mfma_f32_16x16x32_bf16 v[40:43], a[236:239], v[144:147], v[40:43]
    v_mfma_f32_16x16x32_bf16 v[44:47], a[236:239], v[148:151], v[44:47]
    buffer_load_dwordx4 v[108:111], v224, s[12:15], s38 offen offset:2048 sc1
    v_mfma_f32_16x16x32_bf16 v[48:51], a[240:243], v[136:139], v[48:51]
    v_mfma_f32_16x16x32_bf16 v[52:55], a[240:243], v[140:143], v[52:55]
    buffer_load_dwordx4 v[92:95], v224, s[8:11], s39 offen offset:3072 sc1
    v_mfma_f32_16x16x32_bf16 v[56:59], a[240:243], v[144:147], v[56:59]
    v_mfma_f32_16x16x32_bf16 v[60:63], a[240:243], v[148:151], v[60:63]
    buffer_load_dwordx4 v[112:115], v224, s[12:15], s38 offen offset:3072 sc1
    v_mfma_f32_16x16x32_bf16 v[64:67], a[244:247], v[136:139], v[64:67]
    v_mfma_f32_16x16x32_bf16 v[68:71], a[244:247], v[140:143], v[68:71]
    buffer_load_dwordx4 v[96:99], v225, s[8:11], s39 offen offset:0 sc1
    v_mfma_f32_16x16x32_bf16 v[72:75], a[244:247], v[144:147], v[72:75]
    v_mfma_f32_16x16x32_bf16 v[76:79], a[244:247], v[148:151], v[76:79]
    s_add_u32 s39, s39, 5120
    s_add_u32 s38, s38, 4096
    s_waitcnt vmcnt(18)
    v_mfma_f32_16x16x32_bf16 v[0:3], v[152:155], v[172:175], v[0:3]
    v_mfma_f32_16x16x32_bf16 v[4:7], v[152:155], v[176:179], v[4:7]
    buffer_load_dwordx4 v[116:119], v224, s[8:11], s39 offen offset:0 sc1
    v_mfma_f32_16x16x32_bf16 v[8:11], v[152:155], v[180:183], v[8:11]
    v_mfma_f32_16x16x32_bf16 v[12:15], v[152:155], v[184:187], v[12:15]
    buffer_load_dwordx4 v[136:139], v224, s[12:15], s38 offen offset:0 sc1
    v_mfma_f32_16x16x32_bf16 v[16:19], v[156:159], v[172:175], v[16:19]
    v_mfma_f32_16x16x32_bf16 v[20:23], v[156:159], v[176:179], v[20:23]
    buffer_load_dwordx4 v[120:123], v224, s[8:11], s39 offen offset:1024 sc1
    v_mfma_f32_16x16x32_bf16 v[24:27], v[156:159], v[180:183], v[24:27]
    v_mfma_f32_16x16x32_bf16 v[28:31], v[156:159], v[184:187], v[28:31]
    buffer_load_dwordx4 v[140:143], v224, s[12:15], s38 offen offset:1024 sc1
    v_mfma_f32_16x16x32_bf16 v[32:35], v[160:163], v[172:175], v[32:35]
    v_mfma_f32_16x16x32_bf16 v[36:39], v[160:163], v[176:179], v[36:39]
    buffer_load_dwordx4 v[124:127], v224, s[8:11], s39 offen offset:2048 sc1
    v_mfma_f32_16x16x32_bf16 v[40:43], v[160:163], v[180:183], v[40:43]
    v_mfma_f32_16x16x32_bf16 v[44:47], v[160:163], v[184:187], v[44:47]
    buffer_load_dwordx4 v[144:147], v224, s[12:15], s38 offen offset:2048 sc1
    v_mfma_f32_16x16x32_bf16 v[48:51], v[164:167], v[172:175], v[48:51]
    v_mfma_f32_16x16x32_bf16 v[52:55], v[164:167], v[176:179], v[52:55]
    buffer_load_dwordx4 v[128:131], v224, s[8:11], s39 offen offset:3072 sc1
    v_mfma_f32_16x16x32_bf16 v[56:59], v[164:167], v[180:183], v[56:59]
    v_mfma_f32_16x16x32_bf16 v[60:63], v[164:167], v[184:187], v[60:63]
    buffer_load_dwordx4 v[148:151], v224, s[12:15], s38 offen offset:3072 sc1
    v_mfma_f32_16x16x32_bf16 v[64:67], v[168:171], v[172:175], v[64:67]
    v_mfma_f32_16x16x32_bf16 v[68:71], v[168:171], v[176:179], v[68:71]
    buffer_load_dwordx4 v[132:135], v225, s[8:11], s39 offen offset:0 sc1
    v_mfma_f32_16x16x32_bf16 v[72:75], v[168:171], v[180:183], v[72:75]
    v_mfma_f32_16x16x32_bf16 v[76:79], v[168:171], v[184:187], v[76:79]
    s_add_u32 s39, s39, 5120
    s_add_u32 s38, s38, 4096
    s_waitcnt vmcnt(18)
    v_mfma_f32_16x16x32_bf16 v[0:3], v[188:191], v[208:211], v[0:3]
    v_mfma_f32_16x16x32_bf16 v[4:7], v[188:191], v[212:215], v[4:7]
    buffer_load_dwordx4 v[152:155], v224, s[8:11], s39 offen offset:0 sc1
    v_mfma_f32_16x16x32_bf16 v[8:11], v[188:191], v[216:219], v[8:11]
    v_mfma_f32_16x16x32_bf16 v[12:15], v[188:191], v[220:223], v[12:15]
    buffer_load_dwordx4 v[172:175], v224, s[12:15], s38 offen offset:0 sc1
    v_mfma_f32_16x16x32_bf16 v[16:19], v[192:195], v[208:211], v[16:19]
    v_mfma_f32_16x16x32_bf16 v[20:23], v[192:195], v[212:215], v[20:23]
    buffer_load_dwordx4 v[156:159], v224, s[8:11], s39 offen offset:1024 sc1
    v_mfma_f32_16x16x32_bf16 v[24:27], v[192:195], v[216:219], v[24:27]
    v_mfma_f32_16x16x32_bf16 v[28:31], v[192:195], v[220:223], v[28:31]
    buffer_load_dwordx4 v[176:179], v224, s[12:15], s38 offen offset:1024 sc1
    v_mfma_f32_16x16x32_bf16 v[32:35], v[196:199], v[208:211], v[32:35]
    v_mfma_f32_16x16x32_bf16 v[36:39], v[196:199], v[212:215], v[36:39]
    buffer_load_dwordx4 v[160:163], v224, s[8:11], s39 offen offset:2048 sc1
    v_mfma_f32_16x16x32_bf16 v[40:43], v[196:199], v[216:219], v[40:43]
    v_mfma_f32_16x16x32_bf16 v[44:47], v[196:199], v[220:223], v[44:47]
    buffer_load_dwordx4 v[180:183], v224, s[12:15], s38 offen offset:2048 sc1
    v_mfma_f32_16x16x32_bf16 v[48:51], v[200:203], v[208:211], v[48:51]
    v_mfma_f32_16x16x32_bf16 v[52:55], v[200:203], v[212:215], v[52:55]
    buffer_load_dwordx4 v[164:167], v224, s[8:11], s39 offen offset:3072 sc1
    v_mfma_f32_16x16x32_bf16 v[56:59], v[200:203], v[216:219], v[56:59]
    v_mfma_f32_16x16x32_bf16 v[60:63], v[200:203], v[220:223], v[60:63]
    buffer_load_dwordx4 v[184:187], v224, s[12:15], s38 offen offset:3072 sc1
    v_mfma_f32_16x16x32_bf16 v[64:67], v[204:207], v[208:211], v[64:67]
    v_mfma_f32_16x16x32_bf16 v[68:71], v[204:207], v[212:215], v[68:71]
    buffer_load_dwordx4 v[168:171], v225, s[8:11], s39 offen offset:0 sc1
    v_mfma_f32_16x16x32_bf16 v[72:75], v[204:207], v[216:219], v[72:75]
    v_mfma_f32_16x16x32_bf16 v[76:79], v[204:207], v[220:223], v[76:79]
    s_add_u32 s39, s39, 5120
    s_add_u32 s38, s38, 4096
    s_waitcnt vmcnt(18)
    v_mfma_f32_16x16x32_bf16 v[0:3], v[80:83], v[100:103], v[0:3]
    v_mfma_f32_16x16x32_bf16 v[4:7], v[80:83], v[104:107], v[4:7]
    buffer_load_dwordx4 v[188:191], v224, s[8:11], s39 offen offset:0 sc1
    v_mfma_f32_16x16x32_bf16 v[8:11], v[80:83], v[108:111], v[8:11]
    v_mfma_f32_16x16x32_bf16 v[12:15], v[80:83], v[112:115], v[12:15]
    buffer_load_dwordx4 v[208:211], v224, s[12:15], s38 offen offset:0 sc1
    v_mfma_f32_16x16x32_bf16 v[16:19], v[84:87], v[100:103], v[16:19]
    v_mfma_f32_16x16x32_bf16 v[20:23], v[84:87], v[104:107], v[20:23]
    buffer_load_dwordx4 v[192:195], v224, s[8:11], s39 offen offset:1024 sc1
    v_mfma_f32_16x16x32_bf16 v[24:27], v[84:87], v[108:111], v[24:27]
    v_mfma_f32_16x16x32_bf16 v[28:31], v[84:87], v[112:115], v[28:31]
    buffer_load_dwordx4 v[212:215], v224, s[12:15], s38 offen offset:1024 sc1
    v_mfma_f32_16x16x32_bf16 v[32:35], v[88:91], v[100:103], v[32:35]
    v_mfma_f32_16x16x32_bf16 v[36:39], v[88:91], v[104:107], v[36:39]
    buffer_load_dwordx4 v[196:199], v224, s[8:11], s39 offen offset:2048 sc1
    v_mfma_f32_16x16x32_bf16 v[40:43], v[88:91], v[108:111], v[40:43]
    v_mfma_f32_16x16x32_bf16 v[44:47], v[88:91], v[112:115], v[44:47]
    buffer_load_dwordx4 v[216:219], v224, s[12:15], s38 offen offset:2048 sc1
    v_mfma_f32_16x16x32_bf16 v[48:51], v[92:95], v[100:103], v[48:51]
    v_mfma_f32_16x16x32_bf16 v[52:55], v[92:95], v[104:107], v[52:55]
    buffer_load_dwordx4 v[200:203], v224, s[8:11], s39 offen offset:3072 sc1
    v_mfma_f32_16x16x32_bf16 v[56:59], v[92:95], v[108:111], v[56:59]
    v_mfma_f32_16x16x32_bf16 v[60:63], v[92:95], v[112:115], v[60:63]
    buffer_load_dwordx4 v[220:223], v224, s[12:15], s38 offen offset:3072 sc1
    v_mfma_f32_16x16x32_bf16 v[64:67], v[96:99], v[100:103], v[64:67]
    v_mfma_f32_16x16x32_bf16 v[68:71], v[96:99], v[104:107], v[68:71]
    buffer_load_dwordx4 v[204:207], v225, s[8:11], s39 offen offset:0 sc1
    v_mfma_f32_16x16x32_bf16 v[72:75], v[96:99], v[108:111], v[72:75]
    v_mfma_f32_16x16x32_bf16 v[76:79], v[96:99], v[112:115], v[76:79]
    s_add_u32 s39, s39, 5120
    s_add_u32 s38, s38, 4096
    s_waitcnt vmcnt(18)
    v_mfma_f32_16x16x32_bf16 v[0:3], v[116:119], v[136:139], v[0:3]
    v_mfma_f32_16x16x32_bf16 v[4:7], v[116:119], v[140:143], v[4:7]
    buffer_load_dwordx4 v[80:83], v224, s[8:11], s39 offen offset:0 sc1
    v_mfma_f32_16x16x32_bf16 v[8:11], v[116:119], v[144:147], v[8:11]
    v_mfma_f32_16x16x32_bf16 v[12:15], v[116:119], v[148:151], v[12:15]
    buffer_load_dwordx4 v[100:103], v224, s[12:15], s38 offen offset:0 sc1
    v_mfma_f32_16x16x32_bf16 v[16:19], v[120:123], v[136:139], v[16:19]
    v_mfma_f32_16x16x32_bf16 v[20:23], v[120:123], v[140:143], v[20:23]
    buffer_load_dwordx4 v[84:87], v224, s[8:11], s39 offen offset:1024 sc1
    v_mfma_f32_16x16x32_bf16 v[24:27], v[120:123], v[144:147], v[24:27]
    v_mfma_f32_16x16x32_bf16 v[28:31], v[120:123], v[148:151], v[28:31]
    buffer_load_dwordx4 v[104:107], v224, s[12:15], s38 offen offset:1024 sc1
    v_mfma_f32_16x16x32_bf16 v[32:35], v[124:127], v[136:139], v[32:35]
    v_mfma_f32_16x16x32_bf16 v[36:39], v[124:127], v[140:143], v[36:39]
    buffer_load_dwordx4 v[88:91], v224, s[8:11], s39 offen offset:2048 sc1
    v_mfma_f32_16x16x32_bf16 v[40:43], v[124:127], v[144:147], v[40:43]
    v_mfma_f32_16x16x32_bf16 v[44:47], v[124:127], v[148:151], v[44:47]
    buffer_load_dwordx4 v[108:111], v224, s[12:15], s38 offen offset:2048 sc1
    v_mfma_f32_16x16x32_bf16 v[48:51], v[128:131], v[136:139], v[48:51]
    v_mfma_f32_16x16x32_bf16 v[52:55], v[128:131], v[140:143], v[52:55]
    buffer_load_dwordx4 v[92:95], v224, s[8:11], s39 offen offset:3072 sc1
    v_mfma_f32_16x16x32_bf16 v[56:59], v[128:131], v[144:147], v[56:59]
    v_mfma_f32_16x16x32_bf16 v[60:63], v[128:131], v[148:151], v[60:63]
    buffer_load_dwordx4 v[112:115], v224, s[12:15], s38 offen offset:3072 sc1
    v_mfma_f32_16x16x32_bf16 v[64:67], v[132:135], v[136:139], v[64:67]
    v_mfma_f32_16x16x32_bf16 v[68:71], v[132:135], v[140:143], v[68:71]
    buffer_load_dwordx4 v[96:99], v225, s[8:11], s39 offen offset:0 sc1
    v_mfma_f32_16x16x32_bf16 v[72:75], v[132:135], v[144:147], v[72:75]
    v_mfma_f32_16x16x32_bf16 v[76:79], v[132:135], v[148:151], v[76:79]
    s_add_u32 s39, s39, 5120
    s_add_u32 s38, s38, 4096
    s_waitcnt vmcnt(18)
    v_mfma_f32_16x16x32_bf16 v[0:3], v[152:155], v[172:175], v[0:3]
    v_mfma_f32_16x16x32_bf16 v[4:7], v[152:155], v[176:179], v[4:7]
    buffer_load_dwordx4 v[116:119], v224, s[8:11], s39 offen offset:0 sc1
    v_mfma_f32_16x16x32_bf16 v[8:11], v[152:155], v[180:183], v[8:11]
    v_mfma_f32_16x16x32_bf16 v[12:15], v[152:155], v[184:187], v[12:15]
    buffer_load_dwordx4 v[136:139], v224, s[12:15], s38 offen offset:0 sc1
    v_mfma_f32_16x16x32_bf16 v[16:19], v[156:159], v[172:175], v[16:19]
    v_mfma_f32_16x16x32_bf16 v[20:23], v[156:159], v[176:179], v[20:23]
    buffer_load_dwordx4 v[120:123], v224, s[8:11], s39 offen offset:1024 sc1
    v_mfma_f32_16x16x32_bf16 v[24:27], v[156:159], v[180:183], v[24:27]
    v_mfma_f32_16x16x32_bf16 v[28:31], v[156:159], v[184:187], v[28:31]
    buffer_load_dwordx4 v[140:143], v224, s[12:15], s38 offen offset:1024 sc1
    v_mfma_f32_16x16x32_bf16 v[32:35], v[160:163], v[172:175], v[32:35]
    v_mfma_f32_16x16x32_bf16 v[36:39], v[160:163], v[176:179], v[36:39]
    buffer_load_dwordx4 v[124:127], v224, s[8:11], s39 offen offset:2048 sc1
    v_mfma_f32_16x16x32_bf16 v[40:43], v[160:163], v[180:183], v[40:43]
    v_mfma_f32_16x16x32_bf16 v[44:47], v[160:163], v[184:187], v[44:47]
    buffer_load_dwordx4 v[144:147], v224, s[12:15], s38 offen offset:2048 sc1
    v_mfma_f32_16x16x32_bf16 v[48:51], v[164:167], v[172:175], v[48:51]
    v_mfma_f32_16x16x32_bf16 v[52:55], v[164:167], v[176:179], v[52:55]
    buffer_load_dwordx4 v[128:131], v224, s[8:11], s39 offen offset:3072 sc1
    v_mfma_f32_16x16x32_bf16 v[56:59], v[164:167], v[180:183], v[56:59]
    v_mfma_f32_16x16x32_bf16 v[60:63], v[164:167], v[184:187], v[60:63]
    buffer_load_dwordx4 v[148:151], v224, s[12:15], s38 offen offset:3072 sc1
    v_mfma_f32_16x16x32_bf16 v[64:67], v[168:171], v[172:175], v[64:67]
    v_mfma_f32_16x16x32_bf16 v[68:71], v[168:171], v[176:179], v[68:71]
    buffer_load_dwordx4 v[132:135], v225, s[8:11], s39 offen offset:0 sc1
    v_mfma_f32_16x16x32_bf16 v[72:75], v[168:171], v[180:183], v[72:75]
    v_mfma_f32_16x16x32_bf16 v[76:79], v[168:171], v[184:187], v[76:79]
    s_add_u32 s39, s39, 5120
    s_add_u32 s38, s38, 4096
    s_waitcnt vmcnt(18)
    v_mfma_f32_16x16x32_bf16 v[0:3], v[188:191], v[208:211], v[0:3]
    v_mfma_f32_16x16x32_bf16 v[4:7], v[188:191], v[212:215], v[4:7]
    buffer_load_dwordx4 v[152:155], v224, s[8:11], s39 offen offset:0 sc1
    v_mfma_f32_16x16x32_bf16 v[8:11], v[188:191], v[216:219], v[8:11]
    v_mfma_f32_16x16x32_bf16 v[12:15], v[188:191], v[220:223], v[12:15]
    buffer_load_dwordx4 v[172:175], v224, s[12:15], s38 offen offset:0 sc1
    v_mfma_f32_16x16x32_bf16 v[16:19], v[192:195], v[208:211], v[16:19]
    v_mfma_f32_16x16x32_bf16 v[20:23], v[192:195], v[212:215], v[20:23]
    buffer_load_dwordx4 v[156:159], v224, s[8:11], s39 offen offset:1024 sc1
    v_mfma_f32_16x16x32_bf16 v[24:27], v[192:195], v[216:219], v[24:27]
    v_mfma_f32_16x16x32_bf16 v[28:31], v[192:195], v[220:223], v[28:31]
    buffer_load_dwordx4 v[176:179], v224, s[12:15], s38 offen offset:1024 sc1
    v_mfma_f32_16x16x32_bf16 v[32:35], v[196:199], v[208:211], v[32:35]
    v_mfma_f32_16x16x32_bf16 v[36:39], v[196:199], v[212:215], v[36:39]
    buffer_load_dwordx4 v[160:163], v224, s[8:11], s39 offen offset:2048 sc1
    v_mfma_f32_16x16x32_bf16 v[40:43], v[196:199], v[216:219], v[40:43]
    v_mfma_f32_16x16x32_bf16 v[44:47], v[196:199], v[220:223], v[44:47]
    buffer_load_dwordx4 v[180:183], v224, s[12:15], s38 offen offset:2048 sc1
    v_mfma_f32_16x16x32_bf16 v[48:51], v[200:203], v[208:211], v[48:51]
    v_mfma_f32_16x16x32_bf16 v[52:55], v[200:203], v[212:215], v[52:55]
    buffer_load_dwordx4 v[164:167], v224, s[8:11], s39 offen offset:3072 sc1
    v_mfma_f32_16x16x32_bf16 v[56:59], v[200:203], v[216:219], v[56:59]
    v_mfma_f32_16x16x32_bf16 v[60:63], v[200:203], v[220:223], v[60:63]
    buffer_load_dwordx4 v[184:187], v224, s[12:15], s38 offen offset:3072 sc1
    v_mfma_f32_16x16x32_bf16 v[64:67], v[204:207], v[208:211], v[64:67]
    v_mfma_f32_16x16x32_bf16 v[68:71], v[204:207], v[212:215], v[68:71]
    buffer_load_dwordx4 v[168:171], v225, s[8:11], s39 offen offset:0 sc1
    v_mfma_f32_16x16x32_bf16 v[72:75], v[204:207], v[216:219], v[72:75]
    v_mfma_f32_16x16x32_bf16 v[76:79], v[204:207], v[220:223], v[76:79]
    s_add_u32 s39, s39, 5120
    s_add_u32 s38, s38, 4096
    s_waitcnt vmcnt(18)
    v_mfma_f32_16x16x32_bf16 v[0:3], v[80:83], v[100:103], v[0:3]
    v_mfma_f32_16x16x32_bf16 v[4:7], v[80:83], v[104:107], v[4:7]
    buffer_load_dwordx4 v[188:191], v224, s[8:11], s39 offen offset:0 sc1
    v_mfma_f32_16x16x32_bf16 v[8:11], v[80:83], v[108:111], v[8:11]
    v_mfma_f32_16x16x32_bf16 v[12:15], v[80:83], v[112:115], v[12:15]
    buffer_load_dwordx4 v[208:211], v224, s[12:15], s38 offen offset:0 sc1
    v_mfma_f32_16x16x32_bf16 v[16:19], v[84:87], v[100:103], v[16:19]
    v_mfma_f32_16x16x32_bf16 v[20:23], v[84:87], v[104:107], v[20:23]
    buffer_load_dwordx4 v[192:195], v224, s[8:11], s39 offen offset:1024 sc1
    v_mfma_f32_16x16x32_bf16 v[24:27], v[84:87], v[108:111], v[24:27]
    v_mfma_f32_16x16x32_bf16 v[28:31], v[84:87], v[112:115], v[28:31]
    buffer_load_dwordx4 v[212:215], v224, s[12:15], s38 offen offset:1024 sc1
    v_mfma_f32_16x16x32_bf16 v[32:35], v[88:91], v[100:103], v[32:35]
    v_mfma_f32_16x16x32_bf16 v[36:39], v[88:91], v[104:107], v[36:39]
    buffer_load_dwordx4 v[196:199], v224, s[8:11], s39 offen offset:2048 sc1
    v_mfma_f32_16x16x32_bf16 v[40:43], v[88:91], v[108:111], v[40:43]
    v_mfma_f32_16x16x32_bf16 v[44:47], v[88:91], v[112:115], v[44:47]
    buffer_load_dwordx4 v[216:219], v224, s[12:15], s38 offen offset:2048 sc1
    v_mfma_f32_16x16x32_bf16 v[48:51], v[92:95], v[100:103], v[48:51]
    v_mfma_f32_16x16x32_bf16 v[52:55], v[92:95], v[104:107], v[52:55]
    buffer_load_dwordx4 v[200:203], v224, s[8:11], s39 offen offset:3072 sc1
    v_mfma_f32_16x16x32_bf16 v[56:59], v[92:95], v[108:111], v[56:59]
    v_mfma_f32_16x16x32_bf16 v[60:63], v[92:95], v[112:115], v[60:63]
    buffer_load_dwordx4 v[220:223], v224, s[12:15], s38 offen offset:3072 sc1
    v_mfma_f32_16x16x32_bf16 v[64:67], v[96:99], v[100:103], v[64:67]
    v_mfma_f32_16x16x32_bf16 v[68:71], v[96:99], v[104:107], v[68:71]
    buffer_load_dwordx4 v[204:207], v225, s[8:11], s39 offen offset:0 sc1
    v_mfma_f32_16x16x32_bf16 v[72:75], v[96:99], v[108:111], v[72:75]
    v_mfma_f32_16x16x32_bf16 v[76:79], v[96:99], v[112:115], v[76:79]
    s_add_u32 s39, s39, 5120
    s_add_u32 s38, s38, 4096
    s_waitcnt vmcnt(18)
    v_mfma_f32_16x16x32_bf16 v[0:3], v[116:119], v[136:139], v[0:3]
    v_mfma_f32_16x16x32_bf16 v[4:7], v[116:119], v[140:143], v[4:7]
    buffer_load_dwordx4 v[80:83], v224, s[8:11], s39 offen offset:0 sc1
    v_mfma_f32_16x16x32_bf16 v[8:11], v[116:119], v[144:147], v[8:11]
    v_mfma_f32_16x16x32_bf16 v[12:15], v[116:119], v[148:151], v[12:15]
    buffer_load_dwordx4 v[100:103], v224, s[12:15], s38 offen offset:0 sc1
    v_mfma_f32_16x16x32_bf16 v[16:19], v[120:123], v[136:139], v[16:19]
    v_mfma_f32_16x16x32_bf16 v[20:23], v[120:123], v[140:143], v[20:23]
    buffer_load_dwordx4 v[84:87], v224, s[8:11], s39 offen offset:1024 sc1
    v_mfma_f32_16x16x32_bf16 v[24:27], v[120:123], v[144:147], v[24:27]
    v_mfma_f32_16x16x32_bf16 v[28:31], v[120:123], v[148:151], v[28:31]
    buffer_load_dwordx4 v[104:107], v224, s[12:15], s38 offen offset:1024 sc1
    v_mfma_f32_16x16x32_bf16 v[32:35], v[124:127], v[136:139], v[32:35]
    v_mfma_f32_16x16x32_bf16 v[36:39], v[124:127], v[140:143], v[36:39]
    buffer_load_dwordx4 v[88:91], v224, s[8:11], s39 offen offset:2048 sc1
    v_mfma_f32_16x16x32_bf16 v[40:43], v[124:127], v[144:147], v[40:43]
    v_mfma_f32_16x16x32_bf16 v[44:47], v[124:127], v[148:151], v[44:47]
    buffer_load_dwordx4 v[108:111], v224, s[12:15], s38 offen offset:2048 sc1
    v_mfma_f32_16x16x32_bf16 v[48:51], v[128:131], v[136:139], v[48:51]
    v_mfma_f32_16x16x32_bf16 v[52:55], v[128:131], v[140:143], v[52:55]
    buffer_load_dwordx4 v[92:95], v224, s[8:11], s39 offen offset:3072 sc1
    v_mfma_f32_16x16x32_bf16 v[56:59], v[128:131], v[144:147], v[56:59]
    v_mfma_f32_16x16x32_bf16 v[60:63], v[128:131], v[148:151], v[60:63]
    buffer_load_dwordx4 v[112:115], v224, s[12:15], s38 offen offset:3072 sc1
    v_mfma_f32_16x16x32_bf16 v[64:67], v[132:135], v[136:139], v[64:67]
    v_mfma_f32_16x16x32_bf16 v[68:71], v[132:135], v[140:143], v[68:71]
    buffer_load_dwordx4 v[96:99], v225, s[8:11], s39 offen offset:0 sc1
    v_mfma_f32_16x16x32_bf16 v[72:75], v[132:135], v[144:147], v[72:75]
    v_mfma_f32_16x16x32_bf16 v[76:79], v[132:135], v[148:151], v[76:79]
    s_add_u32 s39, s39, 5120
    s_add_u32 s38, s38, 4096
    s_waitcnt vmcnt(18)
    v_mfma_f32_16x16x32_bf16 v[0:3], v[152:155], v[172:175], v[0:3]
    v_mfma_f32_16x16x32_bf16 v[4:7], v[152:155], v[176:179], v[4:7]
    buffer_load_dwordx4 v[116:119], v224, s[8:11], s39 offen offset:0 sc1
    v_mfma_f32_16x16x32_bf16 v[8:11], v[152:155], v[180:183], v[8:11]
    v_mfma_f32_16x16x32_bf16 v[12:15], v[152:155], v[184:187], v[12:15]
    buffer_load_dwordx4 v[136:139], v224, s[12:15], s38 offen offset:0 sc1
    v_mfma_f32_16x16x32_bf16 v[16:19], v[156:159], v[172:175], v[16:19]
    v_mfma_f32_16x16x32_bf16 v[20:23], v[156:159], v[176:179], v[20:23]
    buffer_load_dwordx4 v[120:123], v224, s[8:11], s39 offen offset:1024 sc1
    v_mfma_f32_16x16x32_bf16 v[24:27], v[156:159], v[180:183], v[24:27]
    v_mfma_f32_16x16x32_bf16 v[28:31], v[156:159], v[184:187], v[28:31]
    buffer_load_dwordx4 v[140:143], v224, s[12:15], s38 offen offset:1024 sc1
    v_mfma_f32_16x16x32_bf16 v[32:35], v[160:163], v[172:175], v[32:35]
    v_mfma_f32_16x16x32_bf16 v[36:39], v[160:163], v[176:179], v[36:39]
    buffer_load_dwordx4 v[124:127], v224, s[8:11], s39 offen offset:2048 sc1
    v_mfma_f32_16x16x32_bf16 v[40:43], v[160:163], v[180:183], v[40:43]
    v_mfma_f32_16x16x32_bf16 v[44:47], v[160:163], v[184:187], v[44:47]
    buffer_load_dwordx4 v[144:147], v224, s[12:15], s38 offen offset:2048 sc1
    v_mfma_f32_16x16x32_bf16 v[48:51], v[164:167], v[172:175], v[48:51]
    v_mfma_f32_16x16x32_bf16 v[52:55], v[164:167], v[176:179], v[52:55]
    buffer_load_dwordx4 v[128:131], v224, s[8:11], s39 offen offset:3072 sc1
    v_mfma_f32_16x16x32_bf16 v[56:59], v[164:167], v[180:183], v[56:59]
    v_mfma_f32_16x16x32_bf16 v[60:63], v[164:167], v[184:187], v[60:63]
    buffer_load_dwordx4 v[148:151], v224, s[12:15], s38 offen offset:3072 sc1
    v_mfma_f32_16x16x32_bf16 v[64:67], v[168:171], v[172:175], v[64:67]
    v_mfma_f32_16x16x32_bf16 v[68:71], v[168:171], v[176:179], v[68:71]
    buffer_load_dwordx4 v[132:135], v225, s[8:11], s39 offen offset:0 sc1
    v_mfma_f32_16x16x32_bf16 v[72:75], v[168:171], v[180:183], v[72:75]
    v_mfma_f32_16x16x32_bf16 v[76:79], v[168:171], v[184:187], v[76:79]
    s_add_u32 s39, s39, 5120
    s_add_u32 s38, s38, 4096
    s_waitcnt vmcnt(18)
    v_mfma_f32_16x16x32_bf16 v[0:3], v[188:191], v[208:211], v[0:3]
    v_mfma_f32_16x16x32_bf16 v[4:7], v[188:191], v[212:215], v[4:7]
    buffer_load_dwordx4 v[152:155], v224, s[8:11], s39 offen offset:0 sc1
    v_mfma_f32_16x16x32_bf16 v[8:11], v[188:191], v[216:219], v[8:11]
    v_mfma_f32_16x16x32_bf16 v[12:15], v[188:191], v[220:223], v[12:15]
    buffer_load_dwordx4 v[172:175], v224, s[12:15], s38 offen offset:0 sc1
    v_mfma_f32_16x16x32_bf16 v[16:19], v[192:195], v[208:211], v[16:19]
    v_mfma_f32_16x16x32_bf16 v[20:23], v[192:195], v[212:215], v[20:23]
    buffer_load_dwordx4 v[156:159], v224, s[8:11], s39 offen offset:1024 sc1
    v_mfma_f32_16x16x32_bf16 v[24:27], v[192:195], v[216:219], v[24:27]
    v_mfma_f32_16x16x32_bf16 v[28:31], v[192:195], v[220:223], v[28:31]
    buffer_load_dwordx4 v[176:179], v224, s[12:15], s38 offen offset:1024 sc1
    v_mfma_f32_16x16x32_bf16 v[32:35], v[196:199], v[208:211], v[32:35]
    v_mfma_f32_16x16x32_bf16 v[36:39], v[196:199], v[212:215], v[36:39]
    buffer_load_dwordx4 v[160:163], v224, s[8:11], s39 offen offset:2048 sc1
    v_mfma_f32_16x16x32_bf16 v[40:43], v[196:199], v[216:219], v[40:43]
    v_mfma_f32_16x16x32_bf16 v[44:47], v[196:199], v[220:223], v[44:47]
    buffer_load_dwordx4 v[180:183], v224, s[12:15], s38 offen offset:2048 sc1
    v_mfma_f32_16x16x32_bf16 v[48:51], v[200:203], v[208:211], v[48:51]
    v_mfma_f32_16x16x32_bf16 v[52:55], v[200:203], v[212:215], v[52:55]
    buffer_load_dwordx4 v[164:167], v224, s[8:11], s39 offen offset:3072 sc1
    v_mfma_f32_16x16x32_bf16 v[56:59], v[200:203], v[216:219], v[56:59]
    v_mfma_f32_16x16x32_bf16 v[60:63], v[200:203], v[220:223], v[60:63]
    buffer_load_dwordx4 v[184:187], v224, s[12:15], s38 offen offset:3072 sc1
    v_mfma_f32_16x16x32_bf16 v[64:67], v[204:207], v[208:211], v[64:67]
    v_mfma_f32_16x16x32_bf16 v[68:71], v[204:207], v[212:215], v[68:71]
    buffer_load_dwordx4 v[168:171], v225, s[8:11], s39 offen offset:0 sc1
    v_mfma_f32_16x16x32_bf16 v[72:75], v[204:207], v[216:219], v[72:75]
    v_mfma_f32_16x16x32_bf16 v[76:79], v[204:207], v[220:223], v[76:79]
    s_add_u32 s39, s39, 5120
    s_add_u32 s38, s38, 4096
    s_waitcnt vmcnt(18)
    v_mfma_f32_16x16x32_bf16 v[0:3], v[80:83], v[100:103], v[0:3]
    v_mfma_f32_16x16x32_bf16 v[4:7], v[80:83], v[104:107], v[4:7]
    buffer_load_dwordx4 v[188:191], v224, s[8:11], s39 offen offset:0 sc1
    v_mfma_f32_16x16x32_bf16 v[8:11], v[80:83], v[108:111], v[8:11]
    v_mfma_f32_16x16x32_bf16 v[12:15], v[80:83], v[112:115], v[12:15]
    buffer_load_dwordx4 v[208:211], v224, s[12:15], s38 offen offset:0 sc1
    v_mfma_f32_16x16x32_bf16 v[16:19], v[84:87], v[100:103], v[16:19]
    v_mfma_f32_16x16x32_bf16 v[20:23], v[84:87], v[104:107], v[20:23]
    buffer_load_dwordx4 v[192:195], v224, s[8:11], s39 offen offset:1024 sc1
    v_mfma_f32_16x16x32_bf16 v[24:27], v[84:87], v[108:111], v[24:27]
    v_mfma_f32_16x16x32_bf16 v[28:31], v[84:87], v[112:115], v[28:31]
    buffer_load_dwordx4 v[212:215], v224, s[12:15], s38 offen offset:1024 sc1
    v_mfma_f32_16x16x32_bf16 v[32:35], v[88:91], v[100:103], v[32:35]
    v_mfma_f32_16x16x32_bf16 v[36:39], v[88:91], v[104:107], v[36:39]
    buffer_load_dwordx4 v[196:199], v224, s[8:11], s39 offen offset:2048 sc1
    v_mfma_f32_16x16x32_bf16 v[40:43], v[88:91], v[108:111], v[40:43]
    v_mfma_f32_16x16x32_bf16 v[44:47], v[88:91], v[112:115], v[44:47]
    buffer_load_dwordx4 v[216:219], v224, s[12:15], s38 offen offset:2048 sc1
    v_mfma_f32_16x16x32_bf16 v[48:51], v[92:95], v[100:103], v[48:51]
    v_mfma_f32_16x16x32_bf16 v[52:55], v[92:95], v[104:107], v[52:55]
    buffer_load_dwordx4 v[200:203], v224, s[8:11], s39 offen offset:3072 sc1
    v_mfma_f32_16x16x32_bf16 v[56:59], v[92:95], v[108:111], v[56:59]
    v_mfma_f32_16x16x32_bf16 v[60:63], v[92:95], v[112:115], v[60:63]
    buffer_load_dwordx4 v[220:223], v224, s[12:15], s38 offen offset:3072 sc1
    v_mfma_f32_16x16x32_bf16 v[64:67], v[96:99], v[100:103], v[64:67]
    v_mfma_f32_16x16x32_bf16 v[68:71], v[96:99], v[104:107], v[68:71]
    buffer_load_dwordx4 v[204:207], v225, s[8:11], s39 offen offset:0 sc1
    v_mfma_f32_16x16x32_bf16 v[72:75], v[96:99], v[108:111], v[72:75]
    v_mfma_f32_16x16x32_bf16 v[76:79], v[96:99], v[112:115], v[76:79]
    s_add_u32 s39, s39, 5120
    s_add_u32 s38, s38, 4096
    s_waitcnt vmcnt(18)
    v_mfma_f32_16x16x32_bf16 v[0:3], v[116:119], v[136:139], v[0:3]
    v_mfma_f32_16x16x32_bf16 v[4:7], v[116:119], v[140:143], v[4:7]
    buffer_load_dwordx4 v[80:83], v224, s[8:11], s39 offen offset:0 sc1
    v_mfma_f32_16x16x32_bf16 v[8:11], v[116:119], v[144:147], v[8:11]
    v_mfma_f32_16x16x32_bf16 v[12:15], v[116:119], v[148:151], v[12:15]
    buffer_load_dwordx4 v[100:103], v224, s[12:15], s38 offen offset:0 sc1
    v_mfma_f32_16x16x32_bf16 v[16:19], v[120:123], v[136:139], v[16:19]
    v_mfma_f32_16x16x32_bf16 v[20:23], v[120:123], v[140:143], v[20:23]
    buffer_load_dwordx4 v[84:87], v224, s[8:11], s39 offen offset:1024 sc1
    v_mfma_f32_16x16x32_bf16 v[24:27], v[120:123], v[144:147], v[24:27]
    v_mfma_f32_16x16x32_bf16 v[28:31], v[120:123], v[148:151], v[28:31]
    buffer_load_dwordx4 v[104:107], v224, s[12:15], s38 offen offset:1024 sc1
    v_mfma_f32_16x16x32_bf16 v[32:35], v[124:127], v[136:139], v[32:35]
    v_mfma_f32_16x16x32_bf16 v[36:39], v[124:127], v[140:143], v[36:39]
    buffer_load_dwordx4 v[88:91], v224, s[8:11], s39 offen offset:2048 sc1
    v_mfma_f32_16x16x32_bf16 v[40:43], v[124:127], v[144:147], v[40:43]
    v_mfma_f32_16x16x32_bf16 v[44:47], v[124:127], v[148:151], v[44:47]
    buffer_load_dwordx4 v[108:111], v224, s[12:15], s38 offen offset:2048 sc1
    v_mfma_f32_16x16x32_bf16 v[48:51], v[128:131], v[136:139], v[48:51]
    v_mfma_f32_16x16x32_bf16 v[52:55], v[128:131], v[140:143], v[52:55]
    buffer_load_dwordx4 v[92:95], v224, s[8:11], s39 offen offset:3072 sc1
    v_mfma_f32_16x16x32_bf16 v[56:59], v[128:131], v[144:147], v[56:59]
    v_mfma_f32_16x16x32_bf16 v[60:63], v[128:131], v[148:151], v[60:63]
    buffer_load_dwordx4 v[112:115], v224, s[12:15], s38 offen offset:3072 sc1
    v_mfma_f32_16x16x32_bf16 v[64:67], v[132:135], v[136:139], v[64:67]
    v_mfma_f32_16x16x32_bf16 v[68:71], v[132:135], v[140:143], v[68:71]
    buffer_load_dwordx4 v[96:99], v225, s[8:11], s39 offen offset:0 sc1
    v_mfma_f32_16x16x32_bf16 v[72:75], v[132:135], v[144:147], v[72:75]
    v_mfma_f32_16x16x32_bf16 v[76:79], v[132:135], v[148:151], v[76:79]
    s_add_u32 s39, s39, 5120
    s_add_u32 s38, s38, 4096
    s_waitcnt vmcnt(18)
    v_mfma_f32_16x16x32_bf16 v[0:3], v[152:155], v[172:175], v[0:3]
    v_mfma_f32_16x16x32_bf16 v[4:7], v[152:155], v[176:179], v[4:7]
    buffer_load_dwordx4 v[116:119], v224, s[8:11], s39 offen offset:0 sc1
    v_mfma_f32_16x16x32_bf16 v[8:11], v[152:155], v[180:183], v[8:11]
    v_mfma_f32_16x16x32_bf16 v[12:15], v[152:155], v[184:187], v[12:15]
    buffer_load_dwordx4 v[136:139], v224, s[12:15], s38 offen offset:0 sc1
    v_mfma_f32_16x16x32_bf16 v[16:19], v[156:159], v[172:175], v[16:19]
    v_mfma_f32_16x16x32_bf16 v[20:23], v[156:159], v[176:179], v[20:23]
    buffer_load_dwordx4 v[120:123], v224, s[8:11], s39 offen offset:1024 sc1
    v_mfma_f32_16x16x32_bf16 v[24:27], v[156:159], v[180:183], v[24:27]
    v_mfma_f32_16x16x32_bf16 v[28:31], v[156:159], v[184:187], v[28:31]
    buffer_load_dwordx4 v[140:143], v224, s[12:15], s38 offen offset:1024 sc1
    v_mfma_f32_16x16x32_bf16 v[32:35], v[160:163], v[172:175], v[32:35]
    v_mfma_f32_16x16x32_bf16 v[36:39], v[160:163], v[176:179], v[36:39]
    buffer_load_dwordx4 v[124:127], v224, s[8:11], s39 offen offset:2048 sc1
    v_mfma_f32_16x16x32_bf16 v[40:43], v[160:163], v[180:183], v[40:43]
    v_mfma_f32_16x16x32_bf16 v[44:47], v[160:163], v[184:187], v[44:47]
    buffer_load_dwordx4 v[144:147], v224, s[12:15], s38 offen offset:2048 sc1
    v_mfma_f32_16x16x32_bf16 v[48:51], v[164:167], v[172:175], v[48:51]
    v_mfma_f32_16x16x32_bf16 v[52:55], v[164:167], v[176:179], v[52:55]
    buffer_load_dwordx4 v[128:131], v224, s[8:11], s39 offen offset:3072 sc1
    v_mfma_f32_16x16x32_bf16 v[56:59], v[164:167], v[180:183], v[56:59]
    v_mfma_f32_16x16x32_bf16 v[60:63], v[164:167], v[184:187], v[60:63]
    buffer_load_dwordx4 v[148:151], v224, s[12:15], s38 offen offset:3072 sc1
    v_mfma_f32_16x16x32_bf16 v[64:67], v[168:171], v[172:175], v[64:67]
    v_mfma_f32_16x16x32_bf16 v[68:71], v[168:171], v[176:179], v[68:71]
    buffer_load_dwordx4 v[132:135], v225, s[8:11], s39 offen offset:0 sc1
    v_mfma_f32_16x16x32_bf16 v[72:75], v[168:171], v[180:183], v[72:75]
    v_mfma_f32_16x16x32_bf16 v[76:79], v[168:171], v[184:187], v[76:79]
    s_add_u32 s39, s39, 5120
    s_add_u32 s38, s38, 4096
    s_waitcnt vmcnt(18)
    v_mfma_f32_16x16x32_bf16 v[0:3], v[188:191], v[208:211], v[0:3]
    v_mfma_f32_16x16x32_bf16 v[4:7], v[188:191], v[212:215], v[4:7]
    buffer_load_dwordx4 v[152:155], v224, s[8:11], s39 offen offset:0 sc1
    v_mfma_f32_16x16x32_bf16 v[8:11], v[188:191], v[216:219], v[8:11]
    v_mfma_f32_16x16x32_bf16 v[12:15], v[188:191], v[220:223], v[12:15]
    buffer_load_dwordx4 v[172:175], v224, s[12:15], s38 offen offset:0 sc1
    v_mfma_f32_16x16x32_bf16 v[16:19], v[192:195], v[208:211], v[16:19]
    v_mfma_f32_16x16x32_bf16 v[20:23], v[192:195], v[212:215], v[20:23]
    buffer_load_dwordx4 v[156:159], v224, s[8:11], s39 offen offset:1024 sc1
    v_mfma_f32_16x16x32_bf16 v[24:27], v[192:195], v[216:219], v[24:27]
    v_mfma_f32_16x16x32_bf16 v[28:31], v[192:195], v[220:223], v[28:31]
    buffer_load_dwordx4 v[176:179], v224, s[12:15], s38 offen offset:1024 sc1
    v_mfma_f32_16x16x32_bf16 v[32:35], v[196:199], v[208:211], v[32:35]
    v_mfma_f32_16x16x32_bf16 v[36:39], v[196:199], v[212:215], v[36:39]
    buffer_load_dwordx4 v[160:163], v224, s[8:11], s39 offen offset:2048 sc1
    v_mfma_f32_16x16x32_bf16 v[40:43], v[196:199], v[216:219], v[40:43]
    v_mfma_f32_16x16x32_bf16 v[44:47], v[196:199], v[220:223], v[44:47]
    buffer_load_dwordx4 v[180:183], v224, s[12:15], s38 offen offset:2048 sc1
    v_mfma_f32_16x16x32_bf16 v[48:51], v[200:203], v[208:211], v[48:51]
    v_mfma_f32_16x16x32_bf16 v[52:55], v[200:203], v[212:215], v[52:55]
    buffer_load_dwordx4 v[164:167], v224, s[8:11], s39 offen offset:3072 sc1
    v_mfma_f32_16x16x32_bf16 v[56:59], v[200:203], v[216:219], v[56:59]
    v_mfma_f32_16x16x32_bf16 v[60:63], v[200:203], v[220:223], v[60:63]
    buffer_load_dwordx4 v[184:187], v224, s[12:15], s38 offen offset:3072 sc1
    v_mfma_f32_16x16x32_bf16 v[64:67], v[204:207], v[208:211], v[64:67]
    v_mfma_f32_16x16x32_bf16 v[68:71], v[204:207], v[212:215], v[68:71]
    buffer_load_dwordx4 v[168:171], v225, s[8:11], s39 offen offset:0 sc1
    v_mfma_f32_16x16x32_bf16 v[72:75], v[204:207], v[216:219], v[72:75]
    v_mfma_f32_16x16x32_bf16 v[76:79], v[204:207], v[220:223], v[76:79]
    s_add_u32 s39, s39, 5120
    s_add_u32 s38, s38, 4096
    s_waitcnt vmcnt(18)
    v_mfma_f32_16x16x32_bf16 v[0:3], v[80:83], v[100:103], v[0:3]
    v_mfma_f32_16x16x32_bf16 v[4:7], v[80:83], v[104:107], v[4:7]
    buffer_load_dwordx4 v[188:191], v224, s[8:11], s39 offen offset:0 sc1
    v_mfma_f32_16x16x32_bf16 v[8:11], v[80:83], v[108:111], v[8:11]
    v_mfma_f32_16x16x32_bf16 v[12:15], v[80:83], v[112:115], v[12:15]
    buffer_load_dwordx4 v[208:211], v224, s[12:15], s38 offen offset:0 sc1
    v_mfma_f32_16x16x32_bf16 v[16:19], v[84:87], v[100:103], v[16:19]
    v_mfma_f32_16x16x32_bf16 v[20:23], v[84:87], v[104:107], v[20:23]
    buffer_load_dwordx4 v[192:195], v224, s[8:11], s39 offen offset:1024 sc1
    v_mfma_f32_16x16x32_bf16 v[24:27], v[84:87], v[108:111], v[24:27]
    v_mfma_f32_16x16x32_bf16 v[28:31], v[84:87], v[112:115], v[28:31]
    buffer_load_dwordx4 v[212:215], v224, s[12:15], s38 offen offset:1024 sc1
    v_mfma_f32_16x16x32_bf16 v[32:35], v[88:91], v[100:103], v[32:35]
    v_mfma_f32_16x16x32_bf16 v[36:39], v[88:91], v[104:107], v[36:39]
    buffer_load_dwordx4 v[196:199], v224, s[8:11], s39 offen offset:2048 sc1
    v_mfma_f32_16x16x32_bf16 v[40:43], v[88:91], v[108:111], v[40:43]
    v_mfma_f32_16x16x32_bf16 v[44:47], v[88:91], v[112:115], v[44:47]
    buffer_load_dwordx4 v[216:219], v224, s[12:15], s38 offen offset:2048 sc1
    v_mfma_f32_16x16x32_bf16 v[48:51], v[92:95], v[100:103], v[48:51]
    v_mfma_f32_16x16x32_bf16 v[52:55], v[92:95], v[104:107], v[52:55]
    buffer_load_dwordx4 v[200:203], v224, s[8:11], s39 offen offset:3072 sc1
    v_mfma_f32_16x16x32_bf16 v[56:59], v[92:95], v[108:111], v[56:59]
    v_mfma_f32_16x16x32_bf16 v[60:63], v[92:95], v[112:115], v[60:63]
    buffer_load_dwordx4 v[220:223], v224, s[12:15], s38 offen offset:3072 sc1
    v_mfma_f32_16x16x32_bf16 v[64:67], v[96:99], v[100:103], v[64:67]
    v_mfma_f32_16x16x32_bf16 v[68:71], v[96:99], v[104:107], v[68:71]
    buffer_load_dwordx4 v[204:207], v225, s[8:11], s39 offen offset:0 sc1
    v_mfma_f32_16x16x32_bf16 v[72:75], v[96:99], v[108:111], v[72:75]
    v_mfma_f32_16x16x32_bf16 v[76:79], v[96:99], v[112:115], v[76:79]
    s_add_u32 s39, s39, 5120
    s_add_u32 s38, s38, 4096
    s_waitcnt vmcnt(18)
    v_mfma_f32_16x16x32_bf16 v[0:3], v[116:119], v[136:139], v[0:3]
    v_mfma_f32_16x16x32_bf16 v[4:7], v[116:119], v[140:143], v[4:7]
    buffer_load_dwordx4 v[80:83], v224, s[8:11], s39 offen offset:0 sc1
    v_mfma_f32_16x16x32_bf16 v[8:11], v[116:119], v[144:147], v[8:11]
    v_mfma_f32_16x16x32_bf16 v[12:15], v[116:119], v[148:151], v[12:15]
    buffer_load_dwordx4 v[100:103], v224, s[12:15], s38 offen offset:0 sc1
    v_mfma_f32_16x16x32_bf16 v[16:19], v[120:123], v[136:139], v[16:19]
    v_mfma_f32_16x16x32_bf16 v[20:23], v[120:123], v[140:143], v[20:23]
    buffer_load_dwordx4 v[84:87], v224, s[8:11], s39 offen offset:1024 sc1
    v_mfma_f32_16x16x32_bf16 v[24:27], v[120:123], v[144:147], v[24:27]
    v_mfma_f32_16x16x32_bf16 v[28:31], v[120:123], v[148:151], v[28:31]
    buffer_load_dwordx4 v[104:107], v224, s[12:15], s38 offen offset:1024 sc1
    v_mfma_f32_16x16x32_bf16 v[32:35], v[124:127], v[136:139], v[32:35]
    v_mfma_f32_16x16x32_bf16 v[36:39], v[124:127], v[140:143], v[36:39]
    buffer_load_dwordx4 v[88:91], v224, s[8:11], s39 offen offset:2048 sc1
    v_mfma_f32_16x16x32_bf16 v[40:43], v[124:127], v[144:147], v[40:43]
    v_mfma_f32_16x16x32_bf16 v[44:47], v[124:127], v[148:151], v[44:47]
    buffer_load_dwordx4 v[108:111], v224, s[12:15], s38 offen offset:2048 sc1
    v_mfma_f32_16x16x32_bf16 v[48:51], v[128:131], v[136:139], v[48:51]
    v_mfma_f32_16x16x32_bf16 v[52:55], v[128:131], v[140:143], v[52:55]
    buffer_load_dwordx4 v[92:95], v224, s[8:11], s39 offen offset:3072 sc1
    v_mfma_f32_16x16x32_bf16 v[56:59], v[128:131], v[144:147], v[56:59]
    v_mfma_f32_16x16x32_bf16 v[60:63], v[128:131], v[148:151], v[60:63]
    buffer_load_dwordx4 v[112:115], v224, s[12:15], s38 offen offset:3072 sc1
    v_mfma_f32_16x16x32_bf16 v[64:67], v[132:135], v[136:139], v[64:67]
    v_mfma_f32_16x16x32_bf16 v[68:71], v[132:135], v[140:143], v[68:71]
    buffer_load_dwordx4 v[96:99], v225, s[8:11], s39 offen offset:0 sc1
    v_mfma_f32_16x16x32_bf16 v[72:75], v[132:135], v[144:147], v[72:75]
    v_mfma_f32_16x16x32_bf16 v[76:79], v[132:135], v[148:151], v[76:79]
    s_add_u32 s39, s39, 5120
    s_add_u32 s38, s38, 4096
    s_waitcnt vmcnt(18)
    v_mfma_f32_16x16x32_bf16 v[0:3], v[152:155], v[172:175], v[0:3]
    v_mfma_f32_16x16x32_bf16 v[4:7], v[152:155], v[176:179], v[4:7]
    buffer_load_dwordx4 v[116:119], v224, s[8:11], s39 offen offset:0 sc1
    v_mfma_f32_16x16x32_bf16 v[8:11], v[152:155], v[180:183], v[8:11]
    v_mfma_f32_16x16x32_bf16 v[12:15], v[152:155], v[184:187], v[12:15]
    buffer_load_dwordx4 v[136:139], v224, s[12:15], s38 offen offset:0 sc1
    v_mfma_f32_16x16x32_bf16 v[16:19], v[156:159], v[172:175], v[16:19]
    v_mfma_f32_16x16x32_bf16 v[20:23], v[156:159], v[176:179], v[20:23]
    buffer_load_dwordx4 v[120:123], v224, s[8:11], s39 offen offset:1024 sc1
    v_mfma_f32_16x16x32_bf16 v[24:27], v[156:159], v[180:183], v[24:27]
    v_mfma_f32_16x16x32_bf16 v[28:31], v[156:159], v[184:187], v[28:31]
    buffer_load_dwordx4 v[140:143], v224, s[12:15], s38 offen offset:1024 sc1
    v_mfma_f32_16x16x32_bf16 v[32:35], v[160:163], v[172:175], v[32:35]
    v_mfma_f32_16x16x32_bf16 v[36:39], v[160:163], v[176:179], v[36:39]
    buffer_load_dwordx4 v[124:127], v224, s[8:11], s39 offen offset:2048 sc1
    v_mfma_f32_16x16x32_bf16 v[40:43], v[160:163], v[180:183], v[40:43]
    v_mfma_f32_16x16x32_bf16 v[44:47], v[160:163], v[184:187], v[44:47]
    buffer_load_dwordx4 v[144:147], v224, s[12:15], s38 offen offset:2048 sc1
    v_mfma_f32_16x16x32_bf16 v[48:51], v[164:167], v[172:175], v[48:51]
    v_mfma_f32_16x16x32_bf16 v[52:55], v[164:167], v[176:179], v[52:55]
    buffer_load_dwordx4 v[128:131], v224, s[8:11], s39 offen offset:3072 sc1
    v_mfma_f32_16x16x32_bf16 v[56:59], v[164:167], v[180:183], v[56:59]
    v_mfma_f32_16x16x32_bf16 v[60:63], v[164:167], v[184:187], v[60:63]
    buffer_load_dwordx4 v[148:151], v224, s[12:15], s38 offen offset:3072 sc1
    v_mfma_f32_16x16x32_bf16 v[64:67], v[168:171], v[172:175], v[64:67]
    v_mfma_f32_16x16x32_bf16 v[68:71], v[168:171], v[176:179], v[68:71]
    buffer_load_dwordx4 v[132:135], v225, s[8:11], s39 offen offset:0 sc1
    v_mfma_f32_16x16x32_bf16 v[72:75], v[168:171], v[180:183], v[72:75]
    v_mfma_f32_16x16x32_bf16 v[76:79], v[168:171], v[184:187], v[76:79]
    s_add_u32 s39, s39, 5120
    s_add_u32 s38, s38, 4096
    s_waitcnt vmcnt(18)
    v_mfma_f32_16x16x32_bf16 v[0:3], v[188:191], v[208:211], v[0:3]
    v_mfma_f32_16x16x32_bf16 v[4:7], v[188:191], v[212:215], v[4:7]
    buffer_load_dwordx4 v[152:155], v224, s[8:11], s39 offen offset:0 sc1
    v_mfma_f32_16x16x32_bf16 v[8:11], v[188:191], v[216:219], v[8:11]
    v_mfma_f32_16x16x32_bf16 v[12:15], v[188:191], v[220:223], v[12:15]
    buffer_load_dwordx4 v[172:175], v224, s[12:15], s38 offen offset:0 sc1
    v_mfma_f32_16x16x32_bf16 v[16:19], v[192:195], v[208:211], v[16:19]
    v_mfma_f32_16x16x32_bf16 v[20:23], v[192:195], v[212:215], v[20:23]
    buffer_load_dwordx4 v[156:159], v224, s[8:11], s39 offen offset:1024 sc1
    v_mfma_f32_16x16x32_bf16 v[24:27], v[192:195], v[216:219], v[24:27]
    v_mfma_f32_16x16x32_bf16 v[28:31], v[192:195], v[220:223], v[28:31]
    buffer_load_dwordx4 v[176:179], v224, s[12:15], s38 offen offset:1024 sc1
    v_mfma_f32_16x16x32_bf16 v[32:35], v[196:199], v[208:211], v[32:35]
    v_mfma_f32_16x16x32_bf16 v[36:39], v[196:199], v[212:215], v[36:39]
    buffer_load_dwordx4 v[160:163], v224, s[8:11], s39 offen offset:2048 sc1
    v_mfma_f32_16x16x32_bf16 v[40:43], v[196:199], v[216:219], v[40:43]
    v_mfma_f32_16x16x32_bf16 v[44:47], v[196:199], v[220:223], v[44:47]
    buffer_load_dwordx4 v[180:183], v224, s[12:15], s38 offen offset:2048 sc1
    v_mfma_f32_16x16x32_bf16 v[48:51], v[200:203], v[208:211], v[48:51]
    v_mfma_f32_16x16x32_bf16 v[52:55], v[200:203], v[212:215], v[52:55]
    buffer_load_dwordx4 v[164:167], v224, s[8:11], s39 offen offset:3072 sc1
    v_mfma_f32_16x16x32_bf16 v[56:59], v[200:203], v[216:219], v[56:59]
    v_mfma_f32_16x16x32_bf16 v[60:63], v[200:203], v[220:223], v[60:63]
    buffer_load_dwordx4 v[184:187], v224, s[12:15], s38 offen offset:3072 sc1
    v_mfma_f32_16x16x32_bf16 v[64:67], v[204:207], v[208:211], v[64:67]
    v_mfma_f32_16x16x32_bf16 v[68:71], v[204:207], v[212:215], v[68:71]
    buffer_load_dwordx4 v[168:171], v225, s[8:11], s39 offen offset:0 sc1
    v_mfma_f32_16x16x32_bf16 v[72:75], v[204:207], v[216:219], v[72:75]
    v_mfma_f32_16x16x32_bf16 v[76:79], v[204:207], v[220:223], v[76:79]
    s_add_u32 s39, s39, 5120
    s_add_u32 s38, s38, 4096
    s_waitcnt vmcnt(18)
    v_mfma_f32_16x16x32_bf16 v[0:3], v[80:83], v[100:103], v[0:3]
    v_mfma_f32_16x16x32_bf16 v[4:7], v[80:83], v[104:107], v[4:7]
    buffer_load_dwordx4 v[188:191], v224, s[8:11], s39 offen offset:0 sc1
    v_mfma_f32_16x16x32_bf16 v[8:11], v[80:83], v[108:111], v[8:11]
    v_mfma_f32_16x16x32_bf16 v[12:15], v[80:83], v[112:115], v[12:15]
    buffer_load_dwordx4 v[208:211], v224, s[12:15], s38 offen offset:0 sc1
    v_mfma_f32_16x16x32_bf16 v[16:19], v[84:87], v[100:103], v[16:19]
    v_mfma_f32_16x16x32_bf16 v[20:23], v[84:87], v[104:107], v[20:23]
    buffer_load_dwordx4 v[192:195], v224, s[8:11], s39 offen offset:1024 sc1
    v_mfma_f32_16x16x32_bf16 v[24:27], v[84:87], v[108:111], v[24:27]
    v_mfma_f32_16x16x32_bf16 v[28:31], v[84:87], v[112:115], v[28:31]
    buffer_load_dwordx4 v[212:215], v224, s[12:15], s38 offen offset:1024 sc1
    v_mfma_f32_16x16x32_bf16 v[32:35], v[88:91], v[100:103], v[32:35]
    v_mfma_f32_16x16x32_bf16 v[36:39], v[88:91], v[104:107], v[36:39]
    buffer_load_dwordx4 v[196:199], v224, s[8:11], s39 offen offset:2048 sc1
    v_mfma_f32_16x16x32_bf16 v[40:43], v[88:91], v[108:111], v[40:43]
    v_mfma_f32_16x16x32_bf16 v[44:47], v[88:91], v[112:115], v[44:47]
    buffer_load_dwordx4 v[216:219], v224, s[12:15], s38 offen offset:2048 sc1
    v_mfma_f32_16x16x32_bf16 v[48:51], v[92:95], v[100:103], v[48:51]
    v_mfma_f32_16x16x32_bf16 v[52:55], v[92:95], v[104:107], v[52:55]
    buffer_load_dwordx4 v[200:203], v224, s[8:11], s39 offen offset:3072 sc1
    v_mfma_f32_16x16x32_bf16 v[56:59], v[92:95], v[108:111], v[56:59]
    v_mfma_f32_16x16x32_bf16 v[60:63], v[92:95], v[112:115], v[60:63]
    buffer_load_dwordx4 v[220:223], v224, s[12:15], s38 offen offset:3072 sc1
    v_mfma_f32_16x16x32_bf16 v[64:67], v[96:99], v[100:103], v[64:67]
    v_mfma_f32_16x16x32_bf16 v[68:71], v[96:99], v[104:107], v[68:71]
    buffer_load_dwordx4 v[204:207], v225, s[8:11], s39 offen offset:0 sc1
    v_mfma_f32_16x16x32_bf16 v[72:75], v[96:99], v[108:111], v[72:75]
    v_mfma_f32_16x16x32_bf16 v[76:79], v[96:99], v[112:115], v[76:79]
    s_add_u32 s39, s39, 5120
    s_add_u32 s38, s38, 4096
    s_waitcnt vmcnt(18)
    v_mfma_f32_16x16x32_bf16 v[0:3], v[116:119], v[136:139], v[0:3]
    v_mfma_f32_16x16x32_bf16 v[4:7], v[116:119], v[140:143], v[4:7]
    buffer_load_dwordx4 v[80:83], v224, s[8:11], s39 offen offset:0 sc1
    v_mfma_f32_16x16x32_bf16 v[8:11], v[116:119], v[144:147], v[8:11]
    v_mfma_f32_16x16x32_bf16 v[12:15], v[116:119], v[148:151], v[12:15]
    buffer_load_dwordx4 v[100:103], v224, s[12:15], s38 offen offset:0 sc1
    v_mfma_f32_16x16x32_bf16 v[16:19], v[120:123], v[136:139], v[16:19]
    v_mfma_f32_16x16x32_bf16 v[20:23], v[120:123], v[140:143], v[20:23]
    buffer_load_dwordx4 v[84:87], v224, s[8:11], s39 offen offset:1024 sc1
    v_mfma_f32_16x16x32_bf16 v[24:27], v[120:123], v[144:147], v[24:27]
    v_mfma_f32_16x16x32_bf16 v[28:31], v[120:123], v[148:151], v[28:31]
    buffer_load_dwordx4 v[104:107], v224, s[12:15], s38 offen offset:1024 sc1
    v_mfma_f32_16x16x32_bf16 v[32:35], v[124:127], v[136:139], v[32:35]
    v_mfma_f32_16x16x32_bf16 v[36:39], v[124:127], v[140:143], v[36:39]
    buffer_load_dwordx4 v[88:91], v224, s[8:11], s39 offen offset:2048 sc1
    v_mfma_f32_16x16x32_bf16 v[40:43], v[124:127], v[144:147], v[40:43]
    v_mfma_f32_16x16x32_bf16 v[44:47], v[124:127], v[148:151], v[44:47]
    buffer_load_dwordx4 v[108:111], v224, s[12:15], s38 offen offset:2048 sc1
    v_mfma_f32_16x16x32_bf16 v[48:51], v[128:131], v[136:139], v[48:51]
    v_mfma_f32_16x16x32_bf16 v[52:55], v[128:131], v[140:143], v[52:55]
    buffer_load_dwordx4 v[92:95], v224, s[8:11], s39 offen offset:3072 sc1
    v_mfma_f32_16x16x32_bf16 v[56:59], v[128:131], v[144:147], v[56:59]
    v_mfma_f32_16x16x32_bf16 v[60:63], v[128:131], v[148:151], v[60:63]
    buffer_load_dwordx4 v[112:115], v224, s[12:15], s38 offen offset:3072 sc1
    v_mfma_f32_16x16x32_bf16 v[64:67], v[132:135], v[136:139], v[64:67]
    v_mfma_f32_16x16x32_bf16 v[68:71], v[132:135], v[140:143], v[68:71]
    buffer_load_dwordx4 v[96:99], v225, s[8:11], s39 offen offset:0 sc1
    v_mfma_f32_16x16x32_bf16 v[72:75], v[132:135], v[144:147], v[72:75]
    v_mfma_f32_16x16x32_bf16 v[76:79], v[132:135], v[148:151], v[76:79]
    s_add_u32 s39, s39, 5120
    s_add_u32 s38, s38, 4096
    s_waitcnt vmcnt(18)
    v_mfma_f32_16x16x32_bf16 v[0:3], v[152:155], v[172:175], v[0:3]
    v_mfma_f32_16x16x32_bf16 v[4:7], v[152:155], v[176:179], v[4:7]
    buffer_load_dwordx4 v[116:119], v224, s[8:11], s39 offen offset:0 sc1
    v_mfma_f32_16x16x32_bf16 v[8:11], v[152:155], v[180:183], v[8:11]
    v_mfma_f32_16x16x32_bf16 v[12:15], v[152:155], v[184:187], v[12:15]
    buffer_load_dwordx4 v[136:139], v224, s[12:15], s38 offen offset:0 sc1
    v_mfma_f32_16x16x32_bf16 v[16:19], v[156:159], v[172:175], v[16:19]
    v_mfma_f32_16x16x32_bf16 v[20:23], v[156:159], v[176:179], v[20:23]
    buffer_load_dwordx4 v[120:123], v224, s[8:11], s39 offen offset:1024 sc1
    v_mfma_f32_16x16x32_bf16 v[24:27], v[156:159], v[180:183], v[24:27]
    v_mfma_f32_16x16x32_bf16 v[28:31], v[156:159], v[184:187], v[28:31]
    buffer_load_dwordx4 v[140:143], v224, s[12:15], s38 offen offset:1024 sc1
    v_mfma_f32_16x16x32_bf16 v[32:35], v[160:163], v[172:175], v[32:35]
    v_mfma_f32_16x16x32_bf16 v[36:39], v[160:163], v[176:179], v[36:39]
    buffer_load_dwordx4 v[124:127], v224, s[8:11], s39 offen offset:2048 sc1
    v_mfma_f32_16x16x32_bf16 v[40:43], v[160:163], v[180:183], v[40:43]
    v_mfma_f32_16x16x32_bf16 v[44:47], v[160:163], v[184:187], v[44:47]
    buffer_load_dwordx4 v[144:147], v224, s[12:15], s38 offen offset:2048 sc1
    v_mfma_f32_16x16x32_bf16 v[48:51], v[164:167], v[172:175], v[48:51]
    v_mfma_f32_16x16x32_bf16 v[52:55], v[164:167], v[176:179], v[52:55]
    buffer_load_dwordx4 v[128:131], v224, s[8:11], s39 offen offset:3072 sc1
    v_mfma_f32_16x16x32_bf16 v[56:59], v[164:167], v[180:183], v[56:59]
    v_mfma_f32_16x16x32_bf16 v[60:63], v[164:167], v[184:187], v[60:63]
    buffer_load_dwordx4 v[148:151], v224, s[12:15], s38 offen offset:3072 sc1
    v_mfma_f32_16x16x32_bf16 v[64:67], v[168:171], v[172:175], v[64:67]
    v_mfma_f32_16x16x32_bf16 v[68:71], v[168:171], v[176:179], v[68:71]
    buffer_load_dwordx4 v[132:135], v225, s[8:11], s39 offen offset:0 sc1
    v_mfma_f32_16x16x32_bf16 v[72:75], v[168:171], v[180:183], v[72:75]
    v_mfma_f32_16x16x32_bf16 v[76:79], v[168:171], v[184:187], v[76:79]
    s_add_u32 s39, s39, 5120
    s_add_u32 s38, s38, 4096
    s_waitcnt vmcnt(18)
    v_mfma_f32_16x16x32_bf16 v[0:3], v[188:191], v[208:211], v[0:3]
    v_mfma_f32_16x16x32_bf16 v[4:7], v[188:191], v[212:215], v[4:7]
    buffer_load_dwordx4 v[152:155], v224, s[8:11], s39 offen offset:0 sc1
    v_mfma_f32_16x16x32_bf16 v[8:11], v[188:191], v[216:219], v[8:11]
    v_mfma_f32_16x16x32_bf16 v[12:15], v[188:191], v[220:223], v[12:15]
    buffer_load_dwordx4 v[172:175], v224, s[12:15], s38 offen offset:0 sc1
    v_mfma_f32_16x16x32_bf16 v[16:19], v[192:195], v[208:211], v[16:19]
    v_mfma_f32_16x16x32_bf16 v[20:23], v[192:195], v[212:215], v[20:23]
    buffer_load_dwordx4 v[156:159], v224, s[8:11], s39 offen offset:1024 sc1
    v_mfma_f32_16x16x32_bf16 v[24:27], v[192:195], v[216:219], v[24:27]
    v_mfma_f32_16x16x32_bf16 v[28:31], v[192:195], v[220:223], v[28:31]
    buffer_load_dwordx4 v[176:179], v224, s[12:15], s38 offen offset:1024 sc1
    v_mfma_f32_16x16x32_bf16 v[32:35], v[196:199], v[208:211], v[32:35]
    v_mfma_f32_16x16x32_bf16 v[36:39], v[196:199], v[212:215], v[36:39]
    buffer_load_dwordx4 v[160:163], v224, s[8:11], s39 offen offset:2048 sc1
    v_mfma_f32_16x16x32_bf16 v[40:43], v[196:199], v[216:219], v[40:43]
    v_mfma_f32_16x16x32_bf16 v[44:47], v[196:199], v[220:223], v[44:47]
    buffer_load_dwordx4 v[180:183], v224, s[12:15], s38 offen offset:2048 sc1
    v_mfma_f32_16x16x32_bf16 v[48:51], v[200:203], v[208:211], v[48:51]
    v_mfma_f32_16x16x32_bf16 v[52:55], v[200:203], v[212:215], v[52:55]
    buffer_load_dwordx4 v[164:167], v224, s[8:11], s39 offen offset:3072 sc1
    v_mfma_f32_16x16x32_bf16 v[56:59], v[200:203], v[216:219], v[56:59]
    v_mfma_f32_16x16x32_bf16 v[60:63], v[200:203], v[220:223], v[60:63]
    buffer_load_dwordx4 v[184:187], v224, s[12:15], s38 offen offset:3072 sc1
    v_mfma_f32_16x16x32_bf16 v[64:67], v[204:207], v[208:211], v[64:67]
    v_mfma_f32_16x16x32_bf16 v[68:71], v[204:207], v[212:215], v[68:71]
    buffer_load_dwordx4 v[168:171], v225, s[8:11], s39 offen offset:0 sc1
    v_mfma_f32_16x16x32_bf16 v[72:75], v[204:207], v[216:219], v[72:75]
    v_mfma_f32_16x16x32_bf16 v[76:79], v[204:207], v[220:223], v[76:79]
    s_add_u32 s39, s39, 5120
    s_add_u32 s38, s38, 4096
    s_waitcnt vmcnt(18)
    v_mfma_f32_16x16x32_bf16 v[0:3], v[80:83], v[100:103], v[0:3]
    v_mfma_f32_16x16x32_bf16 v[4:7], v[80:83], v[104:107], v[4:7]
    buffer_load_dwordx4 v[188:191], v224, s[8:11], s39 offen offset:0 sc1
    v_mfma_f32_16x16x32_bf16 v[8:11], v[80:83], v[108:111], v[8:11]
    v_mfma_f32_16x16x32_bf16 v[12:15], v[80:83], v[112:115], v[12:15]
    buffer_load_dwordx4 v[208:211], v224, s[12:15], s38 offen offset:0 sc1
    v_mfma_f32_16x16x32_bf16 v[16:19], v[84:87], v[100:103], v[16:19]
    v_mfma_f32_16x16x32_bf16 v[20:23], v[84:87], v[104:107], v[20:23]
    buffer_load_dwordx4 v[192:195], v224, s[8:11], s39 offen offset:1024 sc1
    v_mfma_f32_16x16x32_bf16 v[24:27], v[84:87], v[108:111], v[24:27]
    v_mfma_f32_16x16x32_bf16 v[28:31], v[84:87], v[112:115], v[28:31]
    buffer_load_dwordx4 v[212:215], v224, s[12:15], s38 offen offset:1024 sc1
    v_mfma_f32_16x16x32_bf16 v[32:35], v[88:91], v[100:103], v[32:35]
    v_mfma_f32_16x16x32_bf16 v[36:39], v[88:91], v[104:107], v[36:39]
    buffer_load_dwordx4 v[196:199], v224, s[8:11], s39 offen offset:2048 sc1
    v_mfma_f32_16x16x32_bf16 v[40:43], v[88:91], v[108:111], v[40:43]
    v_mfma_f32_16x16x32_bf16 v[44:47], v[88:91], v[112:115], v[44:47]
    buffer_load_dwordx4 v[216:219], v224, s[12:15], s38 offen offset:2048 sc1
    v_mfma_f32_16x16x32_bf16 v[48:51], v[92:95], v[100:103], v[48:51]
    v_mfma_f32_16x16x32_bf16 v[52:55], v[92:95], v[104:107], v[52:55]
    buffer_load_dwordx4 v[200:203], v224, s[8:11], s39 offen offset:3072 sc1
    v_mfma_f32_16x16x32_bf16 v[56:59], v[92:95], v[108:111], v[56:59]
    v_mfma_f32_16x16x32_bf16 v[60:63], v[92:95], v[112:115], v[60:63]
    buffer_load_dwordx4 v[220:223], v224, s[12:15], s38 offen offset:3072 sc1
    v_mfma_f32_16x16x32_bf16 v[64:67], v[96:99], v[100:103], v[64:67]
    v_mfma_f32_16x16x32_bf16 v[68:71], v[96:99], v[104:107], v[68:71]
    buffer_load_dwordx4 v[204:207], v225, s[8:11], s39 offen offset:0 sc1
    v_mfma_f32_16x16x32_bf16 v[72:75], v[96:99], v[108:111], v[72:75]
    v_mfma_f32_16x16x32_bf16 v[76:79], v[96:99], v[112:115], v[76:79]
    s_add_u32 s39, s39, 5120
    s_add_u32 s38, s38, 4096
    s_waitcnt vmcnt(18)
    v_mfma_f32_16x16x32_bf16 v[0:3], v[116:119], v[136:139], v[0:3]
    v_mfma_f32_16x16x32_bf16 v[4:7], v[116:119], v[140:143], v[4:7]
    buffer_load_dwordx4 v[80:83], v227, s[20:23], s49 offen offset:0 sc1
    v_mfma_f32_16x16x32_bf16 v[8:11], v[116:119], v[144:147], v[8:11]
    v_mfma_f32_16x16x32_bf16 v[12:15], v[116:119], v[148:151], v[12:15]
    buffer_load_dwordx4 v[84:87], v227, s[20:23], s49 offen offset:64 sc1
    v_mfma_f32_16x16x32_bf16 v[16:19], v[120:123], v[136:139], v[16:19]
    v_mfma_f32_16x16x32_bf16 v[20:23], v[120:123], v[140:143], v[20:23]
    buffer_load_dwordx4 v[88:91], v227, s[20:23], s49 offen offset:128 sc1
    v_mfma_f32_16x16x32_bf16 v[24:27], v[120:123], v[144:147], v[24:27]
    v_mfma_f32_16x16x32_bf16 v[28:31], v[120:123], v[148:151], v[28:31]
    buffer_load_dwordx4 v[92:95], v227, s[20:23], s49 offen offset:192 sc1
    v_mfma_f32_16x16x32_bf16 v[32:35], v[124:127], v[136:139], v[32:35]
    v_mfma_f32_16x16x32_bf16 v[36:39], v[124:127], v[140:143], v[36:39]
    buffer_load_dwordx4 v[96:99], v227, s[20:23], s49 offen offset:256 sc1
    v_mfma_f32_16x16x32_bf16 v[40:43], v[124:127], v[144:147], v[40:43]
    v_mfma_f32_16x16x32_bf16 v[44:47], v[124:127], v[148:151], v[44:47]
    v_mfma_f32_16x16x32_bf16 v[48:51], v[128:131], v[136:139], v[48:51]
    v_mfma_f32_16x16x32_bf16 v[52:55], v[128:131], v[140:143], v[52:55]
    v_mfma_f32_16x16x32_bf16 v[56:59], v[128:131], v[144:147], v[56:59]
    v_mfma_f32_16x16x32_bf16 v[60:63], v[128:131], v[148:151], v[60:63]
    v_mfma_f32_16x16x32_bf16 v[64:67], v[132:135], v[136:139], v[64:67]
    v_mfma_f32_16x16x32_bf16 v[68:71], v[132:135], v[140:143], v[68:71]
    v_mfma_f32_16x16x32_bf16 v[72:75], v[132:135], v[144:147], v[72:75]
    v_mfma_f32_16x16x32_bf16 v[76:79], v[132:135], v[148:151], v[76:79]
    s_waitcnt vmcnt(14)
    v_mfma_f32_16x16x32_bf16 v[0:3], v[152:155], v[172:175], v[0:3]
    v_mfma_f32_16x16x32_bf16 v[4:7], v[152:155], v[176:179], v[4:7]
    v_mfma_f32_16x16x32_bf16 v[8:11], v[152:155], v[180:183], v[8:11]
    v_mfma_f32_16x16x32_bf16 v[12:15], v[152:155], v[184:187], v[12:15]
    v_mfma_f32_16x16x32_bf16 v[16:19], v[156:159], v[172:175], v[16:19]
    v_mfma_f32_16x16x32_bf16 v[20:23], v[156:159], v[176:179], v[20:23]
    v_mfma_f32_16x16x32_bf16 v[24:27], v[156:159], v[180:183], v[24:27]
    v_mfma_f32_16x16x32_bf16 v[28:31], v[156:159], v[184:187], v[28:31]
    v_mfma_f32_16x16x32_bf16 v[32:35], v[160:163], v[172:175], v[32:35]
    v_mfma_f32_16x16x32_bf16 v[36:39], v[160:163], v[176:179], v[36:39]
    v_mfma_f32_16x16x32_bf16 v[40:43], v[160:163], v[180:183], v[40:43]
    v_mfma_f32_16x16x32_bf16 v[44:47], v[160:163], v[184:187], v[44:47]
    v_mfma_f32_16x16x32_bf16 v[48:51], v[164:167], v[172:175], v[48:51]
    v_mfma_f32_16x16x32_bf16 v[52:55], v[164:167], v[176:179], v[52:55]
    v_mfma_f32_16x16x32_bf16 v[56:59], v[164:167], v[180:183], v[56:59]
    v_mfma_f32_16x16x32_bf16 v[60:63], v[164:167], v[184:187], v[60:63]
    v_mfma_f32_16x16x32_bf16 v[64:67], v[168:171], v[172:175], v[64:67]
    v_mfma_f32_16x16x32_bf16 v[68:71], v[168:171], v[176:179], v[68:71]
    v_mfma_f32_16x16x32_bf16 v[72:75], v[168:171], v[180:183], v[72:75]
    v_mfma_f32_16x16x32_bf16 v[76:79], v[168:171], v[184:187], v[76:79]
    s_waitcnt vmcnt(5)
    v_mfma_f32_16x16x32_bf16 v[0:3], v[188:191], v[208:211], v[0:3]
    v_mfma_f32_16x16x32_bf16 v[4:7], v[188:191], v[212:215], v[4:7]
    v_mfma_f32_16x16x32_bf16 v[8:11], v[188:191], v[216:219], v[8:11]
    v_mfma_f32_16x16x32_bf16 v[12:15], v[188:191], v[220:223], v[12:15]
    v_mfma_f32_16x16x32_bf16 v[16:19], v[192:195], v[208:211], v[16:19]
    v_mfma_f32_16x16x32_bf16 v[20:23], v[192:195], v[212:215], v[20:23]
    v_mfma_f32_16x16x32_bf16 v[24:27], v[192:195], v[216:219], v[24:27]
    v_mfma_f32_16x16x32_bf16 v[28:31], v[192:195], v[220:223], v[28:31]
    v_mfma_f32_16x16x32_bf16 v[32:35], v[196:199], v[208:211], v[32:35]
    v_mfma_f32_16x16x32_bf16 v[36:39], v[196:199], v[212:215], v[36:39]
    v_mfma_f32_16x16x32_bf16 v[40:43], v[196:199], v[216:219], v[40:43]
    v_mfma_f32_16x16x32_bf16 v[44:47], v[196:199], v[220:223], v[44:47]
    v_mfma_f32_16x16x32_bf16 v[48:51], v[200:203], v[208:211], v[48:51]
    v_mfma_f32_16x16x32_bf16 v[52:55], v[200:203], v[212:215], v[52:55]
    v_mfma_f32_16x16x32_bf16 v[56:59], v[200:203], v[216:219], v[56:59]
    v_mfma_f32_16x16x32_bf16 v[60:63], v[200:203], v[220:223], v[60:63]
    v_mfma_f32_16x16x32_bf16 v[64:67], v[204:207], v[208:211], v[64:67]
    v_mfma_f32_16x16x32_bf16 v[68:71], v[204:207], v[212:215], v[68:71]
    v_mfma_f32_16x16x32_bf16 v[72:75], v[204:207], v[216:219], v[72:75]
    v_mfma_f32_16x16x32_bf16 v[76:79], v[204:207], v[220:223], v[76:79]
    v_add_u32 v231, 0x0, v224
    s_nop 4
    s_cmp_eq_u32 s28, 0
    s_cbranch_scc0 L_o_w1
    ds_write_b128 v231, v[4:7] offset:25600
    ds_write_b128 v231, v[20:23] offset:26624
    ds_write_b128 v231, v[36:39] offset:27648
    ds_write_b128 v231, v[52:55] offset:28672
    ds_write_b128 v231, v[68:71] offset:29696
    ds_write_b128 v231, v[8:11] offset:35840
    ds_write_b128 v231, v[24:27] offset:36864
    ds_write_b128 v231, v[40:43] offset:37888
    ds_write_b128 v231, v[56:59] offset:38912
    ds_write_b128 v231, v[72:75] offset:39936
    ds_write_b128 v231, v[12:15] offset:46080
    ds_write_b128 v231, v[28:31] offset:47104
    ds_write_b128 v231, v[44:47] offset:48128
    ds_write_b128 v231, v[60:63] offset:49152
    ds_write_b128 v231, v[76:79] offset:50176
    v_mov_b32 v184, v0
    v_mov_b32 v185, v1
    v_mov_b32 v186, v2
    v_mov_b32 v187, v3
    v_mov_b32 v188, v16
    v_mov_b32 v189, v17
    v_mov_b32 v190, v18
    v_mov_b32 v191, v19
    v_mov_b32 v192, v32
    v_mov_b32 v193, v33
    v_mov_b32 v194, v34
    v_mov_b32 v195, v35
    v_mov_b32 v196, v48
    v_mov_b32 v197, v49
    v_mov_b32 v198, v50
    v_mov_b32 v199, v51
    v_mov_b32 v200, v64
    v_mov_b32 v201, v65
    v_mov_b32 v202, v66
    v_mov_b32 v203, v67
    s_branch L_o_wdone
L_o_w1:
    s_cmp_eq_u32 s28, 1
    s_cbranch_scc0 L_o_w2
    ds_write_b128 v231, v[8:11] offset:40960
    ds_write_b128 v231, v[24:27] offset:41984
    ds_write_b128 v231, v[40:43] offset:43008
    ds_write_b128 v231, v[56:59] offset:44032
    ds_write_b128 v231, v[72:75] offset:45056
    ds_write_b128 v231, v[12:15] offset:51200
    ds_write_b128 v231, v[28:31] offset:52224
    ds_write_b128 v231, v[44:47] offset:53248
    ds_write_b128 v231, v[60:63] offset:54272
    ds_write_b128 v231, v[76:79] offset:55296
    ds_write_b128 v231, v[0:3] offset:0
    ds_write_b128 v231, v[16:19] offset:1024
    ds_write_b128 v231, v[32:35] offset:2048
    ds_write_b128 v231, v[48:51] offset:3072
    ds_write_b128 v231, v[64:67] offset:4096
    v_mov_b32 v184, v4
    v_mov_b32 v185, v5
    v_mov_b32 v186, v6
    v_mov_b32 v187, v7
    v_mov_b32 v188, v20
    v_mov_b32 v189, v21
    v_mov_b32 v190, v22
    v_mov_b32 v191, v23
    v_mov_b32 v192, v36
    v_mov_b32 v193, v37
    v_mov_b32 v194, v38
    v_mov_b32 v195, v39
    v_mov_b32 v196, v52
    v_mov_b32 v197, v53
    v_mov_b32 v198, v54
    v_mov_b32 v199, v55
    v_mov_b32 v200, v68
    v_mov_b32 v201, v69
    v_mov_b32 v202, v70
    v_mov_b32 v203, v71
    s_branch L_o_wdone
L_o_w2:
    s_cmp_eq_u32 s28, 2
    s_cbranch_scc0 L_o_w3
    ds_write_b128 v231, v[12:15] offset:56320
    ds_write_b128 v231, v[28:31] offset:57344
    ds_write_b128 v231, v[44:47] offset:58368
    ds_write_b128 v231, v[60:63] offset:59392
    ds_write_b128 v231, v[76:79] offset:60416
    ds_write_b128 v231, v[0:3] offset:5120
    ds_write_b128 v231, v[16:19] offset:6144
    ds_write_b128 v231, v[32:35] offset:7168
    ds_write_b128 v231, v[48:51] offset:8192
    ds_write_b128 v231, v[64:67] offset:9216
    ds_write_b128 v231, v[4:7] offset:15360
    ds_write_b128 v231, v[20:23] offset:16384
    ds_write_b128 v231, v[36:39] offset:17408
    ds_write_b128 v231, v[52:55] offset:18432
    ds_write_b128 v231, v[68:71] offset:19456
    v_mov_b32 v184, v8
    v_mov_b32 v185, v9
    v_mov_b32 v186, v10
    v_mov_b32 v187, v11
    v_mov_b32 v188, v24
    v_mov_b32 v189, v25
    v_mov_b32 v190, v26
    v_mov_b32 v191, v27
    v_mov_b32 v192, v40
    v_mov_b32 v193, v41
    v_mov_b32 v194, v42
    v_mov_b32 v195, v43
    v_mov_b32 v196, v56
    v_mov_b32 v197, v57
    v_mov_b32 v198, v58
    v_mov_b32 v199, v59
    v_mov_b32 v200, v72
    v_mov_b32 v201, v73
    v_mov_b32 v202, v74
    v_mov_b32 v203, v75
    s_branch L_o_wdone
L_o_w3:
    ds_write_b128 v231, v[0:3] offset:10240
    ds_write_b128 v231, v[16:19] offset:11264
    ds_write_b128 v231, v[32:35] offset:12288
    ds_write_b128 v231, v[48:51] offset:13312
    ds_write_b128 v231, v[64:67] offset:14336
    ds_write_b128 v231, v[4:7] offset:20480
    ds_write_b128 v231, v[20:23] offset:21504
    ds_write_b128 v231, v[36:39] offset:22528
    ds_write_b128 v231, v[52:55] offset:23552
    ds_write_b128 v231, v[68:71] offset:24576
    ds_write_b128 v231, v[8:11] offset:30720
    ds_write_b128 v231, v[24:27] offset:31744
    ds_write_b128 v231, v[40:43] offset:32768
    ds_write_b128 v231, v[56:59] offset:33792
    ds_write_b128 v231, v[72:75] offset:34816
    v_mov_b32 v184, v12
    v_mov_b32 v185, v13
    v_mov_b32 v186, v14
    v_mov_b32 v187, v15
    v_mov_b32 v188, v28
    v_mov_b32 v189, v29
    v_mov_b32 v190, v30
    v_mov_b32 v191, v31
    v_mov_b32 v192, v44
    v_mov_b32 v193, v45
    v_mov_b32 v194, v46
    v_mov_b32 v195, v47
    v_mov_b32 v196, v60
    v_mov_b32 v197, v61
    v_mov_b32 v198, v62
    v_mov_b32 v199, v63
    v_mov_b32 v200, v76
    v_mov_b32 v201, v77
    v_mov_b32 v202, v78
    v_mov_b32 v203, v79
L_o_wdone:
    s_waitcnt lgkmcnt(0)
    s_barrier
    s_mul_i32 s46, s28, 15360
    v_add_u32 v228, s46, v231
    ds_read_b128 v[0:3], v228 offset:0
    ds_read_b128 v[4:7], v228 offset:1024
    ds_read_b128 v[8:11], v228 offset:2048
    ds_read_b128 v[12:15], v228 offset:3072
    ds_read_b128 v[16:19], v228 offset:4096
    ds_read_b128 v[20:23], v228 offset:5120
    ds_read_b128 v[24:27], v228 offset:6144
    ds_read_b128 v[28:31], v228 offset:7168
    ds_read_b128 v[32:35], v228 offset:8192
    ds_read_b128 v[36:39], v228 offset:9216
    ds_read_b128 v[40:43], v228 offset:10240
    ds_read_b128 v[44:47], v228 offset:11264
    ds_read_b128 v[48:51], v228 offset:12288
    ds_read_b128 v[52:55], v228 offset:13312
    ds_read_b128 v[56:59], v228 offset:14336
    s_waitcnt lgkmcnt(10)
    v_add_f32 v184, v184, v0
    v_add_f32 v185, v185, v1
    v_add_f32 v186, v186, v2
    v_add_f32 v187, v187, v3
    v_add_f32 v188, v188, v4
    v_add_f32 v189, v189, v5
    v_add_f32 v190, v190, v6
    v_add_f32 v191, v191, v7
    v_add_f32 v192, v192, v8
    v_add_f32 v193, v193, v9
    v_add_f32 v194, v194, v10
    v_add_f32 v195, v195, v11
    v_add_f32 v196, v196, v12
    v_add_f32 v197, v197, v13
    v_add_f32 v198, v198, v14
    v_add_f32 v199, v199, v15
    v_add_f32 v200, v200, v16
    v_add_f32 v201, v201, v17
    v_add_f32 v202, v202, v18
    v_add_f32 v203, v203, v19
    s_waitcnt lgkmcnt(5)
    v_add_f32 v184, v184, v20
    v_add_f32 v185, v185, v21
    v_add_f32 v186, v186, v22
    v_add_f32 v187, v187, v23
    v_add_f32 v188, v188, v24
    v_add_f32 v189, v189, v25
    v_add_f32 v190, v190, v26
    v_add_f32 v191, v191, v27
    v_add_f32 v192, v192, v28
    v_add_f32 v193, v193, v29
    v_add_f32 v194, v194, v30
    v_add_f32 v195, v195, v31
    v_add_f32 v196, v196, v32
    v_add_f32 v197, v197, v33
    v_add_f32 v198, v198, v34
    v_add_f32 v199, v199, v35
    v_add_f32 v200, v200, v36
    v_add_f32 v201, v201, v37
    v_add_f32 v202, v202, v38
    v_add_f32 v203, v203, v39
    s_waitcnt lgkmcnt(0)
    v_add_f32 v184, v184, v40
    v_add_f32 v185, v185, v41
    v_add_f32 v186, v186, v42
    v_add_f32 v187, v187, v43
    v_add_f32 v188, v188, v44
    v_add_f32 v189, v189, v45
    v_add_f32 v190, v190, v46
    v_add_f32 v191, v191, v47
    v_add_f32 v192, v192, v48
    v_add_f32 v193, v193, v49
    v_add_f32 v194, v194, v50
    v_add_f32 v195, v195, v51
    v_add_f32 v196, v196, v52
    v_add_f32 v197, v197, v53
    v_add_f32 v198, v198, v54
    v_add_f32 v199, v199, v55
    v_add_f32 v200, v200, v56
    v_add_f32 v201, v201, v57
    v_add_f32 v202, v202, v58
    v_add_f32 v203, v203, v59
    s_waitcnt vmcnt(0)
    s_mov_b32 s39, 0xffff0000
    v_lshlrev_b32 v60, 16, v232
    v_and_b32 v61, s39, v232
    v_lshlrev_b32 v62, 16, v233
    v_and_b32 v63, s39, v233
    v_lshlrev_b32 v64, 16, v234
    v_and_b32 v65, s39, v234
    v_lshlrev_b32 v66, 16, v235
    v_and_b32 v67, s39, v235
    v_lshlrev_b32 v68, 16, v236
    v_and_b32 v69, s39, v236
    v_lshlrev_b32 v70, 16, v237
    v_and_b32 v71, s39, v237
    v_lshlrev_b32 v72, 16, v238
    v_and_b32 v73, s39, v238
    v_lshlrev_b32 v74, 16, v239
    v_and_b32 v75, s39, v239
    v_lshlrev_b32 v76, 16, v240
    v_and_b32 v77, s39, v240
    v_lshlrev_b32 v78, 16, v241
    v_and_b32 v79, s39, v241
    v_fma_f32 v184, v184, v80, v60
    v_fma_f32 v185, v185, v81, v61
    v_fma_f32 v186, v186, v82, v62
    v_fma_f32 v187, v187, v83, v63
    v_fma_f32 v188, v188, v84, v64
    v_fma_f32 v189, v189, v85, v65
    v_fma_f32 v190, v190, v86, v66
    v_fma_f32 v191, v191, v87, v67
    v_fma_f32 v192, v192, v88, v68
    v_fma_f32 v193, v193, v89, v69
    v_fma_f32 v194, v194, v90, v70
    v_fma_f32 v195, v195, v91, v71
    v_fma_f32 v196, v196, v92, v72
    v_fma_f32 v197, v197, v93, v73
    v_fma_f32 v198, v198, v94, v74
    v_fma_f32 v199, v199, v95, v75
    v_fma_f32 v200, v200, v96, v76
    v_fma_f32 v201, v201, v97, v77
    v_fma_f32 v202, v202, v98, v78
    v_fma_f32 v203, v203, v99, v79
    v_cvt_pk_bf16_f32 v0, v184, v185
    v_cvt_pk_bf16_f32 v1, v186, v187
    v_cvt_pk_bf16_f32 v2, v188, v189
    v_cvt_pk_bf16_f32 v3, v190, v191
    v_cvt_pk_bf16_f32 v4, v192, v193
    v_cvt_pk_bf16_f32 v5, v194, v195
    v_cvt_pk_bf16_f32 v6, v196, v197
    v_cvt_pk_bf16_f32 v7, v198, v199
    v_cvt_pk_bf16_f32 v8, v200, v201
    v_cvt_pk_bf16_f32 v9, v202, v203
    s_bitcmp1_b32 s35, 0
    s_cbranch_scc1 L_o_odd
    buffer_store_dwordx4 v[0:3], v224, s[24:27], s50 offen sc1
    buffer_store_dwordx4 v[4:7], v224, s[24:27], s52 offen sc1
    buffer_store_dwordx2 v[8:9], v224, s[24:27], s54 offen sc1
    s_branch L_o_stored
L_o_odd:
    buffer_store_dwordx2 v[0:1], v224, s[24:27], s50 offen sc1
    buffer_store_dwordx4 v[2:5], v224, s[24:27], s51 offen sc1
    buffer_store_dwordx4 v[6:9], v224, s[24:27], s53 offen sc1
L_o_stored:
    v_accvgpr_write_b32 a240, v0
    v_accvgpr_write_b32 a241, v1
    v_accvgpr_write_b32 a242, v2
    v_accvgpr_write_b32 a243, v3
    v_accvgpr_write_b32 a244, v4
    v_accvgpr_write_b32 a245, v5
    v_accvgpr_write_b32 a246, v6
    v_accvgpr_write_b32 a247, v7
    v_accvgpr_write_b32 a248, v8
    v_accvgpr_write_b32 a249, v9
    v_lshlrev_b32 v60, 16, v0
    v_and_b32 v61, s39, v0
    v_lshlrev_b32 v62, 16, v1
    v_and_b32 v63, s39, v1
    v_lshlrev_b32 v64, 16, v2
    v_and_b32 v65, s39, v2
    v_lshlrev_b32 v66, 16, v3
    v_and_b32 v67, s39, v3
    v_lshlrev_b32 v68, 16, v4
    v_and_b32 v69, s39, v4
    v_lshlrev_b32 v70, 16, v5
    v_and_b32 v71, s39, v5
    v_lshlrev_b32 v72, 16, v6
    v_and_b32 v73, s39, v6
    v_lshlrev_b32 v74, 16, v7
    v_and_b32 v75, s39, v7
    v_lshlrev_b32 v76, 16, v8
    v_and_b32 v77, s39, v8
    v_lshlrev_b32 v78, 16, v9
    v_and_b32 v79, s39, v9
    v_add_f32 v20, v60, v61
    v_mul_f32 v21, v60, v60
    v_fmac_f32 v21, v61, v61
    v_add_f32 v20, v20, v62
    v_fmac_f32 v21, v62, v62
    v_add_f32 v20, v20, v63
    v_fmac_f32 v21, v63, v63
    v_add_f32 v20, v20, v64
    v_fmac_f32 v21, v64, v64
    v_add_f32 v20, v20, v65
    v_fmac_f32 v21, v65, v65
    v_add_f32 v20, v20, v66
    v_fmac_f32 v21, v66, v66
    v_add_f32 v20, v20, v67
    v_fmac_f32 v21, v67, v67
    v_add_f32 v20, v20, v68
    v_fmac_f32 v21, v68, v68
    v_add_f32 v20, v20, v69
    v_fmac_f32 v21, v69, v69
    v_add_f32 v20, v20, v70
    v_fmac_f32 v21, v70, v70
    v_add_f32 v20, v20, v71
    v_fmac_f32 v21, v71, v71
    v_add_f32 v20, v20, v72
    v_fmac_f32 v21, v72, v72
    v_add_f32 v20, v20, v73
    v_fmac_f32 v21, v73, v73
    v_add_f32 v20, v20, v74
    v_fmac_f32 v21, v74, v74
    v_add_f32 v20, v20, v75
    v_fmac_f32 v21, v75, v75
    v_add_f32 v20, v20, v76
    v_fmac_f32 v21, v76, v76
    v_add_f32 v20, v20, v77
    v_fmac_f32 v21, v77, v77
    v_add_f32 v20, v20, v78
    v_fmac_f32 v21, v78, v78
    v_add_f32 v20, v20, v79
    v_fmac_f32 v21, v79, v79
    v_mov_b32 v22, v20
    s_nop 1
    v_permlane16_swap_b32 v20, v22
    v_add_f32 v20, v20, v22
    v_mov_b32 v22, v20
    s_nop 1
    v_permlane32_swap_b32 v20, v22
    v_add_f32 v20, v20, v22
    v_mov_b32 v22, v21
    s_nop 1
    v_permlane16_swap_b32 v21, v22
    v_add_f32 v21, v21, v22
    v_mov_b32 v22, v21
    s_nop 1
    v_permlane32_swap_b32 v21, v22
    v_add_f32 v21, v21, v22
    v_lshlrev_b32 v23, 3, v230
    s_lshl_b32 s38, s29, 9
    s_lshl_b32 s46, s35, 14
    s_add_u32 s38, s38, s46
    v_cmp_gt_u32 vcc, 0x100, v224
    s_nop 1
    s_and_saveexec_b64 s[56:57], vcc
    buffer_store_dwordx2 v[20:21], v23, s[40:43], s38 offen sc1
    s_mov_b64 exec, -1
    s_lshr_b32 s59, s29, 1
    s_lshl_b32 s59, s59, 7
    s_add_u32 s59, s59, 1024
    s_waitcnt vmcnt(0)
    s_barrier
    s_cmp_lg_u32 s28, 0
    s_cbranch_scc1 L_arr_B
    s_add_u32 s56, s88, 0x60000
    s_addc_u32 s57, s89, 0
    v_mov_b32 v248, s59
    v_mov_b32 v249, 1
    s_mov_b64 exec, 1
    global_atomic_add v248, v249, s[56:57] sc1
    s_mov_b64 exec, -1
L_arr_B:
    s_mov_b64 s[4:5], s[88:89]
    v_mbcnt_lo_u32_b32 v221, -1, 0
    v_mbcnt_hi_u32_b32 v221, -1, v221
    s_and_b32 s30, s2, 7
    s_lshr_b32 s31, s2, 3
    s_lshr_b32 s32, s30, 1
    s_lshl_b32 s32, s32, 2
    s_and_b32 s33, s31, 3
    s_add_u32 s29, s32, s33
    s_and_b32 s32, s30, 1
    s_lshl_b32 s32, s32, 3
    s_lshr_b32 s33, s31, 2
    s_add_u32 s32, s32, s33
    s_mul_i32 s35, s32, 7
    s_mov_b32 s47, s32
    v_lshlrev_b32 v216, 4, v221
    v_mov_b32 v217, v216
    v_add_u32 v218, 0xf000, v216
    v_add_u32 v219, 0x1e000, v216
    v_lshrrev_b32 v222, 4, v221
    v_lshlrev_b32 v220, 4, v222
    s_mul_i32 s46, s35, 20480
    s_add_u32 s37, s46, 0x2900000
    s_lshl_b32 s38, s29, 3
    s_lshl_b32 s39, s28, 1
    s_add_u32 s38, s38, s39
    s_mul_i32 s38, s38, 20480
    s_add_u32 s38, s38, 0x1400000
    s_lshl_b32 s36, s28, 10
    s_add_u32 s44, s4, s37
    s_addc_u32 s45, s5, 0
    s_mov_b32 s8, s44
    s_and_b32 s9, s45, 0xffff
    s_mov_b32 s10, 0x0
    s_mov_b32 s11, 0x20000
    s_sub_u32 s10, 0x21c000, s46
    s_add_u32 s44, s4, s38
    s_addc_u32 s45, s5, 0
    s_mov_b32 s12, s44
    s_and_b32 s13, s45, 0xffff
    s_mov_b32 s14, 0xa000
    s_mov_b32 s15, 0x20000
    s_add_u32 m0, s36, 0
    s_add_u32 s41, s36, 0
    buffer_load_dwordx4 v216, s[8:11], s41 offen sc1 lds
    s_add_u32 m0, s36, 20480
    s_add_u32 s41, s36, 20480
    buffer_load_dwordx4 v216, s[8:11], s41 offen sc1 lds
    s_add_u32 m0, s36, 40960
    s_add_u32 s41, s36, 40960
    buffer_load_dwordx4 v216, s[8:11], s41 offen sc1 lds
    s_add_u32 m0, s36, 61440
    s_add_u32 s41, s36, 61440
    buffer_load_dwordx4 v216, s[8:11], s41 offen sc1 lds
    s_add_u32 m0, s36, 81920
    s_add_u32 s41, s36, 81920
    buffer_load_dwordx4 v216, s[8:11], s41 offen sc1 lds
    s_add_u32 m0, s36, 102400
    s_add_u32 s41, s36, 102400
    buffer_load_dwordx4 v216, s[8:11], s41 offen sc1 lds
    s_add_u32 m0, s36, 122880
    s_add_u32 s41, s36, 122880
    buffer_load_dwordx4 v216, s[8:11], s41 offen sc1 lds
    s_add_u32 m0, s36, 4096
    s_add_u32 s41, s36, 4096
    buffer_load_dwordx4 v216, s[8:11], s41 offen sc1 lds
    s_add_u32 m0, s36, 24576
    s_add_u32 s41, s36, 24576
    buffer_load_dwordx4 v216, s[8:11], s41 offen sc1 lds
    s_add_u32 m0, s36, 45056
    s_add_u32 s41, s36, 45056
    buffer_load_dwordx4 v216, s[8:11], s41 offen sc1 lds
    s_add_u32 m0, s36, 65536
    s_add_u32 s41, s36, 65536
    buffer_load_dwordx4 v216, s[8:11], s41 offen sc1 lds
    s_add_u32 m0, s36, 86016
    s_add_u32 s41, s36, 86016
    buffer_load_dwordx4 v216, s[8:11], s41 offen sc1 lds
    s_add_u32 m0, s36, 106496
    s_add_u32 s41, s36, 106496
    buffer_load_dwordx4 v216, s[8:11], s41 offen sc1 lds
    s_add_u32 m0, s36, 126976
    s_add_u32 s41, s36, 126976
    buffer_load_dwordx4 v216, s[8:11], s41 offen sc1 lds
    s_add_u32 m0, s36, 8192
    s_add_u32 s41, s36, 8192
    buffer_load_dwordx4 v216, s[8:11], s41 offen sc1 lds
    s_add_u32 m0, s36, 28672
    s_add_u32 s41, s36, 28672
    buffer_load_dwordx4 v216, s[8:11], s41 offen sc1 lds
    s_add_u32 m0, s36, 49152
    s_add_u32 s41, s36, 49152
    buffer_load_dwordx4 v216, s[8:11], s41 offen sc1 lds
    s_add_u32 m0, s36, 69632
    s_add_u32 s41, s36, 69632
    buffer_load_dwordx4 v216, s[8:11], s41 offen sc1 lds
    s_add_u32 m0, s36, 90112
    s_add_u32 s41, s36, 90112
    buffer_load_dwordx4 v216, s[8:11], s41 offen sc1 lds
    s_add_u32 m0, s36, 110592
    s_add_u32 s41, s36, 110592
    buffer_load_dwordx4 v216, s[8:11], s41 offen sc1 lds
    s_add_u32 m0, s36, 131072
    s_add_u32 s41, s36, 131072
    buffer_load_dwordx4 v216, s[8:11], s41 offen sc1 lds
    s_add_u32 s16, s4, 0x40000
    s_addc_u32 s17, s5, 0
    s_and_b32 s17, s17, 0xffff
    s_mov_b32 s18, 0x14000
    s_mov_b32 s19, 0x20000
    s_add_u32 s20, s4, 0x8000
    s_addc_u32 s21, s5, 0
    s_and_b32 s21, s21, 0xffff
    s_mov_b32 s22, 0x20000
    s_mov_b32 s23, 0x20000
    s_lshl_b32 s38, s29, 1
    s_lshr_b32 s39, s28, 1
    s_add_u32 s38, s38, s39
    s_mul_i32 s38, s38, 221184
    s_add_u32 s38, s38, 0x1800000
    s_add_u32 s44, s4, s38
    s_addc_u32 s45, s5, 0
    s_mov_b32 s24, s44
    s_and_b32 s25, s45, 0xffff
    s_mov_b32 s26, 0x36000
    s_mov_b32 s27, 0x20000
    v_and_b32 v223, 15, v221
    s_lshl_b32 s38, s29, 7
    s_lshl_b32 s39, s28, 5
    s_add_u32 s38, s38, s39
    v_add_u32 v223, s38, v223
    v_lshlrev_b32 v223, 3, v223
    v_lshl_add_u32 v223, v220, 11, v223
    s_lshl_b32 s50, s35, 6
    v_min_u32 v232, 55, v221
    v_cmp_lt_u32 vcc, 27, v232
    v_lshlrev_b32 v232, 4, v232
    v_add_u32 v233, 0x9e40, v232
    v_cndmask_b32 v232, v232, v233, vcc
    s_lshl_b32 s51, s28, 10
    s_add_u32 s51, s51, 0x23000
    v_add_u32 v233, s51, v216
    v_add_u32 v234, s51, v220
    s_waitcnt vmcnt(0)
    s_lshl_b32 s59, s29, 7
    s_cmp_lg_u32 s28, 0
    s_cbranch_scc1 L_wt_B_done
    s_add_u32 s56, s88, 0x60400
    s_addc_u32 s57, s89, 0
    v_mbcnt_lo_u32_b32 v248, -1, 0
    v_mbcnt_hi_u32_b32 v248, -1, v248
    v_min_u32 v248, 0, v248
    v_lshlrev_b32 v248, 7, v248
    v_add_u32 v248, s59, v248
    s_mov_b32 s58, 60000
    global_load_dword v249, v248, s[56:57] sc1
L_wt_B_loop:
    global_load_dword v251, v248, s[56:57] sc1
    s_waitcnt vmcnt(1)
    v_cmp_gt_u32 vcc, 16, v249
    s_sub_u32 s58, s58, 1
    s_cmp_eq_u32 s58, 0
    s_cbranch_scc1 L_wt_B_done
    s_cmp_eq_u64 vcc, 0
    s_cbranch_scc1 L_wt_B_done
    s_sleep 2
    global_load_dword v249, v248, s[56:57] sc1
    s_waitcnt vmcnt(1)
    v_cmp_gt_u32 vcc, 16, v251
    s_sub_u32 s58, s58, 1
    s_cmp_eq_u32 s58, 0
    s_cbranch_scc1 L_wt_B_done
    s_cmp_eq_u64 vcc, 0
    s_cbranch_scc1 L_wt_B_done
    s_sleep 2
    s_branch L_wt_B_loop
L_wt_B_done:
    s_barrier
    s_mov_b32 s42, 0
    buffer_load_dwordx4 v[0:3], v216, s[12:15], s42 offen offset:0 sc1
    s_mov_b32 s43, 20480
    buffer_load_dwordx4 v[4:7], v216, s[12:15], s43 offen offset:0 sc1
    buffer_load_dwordx4 v[8:11], v216, s[12:15], s42 offen offset:1024 sc1
    buffer_load_dwordx4 v[12:15], v216, s[12:15], s43 offen offset:1024 sc1
    buffer_load_dwordx4 v[16:19], v216, s[12:15], s42 offen offset:2048 sc1
    buffer_load_dwordx4 v[20:23], v216, s[12:15], s43 offen offset:2048 sc1
    buffer_load_dwordx4 v[24:27], v216, s[12:15], s42 offen offset:3072 sc1
    buffer_load_dwordx4 v[28:31], v216, s[12:15], s43 offen offset:3072 sc1
    s_mov_b32 s42, 4096
    buffer_load_dwordx4 v[32:35], v216, s[12:15], s42 offen offset:0 sc1
    s_mov_b32 s43, 24576
    buffer_load_dwordx4 v[36:39], v216, s[12:15], s43 offen offset:0 sc1
    buffer_load_dwordx4 v[40:43], v216, s[12:15], s42 offen offset:1024 sc1
    buffer_load_dwordx4 v[44:47], v216, s[12:15], s43 offen offset:1024 sc1
    buffer_load_dwordx4 v[48:51], v216, s[12:15], s42 offen offset:2048 sc1
    buffer_load_dwordx4 v[52:55], v216, s[12:15], s43 offen offset:2048 sc1
    buffer_load_dwordx4 v[56:59], v216, s[12:15], s42 offen offset:3072 sc1
    buffer_load_dwordx4 v[60:63], v216, s[12:15], s43 offen offset:3072 sc1
    ds_read_b128 a[0:3], v217 offset:0
    ds_read_b128 a[4:7], v217 offset:20480
    ds_read_b128 a[8:11], v217 offset:40960
    ds_read_b128 a[12:15], v218 offset:0
    ds_read_b128 a[16:19], v218 offset:20480
    ds_read_b128 a[20:23], v218 offset:40960
    ds_read_b128 a[24:27], v219 offset:0
    s_waitcnt vmcnt(14) lgkmcnt(0)
    v_mfma_f32_16x16x32_bf16 v[160:163], a[0:3], v[0:3], 0
    ds_read_b128 a[28:31], v217 offset:1024
    v_mfma_f32_16x16x32_bf16 v[164:167], a[0:3], v[4:7], 0
    ds_read_b128 a[32:35], v217 offset:21504
    v_mfma_f32_16x16x32_bf16 v[168:171], a[4:7], v[0:3], 0
    ds_read_b128 a[36:39], v217 offset:41984
    v_mfma_f32_16x16x32_bf16 v[172:175], a[4:7], v[4:7], 0
    ds_read_b128 a[40:43], v218 offset:1024
    v_mfma_f32_16x16x32_bf16 v[176:179], a[8:11], v[0:3], 0
    ds_read_b128 a[44:47], v218 offset:21504
    v_mfma_f32_16x16x32_bf16 v[180:183], a[8:11], v[4:7], 0
    ds_read_b128 a[48:51], v218 offset:41984
    v_mfma_f32_16x16x32_bf16 v[184:187], a[12:15], v[0:3], 0
    ds_read_b128 a[52:55], v219 offset:1024
    s_mov_b32 s42, 8192
    buffer_load_dwordx4 v[64:67], v216, s[12:15], s42 offen offset:0 sc1
    v_mfma_f32_16x16x32_bf16 v[188:191], a[12:15], v[4:7], 0
    v_mfma_f32_16x16x32_bf16 v[192:195], a[16:19], v[0:3], 0
    s_mov_b32 s43, 28672
    buffer_load_dwordx4 v[68:71], v216, s[12:15], s43 offen offset:0 sc1
    v_mfma_f32_16x16x32_bf16 v[196:199], a[16:19], v[4:7], 0
    v_mfma_f32_16x16x32_bf16 v[200:203], a[20:23], v[0:3], 0
    v_mfma_f32_16x16x32_bf16 v[204:207], a[20:23], v[4:7], 0
    v_mfma_f32_16x16x32_bf16 v[208:211], a[24:27], v[0:3], 0
    v_mfma_f32_16x16x32_bf16 v[212:215], a[24:27], v[4:7], 0
    s_waitcnt vmcnt(14) lgkmcnt(0)
    v_mfma_f32_16x16x32_bf16 v[160:163], a[28:31], v[8:11], v[160:163]
    ds_read_b128 a[0:3], v217 offset:2048
    v_mfma_f32_16x16x32_bf16 v[164:167], a[28:31], v[12:15], v[164:167]
    ds_read_b128 a[4:7], v217 offset:22528
    v_mfma_f32_16x16x32_bf16 v[168:171], a[32:35], v[8:11], v[168:171]
    ds_read_b128 a[8:11], v217 offset:43008
    v_mfma_f32_16x16x32_bf16 v[172:175], a[32:35], v[12:15], v[172:175]
    ds_read_b128 a[12:15], v218 offset:2048
    v_mfma_f32_16x16x32_bf16 v[176:179], a[36:39], v[8:11], v[176:179]
    ds_read_b128 a[16:19], v218 offset:22528
    v_mfma_f32_16x16x32_bf16 v[180:183], a[36:39], v[12:15], v[180:183]
    ds_read_b128 a[20:23], v218 offset:43008
    v_mfma_f32_16x16x32_bf16 v[184:187], a[40:43], v[8:11], v[184:187]
    ds_read_b128 a[24:27], v219 offset:2048
    buffer_load_dwordx4 v[72:75], v216, s[12:15], s42 offen offset:1024 sc1
    v_mfma_f32_16x16x32_bf16 v[188:191], a[40:43], v[12:15], v[188:191]
    v_mfma_f32_16x16x32_bf16 v[192:195], a[44:47], v[8:11], v[192:195]
    buffer_load_dwordx4 v[76:79], v216, s[12:15], s43 offen offset:1024 sc1
    v_mfma_f32_16x16x32_bf16 v[196:199], a[44:47], v[12:15], v[196:199]
    v_mfma_f32_16x16x32_bf16 v[200:203], a[48:51], v[8:11], v[200:203]
    v_mfma_f32_16x16x32_bf16 v[204:207], a[48:51], v[12:15], v[204:207]
    v_mfma_f32_16x16x32_bf16 v[208:211], a[52:55], v[8:11], v[208:211]
    v_mfma_f32_16x16x32_bf16 v[212:215], a[52:55], v[12:15], v[212:215]
    s_waitcnt vmcnt(14) lgkmcnt(0)
    v_mfma_f32_16x16x32_bf16 v[160:163], a[0:3], v[16:19], v[160:163]
    ds_read_b128 a[28:31], v217 offset:3072
    v_mfma_f32_16x16x32_bf16 v[164:167], a[0:3], v[20:23], v[164:167]
    ds_read_b128 a[32:35], v217 offset:23552
    v_mfma_f32_16x16x32_bf16 v[168:171], a[4:7], v[16:19], v[168:171]
    ds_read_b128 a[36:39], v217 offset:44032
    v_mfma_f32_16x16x32_bf16 v[172:175], a[4:7], v[20:23], v[172:175]
    ds_read_b128 a[40:43], v218 offset:3072
    v_mfma_f32_16x16x32_bf16 v[176:179], a[8:11], v[16:19], v[176:179]
    ds_read_b128 a[44:47], v218 offset:23552
    v_mfma_f32_16x16x32_bf16 v[180:183], a[8:11], v[20:23], v[180:183]
    ds_read_b128 a[48:51], v218 offset:44032
    v_mfma_f32_16x16x32_bf16 v[184:187], a[12:15], v[16:19], v[184:187]
    ds_read_b128 a[52:55], v219 offset:3072
    buffer_load_dwordx4 v[80:83], v216, s[12:15], s42 offen offset:2048 sc1
    v_mfma_f32_16x16x32_bf16 v[188:191], a[12:15], v[20:23], v[188:191]
    v_mfma_f32_16x16x32_bf16 v[192:195], a[16:19], v[16:19], v[192:195]
    buffer_load_dwordx4 v[84:87], v216, s[12:15], s43 offen offset:2048 sc1
    v_mfma_f32_16x16x32_bf16 v[196:199], a[16:19], v[20:23], v[196:199]
    v_mfma_f32_16x16x32_bf16 v[200:203], a[20:23], v[16:19], v[200:203]
    v_mfma_f32_16x16x32_bf16 v[204:207], a[20:23], v[20:23], v[204:207]
    v_mfma_f32_16x16x32_bf16 v[208:211], a[24:27], v[16:19], v[208:211]
    v_mfma_f32_16x16x32_bf16 v[212:215], a[24:27], v[20:23], v[212:215]
    s_waitcnt vmcnt(14) lgkmcnt(0)
    v_mfma_f32_16x16x32_bf16 v[160:163], a[28:31], v[24:27], v[160:163]
    ds_read_b128 a[0:3], v217 offset:4096
    v_mfma_f32_16x16x32_bf16 v[164:167], a[28:31], v[28:31], v[164:167]
    ds_read_b128 a[4:7], v217 offset:24576
    v_mfma_f32_16x16x32_bf16 v[168:171], a[32:35], v[24:27], v[168:171]
    ds_read_b128 a[8:11], v217 offset:45056
    v_mfma_f32_16x16x32_bf16 v[172:175], a[32:35], v[28:31], v[172:175]
    ds_read_b128 a[12:15], v218 offset:4096
    v_mfma_f32_16x16x32_bf16 v[176:179], a[36:39], v[24:27], v[176:179]
    ds_read_b128 a[16:19], v218 offset:24576
    v_mfma_f32_16x16x32_bf16 v[180:183], a[36:39], v[28:31], v[180:183]
    ds_read_b128 a[20:23], v218 offset:45056
    v_mfma_f32_16x16x32_bf16 v[184:187], a[40:43], v[24:27], v[184:187]
    ds_read_b128 a[24:27], v219 offset:4096
    buffer_load_dwordx4 v[88:91], v216, s[12:15], s42 offen offset:3072 sc1
    v_mfma_f32_16x16x32_bf16 v[188:191], a[40:43], v[28:31], v[188:191]
    v_mfma_f32_16x16x32_bf16 v[192:195], a[44:47], v[24:27], v[192:195]
    buffer_load_dwordx4 v[92:95], v216, s[12:15], s43 offen offset:3072 sc1
    v_mfma_f32_16x16x32_bf16 v[196:199], a[44:47], v[28:31], v[196:199]
    v_mfma_f32_16x16x32_bf16 v[200:203], a[48:51], v[24:27], v[200:203]
    v_mfma_f32_16x16x32_bf16 v[204:207], a[48:51], v[28:31], v[204:207]
    v_mfma_f32_16x16x32_bf16 v[208:211], a[52:55], v[24:27], v[208:211]
    v_mfma_f32_16x16x32_bf16 v[212:215], a[52:55], v[28:31], v[212:215]
    s_waitcnt vmcnt(14) lgkmcnt(0)
    v_mfma_f32_16x16x32_bf16 v[160:163], a[0:3], v[32:35], v[160:163]
    ds_read_b128 a[28:31], v217 offset:5120
    v_mfma_f32_16x16x32_bf16 v[164:167], a[0:3], v[36:39], v[164:167]
    ds_read_b128 a[32:35], v217 offset:25600
    v_mfma_f32_16x16x32_bf16 v[168:171], a[4:7], v[32:35], v[168:171]
    ds_read_b128 a[36:39], v217 offset:46080
    v_mfma_f32_16x16x32_bf16 v[172:175], a[4:7], v[36:39], v[172:175]
    ds_read_b128 a[40:43], v218 offset:5120
    v_mfma_f32_16x16x32_bf16 v[176:179], a[8:11], v[32:35], v[176:179]
    ds_read_b128 a[44:47], v218 offset:25600
    v_mfma_f32_16x16x32_bf16 v[180:183], a[8:11], v[36:39], v[180:183]
    ds_read_b128 a[48:51], v218 offset:46080
    v_mfma_f32_16x16x32_bf16 v[184:187], a[12:15], v[32:35], v[184:187]
    ds_read_b128 a[52:55], v219 offset:5120
    s_add_u32 m0, s36, 12288
    s_add_u32 s41, s36, 12288
    buffer_load_dwordx4 v216, s[8:11], s41 offen sc1 lds
    v_mfma_f32_16x16x32_bf16 v[188:191], a[12:15], v[36:39], v[188:191]
    v_mfma_f32_16x16x32_bf16 v[192:195], a[16:19], v[32:35], v[192:195]
    s_mov_b32 s42, 12288
    buffer_load_dwordx4 v[96:99], v216, s[12:15], s42 offen offset:0 sc1
    v_mfma_f32_16x16x32_bf16 v[196:199], a[16:19], v[36:39], v[196:199]
    v_mfma_f32_16x16x32_bf16 v[200:203], a[20:23], v[32:35], v[200:203]
    s_mov_b32 s43, 32768
    buffer_load_dwordx4 v[100:103], v216, s[12:15], s43 offen offset:0 sc1
    v_mfma_f32_16x16x32_bf16 v[204:207], a[20:23], v[36:39], v[204:207]
    v_mfma_f32_16x16x32_bf16 v[208:211], a[24:27], v[32:35], v[208:211]
    s_add_u32 m0, s36, 32768
    s_add_u32 s41, s36, 32768
    buffer_load_dwordx4 v216, s[8:11], s41 offen sc1 lds
    v_mfma_f32_16x16x32_bf16 v[212:215], a[24:27], v[36:39], v[212:215]
    s_waitcnt vmcnt(16) lgkmcnt(0)
    v_mfma_f32_16x16x32_bf16 v[160:163], a[28:31], v[40:43], v[160:163]
    ds_read_b128 a[0:3], v217 offset:6144
    v_mfma_f32_16x16x32_bf16 v[164:167], a[28:31], v[44:47], v[164:167]
    ds_read_b128 a[4:7], v217 offset:26624
    v_mfma_f32_16x16x32_bf16 v[168:171], a[32:35], v[40:43], v[168:171]
    ds_read_b128 a[8:11], v217 offset:47104
    v_mfma_f32_16x16x32_bf16 v[172:175], a[32:35], v[44:47], v[172:175]
    ds_read_b128 a[12:15], v218 offset:6144
    v_mfma_f32_16x16x32_bf16 v[176:179], a[36:39], v[40:43], v[176:179]
    ds_read_b128 a[16:19], v218 offset:26624
    v_mfma_f32_16x16x32_bf16 v[180:183], a[36:39], v[44:47], v[180:183]
    ds_read_b128 a[20:23], v218 offset:47104
    v_mfma_f32_16x16x32_bf16 v[184:187], a[40:43], v[40:43], v[184:187]
    ds_read_b128 a[24:27], v219 offset:6144
    s_add_u32 m0, s36, 53248
    s_add_u32 s41, s36, 53248
    buffer_load_dwordx4 v216, s[8:11], s41 offen sc1 lds
    v_mfma_f32_16x16x32_bf16 v[188:191], a[40:43], v[44:47], v[188:191]
    v_mfma_f32_16x16x32_bf16 v[192:195], a[44:47], v[40:43], v[192:195]
    buffer_load_dwordx4 v[104:107], v216, s[12:15], s42 offen offset:1024 sc1
    v_mfma_f32_16x16x32_bf16 v[196:199], a[44:47], v[44:47], v[196:199]
    v_mfma_f32_16x16x32_bf16 v[200:203], a[48:51], v[40:43], v[200:203]
    buffer_load_dwordx4 v[108:111], v216, s[12:15], s43 offen offset:1024 sc1
    v_mfma_f32_16x16x32_bf16 v[204:207], a[48:51], v[44:47], v[204:207]
    v_mfma_f32_16x16x32_bf16 v[208:211], a[52:55], v[40:43], v[208:211]
    s_add_u32 m0, s36, 73728
    s_add_u32 s41, s36, 73728
    buffer_load_dwordx4 v216, s[8:11], s41 offen sc1 lds
    v_mfma_f32_16x16x32_bf16 v[212:215], a[52:55], v[44:47], v[212:215]
    s_waitcnt vmcnt(18) lgkmcnt(0)
    v_mfma_f32_16x16x32_bf16 v[160:163], a[0:3], v[48:51], v[160:163]
    ds_read_b128 a[28:31], v217 offset:7168
    v_mfma_f32_16x16x32_bf16 v[164:167], a[0:3], v[52:55], v[164:167]
    ds_read_b128 a[32:35], v217 offset:27648
    v_mfma_f32_16x16x32_bf16 v[168:171], a[4:7], v[48:51], v[168:171]
    ds_read_b128 a[36:39], v217 offset:48128
    v_mfma_f32_16x16x32_bf16 v[172:175], a[4:7], v[52:55], v[172:175]
    ds_read_b128 a[40:43], v218 offset:7168
    v_mfma_f32_16x16x32_bf16 v[176:179], a[8:11], v[48:51], v[176:179]
    ds_read_b128 a[44:47], v218 offset:27648
    v_mfma_f32_16x16x32_bf16 v[180:183], a[8:11], v[52:55], v[180:183]
    ds_read_b128 a[48:51], v218 offset:48128
    v_mfma_f32_16x16x32_bf16 v[184:187], a[12:15], v[48:51], v[184:187]
    ds_read_b128 a[52:55], v219 offset:7168
    s_add_u32 m0, s36, 94208
    s_add_u32 s41, s36, 94208
    buffer_load_dwordx4 v216, s[8:11], s41 offen sc1 lds
    v_mfma_f32_16x16x32_bf16 v[188:191], a[12:15], v[52:55], v[188:191]
    v_mfma_f32_16x16x32_bf16 v[192:195], a[16:19], v[48:51], v[192:195]
    buffer_load_dwordx4 v[112:115], v216, s[12:15], s42 offen offset:2048 sc1
    v_mfma_f32_16x16x32_bf16 v[196:199], a[16:19], v[52:55], v[196:199]
    v_mfma_f32_16x16x32_bf16 v[200:203], a[20:23], v[48:51], v[200:203]
    buffer_load_dwordx4 v[116:119], v216, s[12:15], s43 offen offset:2048 sc1
    v_mfma_f32_16x16x32_bf16 v[204:207], a[20:23], v[52:55], v[204:207]
    v_mfma_f32_16x16x32_bf16 v[208:211], a[24:27], v[48:51], v[208:211]
    s_add_u32 m0, s36, 114688
    s_add_u32 s41, s36, 114688
    buffer_load_dwordx4 v216, s[8:11], s41 offen sc1 lds
    v_mfma_f32_16x16x32_bf16 v[212:215], a[24:27], v[52:55], v[212:215]
    s_waitcnt vmcnt(20) lgkmcnt(0)
    v_mfma_f32_16x16x32_bf16 v[160:163], a[28:31], v[56:59], v[160:163]
    ds_read_b128 a[0:3], v217 offset:8192
    v_mfma_f32_16x16x32_bf16 v[164:167], a[28:31], v[60:63], v[164:167]
    ds_read_b128 a[4:7], v217 offset:28672
    v_mfma_f32_16x16x32_bf16 v[168:171], a[32:35], v[56:59], v[168:171]
    ds_read_b128 a[8:11], v217 offset:49152
    v_mfma_f32_16x16x32_bf16 v[172:175], a[32:35], v[60:63], v[172:175]
    ds_read_b128 a[12:15], v218 offset:8192
    v_mfma_f32_16x16x32_bf16 v[176:179], a[36:39], v[56:59], v[176:179]
    ds_read_b128 a[16:19], v218 offset:28672
    v_mfma_f32_16x16x32_bf16 v[180:183], a[36:39], v[60:63], v[180:183]
    ds_read_b128 a[20:23], v218 offset:49152
    v_mfma_f32_16x16x32_bf16 v[184:187], a[40:43], v[56:59], v[184:187]
    ds_read_b128 a[24:27], v219 offset:8192
    s_add_u32 m0, s36, 135168
    s_add_u32 s41, s36, 135168
    buffer_load_dwordx4 v216, s[8:11], s41 offen sc1 lds
    v_mfma_f32_16x16x32_bf16 v[188:191], a[40:43], v[60:63], v[188:191]
    v_mfma_f32_16x16x32_bf16 v[192:195], a[44:47], v[56:59], v[192:195]
    buffer_load_dwordx4 v[120:123], v216, s[12:15], s42 offen offset:3072 sc1
    v_mfma_f32_16x16x32_bf16 v[196:199], a[44:47], v[60:63], v[196:199]
    v_mfma_f32_16x16x32_bf16 v[200:203], a[48:51], v[56:59], v[200:203]
    buffer_load_dwordx4 v[124:127], v216, s[12:15], s43 offen offset:3072 sc1
    v_mfma_f32_16x16x32_bf16 v[204:207], a[48:51], v[60:63], v[204:207]
    v_mfma_f32_16x16x32_bf16 v[208:211], a[52:55], v[56:59], v[208:211]
    v_mfma_f32_16x16x32_bf16 v[212:215], a[52:55], v[60:63], v[212:215]
    s_waitcnt vmcnt(21) lgkmcnt(0)
    v_mfma_f32_16x16x32_bf16 v[160:163], a[0:3], v[64:67], v[160:163]
    ds_read_b128 a[28:31], v217 offset:9216
    v_mfma_f32_16x16x32_bf16 v[164:167], a[0:3], v[68:71], v[164:167]
    ds_read_b128 a[32:35], v217 offset:29696
    v_mfma_f32_16x16x32_bf16 v[168:171], a[4:7], v[64:67], v[168:171]
    ds_read_b128 a[36:39], v217 offset:50176
    v_mfma_f32_16x16x32_bf16 v[172:175], a[4:7], v[68:71], v[172:175]
    ds_read_b128 a[40:43], v218 offset:9216
    v_mfma_f32_16x16x32_bf16 v[176:179], a[8:11], v[64:67], v[176:179]
    ds_read_b128 a[44:47], v218 offset:29696
    v_mfma_f32_16x16x32_bf16 v[180:183], a[8:11], v[68:71], v[180:183]
    ds_read_b128 a[48:51], v218 offset:50176
    v_mfma_f32_16x16x32_bf16 v[184:187], a[12:15], v[64:67], v[184:187]
    ds_read_b128 a[52:55], v219 offset:9216
    s_add_u32 m0, s36, 16384
    s_add_u32 s41, s36, 16384
    buffer_load_dwordx4 v216, s[8:11], s41 offen sc1 lds
    v_mfma_f32_16x16x32_bf16 v[188:191], a[12:15], v[68:71], v[188:191]
    v_mfma_f32_16x16x32_bf16 v[192:195], a[16:19], v[64:67], v[192:195]
    s_mov_b32 s42, 16384
    buffer_load_dwordx4 v[128:131], v216, s[12:15], s42 offen offset:0 sc1
    v_mfma_f32_16x16x32_bf16 v[196:199], a[16:19], v[68:71], v[196:199]
    v_mfma_f32_16x16x32_bf16 v[200:203], a[20:23], v[64:67], v[200:203]
    s_mov_b32 s43, 36864
    buffer_load_dwordx4 v[132:135], v216, s[12:15], s43 offen offset:0 sc1
    v_mfma_f32_16x16x32_bf16 v[204:207], a[20:23], v[68:71], v[204:207]
    v_mfma_f32_16x16x32_bf16 v[208:211], a[24:27], v[64:67], v[208:211]
    s_add_u32 m0, s36, 36864
    s_add_u32 s41, s36, 36864
    buffer_load_dwordx4 v216, s[8:11], s41 offen sc1 lds
    v_mfma_f32_16x16x32_bf16 v[212:215], a[24:27], v[68:71], v[212:215]
    s_waitcnt vmcnt(23) lgkmcnt(0)
    v_mfma_f32_16x16x32_bf16 v[160:163], a[28:31], v[72:75], v[160:163]
    ds_read_b128 a[0:3], v217 offset:10240
    v_mfma_f32_16x16x32_bf16 v[164:167], a[28:31], v[76:79], v[164:167]
    ds_read_b128 a[4:7], v217 offset:30720
    v_mfma_f32_16x16x32_bf16 v[168:171], a[32:35], v[72:75], v[168:171]
    ds_read_b128 a[8:11], v217 offset:51200
    v_mfma_f32_16x16x32_bf16 v[172:175], a[32:35], v[76:79], v[172:175]
    ds_read_b128 a[12:15], v218 offset:10240
    v_mfma_f32_16x16x32_bf16 v[176:179], a[36:39], v[72:75], v[176:179]
    ds_read_b128 a[16:19], v218 offset:30720
    v_mfma_f32_16x16x32_bf16 v[180:183], a[36:39], v[76:79], v[180:183]
    ds_read_b128 a[20:23], v218 offset:51200
    v_mfma_f32_16x16x32_bf16 v[184:187], a[40:43], v[72:75], v[184:187]
    ds_read_b128 a[24:27], v219 offset:10240
    s_add_u32 m0, s36, 57344
    s_add_u32 s41, s36, 57344
    buffer_load_dwordx4 v216, s[8:11], s41 offen sc1 lds
    v_mfma_f32_16x16x32_bf16 v[188:191], a[40:43], v[76:79], v[188:191]
    v_mfma_f32_16x16x32_bf16 v[192:195], a[44:47], v[72:75], v[192:195]
    buffer_load_dwordx4 v[136:139], v216, s[12:15], s42 offen offset:1024 sc1
    v_mfma_f32_16x16x32_bf16 v[196:199], a[44:47], v[76:79], v[196:199]
    v_mfma_f32_16x16x32_bf16 v[200:203], a[48:51], v[72:75], v[200:203]
    buffer_load_dwordx4 v[140:143], v216, s[12:15], s43 offen offset:1024 sc1
    v_mfma_f32_16x16x32_bf16 v[204:207], a[48:51], v[76:79], v[204:207]
    v_mfma_f32_16x16x32_bf16 v[208:211], a[52:55], v[72:75], v[208:211]
    s_add_u32 m0, s36, 77824
    s_add_u32 s41, s36, 77824
    buffer_load_dwordx4 v216, s[8:11], s41 offen sc1 lds
    v_mfma_f32_16x16x32_bf16 v[212:215], a[52:55], v[76:79], v[212:215]
    s_waitcnt vmcnt(25) lgkmcnt(0)
    v_mfma_f32_16x16x32_bf16 v[160:163], a[0:3], v[80:83], v[160:163]
    ds_read_b128 a[28:31], v217 offset:11264
    v_mfma_f32_16x16x32_bf16 v[164:167], a[0:3], v[84:87], v[164:167]
    ds_read_b128 a[32:35], v217 offset:31744
    v_mfma_f32_16x16x32_bf16 v[168:171], a[4:7], v[80:83], v[168:171]
    ds_read_b128 a[36:39], v217 offset:52224
    v_mfma_f32_16x16x32_bf16 v[172:175], a[4:7], v[84:87], v[172:175]
    ds_read_b128 a[40:43], v218 offset:11264
    v_mfma_f32_16x16x32_bf16 v[176:179], a[8:11], v[80:83], v[176:179]
    ds_read_b128 a[44:47], v218 offset:31744
    v_mfma_f32_16x16x32_bf16 v[180:183], a[8:11], v[84:87], v[180:183]
    ds_read_b128 a[48:51], v218 offset:52224
    v_mfma_f32_16x16x32_bf16 v[184:187], a[12:15], v[80:83], v[184:187]
    ds_read_b128 a[52:55], v219 offset:11264
    s_add_u32 m0, s36, 98304
    s_add_u32 s41, s36, 98304
    buffer_load_dwordx4 v216, s[8:11], s41 offen sc1 lds
    v_mfma_f32_16x16x32_bf16 v[188:191], a[12:15], v[84:87], v[188:191]
    v_mfma_f32_16x16x32_bf16 v[192:195], a[16:19], v[80:83], v[192:195]
    buffer_load_dwordx4 v[144:147], v216, s[12:15], s42 offen offset:2048 sc1
    v_mfma_f32_16x16x32_bf16 v[196:199], a[16:19], v[84:87], v[196:199]
    v_mfma_f32_16x16x32_bf16 v[200:203], a[20:23], v[80:83], v[200:203]
    buffer_load_dwordx4 v[148:151], v216, s[12:15], s43 offen offset:2048 sc1
    v_mfma_f32_16x16x32_bf16 v[204:207], a[20:23], v[84:87], v[204:207]
    v_mfma_f32_16x16x32_bf16 v[208:211], a[24:27], v[80:83], v[208:211]
    s_add_u32 m0, s36, 118784
    s_add_u32 s41, s36, 118784
    buffer_load_dwordx4 v216, s[8:11], s41 offen sc1 lds
    v_mfma_f32_16x16x32_bf16 v[212:215], a[24:27], v[84:87], v[212:215]
    s_waitcnt vmcnt(27) lgkmcnt(0)
    v_mfma_f32_16x16x32_bf16 v[160:163], a[28:31], v[88:91], v[160:163]
    s_waitcnt vmcnt(14)
    s_barrier
    v_mfma_f32_16x16x32_bf16 v[164:167], a[28:31], v[92:95], v[164:167]
    ds_read_b128 a[0:3], v217 offset:12288
    v_mfma_f32_16x16x32_bf16 v[168:171], a[32:35], v[88:91], v[168:171]
    ds_read_b128 a[4:7], v217 offset:32768
    v_mfma_f32_16x16x32_bf16 v[172:175], a[32:35], v[92:95], v[172:175]
    ds_read_b128 a[8:11], v217 offset:53248
    v_mfma_f32_16x16x32_bf16 v[176:179], a[36:39], v[88:91], v[176:179]
    ds_read_b128 a[12:15], v218 offset:12288
    v_mfma_f32_16x16x32_bf16 v[180:183], a[36:39], v[92:95], v[180:183]
    ds_read_b128 a[16:19], v218 offset:32768
    v_mfma_f32_16x16x32_bf16 v[184:187], a[40:43], v[88:91], v[184:187]
    ds_read_b128 a[20:23], v218 offset:53248
    s_add_u32 m0, s36, 139264
    s_add_u32 s41, s36, 139264
    buffer_load_dwordx4 v216, s[8:11], s41 offen sc1 lds
    v_mfma_f32_16x16x32_bf16 v[188:191], a[40:43], v[92:95], v[188:191]
    ds_read_b128 a[24:27], v219 offset:12288
    v_mfma_f32_16x16x32_bf16 v[192:195], a[44:47], v[88:91], v[192:195]
    buffer_load_dwordx4 v[152:155], v216, s[12:15], s42 offen offset:3072 sc1
    v_mfma_f32_16x16x32_bf16 v[196:199], a[44:47], v[92:95], v[196:199]
    v_mfma_f32_16x16x32_bf16 v[200:203], a[48:51], v[88:91], v[200:203]
    buffer_load_dwordx4 v[156:159], v216, s[12:15], s43 offen offset:3072 sc1
    v_mfma_f32_16x16x32_bf16 v[204:207], a[48:51], v[92:95], v[204:207]
    v_mfma_f32_16x16x32_bf16 v[208:211], a[52:55], v[88:91], v[208:211]
    v_mfma_f32_16x16x32_bf16 v[212:215], a[52:55], v[92:95], v[212:215]
    s_waitcnt vmcnt(27) lgkmcnt(0)
    v_mfma_f32_16x16x32_bf16 v[160:163], a[0:3], v[96:99], v[160:163]
    ds_read_b128 a[28:31], v217 offset:13312
    v_mfma_f32_16x16x32_bf16 v[164:167], a[0:3], v[100:103], v[164:167]
    ds_read_b128 a[32:35], v217 offset:33792
    v_mfma_f32_16x16x32_bf16 v[168:171], a[4:7], v[96:99], v[168:171]
    ds_read_b128 a[36:39], v217 offset:54272
    v_mfma_f32_16x16x32_bf16 v[172:175], a[4:7], v[100:103], v[172:175]
    ds_read_b128 a[40:43], v218 offset:13312
    v_mfma_f32_16x16x32_bf16 v[176:179], a[8:11], v[96:99], v[176:179]
    ds_read_b128 a[44:47], v218 offset:33792
    v_mfma_f32_16x16x32_bf16 v[180:183], a[8:11], v[100:103], v[180:183]
    ds_read_b128 a[48:51], v218 offset:54272
    v_mfma_f32_16x16x32_bf16 v[184:187], a[12:15], v[96:99], v[184:187]
    ds_read_b128 a[52:55], v219 offset:13312
    s_mov_b32 s53, 0x4000
    buffer_load_dwordx2 v[224:225], v223, s[20:23], 0 offen offset:0 sc1
    buffer_load_dwordx2 v[226:227], v223, s[20:23], s53 offen offset:0 sc1
    v_mfma_f32_16x16x32_bf16 v[188:191], a[12:15], v[100:103], v[188:191]
    s_mov_b32 s53, 0x4000
    buffer_load_dwordx2 v[228:229], v223, s[20:23], 0 offen offset:128 sc1
    buffer_load_dwordx2 v[230:231], v223, s[20:23], s53 offen offset:128 sc1
    v_mfma_f32_16x16x32_bf16 v[192:195], a[16:19], v[96:99], v[192:195]
    s_add_u32 s52, s50, 0
    buffer_load_dwordx4 v[236:239], v232, s[16:19], s52 offen sc1
    v_mfma_f32_16x16x32_bf16 v[196:199], a[16:19], v[100:103], v[196:199]
    s_add_u32 s52, s50, 8192
    buffer_load_dwordx4 v[240:243], v232, s[16:19], s52 offen sc1
    v_mfma_f32_16x16x32_bf16 v[200:203], a[20:23], v[96:99], v[200:203]
    s_add_u32 s52, s50, 16384
    buffer_load_dwordx4 v[244:247], v232, s[16:19], s52 offen sc1
    v_mfma_f32_16x16x32_bf16 v[204:207], a[20:23], v[100:103], v[204:207]
    s_add_u32 s52, s50, 24576
    buffer_load_dwordx4 v[248:251], v232, s[16:19], s52 offen sc1
    v_mfma_f32_16x16x32_bf16 v[208:211], a[24:27], v[96:99], v[208:211]
    s_add_u32 s52, s50, 32768
    buffer_load_dwordx4 v[252:255], v232, s[16:19], s52 offen sc1
    v_mfma_f32_16x16x32_bf16 v[212:215], a[24:27], v[100:103], v[212:215]
    s_waitcnt vmcnt(32) lgkmcnt(0)
    v_mfma_f32_16x16x32_bf16 v[160:163], a[28:31], v[104:107], v[160:163]
    ds_read_b128 a[0:3], v217 offset:14336
    v_mfma_f32_16x16x32_bf16 v[164:167], a[28:31], v[108:111], v[164:167]
    ds_read_b128 a[4:7], v217 offset:34816
    v_mfma_f32_16x16x32_bf16 v[168:171], a[32:35], v[104:107], v[168:171]
    ds_read_b128 a[8:11], v217 offset:55296
    v_mfma_f32_16x16x32_bf16 v[172:175], a[32:35], v[108:111], v[172:175]
    ds_read_b128 a[12:15], v218 offset:14336
    v_mfma_f32_16x16x32_bf16 v[176:179], a[36:39], v[104:107], v[176:179]
    ds_read_b128 a[16:19], v218 offset:34816
    v_mfma_f32_16x16x32_bf16 v[180:183], a[36:39], v[108:111], v[180:183]
    ds_read_b128 a[20:23], v218 offset:55296
    v_mfma_f32_16x16x32_bf16 v[184:187], a[40:43], v[104:107], v[184:187]
    ds_read_b128 a[24:27], v219 offset:14336
    v_mfma_f32_16x16x32_bf16 v[188:191], a[40:43], v[108:111], v[188:191]
    v_mfma_f32_16x16x32_bf16 v[192:195], a[44:47], v[104:107], v[192:195]
    v_mfma_f32_16x16x32_bf16 v[196:199], a[44:47], v[108:111], v[196:199]
    v_mfma_f32_16x16x32_bf16 v[200:203], a[48:51], v[104:107], v[200:203]
    v_mfma_f32_16x16x32_bf16 v[204:207], a[48:51], v[108:111], v[204:207]
    v_mfma_f32_16x16x32_bf16 v[208:211], a[52:55], v[104:107], v[208:211]
    v_mfma_f32_16x16x32_bf16 v[212:215], a[52:55], v[108:111], v[212:215]
    s_waitcnt vmcnt(28) lgkmcnt(0)
    v_mfma_f32_16x16x32_bf16 v[160:163], a[0:3], v[112:115], v[160:163]
    ds_read_b128 a[28:31], v217 offset:15360
    v_mfma_f32_16x16x32_bf16 v[164:167], a[0:3], v[116:119], v[164:167]
    ds_read_b128 a[32:35], v217 offset:35840
    v_mfma_f32_16x16x32_bf16 v[168:171], a[4:7], v[112:115], v[168:171]
    ds_read_b128 a[36:39], v217 offset:56320
    v_mfma_f32_16x16x32_bf16 v[172:175], a[4:7], v[116:119], v[172:175]
    ds_read_b128 a[40:43], v218 offset:15360
    v_mfma_f32_16x16x32_bf16 v[176:179], a[8:11], v[112:115], v[176:179]
    ds_read_b128 a[44:47], v218 offset:35840
    v_mfma_f32_16x16x32_bf16 v[180:183], a[8:11], v[116:119], v[180:183]
    ds_read_b128 a[48:51], v218 offset:56320
    v_mfma_f32_16x16x32_bf16 v[184:187], a[12:15], v[112:115], v[184:187]
    ds_read_b128 a[52:55], v219 offset:15360
    v_mfma_f32_16x16x32_bf16 v[188:191], a[12:15], v[116:119], v[188:191]
    v_mfma_f32_16x16x32_bf16 v[192:195], a[16:19], v[112:115], v[192:195]
    v_mfma_f32_16x16x32_bf16 v[196:199], a[16:19], v[116:119], v[196:199]
    v_mfma_f32_16x16x32_bf16 v[200:203], a[20:23], v[112:115], v[200:203]
    v_mfma_f32_16x16x32_bf16 v[204:207], a[20:23], v[116:119], v[204:207]
    v_mfma_f32_16x16x32_bf16 v[208:211], a[24:27], v[112:115], v[208:211]
    v_mfma_f32_16x16x32_bf16 v[212:215], a[24:27], v[116:119], v[212:215]
    s_waitcnt vmcnt(24) lgkmcnt(0)
    v_mfma_f32_16x16x32_bf16 v[160:163], a[28:31], v[120:123], v[160:163]
    s_waitcnt vmcnt(11)
    s_barrier
    v_mfma_f32_16x16x32_bf16 v[164:167], a[28:31], v[124:127], v[164:167]
    ds_read_b128 a[0:3], v217 offset:16384
    v_mfma_f32_16x16x32_bf16 v[168:171], a[32:35], v[120:123], v[168:171]
    ds_read_b128 a[4:7], v217 offset:36864
    v_mfma_f32_16x16x32_bf16 v[172:175], a[32:35], v[124:127], v[172:175]
    ds_read_b128 a[8:11], v217 offset:57344
    v_mfma_f32_16x16x32_bf16 v[176:179], a[36:39], v[120:123], v[176:179]
    ds_read_b128 a[12:15], v218 offset:16384
    v_mfma_f32_16x16x32_bf16 v[180:183], a[36:39], v[124:127], v[180:183]
    ds_read_b128 a[16:19], v218 offset:36864
    v_mfma_f32_16x16x32_bf16 v[184:187], a[40:43], v[120:123], v[184:187]
    ds_read_b128 a[20:23], v218 offset:57344
    v_mfma_f32_16x16x32_bf16 v[188:191], a[40:43], v[124:127], v[188:191]
    ds_read_b128 a[24:27], v219 offset:16384
    v_mfma_f32_16x16x32_bf16 v[192:195], a[44:47], v[120:123], v[192:195]
    v_mfma_f32_16x16x32_bf16 v[196:199], a[44:47], v[124:127], v[196:199]
    v_mfma_f32_16x16x32_bf16 v[200:203], a[48:51], v[120:123], v[200:203]
    v_mfma_f32_16x16x32_bf16 v[204:207], a[48:51], v[124:127], v[204:207]
    v_mfma_f32_16x16x32_bf16 v[208:211], a[52:55], v[120:123], v[208:211]
    v_mfma_f32_16x16x32_bf16 v[212:215], a[52:55], v[124:127], v[212:215]
    s_waitcnt vmcnt(21) lgkmcnt(0)
    v_mfma_f32_16x16x32_bf16 v[160:163], a[0:3], v[128:131], v[160:163]
    ds_read_b128 a[28:31], v217 offset:17408
    v_mfma_f32_16x16x32_bf16 v[164:167], a[0:3], v[132:135], v[164:167]
    ds_read_b128 a[32:35], v217 offset:37888
    v_mfma_f32_16x16x32_bf16 v[168:171], a[4:7], v[128:131], v[168:171]
    ds_read_b128 a[36:39], v217 offset:58368
    v_mfma_f32_16x16x32_bf16 v[172:175], a[4:7], v[132:135], v[172:175]
    ds_read_b128 a[40:43], v218 offset:17408
    v_mfma_f32_16x16x32_bf16 v[176:179], a[8:11], v[128:131], v[176:179]
    ds_read_b128 a[44:47], v218 offset:37888
    v_mfma_f32_16x16x32_bf16 v[180:183], a[8:11], v[132:135], v[180:183]
    ds_read_b128 a[48:51], v218 offset:58368
    v_mfma_f32_16x16x32_bf16 v[184:187], a[12:15], v[128:131], v[184:187]
    ds_read_b128 a[52:55], v219 offset:17408
    s_waitcnt vmcnt(0)
    v_add_f32 v236, v236, v240
    v_add_f32 v244, v244, v248
    v_add_f32 v237, v237, v241
    v_add_f32 v245, v245, v249
    v_add_f32 v238, v238, v242
    v_add_f32 v246, v246, v250
    v_add_f32 v239, v239, v243
    v_add_f32 v247, v247, v251
    v_add_f32 v236, v236, v244
    v_add_f32 v237, v237, v245
    v_add_f32 v238, v238, v246
    v_add_f32 v239, v239, v247
    v_add_f32 v236, v236, v252
    v_add_f32 v237, v237, v253
    v_add_f32 v238, v238, v254
    v_add_f32 v239, v239, v255
    ds_write_b128 v233, v[236:239]
    v_mfma_f32_16x16x32_bf16 v[188:191], a[12:15], v[132:135], v[188:191]
    v_mfma_f32_16x16x32_bf16 v[192:195], a[16:19], v[128:131], v[192:195]
    v_mfma_f32_16x16x32_bf16 v[196:199], a[16:19], v[132:135], v[196:199]
    v_mfma_f32_16x16x32_bf16 v[200:203], a[20:23], v[128:131], v[200:203]
    v_mfma_f32_16x16x32_bf16 v[204:207], a[20:23], v[132:135], v[204:207]
    v_mfma_f32_16x16x32_bf16 v[208:211], a[24:27], v[128:131], v[208:211]
    v_mfma_f32_16x16x32_bf16 v[212:215], a[24:27], v[132:135], v[212:215]
    s_waitcnt vmcnt(17) lgkmcnt(0)
    v_mfma_f32_16x16x32_bf16 v[160:163], a[28:31], v[136:139], v[160:163]
    ds_read_b128 a[0:3], v217 offset:18432
    v_mfma_f32_16x16x32_bf16 v[164:167], a[28:31], v[140:143], v[164:167]
    ds_read_b128 a[4:7], v217 offset:38912
    v_mfma_f32_16x16x32_bf16 v[168:171], a[32:35], v[136:139], v[168:171]
    ds_read_b128 a[8:11], v217 offset:59392
    v_mfma_f32_16x16x32_bf16 v[172:175], a[32:35], v[140:143], v[172:175]
    ds_read_b128 a[12:15], v218 offset:18432
    v_mfma_f32_16x16x32_bf16 v[176:179], a[36:39], v[136:139], v[176:179]
    ds_read_b128 a[16:19], v218 offset:38912
    v_mfma_f32_16x16x32_bf16 v[180:183], a[36:39], v[140:143], v[180:183]
    ds_read_b128 a[20:23], v218 offset:59392
    v_mfma_f32_16x16x32_bf16 v[184:187], a[40:43], v[136:139], v[184:187]
    ds_read_b128 a[24:27], v219 offset:18432
    v_mfma_f32_16x16x32_bf16 v[188:191], a[40:43], v[140:143], v[188:191]
    v_mfma_f32_16x16x32_bf16 v[192:195], a[44:47], v[136:139], v[192:195]
    v_mfma_f32_16x16x32_bf16 v[196:199], a[44:47], v[140:143], v[196:199]
    v_mfma_f32_16x16x32_bf16 v[200:203], a[48:51], v[136:139], v[200:203]
    v_mfma_f32_16x16x32_bf16 v[204:207], a[48:51], v[140:143], v[204:207]
    v_mfma_f32_16x16x32_bf16 v[208:211], a[52:55], v[136:139], v[208:211]
    v_mfma_f32_16x16x32_bf16 v[212:215], a[52:55], v[140:143], v[212:215]
    s_waitcnt vmcnt(13) lgkmcnt(0)
    v_mfma_f32_16x16x32_bf16 v[160:163], a[0:3], v[144:147], v[160:163]
    ds_read_b128 a[28:31], v217 offset:19456
    v_mfma_f32_16x16x32_bf16 v[164:167], a[0:3], v[148:151], v[164:167]
    ds_read_b128 a[32:35], v217 offset:39936
    v_mfma_f32_16x16x32_bf16 v[168:171], a[4:7], v[144:147], v[168:171]
    ds_read_b128 a[36:39], v217 offset:60416
    v_mfma_f32_16x16x32_bf16 v[172:175], a[4:7], v[148:151], v[172:175]
    ds_read_b128 a[40:43], v218 offset:19456
    v_mfma_f32_16x16x32_bf16 v[176:179], a[8:11], v[144:147], v[176:179]
    ds_read_b128 a[44:47], v218 offset:39936
    v_mfma_f32_16x16x32_bf16 v[180:183], a[8:11], v[148:151], v[180:183]
    ds_read_b128 a[48:51], v218 offset:60416
    v_mfma_f32_16x16x32_bf16 v[184:187], a[12:15], v[144:147], v[184:187]
    ds_read_b128 a[52:55], v219 offset:19456
    ds_read_b128 v[0:3], v234 offset:0
    ds_read_b128 v[28:31], v234 offset:448
    v_mfma_f32_16x16x32_bf16 v[188:191], a[12:15], v[148:151], v[188:191]
    ds_read_b128 v[4:7], v234 offset:64
    ds_read_b128 v[32:35], v234 offset:512
    v_mfma_f32_16x16x32_bf16 v[192:195], a[16:19], v[144:147], v[192:195]
    ds_read_b128 v[8:11], v234 offset:128
    ds_read_b128 v[36:39], v234 offset:576
    v_mfma_f32_16x16x32_bf16 v[196:199], a[16:19], v[148:151], v[196:199]
    ds_read_b128 v[12:15], v234 offset:192
    ds_read_b128 v[40:43], v234 offset:640
    v_mfma_f32_16x16x32_bf16 v[200:203], a[20:23], v[144:147], v[200:203]
    ds_read_b128 v[16:19], v234 offset:256
    ds_read_b128 v[44:47], v234 offset:704
    v_mfma_f32_16x16x32_bf16 v[204:207], a[20:23], v[148:151], v[204:207]
    ds_read_b128 v[20:23], v234 offset:320
    ds_read_b128 v[48:51], v234 offset:768
    v_mfma_f32_16x16x32_bf16 v[208:211], a[24:27], v[144:147], v[208:211]
    ds_read_b128 v[24:27], v234 offset:384
    ds_read_b128 v[52:55], v234 offset:832
    v_mfma_f32_16x16x32_bf16 v[212:215], a[24:27], v[148:151], v[212:215]
    s_waitcnt vmcnt(9) lgkmcnt(0)
    v_mfma_f32_16x16x32_bf16 v[160:163], a[28:31], v[152:155], v[160:163]
    v_mfma_f32_16x16x32_bf16 v[164:167], a[28:31], v[156:159], v[164:167]
    v_mfma_f32_16x16x32_bf16 v[168:171], a[32:35], v[152:155], v[168:171]
    v_mfma_f32_16x16x32_bf16 v[172:175], a[32:35], v[156:159], v[172:175]
    v_mfma_f32_16x16x32_bf16 v[176:179], a[36:39], v[152:155], v[176:179]
    v_mfma_f32_16x16x32_bf16 v[180:183], a[36:39], v[156:159], v[180:183]
    v_mfma_f32_16x16x32_bf16 v[184:187], a[40:43], v[152:155], v[184:187]
    v_mfma_f32_16x16x32_bf16 v[188:191], a[40:43], v[156:159], v[188:191]
    v_mfma_f32_16x16x32_bf16 v[192:195], a[44:47], v[152:155], v[192:195]
    v_mfma_f32_16x16x32_bf16 v[196:199], a[44:47], v[156:159], v[196:199]
    v_mfma_f32_16x16x32_bf16 v[200:203], a[48:51], v[152:155], v[200:203]
    v_mfma_f32_16x16x32_bf16 v[204:207], a[48:51], v[156:159], v[204:207]
    v_mfma_f32_16x16x32_bf16 v[208:211], a[52:55], v[152:155], v[208:211]
    v_mfma_f32_16x16x32_bf16 v[212:215], a[52:55], v[156:159], v[212:215]
    s_waitcnt vmcnt(0) lgkmcnt(0)
    v_add_f32 v224, v224, v226
    v_add_f32 v225, v225, v227
    v_add_f32 v228, v228, v230
    v_add_f32 v229, v229, v231
    v_mov_b32 v226, v224
    s_nop 1
    v_permlane16_swap_b32 v224, v226
    v_add_f32 v224, v224, v226
    v_mov_b32 v226, v224
    s_nop 1
    v_permlane32_swap_b32 v224, v226
    v_add_f32 v224, v224, v226
    v_mov_b32 v226, v225
    s_nop 1
    v_permlane16_swap_b32 v225, v226
    v_add_f32 v225, v225, v226
    v_mov_b32 v226, v225
    s_nop 1
    v_permlane32_swap_b32 v225, v226
    v_add_f32 v225, v225, v226
    v_mov_b32 v230, v228
    s_nop 1
    v_permlane16_swap_b32 v228, v230
    v_add_f32 v228, v228, v230
    v_mov_b32 v230, v228
    s_nop 1
    v_permlane32_swap_b32 v228, v230
    v_add_f32 v228, v228, v230
    v_mov_b32 v230, v229
    s_nop 1
    v_permlane16_swap_b32 v229, v230
    v_add_f32 v229, v229, v230
    v_mov_b32 v230, v229
    s_nop 1
    v_permlane32_swap_b32 v229, v230
    v_add_f32 v229, v229, v230
    s_mov_b32 s38, 0x3acccccd
    s_mov_b32 s39, 0x3fb8aa3b
    v_mul_f32 v28, s39, v28
    v_mul_f32 v29, s39, v29
    v_mul_f32 v30, s39, v30
    v_mul_f32 v31, s39, v31
    v_mul_f32 v32, s39, v32
    v_mul_f32 v33, s39, v33
    v_mul_f32 v34, s39, v34
    v_mul_f32 v35, s39, v35
    v_mul_f32 v36, s39, v36
    v_mul_f32 v37, s39, v37
    v_mul_f32 v38, s39, v38
    v_mul_f32 v39, s39, v39
    v_mul_f32 v40, s39, v40
    v_mul_f32 v41, s39, v41
    v_mul_f32 v42, s39, v42
    v_mul_f32 v43, s39, v43
    v_mul_f32 v44, s39, v44
    v_mul_f32 v45, s39, v45
    v_mul_f32 v46, s39, v46
    v_mul_f32 v47, s39, v47
    v_mul_f32 v48, s39, v48
    v_mul_f32 v49, s39, v49
    v_mul_f32 v50, s39, v50
    v_mul_f32 v51, s39, v51
    v_mul_f32 v52, s39, v52
    v_mul_f32 v53, s39, v53
    v_mul_f32 v54, s39, v54
    v_mul_f32 v55, s39, v55
    v_mul_f32 v224, s38, v224
    v_mul_f32 v225, s38, v225
    v_fma_f32 v225, -v224, v224, v225
    v_max_f32 v225, 0, v225
    v_add_f32 v225, 0x3727c5ac, v225
    v_rsq_f32 v225, v225
    s_nop 0
    v_mul_f32 v225, s39, v225
    v_mul_f32 v224, v224, v225
    v_mul_f32 v228, s38, v228
    v_mul_f32 v229, s38, v229
    v_fma_f32 v229, -v228, v228, v229
    v_max_f32 v229, 0, v229
    v_add_f32 v229, 0x3727c5ac, v229
    v_rsq_f32 v229, v229
    s_nop 0
    v_mul_f32 v229, s39, v229
    v_mul_f32 v228, v228, v229
    s_mov_b32 s39, 0x3fb8aa3b
    s_and_b32 s38, s28, 1
    s_lshl_b32 s38, s38, 11
    v_fma_f32 v64, -v224, v0, v28
    v_fma_f32 v65, -v224, v1, v29
    v_fma_f32 v66, -v224, v2, v30
    v_fma_f32 v67, -v224, v3, v31
    v_fma_f32 v160, v160, v225, v64
    v_fma_f32 v161, v161, v225, v65
    v_fma_f32 v162, v162, v225, v66
    v_fma_f32 v163, v163, v225, v67
    v_exp_f32 v64, -v160
    v_exp_f32 v65, -v161
    v_exp_f32 v66, -v162
    v_exp_f32 v67, -v163
    v_fma_f32 v68, -v228, v0, v28
    v_fma_f32 v69, -v228, v1, v29
    v_fma_f32 v70, -v228, v2, v30
    v_fma_f32 v71, -v228, v3, v31
    v_fma_f32 v164, v164, v229, v68
    v_fma_f32 v165, v165, v229, v69
    v_fma_f32 v166, v166, v229, v70
    v_fma_f32 v167, v167, v229, v71
    v_exp_f32 v68, -v164
    v_exp_f32 v69, -v165
    v_exp_f32 v70, -v166
    v_exp_f32 v71, -v167
    v_fma_f32 v64, v64, s39, s39
    v_fma_f32 v65, v65, s39, s39
    v_fma_f32 v66, v66, s39, s39
    v_fma_f32 v67, v67, s39, s39
    v_rcp_f32 v64, v64
    v_rcp_f32 v65, v65
    v_rcp_f32 v66, v66
    v_rcp_f32 v67, v67
    v_fma_f32 v72, -v224, v4, v32
    v_fma_f32 v73, -v224, v5, v33
    v_fma_f32 v74, -v224, v6, v34
    v_fma_f32 v75, -v224, v7, v35
    v_fma_f32 v168, v168, v225, v72
    v_fma_f32 v169, v169, v225, v73
    v_fma_f32 v170, v170, v225, v74
    v_fma_f32 v171, v171, v225, v75
    v_exp_f32 v72, -v168
    v_exp_f32 v73, -v169
    v_exp_f32 v74, -v170
    v_exp_f32 v75, -v171
    v_fma_f32 v68, v68, s39, s39
    v_fma_f32 v69, v69, s39, s39
    v_fma_f32 v70, v70, s39, s39
    v_fma_f32 v71, v71, s39, s39
    v_rcp_f32 v68, v68
    v_rcp_f32 v69, v69
    v_rcp_f32 v70, v70
    v_rcp_f32 v71, v71
    v_mul_f32 v64, v64, v160
    v_mul_f32 v65, v65, v161
    v_mul_f32 v66, v66, v162
    v_mul_f32 v67, v67, v163
    v_cvt_pk_bf16_f32 v128, v64, v65
    v_cvt_pk_bf16_f32 v129, v66, v67
    v_fma_f32 v76, -v228, v4, v32
    v_fma_f32 v77, -v228, v5, v33
    v_fma_f32 v78, -v228, v6, v34
    v_fma_f32 v79, -v228, v7, v35
    v_fma_f32 v172, v172, v229, v76
    v_fma_f32 v173, v173, v229, v77
    v_fma_f32 v174, v174, v229, v78
    v_fma_f32 v175, v175, v229, v79
    v_exp_f32 v76, -v172
    v_exp_f32 v77, -v173
    v_exp_f32 v78, -v174
    v_exp_f32 v79, -v175
    v_fma_f32 v72, v72, s39, s39
    v_fma_f32 v73, v73, s39, s39
    v_fma_f32 v74, v74, s39, s39
    v_fma_f32 v75, v75, s39, s39
    v_rcp_f32 v72, v72
    v_rcp_f32 v73, v73
    v_rcp_f32 v74, v74
    v_rcp_f32 v75, v75
    v_mul_f32 v68, v68, v164
    v_mul_f32 v69, v69, v165
    v_mul_f32 v70, v70, v166
    v_mul_f32 v71, v71, v167
    v_cvt_pk_bf16_f32 v142, v68, v69
    v_cvt_pk_bf16_f32 v143, v70, v71
    v_fma_f32 v80, -v224, v8, v36
    v_fma_f32 v81, -v224, v9, v37
    v_fma_f32 v82, -v224, v10, v38
    v_fma_f32 v83, -v224, v11, v39
    v_fma_f32 v176, v176, v225, v80
    v_fma_f32 v177, v177, v225, v81
    v_fma_f32 v178, v178, v225, v82
    v_fma_f32 v179, v179, v225, v83
    v_exp_f32 v80, -v176
    v_exp_f32 v81, -v177
    v_exp_f32 v82, -v178
    v_exp_f32 v83, -v179
    v_fma_f32 v76, v76, s39, s39
    v_fma_f32 v77, v77, s39, s39
    v_fma_f32 v78, v78, s39, s39
    v_fma_f32 v79, v79, s39, s39
    v_rcp_f32 v76, v76
    v_rcp_f32 v77, v77
    v_rcp_f32 v78, v78
    v_rcp_f32 v79, v79
    v_mul_f32 v72, v72, v168
    v_mul_f32 v73, v73, v169
    v_mul_f32 v74, v74, v170
    v_mul_f32 v75, v75, v171
    v_cvt_pk_bf16_f32 v130, v72, v73
    v_cvt_pk_bf16_f32 v131, v74, v75
    v_fma_f32 v84, -v228, v8, v36
    v_fma_f32 v85, -v228, v9, v37
    v_fma_f32 v86, -v228, v10, v38
    v_fma_f32 v87, -v228, v11, v39
    v_fma_f32 v180, v180, v229, v84
    v_fma_f32 v181, v181, v229, v85
    v_fma_f32 v182, v182, v229, v86
    v_fma_f32 v183, v183, v229, v87
    v_exp_f32 v84, -v180
    v_exp_f32 v85, -v181
    v_exp_f32 v86, -v182
    v_exp_f32 v87, -v183
    v_fma_f32 v80, v80, s39, s39
    v_fma_f32 v81, v81, s39, s39
    v_fma_f32 v82, v82, s39, s39
    v_fma_f32 v83, v83, s39, s39
    v_rcp_f32 v80, v80
    v_rcp_f32 v81, v81
    v_rcp_f32 v82, v82
    v_rcp_f32 v83, v83
    v_mul_f32 v76, v76, v172
    v_mul_f32 v77, v77, v173
    v_mul_f32 v78, v78, v174
    v_mul_f32 v79, v79, v175
    v_cvt_pk_bf16_f32 v144, v76, v77
    v_cvt_pk_bf16_f32 v145, v78, v79
    v_fma_f32 v88, -v224, v12, v40
    v_fma_f32 v89, -v224, v13, v41
    v_fma_f32 v90, -v224, v14, v42
    v_fma_f32 v91, -v224, v15, v43
    v_fma_f32 v184, v184, v225, v88
    v_fma_f32 v185, v185, v225, v89
    v_fma_f32 v186, v186, v225, v90
    v_fma_f32 v187, v187, v225, v91
    v_exp_f32 v88, -v184
    v_exp_f32 v89, -v185
    v_exp_f32 v90, -v186
    v_exp_f32 v91, -v187
    v_fma_f32 v84, v84, s39, s39
    v_fma_f32 v85, v85, s39, s39
    v_fma_f32 v86, v86, s39, s39
    v_fma_f32 v87, v87, s39, s39
    v_rcp_f32 v84, v84
    v_rcp_f32 v85, v85
    v_rcp_f32 v86, v86
    v_rcp_f32 v87, v87
    v_mul_f32 v80, v80, v176
    v_mul_f32 v81, v81, v177
    v_mul_f32 v82, v82, v178
    v_mul_f32 v83, v83, v179
    v_cvt_pk_bf16_f32 v132, v80, v81
    v_cvt_pk_bf16_f32 v133, v82, v83
    v_fma_f32 v92, -v228, v12, v40
    v_fma_f32 v93, -v228, v13, v41
    v_fma_f32 v94, -v228, v14, v42
    v_fma_f32 v95, -v228, v15, v43
    v_fma_f32 v188, v188, v229, v92
    v_fma_f32 v189, v189, v229, v93
    v_fma_f32 v190, v190, v229, v94
    v_fma_f32 v191, v191, v229, v95
    v_exp_f32 v92, -v188
    v_exp_f32 v93, -v189
    v_exp_f32 v94, -v190
    v_exp_f32 v95, -v191
    v_fma_f32 v88, v88, s39, s39
    v_fma_f32 v89, v89, s39, s39
    v_fma_f32 v90, v90, s39, s39
    v_fma_f32 v91, v91, s39, s39
    v_rcp_f32 v88, v88
    v_rcp_f32 v89, v89
    v_rcp_f32 v90, v90
    v_rcp_f32 v91, v91
    v_mul_f32 v84, v84, v180
    v_mul_f32 v85, v85, v181
    v_mul_f32 v86, v86, v182
    v_mul_f32 v87, v87, v183
    v_cvt_pk_bf16_f32 v146, v84, v85
    v_cvt_pk_bf16_f32 v147, v86, v87
    v_fma_f32 v96, -v224, v16, v44
    v_fma_f32 v97, -v224, v17, v45
    v_fma_f32 v98, -v224, v18, v46
    v_fma_f32 v99, -v224, v19, v47
    v_fma_f32 v192, v192, v225, v96
    v_fma_f32 v193, v193, v225, v97
    v_fma_f32 v194, v194, v225, v98
    v_fma_f32 v195, v195, v225, v99
    v_exp_f32 v96, -v192
    v_exp_f32 v97, -v193
    v_exp_f32 v98, -v194
    v_exp_f32 v99, -v195
    v_fma_f32 v92, v92, s39, s39
    v_fma_f32 v93, v93, s39, s39
    v_fma_f32 v94, v94, s39, s39
    v_fma_f32 v95, v95, s39, s39
    v_rcp_f32 v92, v92
    v_rcp_f32 v93, v93
    v_rcp_f32 v94, v94
    v_rcp_f32 v95, v95
    v_mul_f32 v88, v88, v184
    v_mul_f32 v89, v89, v185
    v_mul_f32 v90, v90, v186
    v_mul_f32 v91, v91, v187
    v_cvt_pk_bf16_f32 v134, v88, v89
    v_cvt_pk_bf16_f32 v135, v90, v91
    v_fma_f32 v100, -v228, v16, v44
    v_fma_f32 v101, -v228, v17, v45
    v_fma_f32 v102, -v228, v18, v46
    v_fma_f32 v103, -v228, v19, v47
    v_fma_f32 v196, v196, v229, v100
    v_fma_f32 v197, v197, v229, v101
    v_fma_f32 v198, v198, v229, v102
    v_fma_f32 v199, v199, v229, v103
    v_exp_f32 v100, -v196
    v_exp_f32 v101, -v197
    v_exp_f32 v102, -v198
    v_exp_f32 v103, -v199
    v_fma_f32 v96, v96, s39, s39
    v_fma_f32 v97, v97, s39, s39
    v_fma_f32 v98, v98, s39, s39
    v_fma_f32 v99, v99, s39, s39
    v_rcp_f32 v96, v96
    v_rcp_f32 v97, v97
    v_rcp_f32 v98, v98
    v_rcp_f32 v99, v99
    v_mul_f32 v92, v92, v188
    v_mul_f32 v93, v93, v189
    v_mul_f32 v94, v94, v190
    v_mul_f32 v95, v95, v191
    v_cvt_pk_bf16_f32 v148, v92, v93
    v_cvt_pk_bf16_f32 v149, v94, v95
    v_fma_f32 v104, -v224, v20, v48
    v_fma_f32 v105, -v224, v21, v49
    v_fma_f32 v106, -v224, v22, v50
    v_fma_f32 v107, -v224, v23, v51
    v_fma_f32 v200, v200, v225, v104
    v_fma_f32 v201, v201, v225, v105
    v_fma_f32 v202, v202, v225, v106
    v_fma_f32 v203, v203, v225, v107
    v_exp_f32 v104, -v200
    v_exp_f32 v105, -v201
    v_exp_f32 v106, -v202
    v_exp_f32 v107, -v203
    v_fma_f32 v100, v100, s39, s39
    v_fma_f32 v101, v101, s39, s39
    v_fma_f32 v102, v102, s39, s39
    v_fma_f32 v103, v103, s39, s39
    v_rcp_f32 v100, v100
    v_rcp_f32 v101, v101
    v_rcp_f32 v102, v102
    v_rcp_f32 v103, v103
    v_mul_f32 v96, v96, v192
    v_mul_f32 v97, v97, v193
    v_mul_f32 v98, v98, v194
    v_mul_f32 v99, v99, v195
    v_cvt_pk_bf16_f32 v136, v96, v97
    v_cvt_pk_bf16_f32 v137, v98, v99
    v_fma_f32 v108, -v228, v20, v48
    v_fma_f32 v109, -v228, v21, v49
    v_fma_f32 v110, -v228, v22, v50
    v_fma_f32 v111, -v228, v23, v51
    v_fma_f32 v204, v204, v229, v108
    v_fma_f32 v205, v205, v229, v109
    v_fma_f32 v206, v206, v229, v110
    v_fma_f32 v207, v207, v229, v111
    v_exp_f32 v108, -v204
    v_exp_f32 v109, -v205
    v_exp_f32 v110, -v206
    v_exp_f32 v111, -v207
    v_fma_f32 v104, v104, s39, s39
    v_fma_f32 v105, v105, s39, s39
    v_fma_f32 v106, v106, s39, s39
    v_fma_f32 v107, v107, s39, s39
    v_rcp_f32 v104, v104
    v_rcp_f32 v105, v105
    v_rcp_f32 v106, v106
    v_rcp_f32 v107, v107
    v_mul_f32 v100, v100, v196
    v_mul_f32 v101, v101, v197
    v_mul_f32 v102, v102, v198
    v_mul_f32 v103, v103, v199
    v_cvt_pk_bf16_f32 v150, v100, v101
    v_cvt_pk_bf16_f32 v151, v102, v103
    v_fma_f32 v112, -v224, v24, v52
    v_fma_f32 v113, -v224, v25, v53
    v_fma_f32 v114, -v224, v26, v54
    v_fma_f32 v115, -v224, v27, v55
    v_fma_f32 v208, v208, v225, v112
    v_fma_f32 v209, v209, v225, v113
    v_fma_f32 v210, v210, v225, v114
    v_fma_f32 v211, v211, v225, v115
    v_exp_f32 v112, -v208
    v_exp_f32 v113, -v209
    v_exp_f32 v114, -v210
    v_exp_f32 v115, -v211
    v_fma_f32 v108, v108, s39, s39
    v_fma_f32 v109, v109, s39, s39
    v_fma_f32 v110, v110, s39, s39
    v_fma_f32 v111, v111, s39, s39
    v_rcp_f32 v108, v108
    v_rcp_f32 v109, v109
    v_rcp_f32 v110, v110
    v_rcp_f32 v111, v111
    v_mul_f32 v104, v104, v200
    v_mul_f32 v105, v105, v201
    v_mul_f32 v106, v106, v202
    v_mul_f32 v107, v107, v203
    v_cvt_pk_bf16_f32 v138, v104, v105
    v_cvt_pk_bf16_f32 v139, v106, v107
    v_fma_f32 v116, -v228, v24, v52
    v_fma_f32 v117, -v228, v25, v53
    v_fma_f32 v118, -v228, v26, v54
    v_fma_f32 v119, -v228, v27, v55
    v_fma_f32 v212, v212, v229, v116
    v_fma_f32 v213, v213, v229, v117
    v_fma_f32 v214, v214, v229, v118
    v_fma_f32 v215, v215, v229, v119
    v_exp_f32 v116, -v212
    v_exp_f32 v117, -v213
    v_exp_f32 v118, -v214
    v_exp_f32 v119, -v215
    v_fma_f32 v112, v112, s39, s39
    v_fma_f32 v113, v113, s39, s39
    v_fma_f32 v114, v114, s39, s39
    v_fma_f32 v115, v115, s39, s39
    v_rcp_f32 v112, v112
    v_rcp_f32 v113, v113
    v_rcp_f32 v114, v114
    v_rcp_f32 v115, v115
    v_mul_f32 v108, v108, v204
    v_mul_f32 v109, v109, v205
    v_mul_f32 v110, v110, v206
    v_mul_f32 v111, v111, v207
    v_cvt_pk_bf16_f32 v152, v108, v109
    v_cvt_pk_bf16_f32 v153, v110, v111
    v_fma_f32 v116, v116, s39, s39
    v_fma_f32 v117, v117, s39, s39
    v_fma_f32 v118, v118, s39, s39
    v_fma_f32 v119, v119, s39, s39
    v_rcp_f32 v116, v116
    v_rcp_f32 v117, v117
    v_rcp_f32 v118, v118
    v_rcp_f32 v119, v119
    v_mul_f32 v112, v112, v208
    v_mul_f32 v113, v113, v209
    v_mul_f32 v114, v114, v210
    v_mul_f32 v115, v115, v211
    v_cvt_pk_bf16_f32 v140, v112, v113
    v_cvt_pk_bf16_f32 v141, v114, v115
    s_nop 0
    v_mul_f32 v116, v116, v212
    v_mul_f32 v117, v117, v213
    v_mul_f32 v118, v118, v214
    v_mul_f32 v119, v119, v215
    v_cvt_pk_bf16_f32 v154, v116, v117
    v_cvt_pk_bf16_f32 v155, v118, v119
    s_nop 0
    s_lshl_b32 s46, s29, 1
    s_lshr_b32 s48, s28, 1
    s_add_u32 s46, s46, s48
    s_lshl_b32 s46, s46, 15
    s_add_u32 s46, s46, 0x2c00000
    s_add_u32 s44, s4, s46
    s_addc_u32 s45, s5, 0
    s_mov_b32 s20, s44
    s_and_b32 s21, s45, 0xffff
    s_mov_b32 s22, 0x8000
    s_mov_b32 s23, 0x20000
    s_lshr_b32 s46, s47, 1
    s_lshl_b32 s46, s46, 12
    s_and_b32 s48, s47, 1
    s_lshl_b32 s48, s48, 11
    s_add_u32 s46, s46, s48
    s_and_b32 s48, s28, 1
    s_lshl_b32 s48, s48, 10
    s_add_u32 s46, s46, s48
    v_lshrrev_b32 v224, 1, v216
    s_lshr_b32 s41, s35, 1
    s_lshl_b32 s41, s41, 12
    s_add_u32 s41, s41, s38
    s_bitcmp1_b32 s35, 0
    s_cbranch_scc1 L_g_odd
    buffer_store_dwordx4 v[128:131], v216, s[24:27], s41 offen offset:0 sc1
    buffer_store_dwordx4 v[142:145], v216, s[24:27], s41 offen offset:1024 sc1
    s_add_u32 s41, s41, 0x1000
    buffer_store_dwordx4 v[132:135], v216, s[24:27], s41 offen offset:0 sc1
    buffer_store_dwordx4 v[146:149], v216, s[24:27], s41 offen offset:1024 sc1
    s_add_u32 s41, s41, 0x1000
    buffer_store_dwordx4 v[136:139], v216, s[24:27], s41 offen offset:0 sc1
    buffer_store_dwordx4 v[150:153], v216, s[24:27], s41 offen offset:1024 sc1
    s_add_u32 s41, s41, 0x1000
    buffer_store_dwordx2 v[140:141], v224, s[20:23], s46 offen offset:0 sc1
    buffer_store_dwordx2 v[154:155], v224, s[20:23], s46 offen offset:512 sc1
    s_branch L_g_stored
L_g_odd:
    buffer_store_dwordx2 v[128:129], v224, s[20:23], s46 offen offset:0 sc1
    buffer_store_dwordx2 v[142:143], v224, s[20:23], s46 offen offset:512 sc1
    s_add_u32 s41, s41, 0x1000
    buffer_store_dwordx4 v[130:133], v216, s[24:27], s41 offen offset:0 sc1
    buffer_store_dwordx4 v[144:147], v216, s[24:27], s41 offen offset:1024 sc1
    s_add_u32 s41, s41, 0x1000
    buffer_store_dwordx4 v[134:137], v216, s[24:27], s41 offen offset:0 sc1
    buffer_store_dwordx4 v[148:151], v216, s[24:27], s41 offen offset:1024 sc1
    s_add_u32 s41, s41, 0x1000
    buffer_store_dwordx4 v[138:141], v216, s[24:27], s41 offen offset:0 sc1
    buffer_store_dwordx4 v[152:155], v216, s[24:27], s41 offen offset:1024 sc1
L_g_stored:
    s_lshl_b32 s59, s29, 7
    s_add_u32 s59, s59, 3072
    s_waitcnt vmcnt(0)
    s_barrier
    s_cmp_lg_u32 s28, 0
    s_cbranch_scc1 L_arr_C
    s_add_u32 s56, s88, 0x60000
    s_addc_u32 s57, s89, 0
    v_mov_b32 v248, s59
    v_mov_b32 v249, 1
    s_mov_b64 exec, 1
    global_atomic_add v248, v249, s[56:57] sc1
    s_mov_b64 exec, -1
L_arr_C:
    s_and_b32 s30, s2, 7
    s_lshr_b32 s31, s2, 3
    s_and_b32 s32, s30, 1
    s_lshl_b32 s32, s32, 2
    s_lshr_b32 s34, s31, 3
    s_add_u32 s33, s32, s34
    s_mul_i32 s34, s33, 276480
    s_add_u32 s34, s34, 0x2600000
    s_add_u32 s8, s88, s34
    s_addc_u32 s9, s89, 0
    s_and_b32 s9, s9, 0xffff
    s_mov_b32 s10, 0x43800
    s_mov_b32 s11, 0x20000
    s_mul_i32 s53, s28, 71680
    v_mbcnt_lo_u32_b32 v252, -1, 0
    v_mbcnt_hi_u32_b32 v252, -1, v252
    v_lshlrev_b32 v252, 4, v252
    v_add_u32 v253, 0x1000, v252
    buffer_load_dwordx4 a[56:59], v252, s[8:11], s53 offen offset:0 sc1
    buffer_load_dwordx4 a[60:63], v252, s[8:11], s53 offen offset:1024 sc1
    buffer_load_dwordx4 a[64:67], v252, s[8:11], s53 offen offset:2048 sc1
    buffer_load_dwordx4 a[68:71], v252, s[8:11], s53 offen offset:3072 sc1
    buffer_load_dwordx4 a[72:75], v253, s[8:11], s53 offen offset:0 sc1
    s_add_u32 s53, s53, 5120
    buffer_load_dwordx4 a[76:79], v252, s[8:11], s53 offen offset:0 sc1
    buffer_load_dwordx4 a[80:83], v252, s[8:11], s53 offen offset:1024 sc1
    buffer_load_dwordx4 a[84:87], v252, s[8:11], s53 offen offset:2048 sc1
    buffer_load_dwordx4 a[88:91], v252, s[8:11], s53 offen offset:3072 sc1
    buffer_load_dwordx4 a[92:95], v253, s[8:11], s53 offen offset:0 sc1
    s_add_u32 s53, s53, 5120
    buffer_load_dwordx4 a[96:99], v252, s[8:11], s53 offen offset:0 sc1
    buffer_load_dwordx4 a[100:103], v252, s[8:11], s53 offen offset:1024 sc1
    buffer_load_dwordx4 a[104:107], v252, s[8:11], s53 offen offset:2048 sc1
    buffer_load_dwordx4 a[108:111], v252, s[8:11], s53 offen offset:3072 sc1
    buffer_load_dwordx4 a[112:115], v253, s[8:11], s53 offen offset:0 sc1
    s_add_u32 s53, s53, 5120
    buffer_load_dwordx4 a[116:119], v252, s[8:11], s53 offen offset:0 sc1
    buffer_load_dwordx4 a[120:123], v252, s[8:11], s53 offen offset:1024 sc1
    buffer_load_dwordx4 a[124:127], v252, s[8:11], s53 offen offset:2048 sc1
    buffer_load_dwordx4 a[128:131], v252, s[8:11], s53 offen offset:3072 sc1
    buffer_load_dwordx4 a[132:135], v253, s[8:11], s53 offen offset:0 sc1
    s_add_u32 s53, s53, 5120
    buffer_load_dwordx4 a[136:139], v252, s[8:11], s53 offen offset:0 sc1
    buffer_load_dwordx4 a[140:143], v252, s[8:11], s53 offen offset:1024 sc1
    buffer_load_dwordx4 a[144:147], v252, s[8:11], s53 offen offset:2048 sc1
    buffer_load_dwordx4 a[148:151], v252, s[8:11], s53 offen offset:3072 sc1
    buffer_load_dwordx4 a[152:155], v253, s[8:11], s53 offen offset:0 sc1
    s_add_u32 s53, s53, 5120
    buffer_load_dwordx4 a[156:159], v252, s[8:11], s53 offen offset:0 sc1
    buffer_load_dwordx4 a[160:163], v252, s[8:11], s53 offen offset:1024 sc1
    buffer_load_dwordx4 a[164:167], v252, s[8:11], s53 offen offset:2048 sc1
    buffer_load_dwordx4 a[168:171], v252, s[8:11], s53 offen offset:3072 sc1
    buffer_load_dwordx4 a[172:175], v253, s[8:11], s53 offen offset:0 sc1
    s_add_u32 s53, s53, 5120
    buffer_load_dwordx4 a[176:179], v252, s[8:11], s53 offen offset:0 sc1
    buffer_load_dwordx4 a[180:183], v252, s[8:11], s53 offen offset:1024 sc1
    buffer_load_dwordx4 a[184:187], v252, s[8:11], s53 offen offset:2048 sc1
    buffer_load_dwordx4 a[188:191], v252, s[8:11], s53 offen offset:3072 sc1
    buffer_load_dwordx4 a[192:195], v253, s[8:11], s53 offen offset:0 sc1
    s_add_u32 s53, s53, 5120
    buffer_load_dwordx4 a[196:199], v252, s[8:11], s53 offen offset:0 sc1
    buffer_load_dwordx4 a[200:203], v252, s[8:11], s53 offen offset:1024 sc1
    buffer_load_dwordx4 a[204:207], v252, s[8:11], s53 offen offset:2048 sc1
    buffer_load_dwordx4 a[208:211], v252, s[8:11], s53 offen offset:3072 sc1
    buffer_load_dwordx4 a[212:215], v253, s[8:11], s53 offen offset:0 sc1
    s_add_u32 s53, s53, 5120
    buffer_load_dwordx4 a[216:219], v252, s[8:11], s53 offen offset:0 sc1
    buffer_load_dwordx4 a[220:223], v252, s[8:11], s53 offen offset:1024 sc1
    buffer_load_dwordx4 a[224:227], v252, s[8:11], s53 offen offset:2048 sc1
    buffer_load_dwordx4 a[228:231], v252, s[8:11], s53 offen offset:3072 sc1
    buffer_load_dwordx4 a[232:235], v253, s[8:11], s53 offen offset:0 sc1
    s_add_u32 s53, s53, 5120
    s_mov_b64 s[4:5], s[88:89]
    s_mov_b64 s[6:7], s[92:93]
    v_mbcnt_lo_u32_b32 v228, -1, 0
    v_mbcnt_hi_u32_b32 v228, -1, v228
    s_and_b32 s30, s2, 7
    s_lshr_b32 s31, s2, 3
    s_lshr_b32 s32, s30, 1
    s_lshl_b32 s32, s32, 3
    s_and_b32 s33, s31, 7
    s_add_u32 s29, s32, s33
    s_and_b32 s32, s30, 1
    s_lshl_b32 s32, s32, 2
    s_lshr_b32 s34, s31, 3
    s_add_u32 s35, s32, s34
    v_lshlrev_b32 v224, 4, v228
    v_add_u32 v225, 0x1000, v224
    v_lshrrev_b32 v229, 4, v228
    v_lshlrev_b32 v227, 4, v229
    v_and_b32 v230, 15, v228
    s_lshl_b32 s37, s28, 4
    v_add_u32 v230, s37, v230
    s_mov_b32 s38, 1280
    v_mul_lo_u32 v226, v230, s38
    v_lshl_add_u32 v226, v229, 3, v226
    s_mul_i32 s46, s35, 276480
    s_add_u32 s46, s46, 0x2600000
    s_mul_i32 s47, s29, 221184
    s_add_u32 s47, s47, 0x1800000
    s_mul_i32 s37, s28, 14
    s_mul_i32 s39, s37, 5120
    s_lshl_b32 s38, s37, 12
    s_add_u32 s44, s4, s46
    s_addc_u32 s45, s5, 0
    s_mov_b32 s8, s44
    s_and_b32 s9, s45, 0xffff
    s_mov_b32 s10, 0x43800
    s_mov_b32 s11, 0x20000
    s_add_u32 s44, s4, s47
    s_addc_u32 s45, s5, 0
    s_mov_b32 s12, s44
    s_and_b32 s13, s45, 0xffff
    s_mov_b32 s14, 0x36000
    s_mov_b32 s15, 0x20000
    s_mul_i32 s46, s29, 81920
    s_mul_i32 s47, s35, 160
    s_add_u32 s46, s46, s47
    s_add_u32 s44, s6, s46
    s_addc_u32 s45, s7, 0
    s_mov_b32 s16, s44
    s_and_b32 s17, s45, 0xffff
    s_mov_b32 s18, 0x0
    s_mov_b32 s19, 0x20000
    s_sub_u32 s18, 0x280000, s46
    s_add_u32 s20, s4, 0x0
    s_addc_u32 s21, s5, 0
    s_and_b32 s21, s21, 0xffff
    s_mov_b32 s22, 0x3c00
    s_mov_b32 s23, 0x20000
    s_add_u32 s24, s4, 0x1400000
    s_addc_u32 s25, s5, 0
    s_and_b32 s25, s25, 0xffff
    s_mov_b32 s26, 0x280000
    s_mov_b32 s27, 0x20000
    s_lshl_b32 s46, s29, 15
    s_add_u32 s46, s46, 0x2c00000
    s_add_u32 s44, s4, s46
    s_addc_u32 s45, s5, 0
    s_mov_b32 s40, s44
    s_and_b32 s41, s45, 0xffff
    s_mov_b32 s42, 0x8000
    s_mov_b32 s43, 0x20000
    v_lshrrev_b32 v231, 1, v224
    s_lshl_b32 s46, s29, 2
    s_add_u32 s46, s46, s28
    s_mul_i32 s46, s46, 20
    s_mul_i32 s47, s35, 5
    s_add_u32 s47, s47, 0
    s_lshr_b32 s48, s47, 1
    s_and_b32 s47, s47, 1
    s_add_u32 s48, s48, s46
    s_lshl_b32 s48, s48, 10
    s_lshl_b32 s47, s47, 3
    s_add_u32 s50, s48, s47
    s_mul_i32 s47, s35, 5
    s_add_u32 s47, s47, 1
    s_lshr_b32 s48, s47, 1
    s_and_b32 s47, s47, 1
    s_add_u32 s48, s48, s46
    s_lshl_b32 s48, s48, 10
    s_lshl_b32 s47, s47, 3
    s_add_u32 s51, s48, s47
    s_mul_i32 s47, s35, 5
    s_add_u32 s47, s47, 2
    s_lshr_b32 s48, s47, 1
    s_and_b32 s47, s47, 1
    s_add_u32 s48, s48, s46
    s_lshl_b32 s48, s48, 10
    s_lshl_b32 s47, s47, 3
    s_add_u32 s52, s48, s47
    s_mul_i32 s47, s35, 5
    s_add_u32 s47, s47, 3
    s_lshr_b32 s48, s47, 1
    s_and_b32 s47, s47, 1
    s_add_u32 s48, s48, s46
    s_lshl_b32 s48, s48, 10
    s_lshl_b32 s47, s47, 3
    s_add_u32 s53, s48, s47
    s_mul_i32 s47, s35, 5
    s_add_u32 s47, s47, 4
    s_lshr_b32 s48, s47, 1
    s_and_b32 s47, s47, 1
    s_add_u32 s48, s48, s46
    s_lshl_b32 s48, s48, 10
    s_lshl_b32 s47, s47, 3
    s_add_u32 s54, s48, s47
    v_accvgpr_read_b32 v232, a240
    v_accvgpr_read_b32 v233, a241
    v_accvgpr_read_b32 v234, a242
    v_accvgpr_read_b32 v235, a243
    v_accvgpr_read_b32 v236, a244
    v_accvgpr_read_b32 v237, a245
    v_accvgpr_read_b32 v238, a246
    v_accvgpr_read_b32 v239, a247
    v_accvgpr_read_b32 v240, a248
    v_accvgpr_read_b32 v241, a249
    s_mul_i32 s49, s35, 320
    s_add_u32 s49, s49, 12800
    s_lshr_b32 s59, s29, 1
    s_lshl_b32 s59, s59, 7
    s_cmp_lg_u32 s28, 0
    s_cbranch_scc1 L_wt_C_done
    s_add_u32 s56, s88, 0x60c00
    s_addc_u32 s57, s89, 0
    v_mbcnt_lo_u32_b32 v248, -1, 0
    v_mbcnt_hi_u32_b32 v248, -1, v248
    v_min_u32 v248, 0, v248
    v_lshlrev_b32 v248, 7, v248
    v_add_u32 v248, s59, v248
    s_mov_b32 s58, 60000
    global_load_dword v249, v248, s[56:57] sc1
L_wt_C_loop:
    global_load_dword v251, v248, s[56:57] sc1
    s_waitcnt vmcnt(1)
    v_cmp_gt_u32 vcc, 16, v249
    s_sub_u32 s58, s58, 1
    s_cmp_eq_u32 s58, 0
    s_cbranch_scc1 L_wt_C_done
    s_cmp_eq_u64 vcc, 0
    s_cbranch_scc1 L_wt_C_done
    s_sleep 2
    global_load_dword v249, v248, s[56:57] sc1
    s_waitcnt vmcnt(1)
    v_cmp_gt_u32 vcc, 16, v251
    s_sub_u32 s58, s58, 1
    s_cmp_eq_u32 s58, 0
    s_cbranch_scc1 L_wt_C_done
    s_cmp_eq_u64 vcc, 0
    s_cbranch_scc1 L_wt_C_done
    s_sleep 2
    s_branch L_wt_C_loop
L_wt_C_done:
    s_barrier
    buffer_load_dwordx4 v[100:103], v224, s[12:15], s38 offen offset:0 sc1
    buffer_load_dwordx4 v[104:107], v224, s[12:15], s38 offen offset:1024 sc1
    buffer_load_dwordx4 v[108:111], v224, s[12:15], s38 offen offset:2048 sc1
    buffer_load_dwordx4 v[112:115], v224, s[12:15], s38 offen offset:3072 sc1
    s_add_u32 s39, s39, 5120
    s_add_u32 s38, s38, 4096
    buffer_load_dwordx4 v[136:139], v224, s[12:15], s38 offen offset:0 sc1
    buffer_load_dwordx4 v[140:143], v224, s[12:15], s38 offen offset:1024 sc1
    buffer_load_dwordx4 v[144:147], v224, s[12:15], s38 offen offset:2048 sc1
    buffer_load_dwordx4 v[148:151], v224, s[12:15], s38 offen offset:3072 sc1
    s_add_u32 s39, s39, 5120
    s_add_u32 s38, s38, 4096
    buffer_load_dwordx4 v[172:175], v224, s[12:15], s38 offen offset:0 sc1
    buffer_load_dwordx4 v[176:179], v224, s[12:15], s38 offen offset:1024 sc1
    buffer_load_dwordx4 v[180:183], v224, s[12:15], s38 offen offset:2048 sc1
    buffer_load_dwordx4 v[184:187], v224, s[12:15], s38 offen offset:3072 sc1
    s_add_u32 s39, s39, 5120
    s_add_u32 s38, s38, 4096
    s_waitcnt vmcnt(8)
    v_mfma_f32_16x16x32_bf16 v[0:3], a[56:59], v[100:103], 0
    v_mfma_f32_16x16x32_bf16 v[4:7], a[56:59], v[104:107], 0
    s_lshl_b32 s36, s28, 13
    s_add_u32 s36, s36, 0
    buffer_load_dwordx2 v[208:209], v231, s[40:43], s36 offen offset:0 sc1
    v_mfma_f32_16x16x32_bf16 v[8:11], a[56:59], v[108:111], 0
    v_mfma_f32_16x16x32_bf16 v[12:15], a[56:59], v[112:115], 0
    buffer_load_dwordx2 v[210:211], v231, s[40:43], s36 offen offset:2048 sc1
    v_mfma_f32_16x16x32_bf16 v[16:19], a[60:63], v[100:103], 0
    v_mfma_f32_16x16x32_bf16 v[20:23], a[60:63], v[104:107], 0
    buffer_load_dwordx2 v[212:213], v231, s[40:43], s36 offen offset:512 sc1
    v_mfma_f32_16x16x32_bf16 v[24:27], a[60:63], v[108:111], 0
    v_mfma_f32_16x16x32_bf16 v[28:31], a[60:63], v[112:115], 0
    buffer_load_dwordx2 v[214:215], v231, s[40:43], s36 offen offset:2560 sc1
    v_mfma_f32_16x16x32_bf16 v[32:35], a[64:67], v[100:103], 0
    v_mfma_f32_16x16x32_bf16 v[36:39], a[64:67], v[104:107], 0
    buffer_load_dwordx2 v[216:217], v231, s[40:43], s36 offen offset:1024 sc1
    v_mfma_f32_16x16x32_bf16 v[40:43], a[64:67], v[108:111], 0
    v_mfma_f32_16x16x32_bf16 v[44:47], a[64:67], v[112:115], 0
    buffer_load_dwordx2 v[218:219], v231, s[40:43], s36 offen offset:3072 sc1
    v_mfma_f32_16x16x32_bf16 v[48:51], a[68:71], v[100:103], 0
    v_mfma_f32_16x16x32_bf16 v[52:55], a[68:71], v[104:107], 0
    buffer_load_dwordx2 v[220:221], v231, s[40:43], s36 offen offset:1536 sc1
    v_mfma_f32_16x16x32_bf16 v[56:59], a[68:71], v[108:111], 0
    v_mfma_f32_16x16x32_bf16 v[60:63], a[68:71], v[112:115], 0
    buffer_load_dwordx2 v[222:223], v231, s[40:43], s36 offen offset:3584 sc1
    v_mfma_f32_16x16x32_bf16 v[64:67], a[72:75], v[100:103], 0
    v_mfma_f32_16x16x32_bf16 v[68:71], a[72:75], v[104:107], 0
    v_mfma_f32_16x16x32_bf16 v[72:75], a[72:75], v[108:111], 0
    v_mfma_f32_16x16x32_bf16 v[76:79], a[72:75], v[112:115], 0
    s_add_u32 s39, s39, 5120
    s_add_u32 s38, s38, 4096
    s_waitcnt vmcnt(12)
    v_mfma_f32_16x16x32_bf16 v[0:3], a[76:79], v[136:139], v[0:3]
    v_mfma_f32_16x16x32_bf16 v[4:7], a[76:79], v[140:143], v[4:7]
    buffer_load_dwordx4 v[100:103], v224, s[12:15], s38 offen offset:0 sc1
    v_mfma_f32_16x16x32_bf16 v[8:11], a[76:79], v[144:147], v[8:11]
    v_mfma_f32_16x16x32_bf16 v[12:15], a[76:79], v[148:151], v[12:15]
    buffer_load_dwordx4 v[104:107], v224, s[12:15], s38 offen offset:1024 sc1
    v_mfma_f32_16x16x32_bf16 v[16:19], a[80:83], v[136:139], v[16:19]
    v_mfma_f32_16x16x32_bf16 v[20:23], a[80:83], v[140:143], v[20:23]
    buffer_load_dwordx4 v[108:111], v224, s[12:15], s38 offen offset:2048 sc1
    v_mfma_f32_16x16x32_bf16 v[24:27], a[80:83], v[144:147], v[24:27]
    v_mfma_f32_16x16x32_bf16 v[28:31], a[80:83], v[148:151], v[28:31]
    buffer_load_dwordx4 v[112:115], v224, s[12:15], s38 offen offset:3072 sc1
    v_mfma_f32_16x16x32_bf16 v[32:35], a[84:87], v[136:139], v[32:35]
    v_mfma_f32_16x16x32_bf16 v[36:39], a[84:87], v[140:143], v[36:39]
    v_mfma_f32_16x16x32_bf16 v[40:43], a[84:87], v[144:147], v[40:43]
    v_mfma_f32_16x16x32_bf16 v[44:47], a[84:87], v[148:151], v[44:47]
    v_mfma_f32_16x16x32_bf16 v[48:51], a[88:91], v[136:139], v[48:51]
    v_mfma_f32_16x16x32_bf16 v[52:55], a[88:91], v[140:143], v[52:55]
    v_mfma_f32_16x16x32_bf16 v[56:59], a[88:91], v[144:147], v[56:59]
    v_mfma_f32_16x16x32_bf16 v[60:63], a[88:91], v[148:151], v[60:63]
    v_mfma_f32_16x16x32_bf16 v[64:67], a[92:95], v[136:139], v[64:67]
    v_mfma_f32_16x16x32_bf16 v[68:71], a[92:95], v[140:143], v[68:71]
    v_mfma_f32_16x16x32_bf16 v[72:75], a[92:95], v[144:147], v[72:75]
    v_mfma_f32_16x16x32_bf16 v[76:79], a[92:95], v[148:151], v[76:79]
    s_add_u32 s39, s39, 5120
    s_add_u32 s38, s38, 4096
    s_waitcnt vmcnt(12)
    v_mfma_f32_16x16x32_bf16 v[0:3], a[96:99], v[172:175], v[0:3]
    v_mfma_f32_16x16x32_bf16 v[4:7], a[96:99], v[176:179], v[4:7]
    buffer_load_dwordx4 v[136:139], v224, s[12:15], s38 offen offset:0 sc1
    v_mfma_f32_16x16x32_bf16 v[8:11], a[96:99], v[180:183], v[8:11]
    v_mfma_f32_16x16x32_bf16 v[12:15], a[96:99], v[184:187], v[12:15]
    buffer_load_dwordx4 v[140:143], v224, s[12:15], s38 offen offset:1024 sc1
    v_mfma_f32_16x16x32_bf16 v[16:19], a[100:103], v[172:175], v[16:19]
    v_mfma_f32_16x16x32_bf16 v[20:23], a[100:103], v[176:179], v[20:23]
    buffer_load_dwordx4 v[144:147], v224, s[12:15], s38 offen offset:2048 sc1
    v_mfma_f32_16x16x32_bf16 v[24:27], a[100:103], v[180:183], v[24:27]
    v_mfma_f32_16x16x32_bf16 v[28:31], a[100:103], v[184:187], v[28:31]
    buffer_load_dwordx4 v[148:151], v224, s[12:15], s38 offen offset:3072 sc1
    v_mfma_f32_16x16x32_bf16 v[32:35], a[104:107], v[172:175], v[32:35]
    v_mfma_f32_16x16x32_bf16 v[36:39], a[104:107], v[176:179], v[36:39]
    v_mfma_f32_16x16x32_bf16 v[40:43], a[104:107], v[180:183], v[40:43]
    v_mfma_f32_16x16x32_bf16 v[44:47], a[104:107], v[184:187], v[44:47]
    v_mfma_f32_16x16x32_bf16 v[48:51], a[108:111], v[172:175], v[48:51]
    v_mfma_f32_16x16x32_bf16 v[52:55], a[108:111], v[176:179], v[52:55]
    v_mfma_f32_16x16x32_bf16 v[56:59], a[108:111], v[180:183], v[56:59]
    v_mfma_f32_16x16x32_bf16 v[60:63], a[108:111], v[184:187], v[60:63]
    v_mfma_f32_16x16x32_bf16 v[64:67], a[112:115], v[172:175], v[64:67]
    v_mfma_f32_16x16x32_bf16 v[68:71], a[112:115], v[176:179], v[68:71]
    v_mfma_f32_16x16x32_bf16 v[72:75], a[112:115], v[180:183], v[72:75]
    v_mfma_f32_16x16x32_bf16 v[76:79], a[112:115], v[184:187], v[76:79]
    s_add_u32 s39, s39, 5120
    s_add_u32 s38, s38, 4096
    s_waitcnt vmcnt(8)
    v_mfma_f32_16x16x32_bf16 v[0:3], a[116:119], v[208:211], v[0:3]
    v_mfma_f32_16x16x32_bf16 v[4:7], a[116:119], v[212:215], v[4:7]
    buffer_load_dwordx4 v[172:175], v224, s[12:15], s38 offen offset:0 sc1
    v_mfma_f32_16x16x32_bf16 v[8:11], a[116:119], v[216:219], v[8:11]
    v_mfma_f32_16x16x32_bf16 v[12:15], a[116:119], v[220:223], v[12:15]
    buffer_load_dwordx4 v[176:179], v224, s[12:15], s38 offen offset:1024 sc1
    v_mfma_f32_16x16x32_bf16 v[16:19], a[120:123], v[208:211], v[16:19]
    v_mfma_f32_16x16x32_bf16 v[20:23], a[120:123], v[212:215], v[20:23]
    buffer_load_dwordx4 v[180:183], v224, s[12:15], s38 offen offset:2048 sc1
    v_mfma_f32_16x16x32_bf16 v[24:27], a[120:123], v[216:219], v[24:27]
    v_mfma_f32_16x16x32_bf16 v[28:31], a[120:123], v[220:223], v[28:31]
    buffer_load_dwordx4 v[184:187], v224, s[12:15], s38 offen offset:3072 sc1
    v_mfma_f32_16x16x32_bf16 v[32:35], a[124:127], v[208:211], v[32:35]
    v_mfma_f32_16x16x32_bf16 v[36:39], a[124:127], v[212:215], v[36:39]
    v_mfma_f32_16x16x32_bf16 v[40:43], a[124:127], v[216:219], v[40:43]
    v_mfma_f32_16x16x32_bf16 v[44:47], a[124:127], v[220:223], v[44:47]
    v_mfma_f32_16x16x32_bf16 v[48:51], a[128:131], v[208:211], v[48:51]
    v_mfma_f32_16x16x32_bf16 v[52:55], a[128:131], v[212:215], v[52:55]
    v_mfma_f32_16x16x32_bf16 v[56:59], a[128:131], v[216:219], v[56:59]
    v_mfma_f32_16x16x32_bf16 v[60:63], a[128:131], v[220:223], v[60:63]
    v_mfma_f32_16x16x32_bf16 v[64:67], a[132:135], v[208:211], v[64:67]
    v_mfma_f32_16x16x32_bf16 v[68:71], a[132:135], v[212:215], v[68:71]
    v_mfma_f32_16x16x32_bf16 v[72:75], a[132:135], v[216:219], v[72:75]
    v_mfma_f32_16x16x32_bf16 v[76:79], a[132:135], v[220:223], v[76:79]
    s_add_u32 s39, s39, 5120
    s_add_u32 s38, s38, 4096
    s_waitcnt vmcnt(8)
    v_mfma_f32_16x16x32_bf16 v[0:3], a[136:139], v[100:103], v[0:3]
    v_mfma_f32_16x16x32_bf16 v[4:7], a[136:139], v[104:107], v[4:7]
    buffer_load_dwordx4 v[208:211], v224, s[12:15], s38 offen offset:0 sc1
    v_mfma_f32_16x16x32_bf16 v[8:11], a[136:139], v[108:111], v[8:11]
    v_mfma_f32_16x16x32_bf16 v[12:15], a[136:139], v[112:115], v[12:15]
    buffer_load_dwordx4 v[212:215], v224, s[12:15], s38 offen offset:1024 sc1
    v_mfma_f32_16x16x32_bf16 v[16:19], a[140:143], v[100:103], v[16:19]
    v_mfma_f32_16x16x32_bf16 v[20:23], a[140:143], v[104:107], v[20:23]
    buffer_load_dwordx4 v[216:219], v224, s[12:15], s38 offen offset:2048 sc1
    v_mfma_f32_16x16x32_bf16 v[24:27], a[140:143], v[108:111], v[24:27]
    v_mfma_f32_16x16x32_bf16 v[28:31], a[140:143], v[112:115], v[28:31]
    buffer_load_dwordx4 v[220:223], v224, s[12:15], s38 offen offset:3072 sc1
    v_mfma_f32_16x16x32_bf16 v[32:35], a[144:147], v[100:103], v[32:35]
    v_mfma_f32_16x16x32_bf16 v[36:39], a[144:147], v[104:107], v[36:39]
    v_mfma_f32_16x16x32_bf16 v[40:43], a[144:147], v[108:111], v[40:43]
    v_mfma_f32_16x16x32_bf16 v[44:47], a[144:147], v[112:115], v[44:47]
    v_mfma_f32_16x16x32_bf16 v[48:51], a[148:151], v[100:103], v[48:51]
    v_mfma_f32_16x16x32_bf16 v[52:55], a[148:151], v[104:107], v[52:55]
    v_mfma_f32_16x16x32_bf16 v[56:59], a[148:151], v[108:111], v[56:59]
    v_mfma_f32_16x16x32_bf16 v[60:63], a[148:151], v[112:115], v[60:63]
    v_mfma_f32_16x16x32_bf16 v[64:67], a[152:155], v[100:103], v[64:67]
    v_mfma_f32_16x16x32_bf16 v[68:71], a[152:155], v[104:107], v[68:71]
    v_mfma_f32_16x16x32_bf16 v[72:75], a[152:155], v[108:111], v[72:75]
    v_mfma_f32_16x16x32_bf16 v[76:79], a[152:155], v[112:115], v[76:79]
    s_add_u32 s39, s39, 5120
    s_add_u32 s38, s38, 4096
    s_waitcnt vmcnt(8)
    v_mfma_f32_16x16x32_bf16 v[0:3], a[156:159], v[136:139], v[0:3]
    v_mfma_f32_16x16x32_bf16 v[4:7], a[156:159], v[140:143], v[4:7]
    buffer_load_dwordx4 v[100:103], v224, s[12:15], s38 offen offset:0 sc1
    v_mfma_f32_16x16x32_bf16 v[8:11], a[156:159], v[144:147], v[8:11]
    v_mfma_f32_16x16x32_bf16 v[12:15], a[156:159], v[148:151], v[12:15]
    buffer_load_dwordx4 v[104:107], v224, s[12:15], s38 offen offset:1024 sc1
    v_mfma_f32_16x16x32_bf16 v[16:19], a[160:163], v[136:139], v[16:19]
    v_mfma_f32_16x16x32_bf16 v[20:23], a[160:163], v[140:143], v[20:23]
    buffer_load_dwordx4 v[108:111], v224, s[12:15], s38 offen offset:2048 sc1
    v_mfma_f32_16x16x32_bf16 v[24:27], a[160:163], v[144:147], v[24:27]
    v_mfma_f32_16x16x32_bf16 v[28:31], a[160:163], v[148:151], v[28:31]
    buffer_load_dwordx4 v[112:115], v224, s[12:15], s38 offen offset:3072 sc1
    v_mfma_f32_16x16x32_bf16 v[32:35], a[164:167], v[136:139], v[32:35]
    v_mfma_f32_16x16x32_bf16 v[36:39], a[164:167], v[140:143], v[36:39]
    v_mfma_f32_16x16x32_bf16 v[40:43], a[164:167], v[144:147], v[40:43]
    v_mfma_f32_16x16x32_bf16 v[44:47], a[164:167], v[148:151], v[44:47]
    v_mfma_f32_16x16x32_bf16 v[48:51], a[168:171], v[136:139], v[48:51]
    v_mfma_f32_16x16x32_bf16 v[52:55], a[168:171], v[140:143], v[52:55]
    v_mfma_f32_16x16x32_bf16 v[56:59], a[168:171], v[144:147], v[56:59]
    v_mfma_f32_16x16x32_bf16 v[60:63], a[168:171], v[148:151], v[60:63]
    v_mfma_f32_16x16x32_bf16 v[64:67], a[172:175], v[136:139], v[64:67]
    v_mfma_f32_16x16x32_bf16 v[68:71], a[172:175], v[140:143], v[68:71]
    v_mfma_f32_16x16x32_bf16 v[72:75], a[172:175], v[144:147], v[72:75]
    v_mfma_f32_16x16x32_bf16 v[76:79], a[172:175], v[148:151], v[76:79]
    s_add_u32 s39, s39, 5120
    s_add_u32 s38, s38, 4096
    s_waitcnt vmcnt(8)
    v_mfma_f32_16x16x32_bf16 v[0:3], a[176:179], v[172:175], v[0:3]
    v_mfma_f32_16x16x32_bf16 v[4:7], a[176:179], v[176:179], v[4:7]
    buffer_load_dwordx4 v[116:119], v224, s[8:11], s39 offen offset:0 sc1
    v_mfma_f32_16x16x32_bf16 v[8:11], a[176:179], v[180:183], v[8:11]
    v_mfma_f32_16x16x32_bf16 v[12:15], a[176:179], v[184:187], v[12:15]
    buffer_load_dwordx4 v[136:139], v224, s[12:15], s38 offen offset:0 sc1
    v_mfma_f32_16x16x32_bf16 v[16:19], a[180:183], v[172:175], v[16:19]
    v_mfma_f32_16x16x32_bf16 v[20:23], a[180:183], v[176:179], v[20:23]
    buffer_load_dwordx4 v[120:123], v224, s[8:11], s39 offen offset:1024 sc1
    v_mfma_f32_16x16x32_bf16 v[24:27], a[180:183], v[180:183], v[24:27]
    v_mfma_f32_16x16x32_bf16 v[28:31], a[180:183], v[184:187], v[28:31]
    buffer_load_dwordx4 v[140:143], v224, s[12:15], s38 offen offset:1024 sc1
    v_mfma_f32_16x16x32_bf16 v[32:35], a[184:187], v[172:175], v[32:35]
    v_mfma_f32_16x16x32_bf16 v[36:39], a[184:187], v[176:179], v[36:39]
    buffer_load_dwordx4 v[124:127], v224, s[8:11], s39 offen offset:2048 sc1
    v_mfma_f32_16x16x32_bf16 v[40:43], a[184:187], v[180:183], v[40:43]
    v_mfma_f32_16x16x32_bf16 v[44:47], a[184:187], v[184:187], v[44:47]
    buffer_load_dwordx4 v[144:147], v224, s[12:15], s38 offen offset:2048 sc1
    v_mfma_f32_16x16x32_bf16 v[48:51], a[188:191], v[172:175], v[48:51]
    v_mfma_f32_16x16x32_bf16 v[52:55], a[188:191], v[176:179], v[52:55]
    buffer_load_dwordx4 v[128:131], v224, s[8:11], s39 offen offset:3072 sc1
    v_mfma_f32_16x16x32_bf16 v[56:59], a[188:191], v[180:183], v[56:59]
    v_mfma_f32_16x16x32_bf16 v[60:63], a[188:191], v[184:187], v[60:63]
    buffer_load_dwordx4 v[148:151], v224, s[12:15], s38 offen offset:3072 sc1
    v_mfma_f32_16x16x32_bf16 v[64:67], a[192:195], v[172:175], v[64:67]
    v_mfma_f32_16x16x32_bf16 v[68:71], a[192:195], v[176:179], v[68:71]
    buffer_load_dwordx4 v[132:135], v225, s[8:11], s39 offen offset:0 sc1
    v_mfma_f32_16x16x32_bf16 v[72:75], a[192:195], v[180:183], v[72:75]
    v_mfma_f32_16x16x32_bf16 v[76:79], a[192:195], v[184:187], v[76:79]
    s_add_u32 s39, s39, 5120
    s_add_u32 s38, s38, 4096
    s_waitcnt vmcnt(13)
    v_mfma_f32_16x16x32_bf16 v[0:3], a[196:199], v[208:211], v[0:3]
    buffer_load_dwordx4 v[152:155], v224, s[8:11], s39 offen offset:0 sc1
    v_mfma_f32_16x16x32_bf16 v[4:7], a[196:199], v[212:215], v[4:7]
    buffer_load_dwordx4 v[156:159], v224, s[8:11], s39 offen offset:1024 sc1
    v_mfma_f32_16x16x32_bf16 v[8:11], a[196:199], v[216:219], v[8:11]
    buffer_load_dwordx4 v[160:163], v224, s[8:11], s39 offen offset:2048 sc1
    v_mfma_f32_16x16x32_bf16 v[12:15], a[196:199], v[220:223], v[12:15]
    buffer_load_dwordx4 v[164:167], v224, s[8:11], s39 offen offset:3072 sc1
    v_mfma_f32_16x16x32_bf16 v[16:19], a[200:203], v[208:211], v[16:19]
    buffer_load_dwordx4 v[168:171], v225, s[8:11], s39 offen offset:0 sc1
    v_mfma_f32_16x16x32_bf16 v[20:23], a[200:203], v[212:215], v[20:23]
    s_lshl_b32 s36, s28, 13
    s_add_u32 s36, s36, 4096
    buffer_load_dwordx2 v[172:173], v231, s[40:43], s36 offen offset:0 sc1
    v_mfma_f32_16x16x32_bf16 v[24:27], a[200:203], v[216:219], v[24:27]
    buffer_load_dwordx2 v[174:175], v231, s[40:43], s36 offen offset:2048 sc1
    v_mfma_f32_16x16x32_bf16 v[28:31], a[200:203], v[220:223], v[28:31]
    buffer_load_dwordx2 v[176:177], v231, s[40:43], s36 offen offset:512 sc1
    v_mfma_f32_16x16x32_bf16 v[32:35], a[204:207], v[208:211], v[32:35]
    buffer_load_dwordx2 v[178:179], v231, s[40:43], s36 offen offset:2560 sc1
    v_mfma_f32_16x16x32_bf16 v[36:39], a[204:207], v[212:215], v[36:39]
    buffer_load_dwordx2 v[180:181], v231, s[40:43], s36 offen offset:1024 sc1
    v_mfma_f32_16x16x32_bf16 v[40:43], a[204:207], v[216:219], v[40:43]
    buffer_load_dwordx2 v[182:183], v231, s[40:43], s36 offen offset:3072 sc1
    v_mfma_f32_16x16x32_bf16 v[44:47], a[204:207], v[220:223], v[44:47]
    buffer_load_dwordx2 v[184:185], v231, s[40:43], s36 offen offset:1536 sc1
    v_mfma_f32_16x16x32_bf16 v[48:51], a[208:211], v[208:211], v[48:51]
    buffer_load_dwordx2 v[186:187], v231, s[40:43], s36 offen offset:3584 sc1
    v_mfma_f32_16x16x32_bf16 v[52:55], a[208:211], v[212:215], v[52:55]
    v_mfma_f32_16x16x32_bf16 v[56:59], a[208:211], v[216:219], v[56:59]
    v_mfma_f32_16x16x32_bf16 v[60:63], a[208:211], v[220:223], v[60:63]
    v_mfma_f32_16x16x32_bf16 v[64:67], a[212:215], v[208:211], v[64:67]
    v_mfma_f32_16x16x32_bf16 v[68:71], a[212:215], v[212:215], v[68:71]
    v_mfma_f32_16x16x32_bf16 v[72:75], a[212:215], v[216:219], v[72:75]
    v_mfma_f32_16x16x32_bf16 v[76:79], a[212:215], v[220:223], v[76:79]
    s_add_u32 s39, s39, 5120
    s_add_u32 s38, s38, 4096
    s_waitcnt vmcnt(22)
    v_mfma_f32_16x16x32_bf16 v[0:3], a[216:219], v[100:103], v[0:3]
    v_mfma_f32_16x16x32_bf16 v[4:7], a[216:219], v[104:107], v[4:7]
    buffer_load_dwordx4 v[188:191], v224, s[8:11], s39 offen offset:0 sc1
    v_mfma_f32_16x16x32_bf16 v[8:11], a[216:219], v[108:111], v[8:11]
    v_mfma_f32_16x16x32_bf16 v[12:15], a[216:219], v[112:115], v[12:15]
    buffer_load_dwordx4 v[208:211], v224, s[12:15], s38 offen offset:0 sc1
    v_mfma_f32_16x16x32_bf16 v[16:19], a[220:223], v[100:103], v[16:19]
    v_mfma_f32_16x16x32_bf16 v[20:23], a[220:223], v[104:107], v[20:23]
    buffer_load_dwordx4 v[192:195], v224, s[8:11], s39 offen offset:1024 sc1
    v_mfma_f32_16x16x32_bf16 v[24:27], a[220:223], v[108:111], v[24:27]
    v_mfma_f32_16x16x32_bf16 v[28:31], a[220:223], v[112:115], v[28:31]
    buffer_load_dwordx4 v[212:215], v224, s[12:15], s38 offen offset:1024 sc1
    v_mfma_f32_16x16x32_bf16 v[32:35], a[224:227], v[100:103], v[32:35]
    v_mfma_f32_16x16x32_bf16 v[36:39], a[224:227], v[104:107], v[36:39]
    buffer_load_dwordx4 v[196:199], v224, s[8:11], s39 offen offset:2048 sc1
    v_mfma_f32_16x16x32_bf16 v[40:43], a[224:227], v[108:111], v[40:43]
    v_mfma_f32_16x16x32_bf16 v[44:47], a[224:227], v[112:115], v[44:47]
    buffer_load_dwordx4 v[216:219], v224, s[12:15], s38 offen offset:2048 sc1
    v_mfma_f32_16x16x32_bf16 v[48:51], a[228:231], v[100:103], v[48:51]
    v_mfma_f32_16x16x32_bf16 v[52:55], a[228:231], v[104:107], v[52:55]
    buffer_load_dwordx4 v[200:203], v224, s[8:11], s39 offen offset:3072 sc1
    v_mfma_f32_16x16x32_bf16 v[56:59], a[228:231], v[108:111], v[56:59]
    v_mfma_f32_16x16x32_bf16 v[60:63], a[228:231], v[112:115], v[60:63]
    buffer_load_dwordx4 v[220:223], v224, s[12:15], s38 offen offset:3072 sc1
    v_mfma_f32_16x16x32_bf16 v[64:67], a[232:235], v[100:103], v[64:67]
    v_mfma_f32_16x16x32_bf16 v[68:71], a[232:235], v[104:107], v[68:71]
    buffer_load_dwordx4 v[204:207], v225, s[8:11], s39 offen offset:0 sc1
    v_mfma_f32_16x16x32_bf16 v[72:75], a[232:235], v[108:111], v[72:75]
    v_mfma_f32_16x16x32_bf16 v[76:79], a[232:235], v[112:115], v[76:79]
    s_add_u32 s39, s39, 5120
    s_add_u32 s38, s38, 4096
    s_waitcnt vmcnt(22)
    v_mfma_f32_16x16x32_bf16 v[0:3], v[116:119], v[136:139], v[0:3]
    v_mfma_f32_16x16x32_bf16 v[4:7], v[116:119], v[140:143], v[4:7]
    buffer_load_dwordx4 v[80:83], v224, s[8:11], s39 offen offset:0 sc1
    v_mfma_f32_16x16x32_bf16 v[8:11], v[116:119], v[144:147], v[8:11]
    v_mfma_f32_16x16x32_bf16 v[12:15], v[116:119], v[148:151], v[12:15]
    buffer_load_dwordx4 v[100:103], v224, s[12:15], s38 offen offset:0 sc1
    v_mfma_f32_16x16x32_bf16 v[16:19], v[120:123], v[136:139], v[16:19]
    v_mfma_f32_16x16x32_bf16 v[20:23], v[120:123], v[140:143], v[20:23]
    buffer_load_dwordx4 v[84:87], v224, s[8:11], s39 offen offset:1024 sc1
    v_mfma_f32_16x16x32_bf16 v[24:27], v[120:123], v[144:147], v[24:27]
    v_mfma_f32_16x16x32_bf16 v[28:31], v[120:123], v[148:151], v[28:31]
    buffer_load_dwordx4 v[104:107], v224, s[12:15], s38 offen offset:1024 sc1
    v_mfma_f32_16x16x32_bf16 v[32:35], v[124:127], v[136:139], v[32:35]
    v_mfma_f32_16x16x32_bf16 v[36:39], v[124:127], v[140:143], v[36:39]
    buffer_load_dwordx4 v[88:91], v224, s[8:11], s39 offen offset:2048 sc1
    v_mfma_f32_16x16x32_bf16 v[40:43], v[124:127], v[144:147], v[40:43]
    v_mfma_f32_16x16x32_bf16 v[44:47], v[124:127], v[148:151], v[44:47]
    buffer_load_dwordx4 v[108:111], v224, s[12:15], s38 offen offset:2048 sc1
    v_mfma_f32_16x16x32_bf16 v[48:51], v[128:131], v[136:139], v[48:51]
    v_mfma_f32_16x16x32_bf16 v[52:55], v[128:131], v[140:143], v[52:55]
    buffer_load_dwordx4 v[92:95], v224, s[8:11], s39 offen offset:3072 sc1
    v_mfma_f32_16x16x32_bf16 v[56:59], v[128:131], v[144:147], v[56:59]
    v_mfma_f32_16x16x32_bf16 v[60:63], v[128:131], v[148:151], v[60:63]
    buffer_load_dwordx4 v[112:115], v224, s[12:15], s38 offen offset:3072 sc1
    v_mfma_f32_16x16x32_bf16 v[64:67], v[132:135], v[136:139], v[64:67]
    v_mfma_f32_16x16x32_bf16 v[68:71], v[132:135], v[140:143], v[68:71]
    buffer_load_dwordx4 v[96:99], v225, s[8:11], s39 offen offset:0 sc1
    v_mfma_f32_16x16x32_bf16 v[72:75], v[132:135], v[144:147], v[72:75]
    v_mfma_f32_16x16x32_bf16 v[76:79], v[132:135], v[148:151], v[76:79]
    s_add_u32 s39, s39, 5120
    s_add_u32 s38, s38, 4096
    s_waitcnt vmcnt(18)
    v_mfma_f32_16x16x32_bf16 v[0:3], v[152:155], v[172:175], v[0:3]
    v_mfma_f32_16x16x32_bf16 v[4:7], v[152:155], v[176:179], v[4:7]
    buffer_load_dwordx4 v[116:119], v224, s[8:11], s39 offen offset:0 sc1
    v_mfma_f32_16x16x32_bf16 v[8:11], v[152:155], v[180:183], v[8:11]
    v_mfma_f32_16x16x32_bf16 v[12:15], v[152:155], v[184:187], v[12:15]
    buffer_load_dwordx4 v[136:139], v224, s[12:15], s38 offen offset:0 sc1
    v_mfma_f32_16x16x32_bf16 v[16:19], v[156:159], v[172:175], v[16:19]
    v_mfma_f32_16x16x32_bf16 v[20:23], v[156:159], v[176:179], v[20:23]
    buffer_load_dwordx4 v[120:123], v224, s[8:11], s39 offen offset:1024 sc1
    v_mfma_f32_16x16x32_bf16 v[24:27], v[156:159], v[180:183], v[24:27]
    v_mfma_f32_16x16x32_bf16 v[28:31], v[156:159], v[184:187], v[28:31]
    buffer_load_dwordx4 v[140:143], v224, s[12:15], s38 offen offset:1024 sc1
    v_mfma_f32_16x16x32_bf16 v[32:35], v[160:163], v[172:175], v[32:35]
    v_mfma_f32_16x16x32_bf16 v[36:39], v[160:163], v[176:179], v[36:39]
    buffer_load_dwordx4 v[124:127], v224, s[8:11], s39 offen offset:2048 sc1
    v_mfma_f32_16x16x32_bf16 v[40:43], v[160:163], v[180:183], v[40:43]
    v_mfma_f32_16x16x32_bf16 v[44:47], v[160:163], v[184:187], v[44:47]
    buffer_load_dwordx4 v[144:147], v224, s[12:15], s38 offen offset:2048 sc1
    v_mfma_f32_16x16x32_bf16 v[48:51], v[164:167], v[172:175], v[48:51]
    v_mfma_f32_16x16x32_bf16 v[52:55], v[164:167], v[176:179], v[52:55]
    buffer_load_dwordx4 v[128:131], v224, s[8:11], s39 offen offset:3072 sc1
    v_mfma_f32_16x16x32_bf16 v[56:59], v[164:167], v[180:183], v[56:59]
    v_mfma_f32_16x16x32_bf16 v[60:63], v[164:167], v[184:187], v[60:63]
    buffer_load_dwordx4 v[148:151], v224, s[12:15], s38 offen offset:3072 sc1
    v_mfma_f32_16x16x32_bf16 v[64:67], v[168:171], v[172:175], v[64:67]
    v_mfma_f32_16x16x32_bf16 v[68:71], v[168:171], v[176:179], v[68:71]
    buffer_load_dwordx4 v[132:135], v225, s[8:11], s39 offen offset:0 sc1
    v_mfma_f32_16x16x32_bf16 v[72:75], v[168:171], v[180:183], v[72:75]
    v_mfma_f32_16x16x32_bf16 v[76:79], v[168:171], v[184:187], v[76:79]
    s_add_u32 s39, s39, 5120
    s_add_u32 s38, s38, 4096
    s_waitcnt vmcnt(18)
    v_mfma_f32_16x16x32_bf16 v[0:3], v[188:191], v[208:211], v[0:3]
    v_mfma_f32_16x16x32_bf16 v[4:7], v[188:191], v[212:215], v[4:7]
    buffer_load_dwordx4 v[152:155], v227, s[20:23], s49 offen offset:0 sc1
    v_mfma_f32_16x16x32_bf16 v[8:11], v[188:191], v[216:219], v[8:11]
    v_mfma_f32_16x16x32_bf16 v[12:15], v[188:191], v[220:223], v[12:15]
    buffer_load_dwordx4 v[156:159], v227, s[20:23], s49 offen offset:64 sc1
    v_mfma_f32_16x16x32_bf16 v[16:19], v[192:195], v[208:211], v[16:19]
    v_mfma_f32_16x16x32_bf16 v[20:23], v[192:195], v[212:215], v[20:23]
    buffer_load_dwordx4 v[160:163], v227, s[20:23], s49 offen offset:128 sc1
    v_mfma_f32_16x16x32_bf16 v[24:27], v[192:195], v[216:219], v[24:27]
    v_mfma_f32_16x16x32_bf16 v[28:31], v[192:195], v[220:223], v[28:31]
    buffer_load_dwordx4 v[164:167], v227, s[20:23], s49 offen offset:192 sc1
    v_mfma_f32_16x16x32_bf16 v[32:35], v[196:199], v[208:211], v[32:35]
    v_mfma_f32_16x16x32_bf16 v[36:39], v[196:199], v[212:215], v[36:39]
    buffer_load_dwordx4 v[168:171], v227, s[20:23], s49 offen offset:256 sc1
    v_mfma_f32_16x16x32_bf16 v[40:43], v[196:199], v[216:219], v[40:43]
    v_mfma_f32_16x16x32_bf16 v[44:47], v[196:199], v[220:223], v[44:47]
    v_mfma_f32_16x16x32_bf16 v[48:51], v[200:203], v[208:211], v[48:51]
    v_mfma_f32_16x16x32_bf16 v[52:55], v[200:203], v[212:215], v[52:55]
    v_mfma_f32_16x16x32_bf16 v[56:59], v[200:203], v[216:219], v[56:59]
    v_mfma_f32_16x16x32_bf16 v[60:63], v[200:203], v[220:223], v[60:63]
    v_mfma_f32_16x16x32_bf16 v[64:67], v[204:207], v[208:211], v[64:67]
    v_mfma_f32_16x16x32_bf16 v[68:71], v[204:207], v[212:215], v[68:71]
    v_mfma_f32_16x16x32_bf16 v[72:75], v[204:207], v[216:219], v[72:75]
    v_mfma_f32_16x16x32_bf16 v[76:79], v[204:207], v[220:223], v[76:79]
    s_waitcnt vmcnt(14)
    v_mfma_f32_16x16x32_bf16 v[0:3], v[80:83], v[100:103], v[0:3]
    v_mfma_f32_16x16x32_bf16 v[4:7], v[80:83], v[104:107], v[4:7]
    v_mfma_f32_16x16x32_bf16 v[8:11], v[80:83], v[108:111], v[8:11]
    v_mfma_f32_16x16x32_bf16 v[12:15], v[80:83], v[112:115], v[12:15]
    v_mfma_f32_16x16x32_bf16 v[16:19], v[84:87], v[100:103], v[16:19]
    v_mfma_f32_16x16x32_bf16 v[20:23], v[84:87], v[104:107], v[20:23]
    v_mfma_f32_16x16x32_bf16 v[24:27], v[84:87], v[108:111], v[24:27]
    v_mfma_f32_16x16x32_bf16 v[28:31], v[84:87], v[112:115], v[28:31]
    v_mfma_f32_16x16x32_bf16 v[32:35], v[88:91], v[100:103], v[32:35]
    v_mfma_f32_16x16x32_bf16 v[36:39], v[88:91], v[104:107], v[36:39]
    v_mfma_f32_16x16x32_bf16 v[40:43], v[88:91], v[108:111], v[40:43]
    v_mfma_f32_16x16x32_bf16 v[44:47], v[88:91], v[112:115], v[44:47]
    v_mfma_f32_16x16x32_bf16 v[48:51], v[92:95], v[100:103], v[48:51]
    v_mfma_f32_16x16x32_bf16 v[52:55], v[92:95], v[104:107], v[52:55]
    v_mfma_f32_16x16x32_bf16 v[56:59], v[92:95], v[108:111], v[56:59]
    v_mfma_f32_16x16x32_bf16 v[60:63], v[92:95], v[112:115], v[60:63]
    v_mfma_f32_16x16x32_bf16 v[64:67], v[96:99], v[100:103], v[64:67]
    v_mfma_f32_16x16x32_bf16 v[68:71], v[96:99], v[104:107], v[68:71]
    v_mfma_f32_16x16x32_bf16 v[72:75], v[96:99], v[108:111], v[72:75]
    v_mfma_f32_16x16x32_bf16 v[76:79], v[96:99], v[112:115], v[76:79]
    s_waitcnt vmcnt(5)
    v_mfma_f32_16x16x32_bf16 v[0:3], v[116:119], v[136:139], v[0:3]
    v_mfma_f32_16x16x32_bf16 v[4:7], v[116:119], v[140:143], v[4:7]
    v_mfma_f32_16x16x32_bf16 v[8:11], v[116:119], v[144:147], v[8:11]
    v_mfma_f32_16x16x32_bf16 v[12:15], v[116:119], v[148:151], v[12:15]
    v_mfma_f32_16x16x32_bf16 v[16:19], v[120:123], v[136:139], v[16:19]
    v_mfma_f32_16x16x32_bf16 v[20:23], v[120:123], v[140:143], v[20:23]
    v_mfma_f32_16x16x32_bf16 v[24:27], v[120:123], v[144:147], v[24:27]
    v_mfma_f32_16x16x32_bf16 v[28:31], v[120:123], v[148:151], v[28:31]
    v_mfma_f32_16x16x32_bf16 v[32:35], v[124:127], v[136:139], v[32:35]
    v_mfma_f32_16x16x32_bf16 v[36:39], v[124:127], v[140:143], v[36:39]
    v_mfma_f32_16x16x32_bf16 v[40:43], v[124:127], v[144:147], v[40:43]
    v_mfma_f32_16x16x32_bf16 v[44:47], v[124:127], v[148:151], v[44:47]
    v_mfma_f32_16x16x32_bf16 v[48:51], v[128:131], v[136:139], v[48:51]
    v_mfma_f32_16x16x32_bf16 v[52:55], v[128:131], v[140:143], v[52:55]
    v_mfma_f32_16x16x32_bf16 v[56:59], v[128:131], v[144:147], v[56:59]
    v_mfma_f32_16x16x32_bf16 v[60:63], v[128:131], v[148:151], v[60:63]
    v_mfma_f32_16x16x32_bf16 v[64:67], v[132:135], v[136:139], v[64:67]
    v_mfma_f32_16x16x32_bf16 v[68:71], v[132:135], v[140:143], v[68:71]
    v_mfma_f32_16x16x32_bf16 v[72:75], v[132:135], v[144:147], v[72:75]
    v_mfma_f32_16x16x32_bf16 v[76:79], v[132:135], v[148:151], v[76:79]
    v_add_u32 v231, 0x0, v224
    s_nop 4
    s_cmp_eq_u32 s28, 0
    s_cbranch_scc0 L_f_w1
    ds_write_b128 v231, v[4:7] offset:25600
    ds_write_b128 v231, v[20:23] offset:26624
    ds_write_b128 v231, v[36:39] offset:27648
    ds_write_b128 v231, v[52:55] offset:28672
    ds_write_b128 v231, v[68:71] offset:29696
    ds_write_b128 v231, v[8:11] offset:35840
    ds_write_b128 v231, v[24:27] offset:36864
    ds_write_b128 v231, v[40:43] offset:37888
    ds_write_b128 v231, v[56:59] offset:38912
    ds_write_b128 v231, v[72:75] offset:39936
    ds_write_b128 v231, v[12:15] offset:46080
    ds_write_b128 v231, v[28:31] offset:47104
    ds_write_b128 v231, v[44:47] offset:48128
    ds_write_b128 v231, v[60:63] offset:49152
    ds_write_b128 v231, v[76:79] offset:50176
    v_mov_b32 v184, v0
    v_mov_b32 v185, v1
    v_mov_b32 v186, v2
    v_mov_b32 v187, v3
    v_mov_b32 v188, v16
    v_mov_b32 v189, v17
    v_mov_b32 v190, v18
    v_mov_b32 v191, v19
    v_mov_b32 v192, v32
    v_mov_b32 v193, v33
    v_mov_b32 v194, v34
    v_mov_b32 v195, v35
    v_mov_b32 v196, v48
    v_mov_b32 v197, v49
    v_mov_b32 v198, v50
    v_mov_b32 v199, v51
    v_mov_b32 v200, v64
    v_mov_b32 v201, v65
    v_mov_b32 v202, v66
    v_mov_b32 v203, v67
    s_branch L_f_wdone
L_f_w1:
    s_cmp_eq_u32 s28, 1
    s_cbranch_scc0 L_f_w2
    ds_write_b128 v231, v[8:11] offset:40960
    ds_write_b128 v231, v[24:27] offset:41984
    ds_write_b128 v231, v[40:43] offset:43008
    ds_write_b128 v231, v[56:59] offset:44032
    ds_write_b128 v231, v[72:75] offset:45056
    ds_write_b128 v231, v[12:15] offset:51200
    ds_write_b128 v231, v[28:31] offset:52224
    ds_write_b128 v231, v[44:47] offset:53248
    ds_write_b128 v231, v[60:63] offset:54272
    ds_write_b128 v231, v[76:79] offset:55296
    ds_write_b128 v231, v[0:3] offset:0
    ds_write_b128 v231, v[16:19] offset:1024
    ds_write_b128 v231, v[32:35] offset:2048
    ds_write_b128 v231, v[48:51] offset:3072
    ds_write_b128 v231, v[64:67] offset:4096
    v_mov_b32 v184, v4
    v_mov_b32 v185, v5
    v_mov_b32 v186, v6
    v_mov_b32 v187, v7
    v_mov_b32 v188, v20
    v_mov_b32 v189, v21
    v_mov_b32 v190, v22
    v_mov_b32 v191, v23
    v_mov_b32 v192, v36
    v_mov_b32 v193, v37
    v_mov_b32 v194, v38
    v_mov_b32 v195, v39
    v_mov_b32 v196, v52
    v_mov_b32 v197, v53
    v_mov_b32 v198, v54
    v_mov_b32 v199, v55
    v_mov_b32 v200, v68
    v_mov_b32 v201, v69
    v_mov_b32 v202, v70
    v_mov_b32 v203, v71
    s_branch L_f_wdone
L_f_w2:
    s_cmp_eq_u32 s28, 2
    s_cbranch_scc0 L_f_w3
    ds_write_b128 v231, v[12:15] offset:56320
    ds_write_b128 v231, v[28:31] offset:57344
    ds_write_b128 v231, v[44:47] offset:58368
    ds_write_b128 v231, v[60:63] offset:59392
    ds_write_b128 v231, v[76:79] offset:60416
    ds_write_b128 v231, v[0:3] offset:5120
    ds_write_b128 v231, v[16:19] offset:6144
    ds_write_b128 v231, v[32:35] offset:7168
    ds_write_b128 v231, v[48:51] offset:8192
    ds_write_b128 v231, v[64:67] offset:9216
    ds_write_b128 v231, v[4:7] offset:15360
    ds_write_b128 v231, v[20:23] offset:16384
    ds_write_b128 v231, v[36:39] offset:17408
    ds_write_b128 v231, v[52:55] offset:18432
    ds_write_b128 v231, v[68:71] offset:19456
    v_mov_b32 v184, v8
    v_mov_b32 v185, v9
    v_mov_b32 v186, v10
    v_mov_b32 v187, v11
    v_mov_b32 v188, v24
    v_mov_b32 v189, v25
    v_mov_b32 v190, v26
    v_mov_b32 v191, v27
    v_mov_b32 v192, v40
    v_mov_b32 v193, v41
    v_mov_b32 v194, v42
    v_mov_b32 v195, v43
    v_mov_b32 v196, v56
    v_mov_b32 v197, v57
    v_mov_b32 v198, v58
    v_mov_b32 v199, v59
    v_mov_b32 v200, v72
    v_mov_b32 v201, v73
    v_mov_b32 v202, v74
    v_mov_b32 v203, v75
    s_branch L_f_wdone
L_f_w3:
    ds_write_b128 v231, v[0:3] offset:10240
    ds_write_b128 v231, v[16:19] offset:11264
    ds_write_b128 v231, v[32:35] offset:12288
    ds_write_b128 v231, v[48:51] offset:13312
    ds_write_b128 v231, v[64:67] offset:14336
    ds_write_b128 v231, v[4:7] offset:20480
    ds_write_b128 v231, v[20:23] offset:21504
    ds_write_b128 v231, v[36:39] offset:22528
    ds_write_b128 v231, v[52:55] offset:23552
    ds_write_b128 v231, v[68:71] offset:24576
    ds_write_b128 v231, v[8:11] offset:30720
    ds_write_b128 v231, v[24:27] offset:31744
    ds_write_b128 v231, v[40:43] offset:32768
    ds_write_b128 v231, v[56:59] offset:33792
    ds_write_b128 v231, v[72:75] offset:34816
    v_mov_b32 v184, v12
    v_mov_b32 v185, v13
    v_mov_b32 v186, v14
    v_mov_b32 v187, v15
    v_mov_b32 v188, v28
    v_mov_b32 v189, v29
    v_mov_b32 v190, v30
    v_mov_b32 v191, v31
    v_mov_b32 v192, v44
    v_mov_b32 v193, v45
    v_mov_b32 v194, v46
    v_mov_b32 v195, v47
    v_mov_b32 v196, v60
    v_mov_b32 v197, v61
    v_mov_b32 v198, v62
    v_mov_b32 v199, v63
    v_mov_b32 v200, v76
    v_mov_b32 v201, v77
    v_mov_b32 v202, v78
    v_mov_b32 v203, v79
L_f_wdone:
    s_waitcnt lgkmcnt(0)
    s_barrier
    s_mul_i32 s46, s28, 15360
    v_add_u32 v228, s46, v231
    ds_read_b128 v[0:3], v228 offset:0
    ds_read_b128 v[4:7], v228 offset:1024
    ds_read_b128 v[8:11], v228 offset:2048
    ds_read_b128 v[12:15], v228 offset:3072
    ds_read_b128 v[16:19], v228 offset:4096
    ds_read_b128 v[20:23], v228 offset:5120
    ds_read_b128 v[24:27], v228 offset:6144
    ds_read_b128 v[28:31], v228 offset:7168
    ds_read_b128 v[32:35], v228 offset:8192
    ds_read_b128 v[36:39], v228 offset:9216
    ds_read_b128 v[40:43], v228 offset:10240
    ds_read_b128 v[44:47], v228 offset:11264
    ds_read_b128 v[48:51], v228 offset:12288
    ds_read_b128 v[52:55], v228 offset:13312
    ds_read_b128 v[56:59], v228 offset:14336
    s_waitcnt lgkmcnt(10)
    v_add_f32 v184, v184, v0
    v_add_f32 v185, v185, v1
    v_add_f32 v186, v186, v2
    v_add_f32 v187, v187, v3
    v_add_f32 v188, v188, v4
    v_add_f32 v189, v189, v5
    v_add_f32 v190, v190, v6
    v_add_f32 v191, v191, v7
    v_add_f32 v192, v192, v8
    v_add_f32 v193, v193, v9
    v_add_f32 v194, v194, v10
    v_add_f32 v195, v195, v11
    v_add_f32 v196, v196, v12
    v_add_f32 v197, v197, v13
    v_add_f32 v198, v198, v14
    v_add_f32 v199, v199, v15
    v_add_f32 v200, v200, v16
    v_add_f32 v201, v201, v17
    v_add_f32 v202, v202, v18
    v_add_f32 v203, v203, v19
    s_waitcnt lgkmcnt(5)
    v_add_f32 v184, v184, v20
    v_add_f32 v185, v185, v21
    v_add_f32 v186, v186, v22
    v_add_f32 v187, v187, v23
    v_add_f32 v188, v188, v24
    v_add_f32 v189, v189, v25
    v_add_f32 v190, v190, v26
    v_add_f32 v191, v191, v27
    v_add_f32 v192, v192, v28
    v_add_f32 v193, v193, v29
    v_add_f32 v194, v194, v30
    v_add_f32 v195, v195, v31
    v_add_f32 v196, v196, v32
    v_add_f32 v197, v197, v33
    v_add_f32 v198, v198, v34
    v_add_f32 v199, v199, v35
    v_add_f32 v200, v200, v36
    v_add_f32 v201, v201, v37
    v_add_f32 v202, v202, v38
    v_add_f32 v203, v203, v39
    s_waitcnt lgkmcnt(0)
    v_add_f32 v184, v184, v40
    v_add_f32 v185, v185, v41
    v_add_f32 v186, v186, v42
    v_add_f32 v187, v187, v43
    v_add_f32 v188, v188, v44
    v_add_f32 v189, v189, v45
    v_add_f32 v190, v190, v46
    v_add_f32 v191, v191, v47
    v_add_f32 v192, v192, v48
    v_add_f32 v193, v193, v49
    v_add_f32 v194, v194, v50
    v_add_f32 v195, v195, v51
    v_add_f32 v196, v196, v52
    v_add_f32 v197, v197, v53
    v_add_f32 v198, v198, v54
    v_add_f32 v199, v199, v55
    v_add_f32 v200, v200, v56
    v_add_f32 v201, v201, v57
    v_add_f32 v202, v202, v58
    v_add_f32 v203, v203, v59
    s_waitcnt vmcnt(0)
    s_mov_b32 s39, 0xffff0000
    v_lshlrev_b32 v60, 16, v232
    v_and_b32 v61, s39, v232
    v_lshlrev_b32 v62, 16, v233
    v_and_b32 v63, s39, v233
    v_lshlrev_b32 v64, 16, v234
    v_and_b32 v65, s39, v234
    v_lshlrev_b32 v66, 16, v235
    v_and_b32 v67, s39, v235
    v_lshlrev_b32 v68, 16, v236
    v_and_b32 v69, s39, v236
    v_lshlrev_b32 v70, 16, v237
    v_and_b32 v71, s39, v237
    v_lshlrev_b32 v72, 16, v238
    v_and_b32 v73, s39, v238
    v_lshlrev_b32 v74, 16, v239
    v_and_b32 v75, s39, v239
    v_lshlrev_b32 v76, 16, v240
    v_and_b32 v77, s39, v240
    v_lshlrev_b32 v78, 16, v241
    v_and_b32 v79, s39, v241
    v_fma_f32 v184, v184, v152, v60
    v_fma_f32 v185, v185, v153, v61
    v_fma_f32 v186, v186, v154, v62
    v_fma_f32 v187, v187, v155, v63
    v_fma_f32 v188, v188, v156, v64
    v_fma_f32 v189, v189, v157, v65
    v_fma_f32 v190, v190, v158, v66
    v_fma_f32 v191, v191, v159, v67
    v_fma_f32 v192, v192, v160, v68
    v_fma_f32 v193, v193, v161, v69
    v_fma_f32 v194, v194, v162, v70
    v_fma_f32 v195, v195, v163, v71
    v_fma_f32 v196, v196, v164, v72
    v_fma_f32 v197, v197, v165, v73
    v_fma_f32 v198, v198, v166, v74
    v_fma_f32 v199, v199, v167, v75
    v_fma_f32 v200, v200, v168, v76
    v_fma_f32 v201, v201, v169, v77
    v_fma_f32 v202, v202, v170, v78
    v_fma_f32 v203, v203, v171, v79
    v_cvt_pk_bf16_f32 v0, v184, v185
    v_cvt_pk_bf16_f32 v1, v186, v187
    v_cvt_pk_bf16_f32 v2, v188, v189
    v_cvt_pk_bf16_f32 v3, v190, v191
    v_cvt_pk_bf16_f32 v4, v192, v193
    v_cvt_pk_bf16_f32 v5, v194, v195
    v_cvt_pk_bf16_f32 v6, v196, v197
    v_cvt_pk_bf16_f32 v7, v198, v199
    v_cvt_pk_bf16_f32 v8, v200, v201
    v_cvt_pk_bf16_f32 v9, v202, v203
    buffer_store_dwordx2 v[0:1], v226, s[16:19], 0 offen offset:0
    buffer_store_dwordx2 v[2:3], v226, s[16:19], 0 offen offset:32
    buffer_store_dwordx2 v[4:5], v226, s[16:19], 0 offen offset:64
    buffer_store_dwordx2 v[6:7], v226, s[16:19], 0 offen offset:96
    buffer_store_dwordx2 v[8:9], v226, s[16:19], 0 offen offset:128
    s_endpgm
L_attn_slow:
    s_waitcnt vmcnt(0) lgkmcnt(0)
    s_barrier
    v_mov_b32 v180, 0xff800000
    v_mov_b32 v176, 0
    v_mov_b32 v181, 0xff800000
    v_mov_b32 v177, 0
    v_mov_b32 v182, 0xff800000
    v_mov_b32 v178, 0
    v_mov_b32 v183, 0xff800000
    v_mov_b32 v179, 0
    v_accvgpr_write_b32 a0, 0
    v_accvgpr_write_b32 a1, 0
    v_accvgpr_write_b32 a2, 0
    v_accvgpr_write_b32 a3, 0
    v_accvgpr_write_b32 a4, 0
    v_accvgpr_write_b32 a5, 0
    v_accvgpr_write_b32 a6, 0
    v_accvgpr_write_b32 a7, 0
    v_accvgpr_write_b32 a8, 0
    v_accvgpr_write_b32 a9, 0
    v_accvgpr_write_b32 a10, 0
    v_accvgpr_write_b32 a11, 0
    v_accvgpr_write_b32 a12, 0
    v_accvgpr_write_b32 a13, 0
    v_accvgpr_write_b32 a14, 0
    v_accvgpr_write_b32 a15, 0
    v_accvgpr_write_b32 a16, 0
    v_accvgpr_write_b32 a17, 0
    v_accvgpr_write_b32 a18, 0
    v_accvgpr_write_b32 a19, 0
    v_accvgpr_write_b32 a20, 0
    v_accvgpr_write_b32 a21, 0
    v_accvgpr_write_b32 a22, 0
    v_accvgpr_write_b32 a23, 0
    v_accvgpr_write_b32 a24, 0
    v_accvgpr_write_b32 a25, 0
    v_accvgpr_write_b32 a26, 0
    v_accvgpr_write_b32 a27, 0
    v_accvgpr_write_b32 a28, 0
    v_accvgpr_write_b32 a29, 0
    v_accvgpr_write_b32 a30, 0
    v_accvgpr_write_b32 a31, 0
    v_accvgpr_write_b32 a32, 0
    v_accvgpr_write_b32 a33, 0
    v_accvgpr_write_b32 a34, 0
    v_accvgpr_write_b32 a35, 0
    v_accvgpr_write_b32 a36, 0
    v_accvgpr_write_b32 a37, 0
    v_accvgpr_write_b32 a38, 0
    v_accvgpr_write_b32 a39, 0
    v_accvgpr_write_b32 a40, 0
    v_accvgpr_write_b32 a41, 0
    v_accvgpr_write_b32 a42, 0
    v_accvgpr_write_b32 a43, 0
    v_accvgpr_write_b32 a44, 0
    v_accvgpr_write_b32 a45, 0
    v_accvgpr_write_b32 a46, 0
    v_accvgpr_write_b32 a47, 0
    v_accvgpr_write_b32 a48, 0
    v_accvgpr_write_b32 a49, 0
    v_accvgpr_write_b32 a50, 0
    v_accvgpr_write_b32 a51, 0
    v_accvgpr_write_b32 a52, 0
    v_accvgpr_write_b32 a53, 0
    v_accvgpr_write_b32 a54, 0
    v_accvgpr_write_b32 a55, 0
    v_accvgpr_write_b32 a56, 0
    v_accvgpr_write_b32 a57, 0
    v_accvgpr_write_b32 a58, 0
    v_accvgpr_write_b32 a59, 0
    v_accvgpr_write_b32 a60, 0
    v_accvgpr_write_b32 a61, 0
    v_accvgpr_write_b32 a62, 0
    v_accvgpr_write_b32 a63, 0
    v_accvgpr_write_b32 a64, 0
    v_accvgpr_write_b32 a65, 0
    v_accvgpr_write_b32 a66, 0
    v_accvgpr_write_b32 a67, 0
    v_accvgpr_write_b32 a68, 0
    v_accvgpr_write_b32 a69, 0
    v_accvgpr_write_b32 a70, 0
    v_accvgpr_write_b32 a71, 0
    v_accvgpr_write_b32 a72, 0
    v_accvgpr_write_b32 a73, 0
    v_accvgpr_write_b32 a74, 0
    v_accvgpr_write_b32 a75, 0
    v_accvgpr_write_b32 a76, 0
    v_accvgpr_write_b32 a77, 0
    v_accvgpr_write_b32 a78, 0
    v_accvgpr_write_b32 a79, 0
    v_accvgpr_write_b32 a80, 0
    v_accvgpr_write_b32 a81, 0
    v_accvgpr_write_b32 a82, 0
    v_accvgpr_write_b32 a83, 0
    v_accvgpr_write_b32 a84, 0
    v_accvgpr_write_b32 a85, 0
    v_accvgpr_write_b32 a86, 0
    v_accvgpr_write_b32 a87, 0
    v_accvgpr_write_b32 a88, 0
    v_accvgpr_write_b32 a89, 0
    v_accvgpr_write_b32 a90, 0
    v_accvgpr_write_b32 a91, 0
    v_accvgpr_write_b32 a92, 0
    v_accvgpr_write_b32 a93, 0
    v_accvgpr_write_b32 a94, 0
    v_accvgpr_write_b32 a95, 0
    v_accvgpr_write_b32 a96, 0
    v_accvgpr_write_b32 a97, 0
    v_accvgpr_write_b32 a98, 0
    v_accvgpr_write_b32 a99, 0
    v_accvgpr_write_b32 a100, 0
    v_accvgpr_write_b32 a101, 0
    v_accvgpr_write_b32 a102, 0
    v_accvgpr_write_b32 a103, 0
    v_accvgpr_write_b32 a104, 0
    v_accvgpr_write_b32 a105, 0
    v_accvgpr_write_b32 a106, 0
    v_accvgpr_write_b32 a107, 0
    v_accvgpr_write_b32 a108, 0
    v_accvgpr_write_b32 a109, 0
    v_accvgpr_write_b32 a110, 0
    v_accvgpr_write_b32 a111, 0
    v_accvgpr_write_b32 a112, 0
    v_accvgpr_write_b32 a113, 0
    v_accvgpr_write_b32 a114, 0
    v_accvgpr_write_b32 a115, 0
    v_accvgpr_write_b32 a116, 0
    v_accvgpr_write_b32 a117, 0
    v_accvgpr_write_b32 a118, 0
    v_accvgpr_write_b32 a119, 0
    v_accvgpr_write_b32 a120, 0
    v_accvgpr_write_b32 a121, 0
    v_accvgpr_write_b32 a122, 0
    v_accvgpr_write_b32 a123, 0
    v_accvgpr_write_b32 a124, 0
    v_accvgpr_write_b32 a125, 0
    v_accvgpr_write_b32 a126, 0
    v_accvgpr_write_b32 a127, 0
    s_mov_b32 s32, 0
    s_mov_b32 s33, 0
    s_mov_b32 s34, 32
    s_mov_b32 s94, 1
L_slow_loop:
    s_add_u32 m0, s29, 0x0
    s_nop 0
    buffer_load_dwordx4 v204, s[8:11], s32 offen offset:0 lds
    buffer_load_dwordx4 v205, s[8:11], s32 offen offset:1024 lds
    buffer_load_dwordx4 v206, s[8:11], s32 offen offset:2048 lds
    buffer_load_dwordx4 v207, s[8:11], s32 offen offset:3072 lds
    s_add_u32 m0, s29, 0x10000
    s_nop 0
    buffer_load_dwordx4 v208, s[12:15], s33 offen offset:0 lds
    buffer_load_dwordx4 v242, s[12:15], s33 offen offset:1024 lds
    buffer_load_dwordx4 v208, s[12:15], s33 offen offset:2048 lds
    buffer_load_dwordx4 v242, s[12:15], s33 offen offset:3072 lds
    s_add_u32 s32, s32, 0x4000
    s_add_u32 s33, s33, 0x4000
    s_waitcnt vmcnt(0)
    s_barrier
    ds_read_b128 a[128:131], v192 offset:0
    ds_read_b128 a[132:135], v193 offset:0
    ds_read_b128 a[136:139], v194 offset:0
    ds_read_b128 a[140:143], v195 offset:0
    ds_read_b128 a[144:147], v192 offset:4096
    ds_read_b128 a[148:151], v193 offset:4096
    ds_read_b128 a[152:155], v194 offset:4096
    ds_read_b128 a[156:159], v195 offset:4096
    s_waitcnt lgkmcnt(0)
    ds_read_b64_tr_b16 a[160:161], v196 offset:0
    ds_read_b64_tr_b16 a[162:163], v196 offset:4096
    ds_read_b64_tr_b16 a[164:165], v197 offset:0
    ds_read_b64_tr_b16 a[166:167], v197 offset:4096
    ds_read_b64_tr_b16 a[168:169], v198 offset:0
    ds_read_b64_tr_b16 a[170:171], v198 offset:4096
    ds_read_b64_tr_b16 a[172:173], v199 offset:0
    ds_read_b64_tr_b16 a[174:175], v199 offset:4096
    ds_read_b64_tr_b16 a[176:177], v200 offset:0
    ds_read_b64_tr_b16 a[178:179], v200 offset:4096
    ds_read_b64_tr_b16 a[180:181], v201 offset:0
    ds_read_b64_tr_b16 a[182:183], v201 offset:4096
    ds_read_b64_tr_b16 a[184:185], v202 offset:0
    ds_read_b64_tr_b16 a[186:187], v202 offset:4096
    ds_read_b64_tr_b16 a[188:189], v203 offset:0
    ds_read_b64_tr_b16 a[190:191], v203 offset:4096
    v_mfma_f32_16x16x32_bf16 v[64:67], a[128:131], v[0:3], 0
    v_mfma_f32_16x16x32_bf16 v[64:67], a[132:135], v[4:7], v[64:67]
    v_mfma_f32_16x16x32_bf16 v[64:67], a[136:139], v[8:11], v[64:67]
    v_mfma_f32_16x16x32_bf16 v[64:67], a[140:143], v[12:15], v[64:67]
    v_mfma_f32_16x16x32_bf16 v[68:71], a[128:131], v[16:19], 0
    v_mfma_f32_16x16x32_bf16 v[68:71], a[132:135], v[20:23], v[68:71]
    v_mfma_f32_16x16x32_bf16 v[68:71], a[136:139], v[24:27], v[68:71]
    v_mfma_f32_16x16x32_bf16 v[68:71], a[140:143], v[28:31], v[68:71]
    v_mfma_f32_16x16x32_bf16 v[72:75], a[128:131], v[32:35], 0
    v_mfma_f32_16x16x32_bf16 v[72:75], a[132:135], v[36:39], v[72:75]
    v_mfma_f32_16x16x32_bf16 v[72:75], a[136:139], v[40:43], v[72:75]
    v_mfma_f32_16x16x32_bf16 v[72:75], a[140:143], v[44:47], v[72:75]
    v_mfma_f32_16x16x32_bf16 v[76:79], a[128:131], v[48:51], 0
    v_mfma_f32_16x16x32_bf16 v[76:79], a[132:135], v[52:55], v[76:79]
    v_mfma_f32_16x16x32_bf16 v[76:79], a[136:139], v[56:59], v[76:79]
    v_mfma_f32_16x16x32_bf16 v[76:79], a[140:143], v[60:63], v[76:79]
    v_mfma_f32_16x16x32_bf16 v[80:83], a[144:147], v[0:3], 0
    v_mfma_f32_16x16x32_bf16 v[80:83], a[148:151], v[4:7], v[80:83]
    v_mfma_f32_16x16x32_bf16 v[80:83], a[152:155], v[8:11], v[80:83]
    v_mfma_f32_16x16x32_bf16 v[80:83], a[156:159], v[12:15], v[80:83]
    v_mfma_f32_16x16x32_bf16 v[84:87], a[144:147], v[16:19], 0
    v_mfma_f32_16x16x32_bf16 v[84:87], a[148:151], v[20:23], v[84:87]
    v_mfma_f32_16x16x32_bf16 v[84:87], a[152:155], v[24:27], v[84:87]
    v_mfma_f32_16x16x32_bf16 v[84:87], a[156:159], v[28:31], v[84:87]
    v_mfma_f32_16x16x32_bf16 v[88:91], a[144:147], v[32:35], 0
    v_mfma_f32_16x16x32_bf16 v[88:91], a[148:151], v[36:39], v[88:91]
    v_mfma_f32_16x16x32_bf16 v[88:91], a[152:155], v[40:43], v[88:91]
    v_mfma_f32_16x16x32_bf16 v[88:91], a[156:159], v[44:47], v[88:91]
    v_mfma_f32_16x16x32_bf16 v[92:95], a[144:147], v[48:51], 0
    v_mfma_f32_16x16x32_bf16 v[92:95], a[148:151], v[52:55], v[92:95]
    v_mfma_f32_16x16x32_bf16 v[92:95], a[152:155], v[56:59], v[92:95]
    v_mfma_f32_16x16x32_bf16 v[92:95], a[156:159], v[60:63], v[92:95]
    s_nop 7
    v_max3_f32 v224, v64, v65, v66
    v_max3_f32 v224, v224, v67, v80
    v_max3_f32 v224, v224, v81, v82
    v_max_f32 v224, v224, v83
    v_max3_f32 v225, v68, v69, v70
    v_max3_f32 v225, v225, v71, v84
    v_max3_f32 v225, v225, v85, v86
    v_max_f32 v225, v225, v87
    v_max3_f32 v226, v72, v73, v74
    v_max3_f32 v226, v226, v75, v88
    v_max3_f32 v226, v226, v89, v90
    v_max_f32 v226, v226, v91
    v_max3_f32 v227, v76, v77, v78
    v_max3_f32 v227, v227, v79, v92
    v_max3_f32 v227, v227, v93, v94
    v_max_f32 v227, v227, v95
    v_mov_b32 v228, v224
    v_mov_b32 v229, v225
    v_mov_b32 v230, v226
    v_mov_b32 v231, v227
    s_nop 1
    v_permlane16_swap_b32 v224, v228
    v_permlane16_swap_b32 v225, v229
    v_permlane16_swap_b32 v226, v230
    v_permlane16_swap_b32 v227, v231
    v_max_f32 v224, v224, v228
    v_max_f32 v225, v225, v229
    v_max_f32 v226, v226, v230
    v_max_f32 v227, v227, v231
    v_mov_b32 v228, v224
    v_mov_b32 v229, v225
    v_mov_b32 v230, v226
    v_mov_b32 v231, v227
    s_nop 1
    v_permlane32_swap_b32 v224, v228
    v_permlane32_swap_b32 v225, v229
    v_permlane32_swap_b32 v226, v230
    v_permlane32_swap_b32 v227, v231
    v_max_f32 v224, v224, v228
    v_max_f32 v225, v225, v229
    v_max_f32 v226, v226, v230
    v_max_f32 v227, v227, v231
    v_max_f32 v224, v224, v180
    v_sub_f32 v228, v180, v224
    v_exp_f32 v228, v228
    v_mov_b32 v180, v224
    v_mul_f32 v176, v176, v228
    v_sub_f32 v64, v64, v224
    v_sub_f32 v65, v65, v224
    v_sub_f32 v66, v66, v224
    v_sub_f32 v67, v67, v224
    v_sub_f32 v80, v80, v224
    v_sub_f32 v81, v81, v224
    v_sub_f32 v82, v82, v224
    v_sub_f32 v83, v83, v224
    v_accvgpr_read_b32 v232, a0
    v_mul_f32 v232, v232, v228
    v_accvgpr_write_b32 a0, v232
    v_accvgpr_read_b32 v232, a1
    v_mul_f32 v232, v232, v228
    v_accvgpr_write_b32 a1, v232
    v_accvgpr_read_b32 v232, a2
    v_mul_f32 v232, v232, v228
    v_accvgpr_write_b32 a2, v232
    v_accvgpr_read_b32 v232, a3
    v_mul_f32 v232, v232, v228
    v_accvgpr_write_b32 a3, v232
    v_accvgpr_read_b32 v232, a16
    v_mul_f32 v232, v232, v228
    v_accvgpr_write_b32 a16, v232
    v_accvgpr_read_b32 v232, a17
    v_mul_f32 v232, v232, v228
    v_accvgpr_write_b32 a17, v232
    v_accvgpr_read_b32 v232, a18
    v_mul_f32 v232, v232, v228
    v_accvgpr_write_b32 a18, v232
    v_accvgpr_read_b32 v232, a19
    v_mul_f32 v232, v232, v228
    v_accvgpr_write_b32 a19, v232
    v_accvgpr_read_b32 v232, a32
    v_mul_f32 v232, v232, v228
    v_accvgpr_write_b32 a32, v232
    v_accvgpr_read_b32 v232, a33
    v_mul_f32 v232, v232, v228
    v_accvgpr_write_b32 a33, v232
    v_accvgpr_read_b32 v232, a34
    v_mul_f32 v232, v232, v228
    v_accvgpr_write_b32 a34, v232
    v_accvgpr_read_b32 v232, a35
    v_mul_f32 v232, v232, v228
    v_accvgpr_write_b32 a35, v232
    v_accvgpr_read_b32 v232, a48
    v_mul_f32 v232, v232, v228
    v_accvgpr_write_b32 a48, v232
    v_accvgpr_read_b32 v232, a49
    v_mul_f32 v232, v232, v228
    v_accvgpr_write_b32 a49, v232
    v_accvgpr_read_b32 v232, a50
    v_mul_f32 v232, v232, v228
    v_accvgpr_write_b32 a50, v232
    v_accvgpr_read_b32 v232, a51
    v_mul_f32 v232, v232, v228
    v_accvgpr_write_b32 a51, v232
    v_accvgpr_read_b32 v232, a64
    v_mul_f32 v232, v232, v228
    v_accvgpr_write_b32 a64, v232
    v_accvgpr_read_b32 v232, a65
    v_mul_f32 v232, v232, v228
    v_accvgpr_write_b32 a65, v232
    v_accvgpr_read_b32 v232, a66
    v_mul_f32 v232, v232, v228
    v_accvgpr_write_b32 a66, v232
    v_accvgpr_read_b32 v232, a67
    v_mul_f32 v232, v232, v228
    v_accvgpr_write_b32 a67, v232
    v_accvgpr_read_b32 v232, a80
    v_mul_f32 v232, v232, v228
    v_accvgpr_write_b32 a80, v232
    v_accvgpr_read_b32 v232, a81
    v_mul_f32 v232, v232, v228
    v_accvgpr_write_b32 a81, v232
    v_accvgpr_read_b32 v232, a82
    v_mul_f32 v232, v232, v228
    v_accvgpr_write_b32 a82, v232
    v_accvgpr_read_b32 v232, a83
    v_mul_f32 v232, v232, v228
    v_accvgpr_write_b32 a83, v232
    v_accvgpr_read_b32 v232, a96
    v_mul_f32 v232, v232, v228
    v_accvgpr_write_b32 a96, v232
    v_accvgpr_read_b32 v232, a97
    v_mul_f32 v232, v232, v228
    v_accvgpr_write_b32 a97, v232
    v_accvgpr_read_b32 v232, a98
    v_mul_f32 v232, v232, v228
    v_accvgpr_write_b32 a98, v232
    v_accvgpr_read_b32 v232, a99
    v_mul_f32 v232, v232, v228
    v_accvgpr_write_b32 a99, v232
    v_accvgpr_read_b32 v232, a112
    v_mul_f32 v232, v232, v228
    v_accvgpr_write_b32 a112, v232
    v_accvgpr_read_b32 v232, a113
    v_mul_f32 v232, v232, v228
    v_accvgpr_write_b32 a113, v232
    v_accvgpr_read_b32 v232, a114
    v_mul_f32 v232, v232, v228
    v_accvgpr_write_b32 a114, v232
    v_accvgpr_read_b32 v232, a115
    v_mul_f32 v232, v232, v228
    v_accvgpr_write_b32 a115, v232
    v_max_f32 v225, v225, v181
    v_sub_f32 v229, v181, v225
    v_exp_f32 v229, v229
    v_mov_b32 v181, v225
    v_mul_f32 v177, v177, v229
    v_sub_f32 v68, v68, v225
    v_sub_f32 v69, v69, v225
    v_sub_f32 v70, v70, v225
    v_sub_f32 v71, v71, v225
    v_sub_f32 v84, v84, v225
    v_sub_f32 v85, v85, v225
    v_sub_f32 v86, v86, v225
    v_sub_f32 v87, v87, v225
    v_accvgpr_read_b32 v232, a4
    v_mul_f32 v232, v232, v229
    v_accvgpr_write_b32 a4, v232
    v_accvgpr_read_b32 v232, a5
    v_mul_f32 v232, v232, v229
    v_accvgpr_write_b32 a5, v232
    v_accvgpr_read_b32 v232, a6
    v_mul_f32 v232, v232, v229
    v_accvgpr_write_b32 a6, v232
    v_accvgpr_read_b32 v232, a7
    v_mul_f32 v232, v232, v229
    v_accvgpr_write_b32 a7, v232
    v_accvgpr_read_b32 v232, a20
    v_mul_f32 v232, v232, v229
    v_accvgpr_write_b32 a20, v232
    v_accvgpr_read_b32 v232, a21
    v_mul_f32 v232, v232, v229
    v_accvgpr_write_b32 a21, v232
    v_accvgpr_read_b32 v232, a22
    v_mul_f32 v232, v232, v229
    v_accvgpr_write_b32 a22, v232
    v_accvgpr_read_b32 v232, a23
    v_mul_f32 v232, v232, v229
    v_accvgpr_write_b32 a23, v232
    v_accvgpr_read_b32 v232, a36
    v_mul_f32 v232, v232, v229
    v_accvgpr_write_b32 a36, v232
    v_accvgpr_read_b32 v232, a37
    v_mul_f32 v232, v232, v229
    v_accvgpr_write_b32 a37, v232
    v_accvgpr_read_b32 v232, a38
    v_mul_f32 v232, v232, v229
    v_accvgpr_write_b32 a38, v232
    v_accvgpr_read_b32 v232, a39
    v_mul_f32 v232, v232, v229
    v_accvgpr_write_b32 a39, v232
    v_accvgpr_read_b32 v232, a52
    v_mul_f32 v232, v232, v229
    v_accvgpr_write_b32 a52, v232
    v_accvgpr_read_b32 v232, a53
    v_mul_f32 v232, v232, v229
    v_accvgpr_write_b32 a53, v232
    v_accvgpr_read_b32 v232, a54
    v_mul_f32 v232, v232, v229
    v_accvgpr_write_b32 a54, v232
    v_accvgpr_read_b32 v232, a55
    v_mul_f32 v232, v232, v229
    v_accvgpr_write_b32 a55, v232
    v_accvgpr_read_b32 v232, a68
    v_mul_f32 v232, v232, v229
    v_accvgpr_write_b32 a68, v232
    v_accvgpr_read_b32 v232, a69
    v_mul_f32 v232, v232, v229
    v_accvgpr_write_b32 a69, v232
    v_accvgpr_read_b32 v232, a70
    v_mul_f32 v232, v232, v229
    v_accvgpr_write_b32 a70, v232
    v_accvgpr_read_b32 v232, a71
    v_mul_f32 v232, v232, v229
    v_accvgpr_write_b32 a71, v232
    v_accvgpr_read_b32 v232, a84
    v_mul_f32 v232, v232, v229
    v_accvgpr_write_b32 a84, v232
    v_accvgpr_read_b32 v232, a85
    v_mul_f32 v232, v232, v229
    v_accvgpr_write_b32 a85, v232
    v_accvgpr_read_b32 v232, a86
    v_mul_f32 v232, v232, v229
    v_accvgpr_write_b32 a86, v232
    v_accvgpr_read_b32 v232, a87
    v_mul_f32 v232, v232, v229
    v_accvgpr_write_b32 a87, v232
    v_accvgpr_read_b32 v232, a100
    v_mul_f32 v232, v232, v229
    v_accvgpr_write_b32 a100, v232
    v_accvgpr_read_b32 v232, a101
    v_mul_f32 v232, v232, v229
    v_accvgpr_write_b32 a101, v232
    v_accvgpr_read_b32 v232, a102
    v_mul_f32 v232, v232, v229
    v_accvgpr_write_b32 a102, v232
    v_accvgpr_read_b32 v232, a103
    v_mul_f32 v232, v232, v229
    v_accvgpr_write_b32 a103, v232
    v_accvgpr_read_b32 v232, a116
    v_mul_f32 v232, v232, v229
    v_accvgpr_write_b32 a116, v232
    v_accvgpr_read_b32 v232, a117
    v_mul_f32 v232, v232, v229
    v_accvgpr_write_b32 a117, v232
    v_accvgpr_read_b32 v232, a118
    v_mul_f32 v232, v232, v229
    v_accvgpr_write_b32 a118, v232
    v_accvgpr_read_b32 v232, a119
    v_mul_f32 v232, v232, v229
    v_accvgpr_write_b32 a119, v232
    v_max_f32 v226, v226, v182
    v_sub_f32 v230, v182, v226
    v_exp_f32 v230, v230
    v_mov_b32 v182, v226
    v_mul_f32 v178, v178, v230
    v_sub_f32 v72, v72, v226
    v_sub_f32 v73, v73, v226
    v_sub_f32 v74, v74, v226
    v_sub_f32 v75, v75, v226
    v_sub_f32 v88, v88, v226
    v_sub_f32 v89, v89, v226
    v_sub_f32 v90, v90, v226
    v_sub_f32 v91, v91, v226
    v_accvgpr_read_b32 v232, a8
    v_mul_f32 v232, v232, v230
    v_accvgpr_write_b32 a8, v232
    v_accvgpr_read_b32 v232, a9
    v_mul_f32 v232, v232, v230
    v_accvgpr_write_b32 a9, v232
    v_accvgpr_read_b32 v232, a10
    v_mul_f32 v232, v232, v230
    v_accvgpr_write_b32 a10, v232
    v_accvgpr_read_b32 v232, a11
    v_mul_f32 v232, v232, v230
    v_accvgpr_write_b32 a11, v232
    v_accvgpr_read_b32 v232, a24
    v_mul_f32 v232, v232, v230
    v_accvgpr_write_b32 a24, v232
    v_accvgpr_read_b32 v232, a25
    v_mul_f32 v232, v232, v230
    v_accvgpr_write_b32 a25, v232
    v_accvgpr_read_b32 v232, a26
    v_mul_f32 v232, v232, v230
    v_accvgpr_write_b32 a26, v232
    v_accvgpr_read_b32 v232, a27
    v_mul_f32 v232, v232, v230
    v_accvgpr_write_b32 a27, v232
    v_accvgpr_read_b32 v232, a40
    v_mul_f32 v232, v232, v230
    v_accvgpr_write_b32 a40, v232
    v_accvgpr_read_b32 v232, a41
    v_mul_f32 v232, v232, v230
    v_accvgpr_write_b32 a41, v232
    v_accvgpr_read_b32 v232, a42
    v_mul_f32 v232, v232, v230
    v_accvgpr_write_b32 a42, v232
    v_accvgpr_read_b32 v232, a43
    v_mul_f32 v232, v232, v230
    v_accvgpr_write_b32 a43, v232
    v_accvgpr_read_b32 v232, a56
    v_mul_f32 v232, v232, v230
    v_accvgpr_write_b32 a56, v232
    v_accvgpr_read_b32 v232, a57
    v_mul_f32 v232, v232, v230
    v_accvgpr_write_b32 a57, v232
    v_accvgpr_read_b32 v232, a58
    v_mul_f32 v232, v232, v230
    v_accvgpr_write_b32 a58, v232
    v_accvgpr_read_b32 v232, a59
    v_mul_f32 v232, v232, v230
    v_accvgpr_write_b32 a59, v232
    v_accvgpr_read_b32 v232, a72
    v_mul_f32 v232, v232, v230
    v_accvgpr_write_b32 a72, v232
    v_accvgpr_read_b32 v232, a73
    v_mul_f32 v232, v232, v230
    v_accvgpr_write_b32 a73, v232
    v_accvgpr_read_b32 v232, a74
    v_mul_f32 v232, v232, v230
    v_accvgpr_write_b32 a74, v232
    v_accvgpr_read_b32 v232, a75
    v_mul_f32 v232, v232, v230
    v_accvgpr_write_b32 a75, v232
    v_accvgpr_read_b32 v232, a88
    v_mul_f32 v232, v232, v230
    v_accvgpr_write_b32 a88, v232
    v_accvgpr_read_b32 v232, a89
    v_mul_f32 v232, v232, v230
    v_accvgpr_write_b32 a89, v232
    v_accvgpr_read_b32 v232, a90
    v_mul_f32 v232, v232, v230
    v_accvgpr_write_b32 a90, v232
    v_accvgpr_read_b32 v232, a91
    v_mul_f32 v232, v232, v230
    v_accvgpr_write_b32 a91, v232
    v_accvgpr_read_b32 v232, a104
    v_mul_f32 v232, v232, v230
    v_accvgpr_write_b32 a104, v232
    v_accvgpr_read_b32 v232, a105
    v_mul_f32 v232, v232, v230
    v_accvgpr_write_b32 a105, v232
    v_accvgpr_read_b32 v232, a106
    v_mul_f32 v232, v232, v230
    v_accvgpr_write_b32 a106, v232
    v_accvgpr_read_b32 v232, a107
    v_mul_f32 v232, v232, v230
    v_accvgpr_write_b32 a107, v232
    v_accvgpr_read_b32 v232, a120
    v_mul_f32 v232, v232, v230
    v_accvgpr_write_b32 a120, v232
    v_accvgpr_read_b32 v232, a121
    v_mul_f32 v232, v232, v230
    v_accvgpr_write_b32 a121, v232
    v_accvgpr_read_b32 v232, a122
    v_mul_f32 v232, v232, v230
    v_accvgpr_write_b32 a122, v232
    v_accvgpr_read_b32 v232, a123
    v_mul_f32 v232, v232, v230
    v_accvgpr_write_b32 a123, v232
    v_max_f32 v227, v227, v183
    v_sub_f32 v231, v183, v227
    v_exp_f32 v231, v231
    v_mov_b32 v183, v227
    v_mul_f32 v179, v179, v231
    v_sub_f32 v76, v76, v227
    v_sub_f32 v77, v77, v227
    v_sub_f32 v78, v78, v227
    v_sub_f32 v79, v79, v227
    v_sub_f32 v92, v92, v227
    v_sub_f32 v93, v93, v227
    v_sub_f32 v94, v94, v227
    v_sub_f32 v95, v95, v227
    v_accvgpr_read_b32 v232, a12
    v_mul_f32 v232, v232, v231
    v_accvgpr_write_b32 a12, v232
    v_accvgpr_read_b32 v232, a13
    v_mul_f32 v232, v232, v231
    v_accvgpr_write_b32 a13, v232
    v_accvgpr_read_b32 v232, a14
    v_mul_f32 v232, v232, v231
    v_accvgpr_write_b32 a14, v232
    v_accvgpr_read_b32 v232, a15
    v_mul_f32 v232, v232, v231
    v_accvgpr_write_b32 a15, v232
    v_accvgpr_read_b32 v232, a28
    v_mul_f32 v232, v232, v231
    v_accvgpr_write_b32 a28, v232
    v_accvgpr_read_b32 v232, a29
    v_mul_f32 v232, v232, v231
    v_accvgpr_write_b32 a29, v232
    v_accvgpr_read_b32 v232, a30
    v_mul_f32 v232, v232, v231
    v_accvgpr_write_b32 a30, v232
    v_accvgpr_read_b32 v232, a31
    v_mul_f32 v232, v232, v231
    v_accvgpr_write_b32 a31, v232
    v_accvgpr_read_b32 v232, a44
    v_mul_f32 v232, v232, v231
    v_accvgpr_write_b32 a44, v232
    v_accvgpr_read_b32 v232, a45
    v_mul_f32 v232, v232, v231
    v_accvgpr_write_b32 a45, v232
    v_accvgpr_read_b32 v232, a46
    v_mul_f32 v232, v232, v231
    v_accvgpr_write_b32 a46, v232
    v_accvgpr_read_b32 v232, a47
    v_mul_f32 v232, v232, v231
    v_accvgpr_write_b32 a47, v232
    v_accvgpr_read_b32 v232, a60
    v_mul_f32 v232, v232, v231
    v_accvgpr_write_b32 a60, v232
    v_accvgpr_read_b32 v232, a61
    v_mul_f32 v232, v232, v231
    v_accvgpr_write_b32 a61, v232
    v_accvgpr_read_b32 v232, a62
    v_mul_f32 v232, v232, v231
    v_accvgpr_write_b32 a62, v232
    v_accvgpr_read_b32 v232, a63
    v_mul_f32 v232, v232, v231
    v_accvgpr_write_b32 a63, v232
    v_accvgpr_read_b32 v232, a76
    v_mul_f32 v232, v232, v231
    v_accvgpr_write_b32 a76, v232
    v_accvgpr_read_b32 v232, a77
    v_mul_f32 v232, v232, v231
    v_accvgpr_write_b32 a77, v232
    v_accvgpr_read_b32 v232, a78
    v_mul_f32 v232, v232, v231
    v_accvgpr_write_b32 a78, v232
    v_accvgpr_read_b32 v232, a79
    v_mul_f32 v232, v232, v231
    v_accvgpr_write_b32 a79, v232
    v_accvgpr_read_b32 v232, a92
    v_mul_f32 v232, v232, v231
    v_accvgpr_write_b32 a92, v232
    v_accvgpr_read_b32 v232, a93
    v_mul_f32 v232, v232, v231
    v_accvgpr_write_b32 a93, v232
    v_accvgpr_read_b32 v232, a94
    v_mul_f32 v232, v232, v231
    v_accvgpr_write_b32 a94, v232
    v_accvgpr_read_b32 v232, a95
    v_mul_f32 v232, v232, v231
    v_accvgpr_write_b32 a95, v232
    v_accvgpr_read_b32 v232, a108
    v_mul_f32 v232, v232, v231
    v_accvgpr_write_b32 a108, v232
    v_accvgpr_read_b32 v232, a109
    v_mul_f32 v232, v232, v231
    v_accvgpr_write_b32 a109, v232
    v_accvgpr_read_b32 v232, a110
    v_mul_f32 v232, v232, v231
    v_accvgpr_write_b32 a110, v232
    v_accvgpr_read_b32 v232, a111
    v_mul_f32 v232, v232, v231
    v_accvgpr_write_b32 a111, v232
    v_accvgpr_read_b32 v232, a124
    v_mul_f32 v232, v232, v231
    v_accvgpr_write_b32 a124, v232
    v_accvgpr_read_b32 v232, a125
    v_mul_f32 v232, v232, v231
    v_accvgpr_write_b32 a125, v232
    v_accvgpr_read_b32 v232, a126
    v_mul_f32 v232, v232, v231
    v_accvgpr_write_b32 a126, v232
    v_accvgpr_read_b32 v232, a127
    v_mul_f32 v232, v232, v231
    v_accvgpr_write_b32 a127, v232
    v_exp_f32 v64, v64
    v_exp_f32 v65, v65
    v_exp_f32 v66, v66
    v_add_f32 v176, v176, v64
    v_exp_f32 v67, v67
    v_add_f32 v176, v176, v65
    v_cvt_pk_bf16_f32 v128, v64, v65
    v_exp_f32 v80, v80
    v_add_f32 v176, v176, v66
    v_exp_f32 v81, v81
    v_add_f32 v176, v176, v67
    v_cvt_pk_bf16_f32 v129, v66, v67
    v_exp_f32 v82, v82
    v_add_f32 v176, v176, v80
    v_exp_f32 v83, v83
    v_add_f32 v176, v176, v81
    v_cvt_pk_bf16_f32 v130, v80, v81
    v_exp_f32 v68, v68
    v_add_f32 v176, v176, v82
    v_exp_f32 v69, v69
    v_add_f32 v176, v176, v83
    v_cvt_pk_bf16_f32 v131, v82, v83
    v_exp_f32 v70, v70
    v_add_f32 v177, v177, v68
    v_exp_f32 v71, v71
    v_add_f32 v177, v177, v69
    v_cvt_pk_bf16_f32 v132, v68, v69
    v_exp_f32 v84, v84
    v_add_f32 v177, v177, v70
    v_exp_f32 v85, v85
    v_add_f32 v177, v177, v71
    v_cvt_pk_bf16_f32 v133, v70, v71
    v_exp_f32 v86, v86
    v_add_f32 v177, v177, v84
    v_exp_f32 v87, v87
    v_add_f32 v177, v177, v85
    v_cvt_pk_bf16_f32 v134, v84, v85
    v_exp_f32 v72, v72
    v_add_f32 v177, v177, v86
    v_exp_f32 v73, v73
    v_add_f32 v177, v177, v87
    v_cvt_pk_bf16_f32 v135, v86, v87
    v_exp_f32 v74, v74
    v_add_f32 v178, v178, v72
    v_exp_f32 v75, v75
    v_add_f32 v178, v178, v73
    v_cvt_pk_bf16_f32 v136, v72, v73
    v_exp_f32 v88, v88
    v_add_f32 v178, v178, v74
    v_exp_f32 v89, v89
    v_add_f32 v178, v178, v75
    v_cvt_pk_bf16_f32 v137, v74, v75
    v_exp_f32 v90, v90
    v_add_f32 v178, v178, v88
    v_exp_f32 v91, v91
    v_add_f32 v178, v178, v89
    v_cvt_pk_bf16_f32 v138, v88, v89
    v_exp_f32 v76, v76
    v_add_f32 v178, v178, v90
    v_exp_f32 v77, v77
    v_add_f32 v178, v178, v91
    v_cvt_pk_bf16_f32 v139, v90, v91
    v_exp_f32 v78, v78
    v_add_f32 v179, v179, v76
    v_exp_f32 v79, v79
    v_add_f32 v179, v179, v77
    v_cvt_pk_bf16_f32 v140, v76, v77
    v_exp_f32 v92, v92
    v_add_f32 v179, v179, v78
    v_exp_f32 v93, v93
    v_add_f32 v179, v179, v79
    v_cvt_pk_bf16_f32 v141, v78, v79
    v_exp_f32 v94, v94
    v_add_f32 v179, v179, v92
    v_exp_f32 v95, v95
    v_add_f32 v179, v179, v93
    v_cvt_pk_bf16_f32 v142, v92, v93
    s_nop 0
    v_add_f32 v179, v179, v94
    v_add_f32 v179, v179, v95
    v_cvt_pk_bf16_f32 v143, v94, v95
    s_waitcnt lgkmcnt(0)
    s_nop 1
    v_mfma_f32_16x16x32_bf16 a[0:3], a[160:163], v[128:131], a[0:3]
    v_mfma_f32_16x16x32_bf16 a[4:7], a[160:163], v[132:135], a[4:7]
    v_mfma_f32_16x16x32_bf16 a[8:11], a[160:163], v[136:139], a[8:11]
    v_mfma_f32_16x16x32_bf16 a[12:15], a[160:163], v[140:143], a[12:15]
    v_mfma_f32_16x16x32_bf16 a[16:19], a[164:167], v[128:131], a[16:19]
    v_mfma_f32_16x16x32_bf16 a[20:23], a[164:167], v[132:135], a[20:23]
    v_mfma_f32_16x16x32_bf16 a[24:27], a[164:167], v[136:139], a[24:27]
    v_mfma_f32_16x16x32_bf16 a[28:31], a[164:167], v[140:143], a[28:31]
    v_mfma_f32_16x16x32_bf16 a[32:35], a[168:171], v[128:131], a[32:35]
    v_mfma_f32_16x16x32_bf16 a[36:39], a[168:171], v[132:135], a[36:39]
    v_mfma_f32_16x16x32_bf16 a[40:43], a[168:171], v[136:139], a[40:43]
    v_mfma_f32_16x16x32_bf16 a[44:47], a[168:171], v[140:143], a[44:47]
    v_mfma_f32_16x16x32_bf16 a[48:51], a[172:175], v[128:131], a[48:51]
    v_mfma_f32_16x16x32_bf16 a[52:55], a[172:175], v[132:135], a[52:55]
    v_mfma_f32_16x16x32_bf16 a[56:59], a[172:175], v[136:139], a[56:59]
    v_mfma_f32_16x16x32_bf16 a[60:63], a[172:175], v[140:143], a[60:63]
    v_mfma_f32_16x16x32_bf16 a[64:67], a[176:179], v[128:131], a[64:67]
    v_mfma_f32_16x16x32_bf16 a[68:71], a[176:179], v[132:135], a[68:71]
    v_mfma_f32_16x16x32_bf16 a[72:75], a[176:179], v[136:139], a[72:75]
    v_mfma_f32_16x16x32_bf16 a[76:79], a[176:179], v[140:143], a[76:79]
    v_mfma_f32_16x16x32_bf16 a[80:83], a[180:183], v[128:131], a[80:83]
    v_mfma_f32_16x16x32_bf16 a[84:87], a[180:183], v[132:135], a[84:87]
    v_mfma_f32_16x16x32_bf16 a[88:91], a[180:183], v[136:139], a[88:91]
    v_mfma_f32_16x16x32_bf16 a[92:95], a[180:183], v[140:143], a[92:95]
    v_mfma_f32_16x16x32_bf16 a[96:99], a[184:187], v[128:131], a[96:99]
    v_mfma_f32_16x16x32_bf16 a[100:103], a[184:187], v[132:135], a[100:103]
    v_mfma_f32_16x16x32_bf16 a[104:107], a[184:187], v[136:139], a[104:107]
    v_mfma_f32_16x16x32_bf16 a[108:111], a[184:187], v[140:143], a[108:111]
    v_mfma_f32_16x16x32_bf16 a[112:115], a[188:191], v[128:131], a[112:115]
    v_mfma_f32_16x16x32_bf16 a[116:119], a[188:191], v[132:135], a[116:119]
    v_mfma_f32_16x16x32_bf16 a[120:123], a[188:191], v[136:139], a[120:123]
    v_mfma_f32_16x16x32_bf16 a[124:127], a[188:191], v[140:143], a[124:127]
    s_nop 7
    ds_read_b128 a[128:131], v192 offset:8192
    ds_read_b128 a[132:135], v193 offset:8192
    ds_read_b128 a[136:139], v194 offset:8192
    ds_read_b128 a[140:143], v195 offset:8192
    ds_read_b128 a[144:147], v192 offset:12288
    ds_read_b128 a[148:151], v193 offset:12288
    ds_read_b128 a[152:155], v194 offset:12288
    ds_read_b128 a[156:159], v195 offset:12288
    s_waitcnt lgkmcnt(0)
    ds_read_b64_tr_b16 a[160:161], v196 offset:8192
    ds_read_b64_tr_b16 a[162:163], v196 offset:12288
    ds_read_b64_tr_b16 a[164:165], v197 offset:8192
    ds_read_b64_tr_b16 a[166:167], v197 offset:12288
    ds_read_b64_tr_b16 a[168:169], v198 offset:8192
    ds_read_b64_tr_b16 a[170:171], v198 offset:12288
    ds_read_b64_tr_b16 a[172:173], v199 offset:8192
    ds_read_b64_tr_b16 a[174:175], v199 offset:12288
    ds_read_b64_tr_b16 a[176:177], v200 offset:8192
    ds_read_b64_tr_b16 a[178:179], v200 offset:12288
    ds_read_b64_tr_b16 a[180:181], v201 offset:8192
    ds_read_b64_tr_b16 a[182:183], v201 offset:12288
    ds_read_b64_tr_b16 a[184:185], v202 offset:8192
    ds_read_b64_tr_b16 a[186:187], v202 offset:12288
    ds_read_b64_tr_b16 a[188:189], v203 offset:8192
    ds_read_b64_tr_b16 a[190:191], v203 offset:12288
    v_mfma_f32_16x16x32_bf16 v[96:99], a[128:131], v[0:3], 0
    v_mfma_f32_16x16x32_bf16 v[96:99], a[132:135], v[4:7], v[96:99]
    v_mfma_f32_16x16x32_bf16 v[96:99], a[136:139], v[8:11], v[96:99]
    v_mfma_f32_16x16x32_bf16 v[96:99], a[140:143], v[12:15], v[96:99]
    v_mfma_f32_16x16x32_bf16 v[100:103], a[128:131], v[16:19], 0
    v_mfma_f32_16x16x32_bf16 v[100:103], a[132:135], v[20:23], v[100:103]
    v_mfma_f32_16x16x32_bf16 v[100:103], a[136:139], v[24:27], v[100:103]
    v_mfma_f32_16x16x32_bf16 v[100:103], a[140:143], v[28:31], v[100:103]
    v_mfma_f32_16x16x32_bf16 v[104:107], a[128:131], v[32:35], 0
    v_mfma_f32_16x16x32_bf16 v[104:107], a[132:135], v[36:39], v[104:107]
    v_mfma_f32_16x16x32_bf16 v[104:107], a[136:139], v[40:43], v[104:107]
    v_mfma_f32_16x16x32_bf16 v[104:107], a[140:143], v[44:47], v[104:107]
    v_mfma_f32_16x16x32_bf16 v[108:111], a[128:131], v[48:51], 0
    v_mfma_f32_16x16x32_bf16 v[108:111], a[132:135], v[52:55], v[108:111]
    v_mfma_f32_16x16x32_bf16 v[108:111], a[136:139], v[56:59], v[108:111]
    v_mfma_f32_16x16x32_bf16 v[108:111], a[140:143], v[60:63], v[108:111]
    v_mfma_f32_16x16x32_bf16 v[112:115], a[144:147], v[0:3], 0
    v_mfma_f32_16x16x32_bf16 v[112:115], a[148:151], v[4:7], v[112:115]
    v_mfma_f32_16x16x32_bf16 v[112:115], a[152:155], v[8:11], v[112:115]
    v_mfma_f32_16x16x32_bf16 v[112:115], a[156:159], v[12:15], v[112:115]
    v_mfma_f32_16x16x32_bf16 v[116:119], a[144:147], v[16:19], 0
    v_mfma_f32_16x16x32_bf16 v[116:119], a[148:151], v[20:23], v[116:119]
    v_mfma_f32_16x16x32_bf16 v[116:119], a[152:155], v[24:27], v[116:119]
    v_mfma_f32_16x16x32_bf16 v[116:119], a[156:159], v[28:31], v[116:119]
    v_mfma_f32_16x16x32_bf16 v[120:123], a[144:147], v[32:35], 0
    v_mfma_f32_16x16x32_bf16 v[120:123], a[148:151], v[36:39], v[120:123]
    v_mfma_f32_16x16x32_bf16 v[120:123], a[152:155], v[40:43], v[120:123]
    v_mfma_f32_16x16x32_bf16 v[120:123], a[156:159], v[44:47], v[120:123]
    v_mfma_f32_16x16x32_bf16 v[124:127], a[144:147], v[48:51], 0
    v_mfma_f32_16x16x32_bf16 v[124:127], a[148:151], v[52:55], v[124:127]
    v_mfma_f32_16x16x32_bf16 v[124:127], a[152:155], v[56:59], v[124:127]
    v_mfma_f32_16x16x32_bf16 v[124:127], a[156:159], v[60:63], v[124:127]
    s_nop 7
    v_max3_f32 v224, v96, v97, v98
    v_max3_f32 v224, v224, v99, v112
    v_max3_f32 v224, v224, v113, v114
    v_max_f32 v224, v224, v115
    v_max3_f32 v225, v100, v101, v102
    v_max3_f32 v225, v225, v103, v116
    v_max3_f32 v225, v225, v117, v118
    v_max_f32 v225, v225, v119
    v_max3_f32 v226, v104, v105, v106
    v_max3_f32 v226, v226, v107, v120
    v_max3_f32 v226, v226, v121, v122
    v_max_f32 v226, v226, v123
    v_max3_f32 v227, v108, v109, v110
    v_max3_f32 v227, v227, v111, v124
    v_max3_f32 v227, v227, v125, v126
    v_max_f32 v227, v227, v127
    v_mov_b32 v228, v224
    v_mov_b32 v229, v225
    v_mov_b32 v230, v226
    v_mov_b32 v231, v227
    s_nop 1
    v_permlane16_swap_b32 v224, v228
    v_permlane16_swap_b32 v225, v229
    v_permlane16_swap_b32 v226, v230
    v_permlane16_swap_b32 v227, v231
    v_max_f32 v224, v224, v228
    v_max_f32 v225, v225, v229
    v_max_f32 v226, v226, v230
    v_max_f32 v227, v227, v231
    v_mov_b32 v228, v224
    v_mov_b32 v229, v225
    v_mov_b32 v230, v226
    v_mov_b32 v231, v227
    s_nop 1
    v_permlane32_swap_b32 v224, v228
    v_permlane32_swap_b32 v225, v229
    v_permlane32_swap_b32 v226, v230
    v_permlane32_swap_b32 v227, v231
    v_max_f32 v224, v224, v228
    v_max_f32 v225, v225, v229
    v_max_f32 v226, v226, v230
    v_max_f32 v227, v227, v231
    v_max_f32 v224, v224, v180
    v_sub_f32 v228, v180, v224
    v_exp_f32 v228, v228
    v_mov_b32 v180, v224
    v_mul_f32 v176, v176, v228
    v_sub_f32 v96, v96, v224
    v_sub_f32 v97, v97, v224
    v_sub_f32 v98, v98, v224
    v_sub_f32 v99, v99, v224
    v_sub_f32 v112, v112, v224
    v_sub_f32 v113, v113, v224
    v_sub_f32 v114, v114, v224
    v_sub_f32 v115, v115, v224
    v_accvgpr_read_b32 v232, a0
    v_mul_f32 v232, v232, v228
    v_accvgpr_write_b32 a0, v232
    v_accvgpr_read_b32 v232, a1
    v_mul_f32 v232, v232, v228
    v_accvgpr_write_b32 a1, v232
    v_accvgpr_read_b32 v232, a2
    v_mul_f32 v232, v232, v228
    v_accvgpr_write_b32 a2, v232
    v_accvgpr_read_b32 v232, a3
    v_mul_f32 v232, v232, v228
    v_accvgpr_write_b32 a3, v232
    v_accvgpr_read_b32 v232, a16
    v_mul_f32 v232, v232, v228
    v_accvgpr_write_b32 a16, v232
    v_accvgpr_read_b32 v232, a17
    v_mul_f32 v232, v232, v228
    v_accvgpr_write_b32 a17, v232
    v_accvgpr_read_b32 v232, a18
    v_mul_f32 v232, v232, v228
    v_accvgpr_write_b32 a18, v232
    v_accvgpr_read_b32 v232, a19
    v_mul_f32 v232, v232, v228
    v_accvgpr_write_b32 a19, v232
    v_accvgpr_read_b32 v232, a32
    v_mul_f32 v232, v232, v228
    v_accvgpr_write_b32 a32, v232
    v_accvgpr_read_b32 v232, a33
    v_mul_f32 v232, v232, v228
    v_accvgpr_write_b32 a33, v232
    v_accvgpr_read_b32 v232, a34
    v_mul_f32 v232, v232, v228
    v_accvgpr_write_b32 a34, v232
    v_accvgpr_read_b32 v232, a35
    v_mul_f32 v232, v232, v228
    v_accvgpr_write_b32 a35, v232
    v_accvgpr_read_b32 v232, a48
    v_mul_f32 v232, v232, v228
    v_accvgpr_write_b32 a48, v232
    v_accvgpr_read_b32 v232, a49
    v_mul_f32 v232, v232, v228
    v_accvgpr_write_b32 a49, v232
    v_accvgpr_read_b32 v232, a50
    v_mul_f32 v232, v232, v228
    v_accvgpr_write_b32 a50, v232
    v_accvgpr_read_b32 v232, a51
    v_mul_f32 v232, v232, v228
    v_accvgpr_write_b32 a51, v232
    v_accvgpr_read_b32 v232, a64
    v_mul_f32 v232, v232, v228
    v_accvgpr_write_b32 a64, v232
    v_accvgpr_read_b32 v232, a65
    v_mul_f32 v232, v232, v228
    v_accvgpr_write_b32 a65, v232
    v_accvgpr_read_b32 v232, a66
    v_mul_f32 v232, v232, v228
    v_accvgpr_write_b32 a66, v232
    v_accvgpr_read_b32 v232, a67
    v_mul_f32 v232, v232, v228
    v_accvgpr_write_b32 a67, v232
    v_accvgpr_read_b32 v232, a80
    v_mul_f32 v232, v232, v228
    v_accvgpr_write_b32 a80, v232
    v_accvgpr_read_b32 v232, a81
    v_mul_f32 v232, v232, v228
    v_accvgpr_write_b32 a81, v232
    v_accvgpr_read_b32 v232, a82
    v_mul_f32 v232, v232, v228
    v_accvgpr_write_b32 a82, v232
    v_accvgpr_read_b32 v232, a83
    v_mul_f32 v232, v232, v228
    v_accvgpr_write_b32 a83, v232
    v_accvgpr_read_b32 v232, a96
    v_mul_f32 v232, v232, v228
    v_accvgpr_write_b32 a96, v232
    v_accvgpr_read_b32 v232, a97
    v_mul_f32 v232, v232, v228
    v_accvgpr_write_b32 a97, v232
    v_accvgpr_read_b32 v232, a98
    v_mul_f32 v232, v232, v228
    v_accvgpr_write_b32 a98, v232
    v_accvgpr_read_b32 v232, a99
    v_mul_f32 v232, v232, v228
    v_accvgpr_write_b32 a99, v232
    v_accvgpr_read_b32 v232, a112
    v_mul_f32 v232, v232, v228
    v_accvgpr_write_b32 a112, v232
    v_accvgpr_read_b32 v232, a113
    v_mul_f32 v232, v232, v228
    v_accvgpr_write_b32 a113, v232
    v_accvgpr_read_b32 v232, a114
    v_mul_f32 v232, v232, v228
    v_accvgpr_write_b32 a114, v232
    v_accvgpr_read_b32 v232, a115
    v_mul_f32 v232, v232, v228
    v_accvgpr_write_b32 a115, v232
    v_max_f32 v225, v225, v181
    v_sub_f32 v229, v181, v225
    v_exp_f32 v229, v229
    v_mov_b32 v181, v225
    v_mul_f32 v177, v177, v229
    v_sub_f32 v100, v100, v225
    v_sub_f32 v101, v101, v225
    v_sub_f32 v102, v102, v225
    v_sub_f32 v103, v103, v225
    v_sub_f32 v116, v116, v225
    v_sub_f32 v117, v117, v225
    v_sub_f32 v118, v118, v225
    v_sub_f32 v119, v119, v225
    v_accvgpr_read_b32 v232, a4
    v_mul_f32 v232, v232, v229
    v_accvgpr_write_b32 a4, v232
    v_accvgpr_read_b32 v232, a5
    v_mul_f32 v232, v232, v229
    v_accvgpr_write_b32 a5, v232
    v_accvgpr_read_b32 v232, a6
    v_mul_f32 v232, v232, v229
    v_accvgpr_write_b32 a6, v232
    v_accvgpr_read_b32 v232, a7
    v_mul_f32 v232, v232, v229
    v_accvgpr_write_b32 a7, v232
    v_accvgpr_read_b32 v232, a20
    v_mul_f32 v232, v232, v229
    v_accvgpr_write_b32 a20, v232
    v_accvgpr_read_b32 v232, a21
    v_mul_f32 v232, v232, v229
    v_accvgpr_write_b32 a21, v232
    v_accvgpr_read_b32 v232, a22
    v_mul_f32 v232, v232, v229
    v_accvgpr_write_b32 a22, v232
    v_accvgpr_read_b32 v232, a23
    v_mul_f32 v232, v232, v229
    v_accvgpr_write_b32 a23, v232
    v_accvgpr_read_b32 v232, a36
    v_mul_f32 v232, v232, v229
    v_accvgpr_write_b32 a36, v232
    v_accvgpr_read_b32 v232, a37
    v_mul_f32 v232, v232, v229
    v_accvgpr_write_b32 a37, v232
    v_accvgpr_read_b32 v232, a38
    v_mul_f32 v232, v232, v229
    v_accvgpr_write_b32 a38, v232
    v_accvgpr_read_b32 v232, a39
    v_mul_f32 v232, v232, v229
    v_accvgpr_write_b32 a39, v232
    v_accvgpr_read_b32 v232, a52
    v_mul_f32 v232, v232, v229
    v_accvgpr_write_b32 a52, v232
    v_accvgpr_read_b32 v232, a53
    v_mul_f32 v232, v232, v229
    v_accvgpr_write_b32 a53, v232
    v_accvgpr_read_b32 v232, a54
    v_mul_f32 v232, v232, v229
    v_accvgpr_write_b32 a54, v232
    v_accvgpr_read_b32 v232, a55
    v_mul_f32 v232, v232, v229
    v_accvgpr_write_b32 a55, v232
    v_accvgpr_read_b32 v232, a68
    v_mul_f32 v232, v232, v229
    v_accvgpr_write_b32 a68, v232
    v_accvgpr_read_b32 v232, a69
    v_mul_f32 v232, v232, v229
    v_accvgpr_write_b32 a69, v232
    v_accvgpr_read_b32 v232, a70
    v_mul_f32 v232, v232, v229
    v_accvgpr_write_b32 a70, v232
    v_accvgpr_read_b32 v232, a71
    v_mul_f32 v232, v232, v229
    v_accvgpr_write_b32 a71, v232
    v_accvgpr_read_b32 v232, a84
    v_mul_f32 v232, v232, v229
    v_accvgpr_write_b32 a84, v232
    v_accvgpr_read_b32 v232, a85
    v_mul_f32 v232, v232, v229
    v_accvgpr_write_b32 a85, v232
    v_accvgpr_read_b32 v232, a86
    v_mul_f32 v232, v232, v229
    v_accvgpr_write_b32 a86, v232
    v_accvgpr_read_b32 v232, a87
    v_mul_f32 v232, v232, v229
    v_accvgpr_write_b32 a87, v232
    v_accvgpr_read_b32 v232, a100
    v_mul_f32 v232, v232, v229
    v_accvgpr_write_b32 a100, v232
    v_accvgpr_read_b32 v232, a101
    v_mul_f32 v232, v232, v229
    v_accvgpr_write_b32 a101, v232
    v_accvgpr_read_b32 v232, a102
    v_mul_f32 v232, v232, v229
    v_accvgpr_write_b32 a102, v232
    v_accvgpr_read_b32 v232, a103
    v_mul_f32 v232, v232, v229
    v_accvgpr_write_b32 a103, v232
    v_accvgpr_read_b32 v232, a116
    v_mul_f32 v232, v232, v229
    v_accvgpr_write_b32 a116, v232
    v_accvgpr_read_b32 v232, a117
    v_mul_f32 v232, v232, v229
    v_accvgpr_write_b32 a117, v232
    v_accvgpr_read_b32 v232, a118
    v_mul_f32 v232, v232, v229
    v_accvgpr_write_b32 a118, v232
    v_accvgpr_read_b32 v232, a119
    v_mul_f32 v232, v232, v229
    v_accvgpr_write_b32 a119, v232
    v_max_f32 v226, v226, v182
    v_sub_f32 v230, v182, v226
    v_exp_f32 v230, v230
    v_mov_b32 v182, v226
    v_mul_f32 v178, v178, v230
    v_sub_f32 v104, v104, v226
    v_sub_f32 v105, v105, v226
    v_sub_f32 v106, v106, v226
    v_sub_f32 v107, v107, v226
    v_sub_f32 v120, v120, v226
    v_sub_f32 v121, v121, v226
    v_sub_f32 v122, v122, v226
    v_sub_f32 v123, v123, v226
    v_accvgpr_read_b32 v232, a8
    v_mul_f32 v232, v232, v230
    v_accvgpr_write_b32 a8, v232
    v_accvgpr_read_b32 v232, a9
    v_mul_f32 v232, v232, v230
    v_accvgpr_write_b32 a9, v232
    v_accvgpr_read_b32 v232, a10
    v_mul_f32 v232, v232, v230
    v_accvgpr_write_b32 a10, v232
    v_accvgpr_read_b32 v232, a11
    v_mul_f32 v232, v232, v230
    v_accvgpr_write_b32 a11, v232
    v_accvgpr_read_b32 v232, a24
    v_mul_f32 v232, v232, v230
    v_accvgpr_write_b32 a24, v232
    v_accvgpr_read_b32 v232, a25
    v_mul_f32 v232, v232, v230
    v_accvgpr_write_b32 a25, v232
    v_accvgpr_read_b32 v232, a26
    v_mul_f32 v232, v232, v230
    v_accvgpr_write_b32 a26, v232
    v_accvgpr_read_b32 v232, a27
    v_mul_f32 v232, v232, v230
    v_accvgpr_write_b32 a27, v232
    v_accvgpr_read_b32 v232, a40
    v_mul_f32 v232, v232, v230
    v_accvgpr_write_b32 a40, v232
    v_accvgpr_read_b32 v232, a41
    v_mul_f32 v232, v232, v230
    v_accvgpr_write_b32 a41, v232
    v_accvgpr_read_b32 v232, a42
    v_mul_f32 v232, v232, v230
    v_accvgpr_write_b32 a42, v232
    v_accvgpr_read_b32 v232, a43
    v_mul_f32 v232, v232, v230
    v_accvgpr_write_b32 a43, v232
    v_accvgpr_read_b32 v232, a56
    v_mul_f32 v232, v232, v230
    v_accvgpr_write_b32 a56, v232
    v_accvgpr_read_b32 v232, a57
    v_mul_f32 v232, v232, v230
    v_accvgpr_write_b32 a57, v232
    v_accvgpr_read_b32 v232, a58
    v_mul_f32 v232, v232, v230
    v_accvgpr_write_b32 a58, v232
    v_accvgpr_read_b32 v232, a59
    v_mul_f32 v232, v232, v230
    v_accvgpr_write_b32 a59, v232
    v_accvgpr_read_b32 v232, a72
    v_mul_f32 v232, v232, v230
    v_accvgpr_write_b32 a72, v232
    v_accvgpr_read_b32 v232, a73
    v_mul_f32 v232, v232, v230
    v_accvgpr_write_b32 a73, v232
    v_accvgpr_read_b32 v232, a74
    v_mul_f32 v232, v232, v230
    v_accvgpr_write_b32 a74, v232
    v_accvgpr_read_b32 v232, a75
    v_mul_f32 v232, v232, v230
    v_accvgpr_write_b32 a75, v232
    v_accvgpr_read_b32 v232, a88
    v_mul_f32 v232, v232, v230
    v_accvgpr_write_b32 a88, v232
    v_accvgpr_read_b32 v232, a89
    v_mul_f32 v232, v232, v230
    v_accvgpr_write_b32 a89, v232
    v_accvgpr_read_b32 v232, a90
    v_mul_f32 v232, v232, v230
    v_accvgpr_write_b32 a90, v232
    v_accvgpr_read_b32 v232, a91
    v_mul_f32 v232, v232, v230
    v_accvgpr_write_b32 a91, v232
    v_accvgpr_read_b32 v232, a104
    v_mul_f32 v232, v232, v230
    v_accvgpr_write_b32 a104, v232
    v_accvgpr_read_b32 v232, a105
    v_mul_f32 v232, v232, v230
    v_accvgpr_write_b32 a105, v232
    v_accvgpr_read_b32 v232, a106
    v_mul_f32 v232, v232, v230
    v_accvgpr_write_b32 a106, v232
    v_accvgpr_read_b32 v232, a107
    v_mul_f32 v232, v232, v230
    v_accvgpr_write_b32 a107, v232
    v_accvgpr_read_b32 v232, a120
    v_mul_f32 v232, v232, v230
    v_accvgpr_write_b32 a120, v232
    v_accvgpr_read_b32 v232, a121
    v_mul_f32 v232, v232, v230
    v_accvgpr_write_b32 a121, v232
    v_accvgpr_read_b32 v232, a122
    v_mul_f32 v232, v232, v230
    v_accvgpr_write_b32 a122, v232
    v_accvgpr_read_b32 v232, a123
    v_mul_f32 v232, v232, v230
    v_accvgpr_write_b32 a123, v232
    v_max_f32 v227, v227, v183
    v_sub_f32 v231, v183, v227
    v_exp_f32 v231, v231
    v_mov_b32 v183, v227
    v_mul_f32 v179, v179, v231
    v_sub_f32 v108, v108, v227
    v_sub_f32 v109, v109, v227
    v_sub_f32 v110, v110, v227
    v_sub_f32 v111, v111, v227
    v_sub_f32 v124, v124, v227
    v_sub_f32 v125, v125, v227
    v_sub_f32 v126, v126, v227
    v_sub_f32 v127, v127, v227
    v_accvgpr_read_b32 v232, a12
    v_mul_f32 v232, v232, v231
    v_accvgpr_write_b32 a12, v232
    v_accvgpr_read_b32 v232, a13
    v_mul_f32 v232, v232, v231
    v_accvgpr_write_b32 a13, v232
    v_accvgpr_read_b32 v232, a14
    v_mul_f32 v232, v232, v231
    v_accvgpr_write_b32 a14, v232
    v_accvgpr_read_b32 v232, a15
    v_mul_f32 v232, v232, v231
    v_accvgpr_write_b32 a15, v232
    v_accvgpr_read_b32 v232, a28
    v_mul_f32 v232, v232, v231
    v_accvgpr_write_b32 a28, v232
    v_accvgpr_read_b32 v232, a29
    v_mul_f32 v232, v232, v231
    v_accvgpr_write_b32 a29, v232
    v_accvgpr_read_b32 v232, a30
    v_mul_f32 v232, v232, v231
    v_accvgpr_write_b32 a30, v232
    v_accvgpr_read_b32 v232, a31
    v_mul_f32 v232, v232, v231
    v_accvgpr_write_b32 a31, v232
    v_accvgpr_read_b32 v232, a44
    v_mul_f32 v232, v232, v231
    v_accvgpr_write_b32 a44, v232
    v_accvgpr_read_b32 v232, a45
    v_mul_f32 v232, v232, v231
    v_accvgpr_write_b32 a45, v232
    v_accvgpr_read_b32 v232, a46
    v_mul_f32 v232, v232, v231
    v_accvgpr_write_b32 a46, v232
    v_accvgpr_read_b32 v232, a47
    v_mul_f32 v232, v232, v231
    v_accvgpr_write_b32 a47, v232
    v_accvgpr_read_b32 v232, a60
    v_mul_f32 v232, v232, v231
    v_accvgpr_write_b32 a60, v232
    v_accvgpr_read_b32 v232, a61
    v_mul_f32 v232, v232, v231
    v_accvgpr_write_b32 a61, v232
    v_accvgpr_read_b32 v232, a62
    v_mul_f32 v232, v232, v231
    v_accvgpr_write_b32 a62, v232
    v_accvgpr_read_b32 v232, a63
    v_mul_f32 v232, v232, v231
    v_accvgpr_write_b32 a63, v232
    v_accvgpr_read_b32 v232, a76
    v_mul_f32 v232, v232, v231
    v_accvgpr_write_b32 a76, v232
    v_accvgpr_read_b32 v232, a77
    v_mul_f32 v232, v232, v231
    v_accvgpr_write_b32 a77, v232
    v_accvgpr_read_b32 v232, a78
    v_mul_f32 v232, v232, v231
    v_accvgpr_write_b32 a78, v232
    v_accvgpr_read_b32 v232, a79
    v_mul_f32 v232, v232, v231
    v_accvgpr_write_b32 a79, v232
    v_accvgpr_read_b32 v232, a92
    v_mul_f32 v232, v232, v231
    v_accvgpr_write_b32 a92, v232
    v_accvgpr_read_b32 v232, a93
    v_mul_f32 v232, v232, v231
    v_accvgpr_write_b32 a93, v232
    v_accvgpr_read_b32 v232, a94
    v_mul_f32 v232, v232, v231
    v_accvgpr_write_b32 a94, v232
    v_accvgpr_read_b32 v232, a95
    v_mul_f32 v232, v232, v231
    v_accvgpr_write_b32 a95, v232
    v_accvgpr_read_b32 v232, a108
    v_mul_f32 v232, v232, v231
    v_accvgpr_write_b32 a108, v232
    v_accvgpr_read_b32 v232, a109
    v_mul_f32 v232, v232, v231
    v_accvgpr_write_b32 a109, v232
    v_accvgpr_read_b32 v232, a110
    v_mul_f32 v232, v232, v231
    v_accvgpr_write_b32 a110, v232
    v_accvgpr_read_b32 v232, a111
    v_mul_f32 v232, v232, v231
    v_accvgpr_write_b32 a111, v232
    v_accvgpr_read_b32 v232, a124
    v_mul_f32 v232, v232, v231
    v_accvgpr_write_b32 a124, v232
    v_accvgpr_read_b32 v232, a125
    v_mul_f32 v232, v232, v231
    v_accvgpr_write_b32 a125, v232
    v_accvgpr_read_b32 v232, a126
    v_mul_f32 v232, v232, v231
    v_accvgpr_write_b32 a126, v232
    v_accvgpr_read_b32 v232, a127
    v_mul_f32 v232, v232, v231
    v_accvgpr_write_b32 a127, v232
    v_exp_f32 v96, v96
    v_exp_f32 v97, v97
    v_exp_f32 v98, v98
    v_add_f32 v176, v176, v96
    v_exp_f32 v99, v99
    v_add_f32 v176, v176, v97
    v_cvt_pk_bf16_f32 v144, v96, v97
    v_exp_f32 v112, v112
    v_add_f32 v176, v176, v98
    v_exp_f32 v113, v113
    v_add_f32 v176, v176, v99
    v_cvt_pk_bf16_f32 v145, v98, v99
    v_exp_f32 v114, v114
    v_add_f32 v176, v176, v112
    v_exp_f32 v115, v115
    v_add_f32 v176, v176, v113
    v_cvt_pk_bf16_f32 v146, v112, v113
    v_exp_f32 v100, v100
    v_add_f32 v176, v176, v114
    v_exp_f32 v101, v101
    v_add_f32 v176, v176, v115
    v_cvt_pk_bf16_f32 v147, v114, v115
    v_exp_f32 v102, v102
    v_add_f32 v177, v177, v100
    v_exp_f32 v103, v103
    v_add_f32 v177, v177, v101
    v_cvt_pk_bf16_f32 v148, v100, v101
    v_exp_f32 v116, v116
    v_add_f32 v177, v177, v102
    v_exp_f32 v117, v117
    v_add_f32 v177, v177, v103
    v_cvt_pk_bf16_f32 v149, v102, v103
    v_exp_f32 v118, v118
    v_add_f32 v177, v177, v116
    v_exp_f32 v119, v119
    v_add_f32 v177, v177, v117
    v_cvt_pk_bf16_f32 v150, v116, v117
    v_exp_f32 v104, v104
    v_add_f32 v177, v177, v118
    v_exp_f32 v105, v105
    v_add_f32 v177, v177, v119
    v_cvt_pk_bf16_f32 v151, v118, v119
    v_exp_f32 v106, v106
    v_add_f32 v178, v178, v104
    v_exp_f32 v107, v107
    v_add_f32 v178, v178, v105
    v_cvt_pk_bf16_f32 v152, v104, v105
    v_exp_f32 v120, v120
    v_add_f32 v178, v178, v106
    v_exp_f32 v121, v121
    v_add_f32 v178, v178, v107
    v_cvt_pk_bf16_f32 v153, v106, v107
    v_exp_f32 v122, v122
    v_add_f32 v178, v178, v120
    v_exp_f32 v123, v123
    v_add_f32 v178, v178, v121
    v_cvt_pk_bf16_f32 v154, v120, v121
    v_exp_f32 v108, v108
    v_add_f32 v178, v178, v122
    v_exp_f32 v109, v109
    v_add_f32 v178, v178, v123
    v_cvt_pk_bf16_f32 v155, v122, v123
    v_exp_f32 v110, v110
    v_add_f32 v179, v179, v108
    v_exp_f32 v111, v111
    v_add_f32 v179, v179, v109
    v_cvt_pk_bf16_f32 v156, v108, v109
    v_exp_f32 v124, v124
    v_add_f32 v179, v179, v110
    v_exp_f32 v125, v125
    v_add_f32 v179, v179, v111
    v_cvt_pk_bf16_f32 v157, v110, v111
    v_exp_f32 v126, v126
    v_add_f32 v179, v179, v124
    v_exp_f32 v127, v127
    v_add_f32 v179, v179, v125
    v_cvt_pk_bf16_f32 v158, v124, v125
    s_nop 0
    v_add_f32 v179, v179, v126
    v_add_f32 v179, v179, v127
    v_cvt_pk_bf16_f32 v159, v126, v127
    s_waitcnt lgkmcnt(0)
    s_nop 1
    v_mfma_f32_16x16x32_bf16 a[0:3], a[160:163], v[144:147], a[0:3]
    v_mfma_f32_16x16x32_bf16 a[4:7], a[160:163], v[148:151], a[4:7]
    v_mfma_f32_16x16x32_bf16 a[8:11], a[160:163], v[152:155], a[8:11]
    v_mfma_f32_16x16x32_bf16 a[12:15], a[160:163], v[156:159], a[12:15]
    v_mfma_f32_16x16x32_bf16 a[16:19], a[164:167], v[144:147], a[16:19]
    v_mfma_f32_16x16x32_bf16 a[20:23], a[164:167], v[148:151], a[20:23]
    v_mfma_f32_16x16x32_bf16 a[24:27], a[164:167], v[152:155], a[24:27]
    v_mfma_f32_16x16x32_bf16 a[28:31], a[164:167], v[156:159], a[28:31]
    v_mfma_f32_16x16x32_bf16 a[32:35], a[168:171], v[144:147], a[32:35]
    v_mfma_f32_16x16x32_bf16 a[36:39], a[168:171], v[148:151], a[36:39]
    v_mfma_f32_16x16x32_bf16 a[40:43], a[168:171], v[152:155], a[40:43]
    v_mfma_f32_16x16x32_bf16 a[44:47], a[168:171], v[156:159], a[44:47]
    v_mfma_f32_16x16x32_bf16 a[48:51], a[172:175], v[144:147], a[48:51]
    v_mfma_f32_16x16x32_bf16 a[52:55], a[172:175], v[148:151], a[52:55]
    v_mfma_f32_16x16x32_bf16 a[56:59], a[172:175], v[152:155], a[56:59]
    v_mfma_f32_16x16x32_bf16 a[60:63], a[172:175], v[156:159], a[60:63]
    v_mfma_f32_16x16x32_bf16 a[64:67], a[176:179], v[144:147], a[64:67]
    v_mfma_f32_16x16x32_bf16 a[68:71], a[176:179], v[148:151], a[68:71]
    v_mfma_f32_16x16x32_bf16 a[72:75], a[176:179], v[152:155], a[72:75]
    v_mfma_f32_16x16x32_bf16 a[76:79], a[176:179], v[156:159], a[76:79]
    v_mfma_f32_16x16x32_bf16 a[80:83], a[180:183], v[144:147], a[80:83]
    v_mfma_f32_16x16x32_bf16 a[84:87], a[180:183], v[148:151], a[84:87]
    v_mfma_f32_16x16x32_bf16 a[88:91], a[180:183], v[152:155], a[88:91]
    v_mfma_f32_16x16x32_bf16 a[92:95], a[180:183], v[156:159], a[92:95]
    v_mfma_f32_16x16x32_bf16 a[96:99], a[184:187], v[144:147], a[96:99]
    v_mfma_f32_16x16x32_bf16 a[100:103], a[184:187], v[148:151], a[100:103]
    v_mfma_f32_16x16x32_bf16 a[104:107], a[184:187], v[152:155], a[104:107]
    v_mfma_f32_16x16x32_bf16 a[108:111], a[184:187], v[156:159], a[108:111]
    v_mfma_f32_16x16x32_bf16 a[112:115], a[188:191], v[144:147], a[112:115]
    v_mfma_f32_16x16x32_bf16 a[116:119], a[188:191], v[148:151], a[116:119]
    v_mfma_f32_16x16x32_bf16 a[120:123], a[188:191], v[152:155], a[120:123]
    v_mfma_f32_16x16x32_bf16 a[124:127], a[188:191], v[156:159], a[124:127]
    s_nop 7
    s_barrier
    s_sub_u32 s34, s34, 1
    s_cmp_lg_u32 s34, 0
    s_cbranch_scc1 L_slow_loop
    v_mov_b32 v228, v176
    v_mov_b32 v229, v177
    v_mov_b32 v230, v178
    v_mov_b32 v231, v179
    s_nop 1
    v_permlane16_swap_b32 v176, v228
    v_permlane16_swap_b32 v177, v229
    v_permlane16_swap_b32 v178, v230
    v_permlane16_swap_b32 v179, v231
    v_add_f32 v176, v176, v228
    v_add_f32 v177, v177, v229
    v_add_f32 v178, v178, v230
    v_add_f32 v179, v179, v231
    v_mov_b32 v228, v176
    v_mov_b32 v229, v177
    v_mov_b32 v230, v178
    v_mov_b32 v231, v179
    s_nop 1
    v_permlane32_swap_b32 v176, v228
    v_permlane32_swap_b32 v177, v229
    v_permlane32_swap_b32 v178, v230
    v_permlane32_swap_b32 v179, v231
    v_add_f32 v176, v176, v228
    v_add_f32 v177, v177, v229
    v_add_f32 v178, v178, v230
    v_add_f32 v179, v179, v231
    s_branch L_attn_epi
L_attn_end:
    s_endpgm
.section .rodata,"a"
.p2align 6
.amdhsa_kernel pre1_kernel
  .amdhsa_next_free_vgpr 104
  .amdhsa_next_free_sgpr 102
  .amdhsa_accum_offset 104
  .amdhsa_group_segment_fixed_size 0
  .amdhsa_kernarg_size 104
  .amdhsa_user_sgpr_count 2
  .amdhsa_user_sgpr_kernarg_segment_ptr 1
  .amdhsa_system_sgpr_workgroup_id_x 1
  .amdhsa_float_denorm_mode_32 3
.end_amdhsa_kernel
.p2align 6
.amdhsa_kernel main_kernel
  .amdhsa_next_free_vgpr 512
  .amdhsa_next_free_sgpr 102
  .amdhsa_accum_offset 256
  .amdhsa_group_segment_fixed_size 0
  .amdhsa_kernarg_size 104
  .amdhsa_user_sgpr_count 2
  .amdhsa_user_sgpr_kernarg_segment_ptr 1
  .amdhsa_system_sgpr_workgroup_id_x 1
  .amdhsa_float_denorm_mode_32 3
.end_amdhsa_kernel
```
